```python
import torch

def _softmax(x, axis=-1):
    return torch.softmax(x, dim=axis)

def _gelu(x):
    return torch.nn.functional.gelu(x, approximate='tanh')

def _silu(x):
    return torch.nn.functional.silu(x)

def _sigmoid(x):
    return torch.sigmoid(x)

def _layernorm(x, axis=-1, eps=1e-05):
    m = x.mean(dim=axis, keepdim=True)
    v = x.var(dim=axis, keepdim=True, unbiased=False)
    return (x - m) / torch.sqrt(v + eps)

def _scatter_add(tgt, idx, src, axis=0):
    return tgt.clone().index_add_(axis, idx, src)

def _segment_sum(src, seg, n):
    out = torch.zeros((n,) + src.shape[1:], dtype=src.dtype)
    return out.index_add_(0, seg, src)

def _pad(x, pw):
    flat = tuple((v for pair in reversed(pw) for v in pair))
    return torch.nn.functional.pad(x, flat)
kernel_name = 'standalone__kv_cache_quant_pre_rope_vs_post_rope__prompt'

def setup_inputs():

    _w = lambda a: (lambda t: t.to(torch.bfloat16) if t.is_floating_point() else t)(torch.as_tensor(a))
    B, Sq, Skv = (1, 2048, 2048)
    H, Dh0 = (32, 128)
    G = 32 if 32 > 0 else Dh0
    G = max(2, G // 2 * 2)
    Dh = max(G, Dh0 // G * G)
    Skv = max(Skv, Sq)
    ng = Dh // G
    bits = 4 if 4 > 1 else 4
    bits = max(2, min(8, bits))
    qmax = (1 << bits) - 1
    half = Dh // 2
    inv = 1.0 / 10000.0 ** (torch.arange(half) / max(1, half))
    ang_k = torch.arange(Skv)[:, None] * inv[None, :]
    ang_q = torch.arange(Skv - Sq, Skv)[:, None] * inv[None, :]
    kc = torch.cat([torch.cos(ang_k), torch.cos(ang_k)], dim=-1)
    ks = torch.cat([torch.sin(ang_k), torch.sin(ang_k)], dim=-1)
    qc = torch.cat([torch.cos(ang_q), torch.cos(ang_q)], dim=-1)
    qs = torch.cat([torch.sin(ang_q), torch.sin(ang_q)], dim=-1)
    qk_i = torch.randint(0, qmax + 1, (B, H, Skv, Dh)).to(torch.int32)
    qv_i = torch.randint(0, qmax + 1, (B, H, Skv, Dh)).to(torch.int32)
    ksc = torch.abs((lambda *s: torch.randn(*s, dtype=torch.bfloat16) * 0.2)(B, H, Skv, ng)) * 0.1 + 0.01
    kzp = torch.full((B, H, Skv, ng), qmax / 2.0)
    vsc = torch.abs((lambda *s: torch.randn(*s, dtype=torch.bfloat16) * 0.2)(B, H, Skv, ng)) * 0.1 + 0.01
    vzp = torch.full((B, H, Skv, ng), qmax / 2.0)
    return {'q': _w((lambda *s: torch.randn(*s, dtype=torch.bfloat16) * 6.4)(B, H, Sq, Dh) * 0.5), 'qk': _w(qk_i), 'k_scales': _w(ksc), 'k_zeros': _w(kzp), 'qv': _w(qv_i), 'v_scales': _w(vsc), 'v_zeros': _w(vzp), 'q_cos': _w(qc), 'q_sin': _w(qs), 'k_cos': _w(kc), 'k_sin': _w(ks)}

def reference(q, qk, k_scales, k_zeros, qv, v_scales, v_zeros, q_cos, q_sin, k_cos, k_sin):
    B, H, Sq, Dh = q.shape
    ng = k_scales.shape[-1]
    G = Dh // ng
    half = Dh // 2
    ks = (lambda x, n, axis: torch.repeat_interleave(x, n, dim=axis))(k_scales, G, axis=-1)
    kz = (lambda x, n, axis: torch.repeat_interleave(x, n, dim=axis))(k_zeros, G, axis=-1)
    k = ((lambda x, dt: x.to(dt))(qk, q.dtype) - kz) * ks
    vs = (lambda x, n, axis: torch.repeat_interleave(x, n, dim=axis))(v_scales, G, axis=-1)
    vz = (lambda x, n, axis: torch.repeat_interleave(x, n, dim=axis))(v_zeros, G, axis=-1)
    v = ((lambda x, dt: x.to(dt))(qv, q.dtype) - vz) * vs
    k1 = k[..., :half].clone()
    k2 = k[..., half:].clone()
    krh = torch.concatenate([-k2, k1], axis=-1)
    kr = k * k_cos[None, None, :, :] + krh * k_sin[None, None, :, :]
    q1 = q[..., :half].clone()
    q2 = q[..., half:].clone()
    qrh = torch.concatenate([-q2, q1], axis=-1)
    qr = q * q_cos[None, None, :, :] + qrh * q_sin[None, None, :, :]
    logits = torch.einsum('bhqd,bhkd->bhqk', qr, kr) * float(Dh) ** (-0.5)
    attn = _softmax(logits, axis=-1)
    out = torch.einsum('bhqk,bhkd->bhqd', attn, v)
    return out
```

```asm
; @launch grid=(256,1,1) block=(256,1,1) lds=148480
.amdgcn_target "amdgcn-amd-amdhsa--gfx950"
.text
.p2align 12
.p2align 8
.globl standalone__kv_cache_quant_pre_rope_vs_post_rope__prompt_kernel
.type standalone__kv_cache_quant_pre_rope_vs_post_rope__prompt_kernel,@function
standalone__kv_cache_quant_pre_rope_vs_post_rope__prompt_kernel:
    s_cmp_ge_u32 s2, 256
    s_cbranch_scc1 L_done
L_again:
    s_load_dwordx16 s[64:79], s[0:1], 0
    s_load_dwordx8 s[80:87], s[0:1], 64
    s_load_dwordx4 s[60:63], s[0:1], 96
    s_memrealtime s[88:89]
    s_getpc_b64 s[92:93]
L_pc:
    s_lshr_b32 s94, s2, 3
    s_lshl_b32 s94, s94, 12
    v_lshl_add_u32 v1, v0, 4, s94
    v_min_u32 v1, L_codeend-standalone__kv_cache_quant_pre_rope_vs_post_rope__prompt_kernel-16, v1
    global_load_dwordx4 v[244:247], v1, s[92:93] offset:-48
    s_and_b32 s3, s2, 7
    s_lshl_b32 s3, s3, 2
    s_bfe_u32 s4, s2, 0x20003
    s_add_u32 s3, s3, s4
    s_and_b32 s7, s2, 0xe0
    s_lshl_b32 s5, s3, 20
    s_and_b32 s4, s2, 7
    s_lshl_b32 s4, s4, 8
    s_add_u32 s7, s7, s4
    v_bfe_u32 v34, v0, 4, 2
    v_bfe_u32 v37, v0, 2, 2
    v_lshl_add_u32 v36, v34, 3, s7
    v_lshrrev_b32 v41, 7, v0
    v_lshl_add_u32 v41, v41, 2, v37
    v_add_u32 v41, v41, v36
    v_lshrrev_b32 v40, 4, v0
    v_and_b32 v40, 6, v40
    v_and_b32 v39, 3, v0
    v_xor_b32 v40, v40, v39
    v_lshl_add_u32 v8, v41, 9, s5
    v_lshl_add_u32 v8, v40, 5, v8
    s_waitcnt lgkmcnt(0)
    global_load_dwordx4 v[16:19], v8, s[66:67] offset:0
    global_load_dwordx4 v[20:23], v8, s[66:67] offset:16
    global_load_dwordx4 v[24:27], v8, s[66:67] offset:256
    global_load_dwordx4 v[28:31], v8, s[66:67] offset:272
    v_lshrrev_b32 v32, 6, v0
    s_lshl_b32 s6, s3, 14
    v_lshlrev_b32 v9, 8, v41
    v_readfirstlane_b32 s96, v32
    v_lshl_add_u32 v9, v40, 4, v9
    v_lshl_add_u32 v10, v41, 3, s6
    v_and_b32 v168, 63, v0
    v_lshl_add_u32 v168, v168, 3, s6
    global_load_dwordx2 v[160:161], v168, s[68:69]
    global_load_dwordx2 v[162:163], v168, s[70:71]
    global_load_dwordx2 v[164:165], v168, s[74:75]
    global_load_dwordx2 v[166:167], v168, s[76:77]
    global_load_dwordx2 v[200:201], v10, s[68:69]
    global_load_dwordx2 v[202:203], v10, s[70:71]
    global_load_dwordx4 v[48:51], v9, s[82:83] offset:0
    global_load_dwordx4 v[56:59], v9, s[84:85] offset:0
    v_and_b32 v35, 15, v0
    v_lshl_add_u32 v11, v36, 9, s5
    v_lshl_add_u32 v11, v32, 7, v11
    v_lshl_add_u32 v11, v39, 5, v11
    v_xor_b32 v37, v37, v32
    v_lshl_add_u32 v11, v37, 3, v11
    v_and_b32 v37, 7, v0
    v_add_u32_e64 v36, v36, v37
    v_lshl_add_u32 v12, v36, 3, s6
    v_lshl_add_u32 v12, v32, 1, v12
    s_or_b32 s88, s88, 1
    s_cmp_lg_u32 s96, 3
    s_cbranch_scc1 L_nocas
    s_lshl_b32 s95, s3, 3
    s_andn2_b32 s95, s95, 8
    s_mov_b64 s[20:21], s[88:89]
    s_mov_b64 s[22:23], 0
    s_atomic_cmpswap_x2 s[20:23], s[60:61], s95 glc
L_nocas:
    global_load_ushort v232, v12, s[74:75]
    global_load_ushort v233, v12, s[76:77]
    global_load_dwordx2 v[216:217], v11, s[72:73] offset:0
    global_load_dwordx2 v[218:219], v11, s[72:73] offset:512
    global_load_dwordx2 v[224:225], v11, s[72:73] offset:1024
    global_load_dwordx2 v[226:227], v11, s[72:73] offset:1536
    global_load_dwordx2 v[220:221], v11, s[72:73] offset:2048
    global_load_dwordx2 v[222:223], v11, s[72:73] offset:2560
    global_load_dwordx2 v[228:229], v11, s[72:73] offset:3072
    global_load_dwordx2 v[230:231], v11, s[72:73] offset:3584
    s_mov_b64 s[24:25], s[62:63]
    s_mov_b64 s[28:29], s[66:67]
    s_mov_b32 s30, 0x2000000
    s_mov_b32 s31, 0x00020000
    s_mov_b64 s[48:49], s[72:73]
    s_mov_b32 s50, 0x2000000
    s_mov_b32 s51, 0x00020000
    s_mov_b64 s[8:9], s[64:65]
    s_mov_b32 s10, 0x1000000
    s_mov_b32 s11, 0x00020000
    s_mov_b64 s[32:33], s[68:69]
    s_mov_b32 s34, 0x80000
    s_mov_b32 s35, 0x00020000
    s_mov_b64 s[36:37], s[70:71]
    s_mov_b32 s38, 0x80000
    s_mov_b32 s39, 0x00020000
    s_mov_b64 s[40:41], s[82:83]
    s_mov_b32 s42, 0x80000
    s_mov_b32 s43, 0x00020000
    s_mov_b64 s[44:45], s[84:85]
    s_mov_b32 s46, 0x80000
    s_mov_b32 s47, 0x00020000
    s_mov_b64 s[52:53], s[74:75]
    s_mov_b32 s54, 0x80000
    s_mov_b32 s55, 0x00020000
    s_mov_b64 s[56:57], s[76:77]
    s_mov_b32 s58, 0x80000
    s_mov_b32 s59, 0x00020000
    s_mov_b64 s[12:13], s[78:79]
    s_mov_b32 s14, 0x80000
    s_mov_b32 s15, 0x00020000
    s_mov_b64 s[16:17], s[80:81]
    s_mov_b32 s18, 0x80000
    s_mov_b32 s19, 0x00020000
    s_mov_b32 s26, 0x2020000
    s_mov_b32 s27, 0x00020000
    s_bfe_u32 s97, s2, 0x30005
    v_and_b32 v33, 63, v0
    v_lshlrev_b32 v1, 4, v33
    s_lshl_b32 s90, s3, 19
    s_lshr_b32 s93, s96, 1
    s_and_b32 s94, s96, 1
    v_lshrrev_b32 v38, 2, v33
    v_and_b32 v39, 3, v40
    s_lshl_b32 s95, s97, 2
    s_add_u32 s95, s95, s96
    s_lshl_b32 s95, s95, 14
    v_lshl_add_u32 v14, v38, 8, s95
    v_lshl_add_u32 v14, v39, 4, v14
    s_lshl_b32 s5, s4, 9
    v_subrev_u32 v8, s5, v8
    s_lshl_b32 s6, s4, 8
    v_subrev_u32 v9, s6, v9
    s_lshl_b32 s7, s4, 3
    v_subrev_u32 v10, s7, v10
    s_lshl_b32 s77, s4, 9
    v_subrev_u32 v11, s77, v11
    s_lshl_b32 s78, s4, 3
    v_subrev_u32 v12, s78, v12
    s_xor_b32 s64, s2, s96
    s_and_b32 s64, s64, 3
    s_lshl_b32 s64, s64, 12
    s_add_u32 s68, s90, s64
    s_xor_b32 s65, s64, 4096
    s_add_u32 s69, s90, s65
    s_xor_b32 s66, s64, 8192
    s_add_u32 s70, s90, s66
    s_xor_b32 s67, s64, 12288
    s_add_u32 s71, s90, s67
    v_mov_b32 v198, 65536
    s_mov_b32 s85, 0x3e0293ee
    s_mov_b32 s86, 0xffff0000
    s_mul_i32 s87, s94, 0x02020000
    s_add_u32 s87, s87, 0x01000c0c
    s_mov_b32 s98, 0
    s_mov_b32 s99, -1
    v_lshrrev_b32 v36, 3, v35
    v_lshlrev_b32 v36, 1, v36
    v_xor_b32 v36, v36, v34
    v_lshl_add_u32 v36, v35, 2, v36
    v_lshlrev_b32 v252, 4, v36
    s_lshl_b32 s95, s96, 14
    s_add_u32 s91, s95, 66560
    v_add_u32 v253, s91, v1
    s_lshl_b32 s95, s96, 11
    v_add_u32 v234, s95, v1
    s_lshl_b32 s95, s97, 13
    s_lshl_b32 s92, s3, 16
    s_add_u32 s95, s95, s92
    v_add_u32 v0, s95, v234
    s_mov_b32 s79, 0
    s_mov_b32 s80, 0x1000000
    s_lshl_b32 s95, s96, 10
    s_sub_u32 s80, s80, s95
    v_add_u32 v199, s95, v1
    s_lshl_b32 s94, s94, 12
    s_lshl_b32 s95, s93, 24
    s_max_u32 s95, s95, s94
    s_add_u32 s95, s95, s92
    v_add_u32 v2, s95, v1
    s_lshl_b32 s95, s93, 15
    s_add_u32 s73, s95, s94
    s_lshl_b32 s76, s93, 21
    s_sub_u32 s75, 0x200000, s76
    s_mov_b32 s72, 0x5d800000
    s_lshl_b32 s94, s3, 12
    s_add_u32 s94, s94, 0x2000000
    v_and_b32 v36, 31, v33
    v_lshl_add_u32 v3, v36, 3, s94
    s_lshl_b32 s95, s97, 2
    s_add_u32 s95, s95, s96
    s_lshl_b32 s95, s95, 3
    s_add_u32 s95, s95, s94
    v_cmp_eq_u32 vcc, 0, v33
    v_mov_b32 v36, 0x7fffff00
    v_mov_b32 v37, s95
    v_cndmask_b32 v13, v36, v37, vcc
    s_mov_b32 s81, 0
    s_mov_b32 s82, 256
    s_lshl_b32 s83, s93, 8
    s_mov_b32 s3, 0x05040100
    s_mov_b32 s4, 0x07060302
    s_waitcnt vmcnt(14)
    v_lshlrev_b32 v168, 16, v160
    v_and_b32 v169, s86, v160
    v_lshlrev_b32 v172, 16, v162
    v_and_b32 v173, s86, v162
    v_lshlrev_b32 v170, 16, v161
    v_and_b32 v171, s86, v161
    v_lshlrev_b32 v174, 16, v163
    v_and_b32 v175, s86, v163
    v_mul_f32 v168, v168, v172
    v_mul_f32 v169, v169, v173
    v_mul_f32 v170, v170, v174
    v_mul_f32 v171, v171, v175
    v_max_f32 v168, 0, v168
    v_max_f32 v169, 0, v169
    v_max_f32 v170, 0, v170
    v_max_f32 v171, 0, v171
    v_min3_u32 v177, v168, v169, v170
    v_min_u32 v177, v177, v171
    v_lshrrev_b32 v168, 8, v168
    v_lshrrev_b32 v169, 8, v169
    v_lshrrev_b32 v170, 8, v170
    v_lshrrev_b32 v171, 8, v171
    v_add3_u32 v176, v168, v169, v170
    v_add_u32 v176, v176, v171
    v_lshlrev_b32 v178, 16, v164
    v_and_b32 v179, s86, v164
    v_lshlrev_b32 v182, 16, v166
    v_and_b32 v183, s86, v166
    v_lshlrev_b32 v180, 16, v165
    v_and_b32 v181, s86, v165
    v_lshlrev_b32 v184, 16, v167
    v_and_b32 v185, s86, v167
    v_mul_f32 v178, v178, v182
    v_mul_f32 v179, v179, v183
    v_mul_f32 v180, v180, v184
    v_mul_f32 v181, v181, v185
    v_max_f32 v178, 0, v178
    v_max_f32 v179, 0, v179
    v_max_f32 v180, 0, v180
    v_max_f32 v181, 0, v181
    v_min3_u32 v187, v178, v179, v180
    v_min_u32 v187, v187, v181
    v_lshrrev_b32 v178, 8, v178
    v_lshrrev_b32 v179, 8, v179
    v_lshrrev_b32_e64 v180, 8, v180
    v_lshrrev_b32_e64 v181, 8, v181
    v_add3_u32 v186, v178, v179, v180
    v_add_u32_e64 v186, v186, v181
    v_add_u32_dpp v176, v176, v176 row_ror:8 row_mask:0xf bank_mask:0xf
    v_min_u32_dpp v177, v177, v177 row_ror:8 row_mask:0xf bank_mask:0xf
    v_add_u32_dpp v186, v186, v186 row_ror:8 row_mask:0xf bank_mask:0xf
    v_min_u32_dpp v187, v187, v187 row_ror:8 row_mask:0xf bank_mask:0xf
    v_add_u32_dpp v176, v176, v176 row_ror:4 row_mask:0xf bank_mask:0xf
    v_min_u32_dpp v177, v177, v177 row_ror:4 row_mask:0xf bank_mask:0xf
    v_add_u32_dpp v186, v186, v186 row_ror:4 row_mask:0xf bank_mask:0xf
    v_min_u32_dpp v187, v187, v187 row_ror:4 row_mask:0xf bank_mask:0xf
    v_add_u32_dpp v176, v176, v176 row_ror:2 row_mask:0xf bank_mask:0xf
    v_min_u32_dpp v177, v177, v177 row_ror:2 row_mask:0xf bank_mask:0xf
    v_add_u32_dpp v186, v186, v186 row_ror:2 row_mask:0xf bank_mask:0xf
    v_min_u32_dpp v187, v187, v187 row_ror:2 row_mask:0xf bank_mask:0xf
    v_add_u32_dpp v176, v176, v176 row_ror:1 row_mask:0xf bank_mask:0xf
    v_min_u32_dpp v177, v177, v177 row_ror:1 row_mask:0xf bank_mask:0xf
    v_add_u32_dpp v186, v186, v186 row_ror:1 row_mask:0xf bank_mask:0xf
    v_min_u32_dpp v187, v187, v187 row_ror:1 row_mask:0xf bank_mask:0xf
    s_nop 0
    v_readlane_b32 s62, v176, 0
    v_readlane_b32 s94, v177, 0
    v_readlane_b32 s95, v176, 16
    v_readlane_b32 s92, v177, 16
    s_add_u32 s62, s62, s95
    s_min_u32 s94, s94, s92
    v_readlane_b32 s95, v176, 32
    v_readlane_b32 s92, v177, 32
    s_add_u32 s62, s62, s95
    s_min_u32 s94, s94, s92
    v_readlane_b32 s95, v176, 48
    v_readlane_b32 s92, v177, 48
    s_add_u32 s62, s62, s95
    s_min_u32 s94, s94, s92
    s_add_u32 s94, s94, 0x1000000
    s_min_u32 s62, s62, s94
    s_add_i32 s62, s62, -16777216
    s_max_i32 s62, s62, 0
    s_min_u32 s62, s62, 0x7e000000
    s_and_b32 s62, s62, 0x7f800000
    s_or_b32 s62, s62, 0x400000
    v_readlane_b32 s63, v186, 0
    v_readlane_b32 s94, v187, 0
    v_readlane_b32 s95, v186, 16
    v_readlane_b32 s92, v187, 16
    s_add_u32 s63, s63, s95
    s_min_u32 s94, s94, s92
    v_readlane_b32 s95, v186, 32
    v_readlane_b32 s92, v187, 32
    s_add_u32 s63, s63, s95
    s_min_u32 s94, s94, s92
    v_readlane_b32 s95, v186, 48
    v_readlane_b32 s92, v187, 48
    s_add_u32 s63, s63, s95
    s_min_u32 s94, s94, s92
    s_add_u32 s94, s94, 0x1000000
    s_min_u32 s63, s63, s94
    s_add_i32 s63, s63, 0
    s_max_i32 s63, s63, 0
    s_min_u32 s63, s63, 0x7e000000
    s_and_b32 s63, s63, 0x7f800000
    s_or_b32 s63, s63, 0x400000
    s_bitcmp1_b32 s2, 31
    s_cbranch_scc1 L_prepass
L_prepass_ret:
    buffer_load_dwordx4 v[128:131], v14, s[12:15], s64 offen offset:0
    buffer_load_dwordx4 v[136:139], v14, s[12:15], s64 offen offset:64
    buffer_load_dwordx4 v[132:135], v14, s[16:19], s64 offen offset:0
    buffer_load_dwordx4 v[140:143], v14, s[16:19], s64 offen offset:64
    s_waitcnt vmcnt(22)
    v_cvt_f32_i32 v32, v16
    v_cvt_f32_i32 v33, v17
    v_cvt_f32_i32 v34, v18
    v_cvt_f32_i32 v35, v19
    v_cvt_f32_i32 v36, v20
    v_cvt_f32_i32 v37, v21
    v_cvt_f32_i32 v38, v22
    v_cvt_f32_i32 v39, v23
    v_cvt_f32_i32 v40, v24
    v_cvt_f32_i32 v41, v25
    v_cvt_f32_i32 v42, v26
    v_cvt_f32_i32 v43, v27
    v_cvt_f32_i32 v44, v28
    v_cvt_f32_i32 v45, v29
    v_cvt_f32_i32 v46, v30
    v_cvt_f32_i32 v47, v31
    s_waitcnt vmcnt(14)
    v_perm_b32 v200, v200, v200, s87
    v_perm_b32 v201, v201, v201, s87
    v_perm_b32 v202, v202, v202, s87
    v_perm_b32 v203, v203, v203, s87
    v_mul_f32 v200, s85, v200
    v_mul_f32 v201, s85, v201
    v_mul_f32_e64 v202, -v202, v200
    v_mul_f32_e64 v203, -v203, v201
    v_fma_f32 v32, v32, v200, v202
    v_fma_f32 v40, v40, v201, v203
    v_lshlrev_b32 v212, 16, v48
    v_lshlrev_b32 v214, 16, v56
    v_fma_f32 v204, v32, v212, s62
    v_fma_f32 v208, v40, v212, s62
    v_fma_f32 v204, -v40, v214, v204
    v_fma_f32 v208, v32, v214, v208
    v_fma_f32 v33, v33, v200, v202
    v_fma_f32 v41, v41, v201, v203
    v_and_b32 v212, s86, v48
    v_and_b32 v214, s86, v56
    v_fma_f32 v205, v33, v212, s62
    v_fma_f32 v209, v41, v212, s62
    v_fma_f32 v205, -v41, v214, v205
    v_fma_f32 v209, v33, v214, v209
    v_fma_f32 v34, v34, v200, v202
    v_fma_f32 v42, v42, v201, v203
    v_lshlrev_b32 v212, 16, v49
    v_lshlrev_b32 v214, 16, v57
    v_fma_f32 v206, v34, v212, s62
    v_fma_f32 v210, v42, v212, s62
    v_fma_f32 v206, -v42, v214, v206
    v_fma_f32 v210, v34, v214, v210
    v_fma_f32 v35, v35, v200, v202
    v_fma_f32 v43, v43, v201, v203
    v_and_b32 v212, s86, v49
    v_and_b32 v214, s86, v57
    v_fma_f32 v207, v35, v212, s62
    v_fma_f32 v211, v43, v212, s62
    v_fma_f32 v207, -v43, v214, v207
    v_fma_f32 v211, v35, v214, v211
    v_cvt_pk_bf16_f32 v32, v204, v205
    v_cvt_pk_bf16_f32 v33, v206, v207
    v_cvt_pk_bf16_f32 v34, v208, v209
    v_cvt_pk_bf16_f32 v35, v210, v211
    ds_write_b128 v234, v[32:35] offset:0
    v_fma_f32 v36, v36, v200, v202
    v_fma_f32 v44, v44, v201, v203
    v_lshlrev_b32 v212, 16, v50
    v_lshlrev_b32 v214, 16, v58
    v_fma_f32 v204, v36, v212, s62
    v_fma_f32 v208, v44, v212, s62
    v_fma_f32 v204, -v44, v214, v204
    v_fma_f32 v208, v36, v214, v208
    v_fma_f32 v37, v37, v200, v202
    v_fma_f32 v45, v45, v201, v203
    v_and_b32 v212, s86, v50
    v_and_b32 v214, s86, v58
    v_fma_f32 v205, v37, v212, s62
    v_fma_f32 v209, v45, v212, s62
    v_fma_f32 v205, -v45, v214, v205
    v_fma_f32 v209, v37, v214, v209
    v_fma_f32 v38, v38, v200, v202
    v_fma_f32 v46, v46, v201, v203
    v_lshlrev_b32 v212, 16, v51
    v_lshlrev_b32 v214, 16, v59
    v_fma_f32 v206, v38, v212, s62
    v_fma_f32 v210, v46, v212, s62
    v_fma_f32 v206, -v46, v214, v206
    v_fma_f32 v210, v38, v214, v210
    v_fma_f32 v39, v39, v200, v202
    v_fma_f32 v47, v47, v201, v203
    v_and_b32 v212, s86, v51
    v_and_b32 v214, s86, v59
    v_fma_f32 v207, v39, v212, s62
    v_fma_f32 v211, v47, v212, s62
    v_fma_f32 v207, -v47, v214, v207
    v_fma_f32 v211, v39, v214, v211
    v_cvt_pk_bf16_f32 v36, v204, v205
    v_cvt_pk_bf16_f32 v37, v206, v207
    v_cvt_pk_bf16_f32 v38, v208, v209
    v_cvt_pk_bf16_f32 v39, v210, v211
    ds_write_b128 v234, v[36:39] offset:1024
    s_waitcnt vmcnt(4)
    v_lshlrev_b32 v232, 16, v232
    v_lshlrev_b32 v233, 16, v233
    v_fma_f32 v233, v233, v232, -s63
    v_cvt_f32_i32 v216, v216
    v_cvt_f32_i32 v217, v217
    v_mul_f32_dpp v216, v232, v216 row_newbcast:0 row_mask:0xf bank_mask:0xf
    v_mul_f32_dpp v217, v232, v217 row_newbcast:0 row_mask:0xf bank_mask:0xf
    v_subrev_f32_dpp v216, v233, v216 row_newbcast:0 row_mask:0xf bank_mask:0xf
    v_subrev_f32_dpp v217, v233, v217 row_newbcast:0 row_mask:0xf bank_mask:0xf
    v_cvt_f32_i32 v218, v218
    v_cvt_f32_i32 v219, v219
    v_mul_f32_dpp v218, v232, v218 row_newbcast:1 row_mask:0xf bank_mask:0xf
    v_mul_f32_dpp v219, v232, v219 row_newbcast:1 row_mask:0xf bank_mask:0xf
    v_subrev_f32_dpp v218, v233, v218 row_newbcast:1 row_mask:0xf bank_mask:0xf
    v_subrev_f32_dpp v219, v233, v219 row_newbcast:1 row_mask:0xf bank_mask:0xf
    v_cvt_f32_i32 v220, v220
    v_cvt_f32_i32 v221, v221
    v_mul_f32_dpp v220, v232, v220 row_newbcast:4 row_mask:0xf bank_mask:0xf
    v_mul_f32_dpp v221, v232, v221 row_newbcast:4 row_mask:0xf bank_mask:0xf
    v_subrev_f32_dpp v220, v233, v220 row_newbcast:4 row_mask:0xf bank_mask:0xf
    v_subrev_f32_dpp v221, v233, v221 row_newbcast:4 row_mask:0xf bank_mask:0xf
    v_cvt_f32_i32 v222, v222
    v_cvt_f32_i32 v223, v223
    v_mul_f32_dpp v222, v232, v222 row_newbcast:5 row_mask:0xf bank_mask:0xf
    v_mul_f32_dpp v223, v232, v223 row_newbcast:5 row_mask:0xf bank_mask:0xf
    v_subrev_f32_dpp v222, v233, v222 row_newbcast:5 row_mask:0xf bank_mask:0xf
    v_subrev_f32_dpp v223, v233, v223 row_newbcast:5 row_mask:0xf bank_mask:0xf
    v_cvt_pk_bf16_f32 v216, v216, v218
    v_cvt_pk_bf16_f32 v218, v220, v222
    v_cvt_pk_bf16_f32 v220, v217, v219
    v_cvt_pk_bf16_f32 v222, v221, v223
    v_cvt_f32_i32 v224, v224
    v_cvt_f32_i32 v225, v225
    v_mul_f32_dpp v224, v232, v224 row_newbcast:2 row_mask:0xf bank_mask:0xf
    v_mul_f32_dpp v225, v232, v225 row_newbcast:2 row_mask:0xf bank_mask:0xf
    v_subrev_f32_dpp v224, v233, v224 row_newbcast:2 row_mask:0xf bank_mask:0xf
    v_subrev_f32_dpp v225, v233, v225 row_newbcast:2 row_mask:0xf bank_mask:0xf
    v_cvt_f32_i32 v226, v226
    v_cvt_f32_i32 v227, v227
    v_mul_f32_dpp v226, v232, v226 row_newbcast:3 row_mask:0xf bank_mask:0xf
    v_mul_f32_dpp v227, v232, v227 row_newbcast:3 row_mask:0xf bank_mask:0xf
    v_subrev_f32_dpp v226, v233, v226 row_newbcast:3 row_mask:0xf bank_mask:0xf
    v_subrev_f32_dpp v227, v233, v227 row_newbcast:3 row_mask:0xf bank_mask:0xf
    v_cvt_pk_bf16_f32 v217, v224, v226
    v_cvt_pk_bf16_f32 v221, v225, v227
    v_cvt_f32_i32 v228, v228
    v_cvt_f32_i32 v229, v229
    v_mul_f32_dpp v228, v232, v228 row_newbcast:6 row_mask:0xf bank_mask:0xf
    v_mul_f32_dpp v229, v232, v229 row_newbcast:6 row_mask:0xf bank_mask:0xf
    v_subrev_f32_dpp v228, v233, v228 row_newbcast:6 row_mask:0xf bank_mask:0xf
    v_subrev_f32_dpp v229, v233, v229 row_newbcast:6 row_mask:0xf bank_mask:0xf
    v_cvt_f32_i32 v230, v230
    v_cvt_f32_i32 v231, v231
    v_mul_f32_dpp v230, v232, v230 row_newbcast:7 row_mask:0xf bank_mask:0xf
    v_mul_f32_dpp v231, v232, v231 row_newbcast:7 row_mask:0xf bank_mask:0xf
    v_subrev_f32_dpp v230, v233, v230 row_newbcast:7 row_mask:0xf bank_mask:0xf
    v_subrev_f32_dpp v231, v233, v231 row_newbcast:7 row_mask:0xf bank_mask:0xf
    v_cvt_pk_bf16_f32 v219, v228, v230
    v_cvt_pk_bf16_f32 v223, v229, v231
    ds_write_b128 v199, v[220:223] offset:61440
    buffer_store_dwordx4 v[32:35], v0, s[24:27], s79 offen offset:0 sc1
    buffer_store_dwordx4 v[36:39], v0, s[24:27], s79 offen offset:1024 sc1
    s_add_u32 s79, s79, 0x200000
    buffer_store_dwordx4 v[216:219], v0, s[24:27], s80 offen offset:0 sc1
    s_add_u32 s80, s80, 4096
    buffer_store_dwordx4 v[220:223], v0, s[24:27], s80 offen offset:0 sc1
    s_add_u32 s80, s80, 0x1ff000
    buffer_load_dwordx4 v[64:67], v14, s[8:11], s68 offen offset:0
    buffer_load_dwordx4 v[72:75], v14, s[8:11], s68 offen offset:64
    buffer_load_dwordx4 v[68:71], v14, s[8:11], s68 offen offset:128
    buffer_load_dwordx4 v[76:79], v14, s[8:11], s68 offen offset:192
    buffer_load_dwordx4 v[144:147], v14, s[12:15], s65 offen offset:0
    buffer_load_dwordx4 v[152:155], v14, s[12:15], s65 offen offset:64
    buffer_load_dwordx4 v[148:151], v14, s[16:19], s65 offen offset:0
    buffer_load_dwordx4 v[156:159], v14, s[16:19], s65 offen offset:64
    s_cmp_lg_u32 s96, 3
    s_cbranch_scc1 L_nocas2
    s_waitcnt lgkmcnt(0)
    s_cmp_eq_u64 s[20:21], 0
    s_cselect_b64 s[20:21], s[88:89], s[20:21]
    v_mov_b32 v4, s20
    v_mov_b32 v5, s21
    ds_write_b64 v198, v[4:5]
L_nocas2:
    s_waitcnt lgkmcnt(0)
    s_barrier
    ds_read_b64 v[4:5], v198
    s_load_dwordx2 s[20:21], s[0:1], 88
    s_mov_b32 s22, 0x1000000
    s_mov_b32 s23, 0x00020000
    v_add_u32 v254, s91, v252
    ds_read_b128 a[192:195], v252 offset:0
    ds_read_b128 a[196:199], v252 offset:1024
    ds_read_b128 a[200:203], v252 offset:2048
    ds_read_b128 a[204:207], v252 offset:3072
    ds_read_b128 a[208:211], v252 offset:4096
    ds_read_b128 a[212:215], v252 offset:5120
    ds_read_b128 a[216:219], v252 offset:6144
    ds_read_b128 a[220:223], v252 offset:7168
    s_mov_b32 m0, 0
    s_mov_b64 exec, 0
    s_cmp_eq_u32 s96, 0
    s_cbranch_scc1 L_stop_first0
    s_cmp_eq_u32 s96, 1
    s_cbranch_scc1 L_stop_first1
    s_cmp_eq_u32 s96, 2
    s_cbranch_scc1 L_stop_first2
    s_branch L_stop_first3
L_tour_end:
    s_mov_b64 exec, -1
    s_waitcnt vmcnt(8) lgkmcnt(0)
    buffer_store_dwordx2 v[4:5], v13, s[24:27], s81 offen sc1
    s_add_u32 s81, s81, 512
    buffer_store_dwordx2 v[4:5], v13, s[24:27], s82 offen sc1
    s_add_u32 s82, s82, 512
    buffer_load_dwordx4 v[80:83], v14, s[8:11], s69 offen offset:0
    buffer_load_dwordx4 v[88:91], v14, s[8:11], s69 offen offset:64
    buffer_load_dwordx4 v[84:87], v14, s[8:11], s69 offen offset:128
    buffer_load_dwordx4 v[92:95], v14, s[8:11], s69 offen offset:192
    buffer_load_dwordx4 v[96:99], v14, s[8:11], s70 offen offset:0
    buffer_load_dwordx4 v[104:107], v14, s[8:11], s70 offen offset:64
    buffer_load_dwordx4 v[100:103], v14, s[8:11], s70 offen offset:128
    buffer_load_dwordx4 v[108:111], v14, s[8:11], s70 offen offset:192
    buffer_load_dwordx4 v[160:163], v14, s[12:15], s66 offen offset:0
    buffer_load_dwordx4 v[168:171], v14, s[12:15], s66 offen offset:64
    buffer_load_dwordx4 v[164:167], v14, s[16:19], s66 offen offset:0
    buffer_load_dwordx4 v[172:175], v14, s[16:19], s66 offen offset:64
    v_accvgpr_write_b32 a0, 0
    v_accvgpr_write_b32 a1, 0
    v_accvgpr_write_b32 a2, 0
    v_accvgpr_write_b32 a3, 0
    v_accvgpr_write_b32 a4, 0
    v_accvgpr_write_b32 a5, 0
    v_accvgpr_write_b32 a6, 0
    v_accvgpr_write_b32 a7, 0
    v_accvgpr_write_b32 a8, 0
    v_accvgpr_write_b32 a9, 0
    v_accvgpr_write_b32 a10, 0
    v_accvgpr_write_b32 a11, 0
    v_accvgpr_write_b32 a12, 0
    v_accvgpr_write_b32 a13, 0
    v_accvgpr_write_b32 a14, 0
    v_accvgpr_write_b32 a15, 0
    v_accvgpr_write_b32 a16, 0
    v_accvgpr_write_b32 a17, 0
    v_accvgpr_write_b32 a18, 0
    v_accvgpr_write_b32 a19, 0
    v_accvgpr_write_b32 a20, 0
    v_accvgpr_write_b32 a21, 0
    v_accvgpr_write_b32 a22, 0
    v_accvgpr_write_b32 a23, 0
    v_accvgpr_write_b32 a24, 0
    v_accvgpr_write_b32 a25, 0
    v_accvgpr_write_b32 a26, 0
    v_accvgpr_write_b32 a27, 0
    v_accvgpr_write_b32 a28, 0
    v_accvgpr_write_b32 a29, 0
    v_accvgpr_write_b32 a30, 0
    v_accvgpr_write_b32 a31, 0
    v_accvgpr_write_b32 a32, 0
    v_accvgpr_write_b32 a33, 0
    v_accvgpr_write_b32 a34, 0
    v_accvgpr_write_b32 a35, 0
    v_accvgpr_write_b32 a36, 0
    v_accvgpr_write_b32 a37, 0
    v_accvgpr_write_b32 a38, 0
    v_accvgpr_write_b32 a39, 0
    v_accvgpr_write_b32 a40, 0
    v_accvgpr_write_b32 a41, 0
    v_accvgpr_write_b32 a42, 0
    v_accvgpr_write_b32 a43, 0
    v_accvgpr_write_b32 a44, 0
    v_accvgpr_write_b32 a45, 0
    v_accvgpr_write_b32 a46, 0
    v_accvgpr_write_b32 a47, 0
    v_accvgpr_write_b32 a48, 0
    v_accvgpr_write_b32 a49, 0
    v_accvgpr_write_b32 a50, 0
    v_accvgpr_write_b32 a51, 0
    v_accvgpr_write_b32 a52, 0
    v_accvgpr_write_b32 a53, 0
    v_accvgpr_write_b32 a54, 0
    v_accvgpr_write_b32 a55, 0
    v_accvgpr_write_b32 a56, 0
    v_accvgpr_write_b32 a57, 0
    v_accvgpr_write_b32 a58, 0
    v_accvgpr_write_b32 a59, 0
    v_accvgpr_write_b32 a60, 0
    v_accvgpr_write_b32 a61, 0
    v_accvgpr_write_b32 a62, 0
    v_accvgpr_write_b32 a63, 0
    v_accvgpr_write_b32 a64, 0
    v_accvgpr_write_b32 a65, 0
    v_accvgpr_write_b32 a66, 0
    v_accvgpr_write_b32 a67, 0
    v_accvgpr_write_b32 a68, 0
    v_accvgpr_write_b32 a69, 0
    v_accvgpr_write_b32 a70, 0
    v_accvgpr_write_b32 a71, 0
    v_accvgpr_write_b32 a72, 0
    v_accvgpr_write_b32 a73, 0
    v_accvgpr_write_b32 a74, 0
    v_accvgpr_write_b32 a75, 0
    v_accvgpr_write_b32 a76, 0
    v_accvgpr_write_b32 a77, 0
    v_accvgpr_write_b32 a78, 0
    v_accvgpr_write_b32 a79, 0
    v_accvgpr_write_b32 a80, 0
    v_accvgpr_write_b32 a81, 0
    v_accvgpr_write_b32 a82, 0
    v_accvgpr_write_b32 a83, 0
    v_accvgpr_write_b32 a84, 0
    v_accvgpr_write_b32 a85, 0
    v_accvgpr_write_b32 a86, 0
    v_accvgpr_write_b32 a87, 0
    v_accvgpr_write_b32 a88, 0
    v_accvgpr_write_b32 a89, 0
    v_accvgpr_write_b32 a90, 0
    v_accvgpr_write_b32 a91, 0
L_stop_first0:
L_stop0:
    s_cbranch_execz L_stop4
    v_accvgpr_write_b32 a92, 0
    v_accvgpr_write_b32 a93, 0
    v_accvgpr_write_b32 a94, 0
    v_accvgpr_write_b32 a95, 0
    v_accvgpr_write_b32 a96, 0
    v_accvgpr_write_b32 a97, 0
    v_accvgpr_write_b32 a98, 0
    v_accvgpr_write_b32 a99, 0
    v_accvgpr_write_b32 a100, 0
    v_accvgpr_write_b32 a101, 0
    v_accvgpr_write_b32 a102, 0
    v_accvgpr_write_b32 a103, 0
    v_accvgpr_write_b32 a104, 0
    v_accvgpr_write_b32 a105, 0
    v_accvgpr_write_b32 a106, 0
    v_accvgpr_write_b32 a107, 0
    v_accvgpr_write_b32 a108, 0
    v_accvgpr_write_b32 a109, 0
    v_accvgpr_write_b32 a110, 0
    v_accvgpr_write_b32 a111, 0
    v_accvgpr_write_b32 a112, 0
    v_accvgpr_write_b32 a113, 0
    v_accvgpr_write_b32 a114, 0
    v_accvgpr_write_b32 a115, 0
    v_accvgpr_write_b32 a116, 0
    v_accvgpr_write_b32 a117, 0
    v_accvgpr_write_b32 a118, 0
    v_accvgpr_write_b32 a119, 0
    v_accvgpr_write_b32 a120, 0
    v_accvgpr_write_b32 a121, 0
    v_accvgpr_write_b32 a122, 0
    v_accvgpr_write_b32 a123, 0
    v_accvgpr_write_b32 a124, 0
    v_accvgpr_write_b32 a125, 0
    v_accvgpr_write_b32 a126, 0
    v_accvgpr_write_b32 a127, 0
    s_waitcnt vmcnt(18)
    v_perm_b32 v192, v68, v64, s3
    v_perm_b32 v193, v68, v64, s4
    v_perm_b32 v194, v132, v128, s3
    v_perm_b32 v195, v132, v128, s4
    v_perm_b32 v196, v128, v132, s3
    v_perm_b32 v197, v128, v132, s4
    v_dot2_f32_bf16 v128, v192, v194, 0 neg_hi:[1,0,0]
    v_dot2_f32_bf16 v132, v193, v195, 0 neg_hi:[1,0,0]
    v_dot2_f32_bf16 v64, v192, v196, 0
    v_dot2_f32_bf16 v68, v193, v197, 0
    v_perm_b32 v192, v69, v65, s3
    v_perm_b32 v193, v69, v65, s4
    v_perm_b32 v194, v133, v129, s3
    v_perm_b32 v195, v133, v129, s4
    v_perm_b32 v196, v129, v133, s3
    v_perm_b32 v197, v129, v133, s4
    v_dot2_f32_bf16 v129, v192, v194, 0 neg_hi:[1,0,0]
    v_dot2_f32_bf16 v133, v193, v195, 0 neg_hi:[1,0,0]
    v_dot2_f32_bf16 v65, v192, v196, 0
    v_dot2_f32_bf16 v69, v193, v197, 0
    v_perm_b32 v192, v70, v66, s3
    v_perm_b32 v193, v70, v66, s4
    v_perm_b32 v194, v134, v130, s3
    v_perm_b32 v195, v134, v130, s4
    v_perm_b32 v196, v130, v134, s3
    v_perm_b32 v197, v130, v134, s4
    v_dot2_f32_bf16 v130, v192, v194, 0 neg_hi:[1,0,0]
    v_dot2_f32_bf16 v134, v193, v195, 0 neg_hi:[1,0,0]
    v_dot2_f32_bf16 v66, v192, v196, 0
    v_dot2_f32_bf16 v70, v193, v197, 0
    v_perm_b32 v192, v71, v67, s3
    v_perm_b32 v193, v71, v67, s4
    v_perm_b32 v194, v135, v131, s3
    v_perm_b32 v195, v135, v131, s4
    v_perm_b32 v196, v131, v135, s3
    v_perm_b32 v197, v131, v135, s4
    v_dot2_f32_bf16 v131, v192, v194, 0 neg_hi:[1,0,0]
    v_dot2_f32_bf16 v135, v193, v195, 0 neg_hi:[1,0,0]
    v_dot2_f32_bf16 v67, v192, v196, 0
    v_dot2_f32_bf16 v71, v193, v197, 0
    v_cvt_pk_bf16_f32 v244, v128, v132
    v_cvt_pk_bf16_f32 v246, v64, v68
    v_cvt_pk_bf16_f32 v245, v129, v133
    v_cvt_pk_bf16_f32 v247, v65, v69
    v_cvt_pk_bf16_f32 v248, v130, v134
    v_cvt_pk_bf16_f32 v250, v66, v70
    v_cvt_pk_bf16_f32 v249, v131, v135
    v_cvt_pk_bf16_f32 v251, v67, v71
    ds_write_b128 v253, v[244:247] offset:0
    ds_write_b128 v253, v[248:251] offset:1024
    v_perm_b32 v192, v76, v72, s3
    v_perm_b32 v193, v76, v72, s4
    v_perm_b32 v194, v140, v136, s3
    v_perm_b32 v195, v140, v136, s4
    v_perm_b32 v196, v136, v140, s3
    v_perm_b32 v197, v136, v140, s4
    v_dot2_f32_bf16 v136, v192, v194, 0 neg_hi:[1,0,0]
    v_dot2_f32_bf16 v140, v193, v195, 0 neg_hi:[1,0,0]
    v_dot2_f32_bf16 v72, v192, v196, 0
    v_dot2_f32_bf16 v76, v193, v197, 0
    v_perm_b32 v192, v77, v73, s3
    v_perm_b32 v193, v77, v73, s4
    v_perm_b32 v194, v141, v137, s3
    v_perm_b32 v195, v141, v137, s4
    v_perm_b32 v196, v137, v141, s3
    v_perm_b32 v197, v137, v141, s4
    v_dot2_f32_bf16 v137, v192, v194, 0 neg_hi:[1,0,0]
    v_dot2_f32_bf16 v141, v193, v195, 0 neg_hi:[1,0,0]
    v_dot2_f32_bf16 v73, v192, v196, 0
    v_dot2_f32_bf16 v77, v193, v197, 0
    v_perm_b32 v192, v78, v74, s3
    v_perm_b32 v193, v78, v74, s4
    v_perm_b32 v194, v142, v138, s3
    v_perm_b32 v195, v142, v138, s4
    v_perm_b32 v196, v138, v142, s3
    v_perm_b32 v197, v138, v142, s4
    v_dot2_f32_bf16 v138, v192, v194, 0 neg_hi:[1,0,0]
    v_dot2_f32_bf16 v142, v193, v195, 0 neg_hi:[1,0,0]
    v_dot2_f32_bf16 v74, v192, v196, 0
    v_dot2_f32_bf16 v78, v193, v197, 0
    v_perm_b32 v192, v79, v75, s3
    v_perm_b32 v193, v79, v75, s4
    v_perm_b32 v194, v143, v139, s3
    v_perm_b32 v195, v143, v139, s4
    v_perm_b32 v196, v139, v143, s3
    v_perm_b32 v197, v139, v143, s4
    v_dot2_f32_bf16 v139, v192, v194, 0 neg_hi:[1,0,0]
    v_dot2_f32_bf16 v143, v193, v195, 0 neg_hi:[1,0,0]
    v_dot2_f32_bf16 v75, v192, v196, 0
    v_dot2_f32_bf16 v79, v193, v197, 0
    v_cvt_pk_bf16_f32 v244, v136, v140
    v_cvt_pk_bf16_f32 v246, v72, v76
    v_cvt_pk_bf16_f32 v245, v137, v141
    v_cvt_pk_bf16_f32 v247, v73, v77
    v_cvt_pk_bf16_f32 v248, v138, v142
    v_cvt_pk_bf16_f32 v250, v74, v78
    v_cvt_pk_bf16_f32 v249, v139, v143
    v_cvt_pk_bf16_f32 v251, v75, v79
    ds_write_b128 v253, v[244:247] offset:2048
    ds_write_b128 v253, v[248:251] offset:3072
    ds_read_b128 a[128:131], v254 offset:0
    ds_read_b128 a[132:135], v254 offset:1024
    ds_read_b128 a[136:139], v254 offset:2048
    ds_read_b128 a[140:143], v254 offset:3072
    s_waitcnt lgkmcnt(0)
    v_mfma_f32_16x16x32_bf16 v[64:67], a[192:195], a[128:131], 0
    v_mfma_f32_16x16x32_bf16 v[64:67], a[196:199], a[132:135], v[64:67]
    v_mfma_f32_16x16x32_bf16 v[64:67], a[200:203], a[136:139], v[64:67]
    v_mfma_f32_16x16x32_bf16 v[64:67], a[204:207], a[140:143], v[64:67]
    v_mfma_f32_16x16x32_bf16 v[68:71], a[208:211], a[128:131], 0
    v_mfma_f32_16x16x32_bf16 v[68:71], a[212:215], a[132:135], v[68:71]
    v_mfma_f32_16x16x32_bf16 v[68:71], a[216:219], a[136:139], v[68:71]
    v_mfma_f32_16x16x32_bf16 v[68:71], a[220:223], a[140:143], v[68:71]
    s_nop 3
    v_max3_f32 v204, v64, v65, v66
    s_nop 2
    v_max3_f32 v204, v204, v67, v68
    v_max3_f32 v204, v204, v69, v70
    v_max_f32 v204, v204, v71
    v_mov_b32 v208, v204
    s_nop 1
    v_permlane16_swap_b32 v204, v208
    s_nop 1
    v_max_f32 v204, v204, v208
    v_mov_b32 v208, v204
    s_nop 1
    v_permlane32_swap_b32 v204, v208
    s_nop 1
    v_max_f32 v204, v204, v208
    v_add_f32 v204, 0x42400000, v204
    v_sub_f32 v64, v64, v204
    v_sub_f32 v65, v65, v204
    v_sub_f32 v66, v66, v204
    v_sub_f32 v67, v67, v204
    v_sub_f32 v68, v68, v204
    v_sub_f32 v69, v69, v204
    v_sub_f32 v70, v70, v204
    v_sub_f32 v71, v71, v204
    s_barrier
    s_waitcnt vmcnt(8)
    v_perm_b32 v192, v84, v80, s3
    v_perm_b32 v193, v84, v80, s4
    v_perm_b32 v194, v148, v144, s3
    v_perm_b32 v195, v148, v144, s4
    v_perm_b32 v196, v144, v148, s3
    v_perm_b32 v197, v144, v148, s4
    v_dot2_f32_bf16 v144, v192, v194, 0 neg_hi:[1,0,0]
    v_dot2_f32_bf16 v148, v193, v195, 0 neg_hi:[1,0,0]
    v_dot2_f32_bf16 v80, v192, v196, 0
    v_dot2_f32_bf16 v84, v193, v197, 0
    v_perm_b32 v192, v85, v81, s3
    v_perm_b32 v193, v85, v81, s4
    v_perm_b32 v194, v149, v145, s3
    v_perm_b32 v195, v149, v145, s4
    v_perm_b32 v196, v145, v149, s3
    v_perm_b32 v197, v145, v149, s4
    v_dot2_f32_bf16 v145, v192, v194, 0 neg_hi:[1,0,0]
    v_dot2_f32_bf16 v149, v193, v195, 0 neg_hi:[1,0,0]
    v_dot2_f32_bf16 v81, v192, v196, 0
    v_dot2_f32_bf16 v85, v193, v197, 0
    v_perm_b32 v192, v86, v82, s3
    v_perm_b32 v193, v86, v82, s4
    v_perm_b32 v194, v150, v146, s3
    v_perm_b32 v195, v150, v146, s4
    v_perm_b32 v196, v146, v150, s3
    v_perm_b32 v197, v146, v150, s4
    v_dot2_f32_bf16 v146, v192, v194, 0 neg_hi:[1,0,0]
    v_dot2_f32_bf16 v150, v193, v195, 0 neg_hi:[1,0,0]
    v_dot2_f32_bf16 v82, v192, v196, 0
    v_dot2_f32_bf16 v86, v193, v197, 0
    v_perm_b32 v192, v87, v83, s3
    v_perm_b32 v193, v87, v83, s4
    v_perm_b32 v194, v151, v147, s3
    v_perm_b32 v195, v151, v147, s4
    v_perm_b32 v196, v147, v151, s3
    v_perm_b32 v197, v147, v151, s4
    v_dot2_f32_bf16 v147, v192, v194, 0 neg_hi:[1,0,0]
    v_dot2_f32_bf16 v151, v193, v195, 0 neg_hi:[1,0,0]
    v_dot2_f32_bf16 v83, v192, v196, 0
    v_dot2_f32_bf16 v87, v193, v197, 0
    v_cvt_pk_bf16_f32 v244, v144, v148
    v_cvt_pk_bf16_f32 v246, v80, v84
    v_cvt_pk_bf16_f32 v245, v145, v149
    v_cvt_pk_bf16_f32 v247, v81, v85
    v_cvt_pk_bf16_f32 v248, v146, v150
    v_cvt_pk_bf16_f32 v250, v82, v86
    v_cvt_pk_bf16_f32 v249, v147, v151
    v_cvt_pk_bf16_f32 v251, v83, v87
    ds_write_b128 v253, v[244:247] offset:4096
    ds_write_b128 v253, v[248:251] offset:5120
    v_perm_b32 v192, v92, v88, s3
    v_perm_b32 v193, v92, v88, s4
    v_perm_b32 v194, v156, v152, s3
    v_perm_b32 v195, v156, v152, s4
    v_perm_b32 v196, v152, v156, s3
    v_perm_b32 v197, v152, v156, s4
    v_dot2_f32_bf16 v152, v192, v194, 0 neg_hi:[1,0,0]
    v_dot2_f32_bf16 v156, v193, v195, 0 neg_hi:[1,0,0]
    v_dot2_f32_bf16 v88, v192, v196, 0
    v_dot2_f32_bf16 v92, v193, v197, 0
    v_perm_b32 v192, v93, v89, s3
    v_perm_b32 v193, v93, v89, s4
    v_perm_b32 v194, v157, v153, s3
    v_perm_b32 v195, v157, v153, s4
    v_perm_b32 v196, v153, v157, s3
    v_perm_b32 v197, v153, v157, s4
    v_dot2_f32_bf16 v153, v192, v194, 0 neg_hi:[1,0,0]
    v_dot2_f32_bf16 v157, v193, v195, 0 neg_hi:[1,0,0]
    v_dot2_f32_bf16 v89, v192, v196, 0
    v_dot2_f32_bf16 v93, v193, v197, 0
    v_perm_b32 v192, v94, v90, s3
    v_perm_b32 v193, v94, v90, s4
    v_perm_b32 v194, v158, v154, s3
    v_perm_b32 v195, v158, v154, s4
    v_perm_b32 v196, v154, v158, s3
    v_perm_b32 v197, v154, v158, s4
    v_dot2_f32_bf16 v154, v192, v194, 0 neg_hi:[1,0,0]
    v_dot2_f32_bf16 v158, v193, v195, 0 neg_hi:[1,0,0]
    v_dot2_f32_bf16 v90, v192, v196, 0
    v_dot2_f32_bf16 v94, v193, v197, 0
    v_perm_b32 v192, v95, v91, s3
    v_perm_b32 v193, v95, v91, s4
    v_perm_b32 v194, v159, v155, s3
    v_perm_b32 v195, v159, v155, s4
    v_perm_b32 v196, v155, v159, s3
    v_perm_b32 v197, v155, v159, s4
    v_dot2_f32_bf16 v155, v192, v194, 0 neg_hi:[1,0,0]
    v_dot2_f32_bf16 v159, v193, v195, 0 neg_hi:[1,0,0]
    v_dot2_f32_bf16 v91, v192, v196, 0
    v_dot2_f32_bf16 v95, v193, v197, 0
    v_cvt_pk_bf16_f32 v244, v152, v156
    v_cvt_pk_bf16_f32 v246, v88, v92
    v_cvt_pk_bf16_f32 v245, v153, v157
    v_cvt_pk_bf16_f32 v247, v89, v93
    v_cvt_pk_bf16_f32 v248, v154, v158
    v_cvt_pk_bf16_f32 v250, v90, v94
    v_cvt_pk_bf16_f32 v249, v155, v159
    v_cvt_pk_bf16_f32 v251, v91, v95
    ds_write_b128 v253, v[244:247] offset:6144
    ds_write_b128 v253, v[248:251] offset:7168
    buffer_load_dwordx2 v[6:7], v3, s[24:27], s83 offen sc1
    buffer_load_dwordx4 v[112:115], v14, s[8:11], s71 offen offset:0
    buffer_load_dwordx4 v[120:123], v14, s[8:11], s71 offen offset:64
    buffer_load_dwordx4 v[116:119], v14, s[8:11], s71 offen offset:128
    buffer_load_dwordx4 v[124:127], v14, s[8:11], s71 offen offset:192
    buffer_load_dwordx4 v[176:179], v14, s[12:15], s67 offen offset:0
    buffer_load_dwordx4 v[184:187], v14, s[12:15], s67 offen offset:64
    buffer_load_dwordx4 v[180:183], v14, s[16:19], s67 offen offset:0
    buffer_load_dwordx4 v[188:191], v14, s[16:19], s67 offen offset:64
    s_cmp_eq_u32 s96, 0
    s_cselect_b64 s[16:17], s[12:13], s[16:17]
    s_cmp_eq_u32 s96, 2
    s_cselect_b64 s[16:17], s[40:41], s[16:17]
    s_cmp_eq_u32 s96, 3
    s_cselect_b64 s[16:17], s[44:45], s[16:17]
    s_mov_b64 s[8:9], s[60:61]
    s_movk_i32 s10, 256
    ds_read_b128 a[144:147], v254 offset:4096
    ds_read_b128 a[148:151], v254 offset:5120
    ds_read_b128 a[152:155], v254 offset:6144
    ds_read_b128 a[156:159], v254 offset:7168
    s_waitcnt lgkmcnt(0)
    v_mfma_f32_16x16x32_bf16 v[72:75], a[192:195], a[144:147], 0
    v_mfma_f32_16x16x32_bf16 v[72:75], a[196:199], a[148:151], v[72:75]
    v_mfma_f32_16x16x32_bf16 v[72:75], a[200:203], a[152:155], v[72:75]
    v_mfma_f32_16x16x32_bf16 v[72:75], a[204:207], a[156:159], v[72:75]
    v_mfma_f32_16x16x32_bf16 v[76:79], a[208:211], a[144:147], 0
    v_mfma_f32_16x16x32_bf16 v[76:79], a[212:215], a[148:151], v[76:79]
    v_mfma_f32_16x16x32_bf16 v[76:79], a[216:219], a[152:155], v[76:79]
    v_mfma_f32_16x16x32_bf16 v[76:79], a[220:223], a[156:159], v[76:79]
    s_nop 3
    v_max3_f32 v205, v72, v73, v74
    s_nop 2
    v_max3_f32 v205, v205, v75, v76
    v_max3_f32 v205, v205, v77, v78
    v_max_f32 v205, v205, v79
    v_mov_b32 v208, v205
    s_nop 1
    v_permlane16_swap_b32 v205, v208
    s_nop 1
    v_max_f32 v205, v205, v208
    v_mov_b32 v208, v205
    s_nop 1
    v_permlane32_swap_b32 v205, v208
    s_nop 1
    v_max_f32 v205, v205, v208
    v_add_f32 v205, 0x42400000, v205
    v_sub_f32 v72, v72, v205
    v_sub_f32 v73, v73, v205
    v_sub_f32 v74, v74, v205
    v_sub_f32 v75, v75, v205
    v_sub_f32 v76, v76, v205
    v_sub_f32 v77, v77, v205
    v_sub_f32 v78, v78, v205
    v_sub_f32 v79, v79, v205
    s_waitcnt vmcnt(9)
    v_perm_b32 v192, v100, v96, s3
    v_perm_b32 v193, v100, v96, s4
    v_perm_b32 v194, v164, v160, s3
    v_perm_b32 v195, v164, v160, s4
    v_perm_b32 v196, v160, v164, s3
    v_perm_b32 v197, v160, v164, s4
    v_dot2_f32_bf16 v160, v192, v194, 0 neg_hi:[1,0,0]
    v_dot2_f32_bf16 v164, v193, v195, 0 neg_hi:[1,0,0]
    v_dot2_f32_bf16 v96, v192, v196, 0
    v_dot2_f32_bf16 v100, v193, v197, 0
    v_perm_b32 v192, v101, v97, s3
    v_perm_b32 v193, v101, v97, s4
    v_perm_b32 v194, v165, v161, s3
    v_perm_b32 v195, v165, v161, s4
    v_perm_b32 v196, v161, v165, s3
    v_perm_b32 v197, v161, v165, s4
    v_dot2_f32_bf16 v161, v192, v194, 0 neg_hi:[1,0,0]
    v_dot2_f32_bf16 v165, v193, v195, 0 neg_hi:[1,0,0]
    v_dot2_f32_bf16 v97, v192, v196, 0
    v_dot2_f32_bf16 v101, v193, v197, 0
    v_perm_b32 v192, v102, v98, s3
    v_perm_b32 v193, v102, v98, s4
    v_perm_b32 v194, v166, v162, s3
    v_perm_b32 v195, v166, v162, s4
    v_perm_b32 v196, v162, v166, s3
    v_perm_b32 v197, v162, v166, s4
    v_dot2_f32_bf16 v162, v192, v194, 0 neg_hi:[1,0,0]
    v_dot2_f32_bf16 v166, v193, v195, 0 neg_hi:[1,0,0]
    v_dot2_f32_bf16 v98, v192, v196, 0
    v_dot2_f32_bf16 v102, v193, v197, 0
    v_perm_b32 v192, v103, v99, s3
    v_perm_b32 v193, v103, v99, s4
    v_perm_b32 v194, v167, v163, s3
    v_perm_b32 v195, v167, v163, s4
    v_perm_b32 v196, v163, v167, s3
    v_perm_b32 v197, v163, v167, s4
    v_dot2_f32_bf16 v163, v192, v194, 0 neg_hi:[1,0,0]
    v_dot2_f32_bf16 v167, v193, v195, 0 neg_hi:[1,0,0]
    v_dot2_f32_bf16 v99, v192, v196, 0
    v_dot2_f32_bf16 v103, v193, v197, 0
    v_cvt_pk_bf16_f32 v244, v160, v164
    v_cvt_pk_bf16_f32 v246, v96, v100
    v_cvt_pk_bf16_f32 v245, v161, v165
    v_cvt_pk_bf16_f32 v247, v97, v101
    v_cvt_pk_bf16_f32 v248, v162, v166
    v_cvt_pk_bf16_f32 v250, v98, v102
    v_cvt_pk_bf16_f32 v249, v163, v167
    v_cvt_pk_bf16_f32 v251, v99, v103
    ds_write_b128 v253, v[244:247] offset:8192
    ds_write_b128 v253, v[248:251] offset:9216
    s_lshr_b32 s93, s96, 1
    s_mul_i32 s94, s93, 3
    s_sub_u32 s94, 5, s94
    s_cmp_eq_u32 s96, 2
    s_cselect_b32 s94, 1, s94
    s_add_u32 s95, s94, s97
    s_add_u32 s94, s95, 0
    s_and_b32 s94, s94, 7
    s_lshl1_add_u32 s94, s94, s93
    s_lshl_b32 s64, s94, 12
    s_add_u32 s94, s95, 1
    s_and_b32 s94, s94, 7
    s_lshl_b32 s65, s94, 13
    s_add_u32 s94, s95, 2
    s_and_b32 s94, s94, 7
    s_lshl1_add_u32 s94, s94, s93
    s_lshl_b32 s66, s94, 12
    s_add_u32 s94, s95, 3
    s_and_b32 s94, s94, 7
    s_lshl_b32 s67, s94, 13
    s_add_u32 s94, s95, 4
    s_and_b32 s94, s94, 7
    s_lshl1_add_u32 s94, s94, s93
    s_lshl_b32 s68, s94, 12
    s_add_u32 s94, s95, 5
    s_and_b32 s94, s94, 7
    s_lshl_b32 s69, s94, 13
    s_add_u32 s94, s95, 6
    s_and_b32 s94, s94, 7
    s_lshl1_add_u32 s94, s94, s93
    s_lshl_b32 s70, s94, 12
    s_add_u32 s94, s95, 7
    s_and_b32 s94, s94, 7
    s_lshl_b32 s71, s94, 13
    s_waitcnt vmcnt(8)
    v_cmp_ne_u64 vcc, v[6:7], v[4:5]
    s_cbranch_vccnz L_spin_p0
L_spinret_p0:
    s_cmp_lg_u32 s93, 0
    s_cbranch_scc1 L_pv
    s_add_u32 m0, s73, 8192
    s_nop 0
    buffer_load_dwordx4 v2, s[24:27], s68 offen offset:0 sc1 lds
    buffer_load_dwordx4 v2, s[24:27], s68 offen offset:1024 sc1 lds
    buffer_load_dwordx4 v2, s[24:27], s68 offen offset:2048 sc1 lds
    buffer_load_dwordx4 v2, s[24:27], s68 offen offset:3072 sc1 lds
    s_add_u32 m0, s73, 16384
    s_nop 0
    buffer_load_dwordx4 v2, s[24:27], s69 offen offset:0 sc1 lds
    buffer_load_dwordx4 v2, s[24:27], s69 offen offset:1024 sc1 lds
    buffer_load_dwordx4 v2, s[24:27], s69 offen offset:2048 sc1 lds
    buffer_load_dwordx4 v2, s[24:27], s69 offen offset:3072 sc1 lds
    s_add_u32 m0, s73, 24576
    s_nop 0
    buffer_load_dwordx4 v2, s[24:27], s70 offen offset:0 sc1 lds
    buffer_load_dwordx4 v2, s[24:27], s70 offen offset:1024 sc1 lds
    buffer_load_dwordx4 v2, s[24:27], s70 offen offset:2048 sc1 lds
    buffer_load_dwordx4 v2, s[24:27], s70 offen offset:3072 sc1 lds
L_pv:
    s_add_u32 m0, s73, 0
    s_nop 0
    buffer_load_dwordx4 v2, s[24:27], s71 offen offset:0 sc1 lds
    buffer_load_dwordx4 v2, s[24:27], s71 offen offset:1024 sc1 lds
    buffer_load_dwordx4 v2, s[24:27], s71 offen offset:2048 sc1 lds
    buffer_load_dwordx4 v2, s[24:27], s71 offen offset:3072 sc1 lds
    s_mov_b32 s83, 512
    s_mov_b32 s84, 768
    v_perm_b32 v192, v108, v104, s3
    v_perm_b32 v193, v108, v104, s4
    v_perm_b32 v194, v172, v168, s3
    v_perm_b32 v195, v172, v168, s4
    v_perm_b32 v196, v168, v172, s3
    v_perm_b32 v197, v168, v172, s4
    v_dot2_f32_bf16 v168, v192, v194, 0 neg_hi:[1,0,0]
    v_dot2_f32_bf16 v172, v193, v195, 0 neg_hi:[1,0,0]
    v_dot2_f32_bf16 v104, v192, v196, 0
    v_dot2_f32_bf16 v108, v193, v197, 0
    v_perm_b32 v192, v109, v105, s3
    v_perm_b32 v193, v109, v105, s4
    v_perm_b32 v194, v173, v169, s3
    v_perm_b32 v195, v173, v169, s4
    v_perm_b32 v196, v169, v173, s3
    v_perm_b32 v197, v169, v173, s4
    v_dot2_f32_bf16 v169, v192, v194, 0 neg_hi:[1,0,0]
    v_dot2_f32_bf16 v173, v193, v195, 0 neg_hi:[1,0,0]
    v_dot2_f32_bf16 v105, v192, v196, 0
    v_dot2_f32_bf16 v109, v193, v197, 0
    v_perm_b32 v192, v110, v106, s3
    v_perm_b32 v193, v110, v106, s4
    v_perm_b32 v194, v174, v170, s3
    v_perm_b32 v195, v174, v170, s4
    v_perm_b32 v196, v170, v174, s3
    v_perm_b32 v197, v170, v174, s4
    v_dot2_f32_bf16 v170, v192, v194, 0 neg_hi:[1,0,0]
    v_dot2_f32_bf16 v174, v193, v195, 0 neg_hi:[1,0,0]
    v_dot2_f32_bf16 v106, v192, v196, 0
    v_dot2_f32_bf16 v110, v193, v197, 0
    v_perm_b32 v192, v111, v107, s3
    v_perm_b32 v193, v111, v107, s4
    v_perm_b32 v194, v175, v171, s3
    v_perm_b32 v195, v175, v171, s4
    v_perm_b32 v196, v171, v175, s3
    v_perm_b32 v197, v171, v175, s4
    v_dot2_f32_bf16 v171, v192, v194, 0 neg_hi:[1,0,0]
    v_dot2_f32_bf16 v175, v193, v195, 0 neg_hi:[1,0,0]
    v_dot2_f32_bf16 v107, v192, v196, 0
    v_dot2_f32_bf16 v111, v193, v197, 0
    v_cvt_pk_bf16_f32 v244, v168, v172
    v_cvt_pk_bf16_f32 v246, v104, v108
    v_cvt_pk_bf16_f32 v245, v169, v173
    v_cvt_pk_bf16_f32 v247, v105, v109
    v_cvt_pk_bf16_f32 v248, v170, v174
    v_cvt_pk_bf16_f32 v250, v106, v110
    v_cvt_pk_bf16_f32 v249, v171, v175
    v_cvt_pk_bf16_f32 v251, v107, v111
    ds_write_b128 v253, v[244:247] offset:10240
    ds_write_b128 v253, v[248:251] offset:11264
    ds_read_b128 a[160:163], v254 offset:8192
    ds_read_b128 a[164:167], v254 offset:9216
    ds_read_b128 a[168:171], v254 offset:10240
    ds_read_b128 a[172:175], v254 offset:11264
    s_waitcnt lgkmcnt(0)
    v_mfma_f32_16x16x32_bf16 v[80:83], a[192:195], a[160:163], 0
    v_mfma_f32_16x16x32_bf16 v[80:83], a[196:199], a[164:167], v[80:83]
    v_mfma_f32_16x16x32_bf16 v[80:83], a[200:203], a[168:171], v[80:83]
    v_mfma_f32_16x16x32_bf16 v[80:83], a[204:207], a[172:175], v[80:83]
    v_mfma_f32_16x16x32_bf16 v[84:87], a[208:211], a[160:163], 0
    v_mfma_f32_16x16x32_bf16 v[84:87], a[212:215], a[164:167], v[84:87]
    v_mfma_f32_16x16x32_bf16 v[84:87], a[216:219], a[168:171], v[84:87]
    v_mfma_f32_16x16x32_bf16 v[84:87], a[220:223], a[172:175], v[84:87]
    s_nop 3
    v_max3_f32 v206, v80, v81, v82
    s_nop 2
    v_max3_f32 v206, v206, v83, v84
    v_max3_f32 v206, v206, v85, v86
    v_max_f32 v206, v206, v87
    v_mov_b32 v208, v206
    s_nop 1
    v_permlane16_swap_b32 v206, v208
    s_nop 1
    v_max_f32 v206, v206, v208
    v_mov_b32 v208, v206
    s_nop 1
    v_permlane32_swap_b32 v206, v208
    s_nop 1
    v_max_f32 v206, v206, v208
    v_add_f32 v206, 0x42400000, v206
    v_sub_f32 v80, v80, v206
    v_sub_f32 v81, v81, v206
    v_sub_f32 v82, v82, v206
    v_sub_f32 v83, v83, v206
    v_sub_f32 v84, v84, v206
    v_sub_f32 v85, v85, v206
    v_sub_f32 v86, v86, v206
    v_sub_f32 v87, v87, v206
    s_add_u32 s5, s5, 0x20000
    s_and_b32 s5, s5, 0xfffff
    s_lshr_b32 s6, s5, 1
    s_lshr_b32 s7, s5, 6
    s_add_u32 s77, s77, 0x20000
    s_and_b32 s77, s77, 0xfffff
    s_lshr_b32 s78, s77, 6
    buffer_load_dwordx4 v[16:19], v8, s[28:31], s5 offen offset:0
    buffer_load_dwordx4 v[20:23], v8, s[28:31], s5 offen offset:16
    buffer_load_dwordx4 v[24:27], v8, s[28:31], s5 offen offset:256
    buffer_load_dwordx4 v[28:31], v8, s[28:31], s5 offen offset:272
    buffer_load_dwordx2 v[200:201], v10, s[32:35], s7 offen
    buffer_load_dwordx2 v[202:203], v10, s[36:39], s7 offen
    buffer_load_dwordx4 v[48:51], v9, s[40:43], s6 offen offset:0
    buffer_load_dwordx4 v[56:59], v9, s[44:47], s6 offen offset:0
    s_add_u32 s5, s5, 0x20000
    s_and_b32 s5, s5, 0xfffff
    s_lshr_b32 s6, s5, 1
    s_lshr_b32 s7, s5, 6
    s_waitcnt vmcnt(12)
    v_perm_b32 v192, v116, v112, s3
    v_perm_b32 v193, v116, v112, s4
    v_perm_b32 v194, v180, v176, s3
    v_perm_b32 v195, v180, v176, s4
    v_perm_b32 v196, v176, v180, s3
    v_perm_b32 v197, v176, v180, s4
    v_dot2_f32_bf16 v176, v192, v194, 0 neg_hi:[1,0,0]
    v_dot2_f32_bf16 v180, v193, v195, 0 neg_hi:[1,0,0]
    v_dot2_f32_bf16 v112, v192, v196, 0
    v_dot2_f32_bf16 v116, v193, v197, 0
    v_perm_b32 v192, v117, v113, s3
    v_perm_b32 v193, v117, v113, s4
    v_perm_b32 v194, v181, v177, s3
    v_perm_b32 v195, v181, v177, s4
    v_perm_b32 v196, v177, v181, s3
    v_perm_b32 v197, v177, v181, s4
    v_dot2_f32_bf16 v177, v192, v194, 0 neg_hi:[1,0,0]
    v_dot2_f32_bf16 v181, v193, v195, 0 neg_hi:[1,0,0]
    v_dot2_f32_bf16 v113, v192, v196, 0
L_stop_first1:
L_stop1:
    s_cbranch_execz L_stop5
    v_dot2_f32_bf16 v117, v193, v197, 0
    v_perm_b32 v192, v118, v114, s3
    v_perm_b32 v193, v118, v114, s4
    v_perm_b32 v194, v182, v178, s3
    v_perm_b32 v195, v182, v178, s4
    v_perm_b32 v196, v178, v182, s3
    v_perm_b32 v197, v178, v182, s4
    v_dot2_f32_bf16 v178, v192, v194, 0 neg_hi:[1,0,0]
    v_dot2_f32_bf16 v182, v193, v195, 0 neg_hi:[1,0,0]
    v_dot2_f32_bf16 v114, v192, v196, 0
    v_dot2_f32_bf16 v118, v193, v197, 0
    v_perm_b32 v192, v119, v115, s3
    v_perm_b32 v193, v119, v115, s4
    v_perm_b32 v194, v183, v179, s3
    v_perm_b32 v195, v183, v179, s4
    v_perm_b32 v196, v179, v183, s3
    v_perm_b32 v197, v179, v183, s4
    v_dot2_f32_bf16 v179, v192, v194, 0 neg_hi:[1,0,0]
    v_dot2_f32_bf16 v183, v193, v195, 0 neg_hi:[1,0,0]
    v_dot2_f32_bf16 v115, v192, v196, 0
    v_dot2_f32_bf16 v119, v193, v197, 0
    v_cvt_pk_bf16_f32 v244, v176, v180
    v_cvt_pk_bf16_f32 v246, v112, v116
    v_cvt_pk_bf16_f32 v245, v177, v181
    v_cvt_pk_bf16_f32 v247, v113, v117
    v_cvt_pk_bf16_f32 v248, v178, v182
    v_cvt_pk_bf16_f32 v250, v114, v118
    v_cvt_pk_bf16_f32 v249, v179, v183
    v_cvt_pk_bf16_f32 v251, v115, v119
    ds_write_b128 v253, v[244:247] offset:12288
    ds_write_b128 v253, v[248:251] offset:13312
    v_perm_b32 v192, v124, v120, s3
    v_perm_b32 v193, v124, v120, s4
    v_perm_b32 v194, v188, v184, s3
    v_perm_b32 v195, v188, v184, s4
    v_perm_b32 v196, v184, v188, s3
    v_perm_b32 v197, v184, v188, s4
    v_dot2_f32_bf16 v184, v192, v194, 0 neg_hi:[1,0,0]
    v_dot2_f32_bf16 v188, v193, v195, 0 neg_hi:[1,0,0]
    v_dot2_f32_bf16 v120, v192, v196, 0
    v_dot2_f32_bf16 v124, v193, v197, 0
    v_perm_b32 v192, v125, v121, s3
    v_perm_b32 v193, v125, v121, s4
    v_perm_b32 v194, v189, v185, s3
    v_perm_b32 v195, v189, v185, s4
    v_perm_b32 v196, v185, v189, s3
    v_perm_b32 v197, v185, v189, s4
    v_dot2_f32_bf16 v185, v192, v194, 0 neg_hi:[1,0,0]
    v_dot2_f32_bf16 v189, v193, v195, 0 neg_hi:[1,0,0]
    v_dot2_f32_bf16 v121, v192, v196, 0
    v_dot2_f32_bf16 v125, v193, v197, 0
    v_perm_b32 v192, v126, v122, s3
    v_perm_b32 v193, v126, v122, s4
    v_perm_b32 v194, v190, v186, s3
    v_perm_b32 v195, v190, v186, s4
    v_perm_b32 v196, v186, v190, s3
    v_perm_b32 v197, v186, v190, s4
    v_dot2_f32_bf16 v186, v192, v194, 0 neg_hi:[1,0,0]
    v_dot2_f32_bf16 v190, v193, v195, 0 neg_hi:[1,0,0]
    v_dot2_f32_bf16 v122, v192, v196, 0
    v_dot2_f32_bf16 v126, v193, v197, 0
    v_perm_b32 v192, v127, v123, s3
    v_perm_b32 v193, v127, v123, s4
    v_perm_b32 v194, v191, v187, s3
    v_perm_b32 v195, v191, v187, s4
    v_perm_b32 v196, v187, v191, s3
    v_perm_b32 v197, v187, v191, s4
    v_dot2_f32_bf16 v187, v192, v194, 0 neg_hi:[1,0,0]
    v_dot2_f32_bf16 v191, v193, v195, 0 neg_hi:[1,0,0]
    v_dot2_f32_bf16 v123, v192, v196, 0
    v_dot2_f32_bf16 v127, v193, v197, 0
    v_cvt_pk_bf16_f32 v244, v184, v188
    v_cvt_pk_bf16_f32 v246, v120, v124
    v_cvt_pk_bf16_f32 v245, v185, v189
    v_cvt_pk_bf16_f32 v247, v121, v125
    v_cvt_pk_bf16_f32 v248, v186, v190
    v_cvt_pk_bf16_f32 v250, v122, v126
    v_cvt_pk_bf16_f32 v249, v187, v191
    v_cvt_pk_bf16_f32 v251, v123, v127
    ds_write_b128 v253, v[244:247] offset:14336
    ds_write_b128 v253, v[248:251] offset:15360
    ds_read_b128 a[176:179], v254 offset:12288
    ds_read_b128 a[180:183], v254 offset:13312
    ds_read_b128 a[184:187], v254 offset:14336
    ds_read_b128 a[188:191], v254 offset:15360
    s_waitcnt lgkmcnt(0)
    v_mfma_f32_16x16x32_bf16 v[88:91], a[192:195], a[176:179], 0
    v_mfma_f32_16x16x32_bf16 v[88:91], a[196:199], a[180:183], v[88:91]
    v_mfma_f32_16x16x32_bf16 v[88:91], a[200:203], a[184:187], v[88:91]
    v_mfma_f32_16x16x32_bf16 v[88:91], a[204:207], a[188:191], v[88:91]
    v_mfma_f32_16x16x32_bf16 v[92:95], a[208:211], a[176:179], 0
    v_mfma_f32_16x16x32_bf16 v[92:95], a[212:215], a[180:183], v[92:95]
    v_mfma_f32_16x16x32_bf16 v[92:95], a[216:219], a[184:187], v[92:95]
    v_mfma_f32_16x16x32_bf16 v[92:95], a[220:223], a[188:191], v[92:95]
    s_waitcnt vmcnt(20)
    s_barrier
    ds_read_b128 a[192:195], v252 offset:8192
    ds_read_b128 a[196:199], v252 offset:9216
    ds_read_b128 a[200:203], v252 offset:10240
    ds_read_b128 a[204:207], v252 offset:11264
    ds_read_b128 a[208:211], v252 offset:12288
    ds_read_b128 a[212:215], v252 offset:13312
    ds_read_b128 a[216:219], v252 offset:14336
    ds_read_b128 a[220:223], v252 offset:15360
    v_mov_b32 v196, 0
    v_mov_b32 v197, 0
    v_mov_b32 v198, 0
    v_mov_b32 v199, 0
    v_mov_b32 v246, 0x3f803f80
    s_mov_b32 vcc_lo, 0x11111111
    s_mov_b32 vcc_hi, 0x11221122
    s_nop 1
    v_cndmask_b32 v144, 0, v246, vcc
    v_cndmask_b32 v145, 0, v246, vcc
    v_cndmask_b32 v146, 0, v246, vcc
    v_cndmask_b32 v147, 0, v246, vcc
    s_mov_b32 vcc_lo, 0x11441144
    s_mov_b32 vcc_hi, 0x11881188
    s_nop 1
    v_cndmask_b32 v148, 0, v246, vcc
    v_cndmask_b32 v149, 0, v246, vcc
    v_cndmask_b32 v150, 0, v246, vcc
    v_cndmask_b32 v151, 0, v246, vcc
    s_mov_b32 vcc_lo, 0xf0f0f0f0
    s_mov_b32 vcc_hi, 0xf0f0f0f0
    v_mov_b32 v244, 0x4444
    v_mov_b32 v245, 0xeeee
    v_cndmask_b32 v255, v244, v245, vcc
    v_max3_f32 v207, v88, v89, v90
    v_max3_f32 v207, v207, v91, v92
    v_max3_f32 v207, v207, v93, v94
    v_max_f32 v207, v207, v95
    v_mov_b32 v208, v207
    s_nop 1
    v_permlane16_swap_b32 v207, v208
    s_nop 1
    v_max_f32 v207, v207, v208
    v_mov_b32 v208, v207
    s_nop 1
    v_permlane32_swap_b32 v207, v208
    s_nop 1
    v_max_f32 v207, v207, v208
    v_add_f32 v207, 0x42400000, v207
    v_sub_f32 v88, v88, v207
    v_sub_f32 v89, v89, v207
    v_sub_f32 v90, v90, v207
    v_sub_f32 v91, v91, v207
    v_sub_f32 v92, v92, v207
    v_sub_f32 v93, v93, v207
    v_sub_f32 v94, v94, v207
    v_sub_f32 v95, v95, v207
    v_sub_f32 v128, 0, v204
    v_sub_f32 v129, 0, v204
    v_sub_f32 v130, 0, v204
    v_sub_f32 v131, 0, v204
    v_sub_f32 v132, 0, v205
    v_sub_f32 v133, 0, v205
    v_sub_f32 v134, 0, v205
    v_sub_f32 v135, 0, v205
    v_sub_f32 v136, 0, v206
    v_sub_f32 v137, 0, v206
    v_sub_f32 v138, 0, v206
    v_sub_f32 v139, 0, v206
    v_sub_f32 v140, 0, v207
    v_sub_f32 v141, 0, v207
    v_sub_f32 v142, 0, v207
    v_sub_f32 v143, 0, v207
    s_waitcnt vmcnt(16) lgkmcnt(0)
    s_barrier
    v_bfe_u32 v244, v1, 6, 2
    v_lshl_add_u32 v14, v244, 10, v1
    v_xor_b32 v253, 64, v14
    v_xor_b32 v254, 128, v14
    v_xor_b32 v234, 192, v14
    s_cmp_eq_u32 s96, 2
    s_cselect_b32 s13, s76, 0
    s_cselect_b32 s76, 0, s76
    v_mfma_f32_16x16x32_bf16 v[96:99], a[192:195], a[128:131], v[128:131]
    v_exp_f32 v244, v64
    v_mfma_f32_16x16x32_bf16 v[96:99], a[196:199], a[132:135], v[96:99]
    buffer_load_ushort v232, v12, s[52:55], s78 offen
    v_mfma_f32_16x16x32_bf16 v[96:99], a[200:203], a[136:139], v[96:99]
    v_exp_f32 v245, v65
    v_mfma_f32_16x16x32_bf16 v[96:99], a[204:207], a[140:143], v[96:99]
    buffer_load_ushort v233, v12, s[56:59], s78 offen
    v_perm_b32 v160, v245, v244, s4
    v_mfma_f32_16x16x32_bf16 v[104:107], a[204:207], a[156:159], v[132:135]
    v_exp_f32 v246, v66
    v_mfma_f32_16x16x32_bf16 v[104:107], a[200:203], a[152:155], v[104:107]
    buffer_load_dwordx2 v[216:217], v11, s[48:51], s77 offen offset:0
    v_mfma_f32_16x16x32_bf16 v[104:107], a[196:199], a[148:151], v[104:107]
    v_exp_f32 v247, v67
    v_mfma_f32_16x16x32_bf16 v[104:107], a[192:195], a[144:147], v[104:107]
    buffer_load_dwordx2 v[218:219], v11, s[48:51], s77 offen offset:512
    v_perm_b32 v161, v247, v246, s4
    v_mfma_f32_16x16x32_bf16 v[112:115], a[192:195], a[160:163], v[136:139]
    v_exp_f32 v248, v68
    v_mfma_f32_16x16x32_bf16 v[112:115], a[196:199], a[164:167], v[112:115]
    buffer_load_dwordx2 v[224:225], v11, s[48:51], s77 offen offset:1024
    v_mfma_f32_16x16x32_bf16 v[112:115], a[200:203], a[168:171], v[112:115]
    v_exp_f32 v249, v69
    v_mfma_f32_16x16x32_bf16 v[112:115], a[204:207], a[172:175], v[112:115]
    buffer_load_dwordx2 v[226:227], v11, s[48:51], s77 offen offset:1536
    v_perm_b32 v162, v249, v248, s4
    v_mfma_f32_16x16x32_bf16 v[120:123], a[204:207], a[188:191], v[140:143]
    v_exp_f32 v250, v70
    v_mfma_f32_16x16x32_bf16 v[120:123], a[200:203], a[184:187], v[120:123]
    buffer_load_dwordx2 v[220:221], v11, s[48:51], s77 offen offset:2048
    s_add_u32 m0, s73, 8192
    v_mfma_f32_16x16x32_bf16 v[120:123], a[196:199], a[180:183], v[120:123]
    v_exp_f32 v251, v71
    v_mfma_f32_16x16x32_bf16 v[120:123], a[192:195], a[176:179], v[120:123]
    buffer_load_dwordx2 v[222:223], v11, s[48:51], s77 offen offset:2560
    v_perm_b32 v163, v251, v250, s4
    v_mfma_f32_16x16x32_bf16 v[124:127], a[208:211], a[176:179], v[140:143]
    v_exp_f32 v244, v72
    v_mfma_f32_16x16x32_bf16 v[124:127], a[212:215], a[180:183], v[124:127]
    buffer_load_dwordx4 v2, s[24:27], s64 offen offset:0 sc1 lds
    v_mfma_f32_16x16x32_bf16 v[124:127], a[216:219], a[184:187], v[124:127]
    v_exp_f32 v245, v73
    v_mfma_f32_16x16x32_bf16 v[124:127], a[220:223], a[188:191], v[124:127]
    ds_read_b128 a[192:195], v252 offset:16384
    v_perm_b32 v164, v245, v244, s4
    v_mfma_f32_16x16x32_bf16 v[116:119], a[220:223], a[172:175], v[136:139]
    v_exp_f32 v246, v74
    v_mfma_f32_16x16x32_bf16 v[116:119], a[216:219], a[168:171], v[116:119]
    buffer_load_dwordx4 v2, s[24:27], s64 offen offset:1024 sc1 lds
    v_mfma_f32_16x16x32_bf16 v[116:119], a[212:215], a[164:167], v[116:119]
    v_exp_f32 v247, v75
    v_mfma_f32_16x16x32_bf16 v[116:119], a[208:211], a[160:163], v[116:119]
    ds_read_b128 a[196:199], v252 offset:17408
    v_perm_b32 v165, v247, v246, s4
    v_mfma_f32_16x16x32_bf16 v[108:111], a[208:211], a[144:147], v[132:135]
    v_exp_f32 v248, v76
    v_mfma_f32_16x16x32_bf16 v[108:111], a[212:215], a[148:151], v[108:111]
    buffer_load_dwordx4 v2, s[24:27], s64 offen offset:2048 sc1 lds
    v_mfma_f32_16x16x32_bf16 v[108:111], a[216:219], a[152:155], v[108:111]
    v_exp_f32 v249, v77
    v_mfma_f32_16x16x32_bf16 v[108:111], a[220:223], a[156:159], v[108:111]
    ds_read_b128 a[200:203], v252 offset:18432
    v_perm_b32 v166, v249, v248, s4
    v_mfma_f32_16x16x32_bf16 v[100:103], a[220:223], a[140:143], v[128:131]
    v_exp_f32 v250, v78
    v_mfma_f32_16x16x32_bf16 v[100:103], a[216:219], a[136:139], v[100:103]
    buffer_load_dwordx4 v2, s[24:27], s64 offen offset:3072 sc1 lds
    v_mfma_f32_16x16x32_bf16 v[100:103], a[212:215], a[132:135], v[100:103]
    v_exp_f32 v251, v79
    v_mfma_f32_16x16x32_bf16 v[100:103], a[208:211], a[128:131], v[100:103]
    ds_read_b128 a[204:207], v252 offset:19456
    v_perm_b32 v167, v251, v250, s4
    v_exp_f32 v244, v80
    ds_read_b128 a[208:211], v252 offset:20480
    buffer_load_dwordx2 v[228:229], v11, s[48:51], s77 offen offset:3072
    v_exp_f32 v245, v81
    s_waitcnt vmcnt(17)
    v_cvt_f32_i32 v32, v16
    v_cvt_f32_i32 v33, v17
    v_cvt_f32_i32 v34, v18
    v_cvt_f32_i32 v35, v19
    ds_read_b128 a[212:215], v252 offset:21504
    ds_read_b128 a[216:219], v252 offset:22528
    buffer_load_dwordx2 v[230:231], v11, s[48:51], s77 offen offset:3584
    s_add_u32 s77, s77, 0x20000
    s_and_b32 s77, s77, 0xfffff
    s_lshr_b32 s78, s77, 6
    v_cvt_f32_i32 v36, v20
    v_exp_f32 v246, v82
    v_cvt_f32_i32 v37, v21
    v_cvt_f32_i32 v38, v22
    v_cvt_f32_i32 v39, v23
    v_cvt_f32_i32 v40, v24
    v_cvt_f32_i32 v41, v25
    v_exp_f32 v247, v83
    v_cvt_f32_i32 v42, v26
    v_cvt_f32_i32 v43, v27
    v_cvt_f32_i32 v44, v28
    v_cvt_f32_i32 v45, v29
    v_cvt_f32_i32 v46, v30
    ds_read_b128 a[220:223], v252 offset:23552
    v_mov_b64 v[192:193], v[196:197]
    v_cvt_f32_i32 v47, v31
    s_waitcnt vmcnt(14)
    v_perm_b32 v200, v200, v200, s87
    v_perm_b32 v201, v201, v201, s87
    v_perm_b32 v202, v202, v202, s87
    v_exp_f32 v248, v84
    v_perm_b32 v203, v203, v203, s87
    v_mul_f32 v200, s85, v200
    v_mul_f32 v201, s85, v201
    v_mul_f32_e64 v202, -v202, v200
    v_mul_f32_e64 v203, -v203, v201
    v_exp_f32 v249, v85
    v_fma_f32 v32, v32, v200, v202
    v_fma_f32 v40, v40, v201, v203
    v_lshlrev_b32 v212, 16, v48
    v_lshlrev_b32 v214, 16, v56
    v_fma_f32 v204, v32, v212, s62
    v_perm_b32 v169, v247, v246, s4
    v_perm_b32 v168, v245, v244, s4
    v_fma_f32 v208, v40, v212, s62
    v_fma_f32 v204, -v40, v214, v204
    v_fma_f32 v208, v32, v214, v208
    v_fma_f32 v33, v33, v200, v202
    v_fma_f32 v41, v41, v201, v203
    v_exp_f32 v250, v86
    v_and_b32 v212, s86, v48
    v_and_b32 v214, s86, v56
    v_fma_f32 v205, v33, v212, s62
    v_fma_f32 v209, v41, v212, s62
    v_fma_f32 v205, -v41, v214, v205
    v_exp_f32 v251, v87
    v_fma_f32 v209, v33, v214, v209
    v_fma_f32 v34, v34, v200, v202
    v_fma_f32 v42, v42, v201, v203
    v_lshlrev_b32 v212, 16, v49
    v_lshlrev_b32 v214, 16, v57
    v_perm_b32 v171, v251, v250, s4
    v_perm_b32 v170, v249, v248, s4
    v_fma_f32 v206, v34, v212, s62
    v_fma_f32 v210, v42, v212, s62
    v_fma_f32 v206, -v42, v214, v206
    v_fma_f32 v210, v34, v214, v210
    v_fma_f32 v35, v35, v200, v202
    v_exp_f32 v244, v88
    v_fma_f32 v43, v43, v201, v203
    v_and_b32 v212, s86, v49
    v_and_b32 v214, s86, v57
    v_fma_f32 v207, v35, v212, s62
    v_fma_f32 v211, v43, v212, s62
    v_exp_f32 v245, v89
    v_fma_f32 v207, -v43, v214, v207
    v_fma_f32 v211, v35, v214, v211
    v_cvt_pk_bf16_f32 v32, v204, v205
    v_cvt_pk_bf16_f32 v33, v206, v207
    v_cvt_pk_bf16_f32 v34, v208, v209
    v_mov_b64 v[194:195], v[198:199]
    v_cvt_pk_bf16_f32 v35, v210, v211
    v_fma_f32 v36, v36, v200, v202
    v_fma_f32 v44, v44, v201, v203
    v_lshlrev_b32 v212, 16, v50
    v_lshlrev_b32 v214, 16, v58
    v_fma_f32 v204, v36, v212, s62
    v_exp_f32 v246, v90
    v_fma_f32 v208, v44, v212, s62
    v_fma_f32 v204, -v44, v214, v204
    v_fma_f32 v208, v36, v214, v208
    v_fma_f32 v37, v37, v200, v202
    v_fma_f32 v45, v45, v201, v203
    v_exp_f32 v247, v91
    v_and_b32 v212, s86, v50
    v_and_b32 v214, s86, v58
    v_fma_f32 v205, v37, v212, s62
    v_fma_f32 v209, v45, v212, s62
    v_fma_f32 v205, -v45, v214, v205
    v_perm_b32 v173, v247, v246, s4
    v_perm_b32 v172, v245, v244, s4
    v_fma_f32 v209, v37, v214, v209
    v_fma_f32 v38, v38, v200, v202
    v_fma_f32 v46, v46, v201, v203
    v_lshlrev_b32 v212, 16, v51
    v_lshlrev_b32 v214, 16, v59
    v_exp_f32 v248, v92
    v_fma_f32 v206, v38, v212, s62
    v_fma_f32 v210, v46, v212, s62
    v_fma_f32 v206, -v46, v214, v206
    v_fma_f32 v210, v38, v214, v210
    v_fma_f32 v39, v39, v200, v202
    v_exp_f32 v249, v93
    v_fma_f32 v47, v47, v201, v203
    v_and_b32 v212, s86, v51
    v_and_b32 v214, s86, v59
    v_fma_f32 v207, v39, v212, s62
    v_fma_f32 v211, v47, v212, s62
    v_perm_b32 v174, v249, v248, s4
    v_fma_f32 v207, -v47, v214, v207
    v_fma_f32 v211, v39, v214, v211
    v_cvt_pk_bf16_f32 v36, v204, v205
    v_cvt_pk_bf16_f32 v37, v206, v207
    v_cvt_pk_bf16_f32 v38, v208, v209
    v_cvt_pk_bf16_f32 v39, v210, v211
    buffer_store_dwordx4 v[32:35], v0, s[24:27], s79 offen offset:0 sc1
    v_exp_f32 v250, v94
    v_exp_f32 v251, v95
    s_nop 0
    v_perm_b32 v175, v251, v250, s4
    v_smfmac_f32_16x16x64_bf16 v[192:195], v[144:147], v[160:167], v255
    buffer_store_dwordx4 v[36:39], v0, s[24:27], s79 offen offset:1024 sc1
    s_add_u32 s79, s79, 0x200000
    v_smfmac_f32_16x16x64_bf16 v[192:195], v[148:151], v[168:175], v255
    s_waitcnt vmcnt(28) lgkmcnt(0)
    s_barrier
    s_nop 5
    v_cmp_lt_f32 vcc, s72, v192
    s_cbranch_vccnz L_rare_r0_0
L_join_r0_0:
    v_mfma_f32_16x16x32_bf16 v[64:67], a[192:195], a[128:131], v[128:131]
    v_exp_f32 v244, v96
    v_mfma_f32_16x16x32_bf16 v[64:67], a[196:199], a[132:135], v[64:67]
    ds_read_b128 a[224:227], v14 offset:57344
    v_and_b32 v213, 0x380, v1
    v_add_u32 v213, v213, v1
    v_mfma_f32_16x16x32_bf16 v[64:67], a[200:203], a[136:139], v[64:67]
    v_exp_f32 v245, v97
    v_mfma_f32_16x16x32_bf16 v[64:67], a[204:207], a[140:143], v[64:67]
    ds_read_b128 a[228:231], v253 offset:57344
    v_perm_b32 v176, v245, v244, s4
    v_mfma_f32_16x16x32_bf16 v[72:75], a[204:207], a[156:159], v[132:135]
    v_exp_f32 v246, v98
    v_mfma_f32_16x16x32_bf16 v[72:75], a[200:203], a[152:155], v[72:75]
    ds_read_b128 a[232:235], v254 offset:57344
    s_lshl_b32 s14, s2, 11
    v_mfma_f32_16x16x32_bf16 v[72:75], a[196:199], a[148:151], v[72:75]
    v_exp_f32 v247, v99
    v_mfma_f32_16x16x32_bf16 v[72:75], a[192:195], a[144:147], v[72:75]
    ds_read_b128 a[236:239], v234 offset:57344
    v_perm_b32 v177, v247, v246, s4
    v_mfma_f32_16x16x32_bf16 v[80:83], a[192:195], a[160:163], v[136:139]
    v_exp_f32 v248, v100
    v_mfma_f32_16x16x32_bf16 v[80:83], a[196:199], a[164:167], v[80:83]
    ds_read_b128 a[240:243], v14 offset:61440
    buffer_load_dwordx4 v[52:55], v213, s[16:19], s14 offen offset:0
    v_mfma_f32_16x16x32_bf16 v[80:83], a[200:203], a[168:171], v[80:83]
    v_exp_f32 v249, v101
    v_mfma_f32_16x16x32_bf16 v[80:83], a[204:207], a[172:175], v[80:83]
    ds_read_b128 a[244:247], v253 offset:61440
    v_perm_b32 v178, v249, v248, s4
    v_mfma_f32_16x16x32_bf16 v[88:91], a[204:207], a[188:191], v[140:143]
    v_exp_f32 v250, v102
    v_mfma_f32_16x16x32_bf16 v[88:91], a[200:203], a[184:187], v[88:91]
    ds_read_b128 a[248:251], v254 offset:61440
    s_add_u32 m0, s73, 16384
    v_mfma_f32_16x16x32_bf16 v[88:91], a[196:199], a[180:183], v[88:91]
    v_exp_f32 v251, v103
    v_mfma_f32_16x16x32_bf16 v[88:91], a[192:195], a[176:179], v[88:91]
    ds_read_b128 a[252:255], v234 offset:61440
    v_perm_b32 v179, v251, v250, s4
    v_mfma_f32_16x16x32_bf16 v[92:95], a[208:211], a[176:179], v[140:143]
    v_exp_f32 v244, v104
    v_mfma_f32_16x16x32_bf16 v[92:95], a[212:215], a[180:183], v[92:95]
    buffer_load_dwordx4 v2, s[24:27], s65 offen offset:0 sc1 lds
    v_mfma_f32_16x16x32_bf16 v[92:95], a[216:219], a[184:187], v[92:95]
    v_exp_f32 v245, v105
    v_mfma_f32_16x16x32_bf16 v[92:95], a[220:223], a[188:191], v[92:95]
    ds_read_b128 a[192:195], v252 offset:24576
    v_perm_b32 v180, v245, v244, s4
    v_mfma_f32_16x16x32_bf16 v[84:87], a[220:223], a[172:175], v[136:139]
    v_exp_f32 v246, v106
    v_mfma_f32_16x16x32_bf16 v[84:87], a[216:219], a[168:171], v[84:87]
    buffer_load_dwordx4 v2, s[24:27], s65 offen offset:1024 sc1 lds
    v_mfma_f32_16x16x32_bf16 v[84:87], a[212:215], a[164:167], v[84:87]
    v_exp_f32 v247, v107
    v_mfma_f32_16x16x32_bf16 v[84:87], a[208:211], a[160:163], v[84:87]
    ds_read_b128 a[196:199], v252 offset:25600
    v_perm_b32 v181, v247, v246, s4
    v_mfma_f32_16x16x32_bf16 v[76:79], a[208:211], a[144:147], v[132:135]
    v_exp_f32 v248, v108
    v_mfma_f32_16x16x32_bf16 v[76:79], a[212:215], a[148:151], v[76:79]
    buffer_load_dwordx4 v2, s[24:27], s65 offen offset:2048 sc1 lds
    v_mfma_f32_16x16x32_bf16 v[76:79], a[216:219], a[152:155], v[76:79]
    v_exp_f32 v249, v109
    v_mfma_f32_16x16x32_bf16 v[76:79], a[220:223], a[156:159], v[76:79]
    ds_read_b128 a[200:203], v252 offset:26624
    v_perm_b32 v182, v249, v248, s4
    v_mfma_f32_16x16x32_bf16 v[68:71], a[220:223], a[140:143], v[128:131]
    v_exp_f32 v250, v110
    v_mfma_f32_16x16x32_bf16 v[68:71], a[216:219], a[136:139], v[68:71]
    buffer_load_dwordx4 v2, s[24:27], s65 offen offset:3072 sc1 lds
    s_waitcnt lgkmcnt(3)
    v_mfma_f32_16x16x32_bf16 v[68:71], a[212:215], a[132:135], v[68:71]
    v_exp_f32 v251, v111
    v_mfma_f32_16x16x32_bf16 v[68:71], a[208:211], a[128:131], v[68:71]
    ds_read_b128 a[204:207], v252 offset:27648
    v_perm_b32 v183, v251, v250, s4
    v_exp_f32 v244, v112
    v_mfma_f32_16x16x32_bf16 a[80:83], v[168:171], a[240:243], a[80:83]
    ds_read_b128 a[208:211], v252 offset:28672
    buffer_load_dwordx4 v[60:63], v213, s[16:19], s14 offen offset:128
    v_mfma_f32_16x16x32_bf16 a[84:87], v[168:171], a[244:247], a[84:87]
    v_exp_f32 v245, v113
    ds_read_b128 a[212:215], v252 offset:29696
    ds_read_b128 a[216:219], v252 offset:30720
    v_exp_f32 v246, v114
    v_mfma_f32_16x16x32_bf16 a[88:91], v[168:171], a[248:251], a[88:91]
    v_exp_f32 v247, v115
    v_mfma_f32_16x16x32_bf16 a[92:95], v[168:171], a[252:255], a[92:95]
    ds_read_b128 a[220:223], v252 offset:31744
    v_mov_b64 v[196:197], v[192:193]
    v_exp_f32 v248, v116
    v_exp_f32 v249, v117
    v_mfma_f32_16x16x32_bf16 a[124:127], v[172:175], a[252:255], a[124:127]
    v_perm_b32 v185, v247, v246, s4
    v_perm_b32 v184, v245, v244, s4
    v_mfma_f32_16x16x32_bf16 a[120:123], v[172:175], a[248:251], a[120:123]
    v_exp_f32 v250, v118
    v_exp_f32 v251, v119
    s_nop 0
    v_perm_b32 v187, v251, v250, s4
    v_perm_b32 v186, v249, v248, s4
    v_mfma_f32_16x16x32_bf16 a[116:119], v[172:175], a[244:247], a[116:119]
    v_exp_f32 v244, v120
    v_mfma_f32_16x16x32_bf16 a[112:115], v[172:175], a[240:243], a[112:115]
    v_exp_f32 v245, v121
    v_mov_b64 v[198:199], v[194:195]
    v_exp_f32 v246, v122
    v_mfma_f32_16x16x32_bf16 a[16:19], v[160:163], a[240:243], a[16:19]
    v_exp_f32 v247, v123
    v_mfma_f32_16x16x32_bf16 a[20:23], v[160:163], a[244:247], a[20:23]
    v_perm_b32 v189, v247, v246, s4
    v_perm_b32 v188, v245, v244, s4
    v_exp_f32 v248, v124
    v_exp_f32 v249, v125
    v_mfma_f32_16x16x32_bf16 a[24:27], v[160:163], a[248:251], a[24:27]
    v_perm_b32 v190, v249, v248, s4
    v_mfma_f32_16x16x32_bf16 a[28:31], v[160:163], a[252:255], a[28:31]
    v_exp_f32 v250, v126
    v_exp_f32 v251, v127
    s_nop 0
    v_perm_b32 v191, v251, v250, s4
    v_mfma_f32_16x16x32_bf16 a[60:63], v[164:167], a[252:255], a[60:63]
    v_smfmac_f32_16x16x64_bf16 v[196:199], v[144:147], v[176:183], v255
    v_smfmac_f32_16x16x64_bf16 v[196:199], v[148:151], v[184:191], v255
    v_mfma_f32_16x16x32_bf16 a[56:59], v[164:167], a[248:251], a[56:59]
    s_waitcnt vmcnt(6) lgkmcnt(0)
    s_barrier
    v_mfma_f32_16x16x32_bf16 a[52:55], v[164:167], a[244:247], a[52:55]
    v_mfma_f32_16x16x32_bf16 a[48:51], v[164:167], a[240:243], a[48:51]
    s_nop 2
    v_cmp_lt_f32 vcc, s72, v196
    s_cbranch_vccnz L_rare_r0_1
L_join_r0_1:
    v_mfma_f32_16x16x32_bf16 v[96:99], a[192:195], a[128:131], v[128:131]
    v_exp_f32 v244, v64
    v_mfma_f32_16x16x32_bf16 v[96:99], a[196:199], a[132:135], v[96:99]
    ds_read_b128 a[224:227], v14 offset:32768
    buffer_store_dwordx2 v[4:5], v13, s[24:27], s81 offen sc1
    s_add_u32 s81, s81, 512
    v_mfma_f32_16x16x32_bf16 v[96:99], a[200:203], a[136:139], v[96:99]
    v_exp_f32 v245, v65
    v_mfma_f32_16x16x32_bf16 v[96:99], a[204:207], a[140:143], v[96:99]
    ds_read_b128 a[228:231], v253 offset:32768
    v_perm_b32 v152, v245, v244, s4
    v_mfma_f32_16x16x32_bf16 v[104:107], a[204:207], a[156:159], v[132:135]
    v_exp_f32 v246, v66
    s_waitcnt vmcnt(9)
    v_mfma_f32_16x16x32_bf16 v[104:107], a[200:203], a[152:155], v[104:107]
    ds_read_b128 a[232:235], v254 offset:32768
    v_lshlrev_b32 v232, 16, v232
    v_mfma_f32_16x16x32_bf16 v[104:107], a[196:199], a[148:151], v[104:107]
    v_exp_f32 v247, v67
    v_mfma_f32_16x16x32_bf16 v[104:107], a[192:195], a[144:147], v[104:107]
    ds_read_b128 a[236:239], v234 offset:32768
    v_perm_b32 v153, v247, v246, s4
    v_lshlrev_b32 v233, 16, v233
    v_mfma_f32_16x16x32_bf16 v[112:115], a[192:195], a[160:163], v[136:139]
    v_exp_f32 v248, v68
    v_mfma_f32_16x16x32_bf16 v[112:115], a[196:199], a[164:167], v[112:115]
    ds_read_b128 a[240:243], v14 offset:36864
    v_fma_f32 v233, v233, v232, -s63
    v_mfma_f32_16x16x32_bf16 v[112:115], a[200:203], a[168:171], v[112:115]
    v_exp_f32 v249, v69
    v_cvt_f32_i32 v216, v216
    v_mfma_f32_16x16x32_bf16 v[112:115], a[204:207], a[172:175], v[112:115]
    ds_read_b128 a[244:247], v253 offset:36864
    v_perm_b32 v154, v249, v248, s4
    v_mfma_f32_16x16x32_bf16 v[120:123], a[204:207], a[188:191], v[140:143]
    v_exp_f32 v250, v70
    v_mfma_f32_16x16x32_bf16 v[120:123], a[200:203], a[184:187], v[120:123]
    ds_read_b128 a[248:251], v254 offset:36864
    s_add_u32 m0, s73, 24576
    v_cvt_f32_i32 v217, v217
    v_mfma_f32_16x16x32_bf16 v[120:123], a[196:199], a[180:183], v[120:123]
    v_exp_f32 v251, v71
    v_mfma_f32_16x16x32_bf16 v[120:123], a[192:195], a[176:179], v[120:123]
    ds_read_b128 a[252:255], v234 offset:36864
    v_perm_b32 v155, v251, v250, s4
    v_mfma_f32_16x16x32_bf16 v[124:127], a[208:211], a[176:179], v[140:143]
    v_exp_f32 v244, v72
    v_mul_f32_dpp v216, v232, v216 row_newbcast:0 row_mask:0xf bank_mask:0xf
    v_mfma_f32_16x16x32_bf16 v[124:127], a[212:215], a[180:183], v[124:127]
    buffer_load_dwordx4 v2, s[24:27], s66 offen offset:0 sc1 lds
    v_mul_f32_dpp v217, v232, v217 row_newbcast:0 row_mask:0xf bank_mask:0xf
    v_mfma_f32_16x16x32_bf16 v[124:127], a[216:219], a[184:187], v[124:127]
    v_exp_f32 v245, v73
    v_mfma_f32_16x16x32_bf16 v[124:127], a[220:223], a[188:191], v[124:127]
    ds_read_b128 a[192:195], v252 offset:0
    v_perm_b32 v156, v245, v244, s4
    v_subrev_f32_dpp v216, v233, v216 row_newbcast:0 row_mask:0xf bank_mask:0xf
    v_mfma_f32_16x16x32_bf16 v[116:119], a[220:223], a[172:175], v[136:139]
    v_exp_f32 v246, v74
    v_mfma_f32_16x16x32_bf16 v[116:119], a[216:219], a[168:171], v[116:119]
    buffer_load_dwordx4 v2, s[24:27], s66 offen offset:1024 sc1 lds
    v_subrev_f32_dpp v217, v233, v217 row_newbcast:0 row_mask:0xf bank_mask:0xf
    v_mfma_f32_16x16x32_bf16 v[116:119], a[212:215], a[164:167], v[116:119]
    v_exp_f32 v247, v75
    v_cvt_f32_i32 v218, v218
    v_mfma_f32_16x16x32_bf16 v[116:119], a[208:211], a[160:163], v[116:119]
    ds_read_b128 a[196:199], v252 offset:1024
    v_perm_b32 v157, v247, v246, s4
    v_mfma_f32_16x16x32_bf16 v[108:111], a[208:211], a[144:147], v[132:135]
    v_exp_f32 v248, v76
    v_mfma_f32_16x16x32_bf16 v[108:111], a[212:215], a[148:151], v[108:111]
    buffer_load_dwordx4 v2, s[24:27], s66 offen offset:2048 sc1 lds
    v_cvt_f32_i32 v219, v219
    v_mul_f32_dpp v218, v232, v218 row_newbcast:1 row_mask:0xf bank_mask:0xf
    v_mfma_f32_16x16x32_bf16 v[108:111], a[216:219], a[152:155], v[108:111]
    v_exp_f32 v249, v77
    v_mfma_f32_16x16x32_bf16 v[108:111], a[220:223], a[156:159], v[108:111]
    ds_read_b128 a[200:203], v252 offset:2048
    v_perm_b32 v158, v249, v248, s4
    v_mfma_f32_16x16x32_bf16 v[100:103], a[220:223], a[140:143], v[128:131]
    v_exp_f32 v250, v78
    v_mul_f32_dpp v219, v232, v219 row_newbcast:1 row_mask:0xf bank_mask:0xf
    v_mfma_f32_16x16x32_bf16 v[100:103], a[216:219], a[136:139], v[100:103]
    buffer_load_dwordx4 v2, s[24:27], s66 offen offset:3072 sc1 lds
    s_waitcnt lgkmcnt(3)
L_stop_first2:
L_stop2:
    s_cbranch_execz L_stop6
    v_mfma_f32_16x16x32_bf16 v[100:103], a[212:215], a[132:135], v[100:103]
    v_exp_f32 v251, v79
    v_mfma_f32_16x16x32_bf16 v[100:103], a[208:211], a[128:131], v[100:103]
    ds_read_b128 a[204:207], v252 offset:3072
    v_perm_b32 v159, v251, v250, s4
    v_subrev_f32_dpp v218, v233, v218 row_newbcast:1 row_mask:0xf bank_mask:0xf
    v_mfma_f32_16x16x32_bf16 a[64:67], v[168:171], a[224:227], a[64:67]
    v_exp_f32 v244, v80
    v_mfma_f32_16x16x32_bf16 a[64:67], v[184:187], a[240:243], a[64:67]
    ds_read_b128 a[208:211], v252 offset:4096
    v_subrev_f32_dpp v219, v233, v219 row_newbcast:1 row_mask:0xf bank_mask:0xf
    v_mfma_f32_16x16x32_bf16 a[68:71], v[184:187], a[244:247], a[68:71]
    v_exp_f32 v245, v81
    v_cvt_f32_i32 v220, v220
    v_mfma_f32_16x16x32_bf16 a[68:71], v[168:171], a[228:231], a[68:71]
    ds_read_b128 a[212:215], v252 offset:5120
    ds_read_b128 a[216:219], v252 offset:6144
    v_mfma_f32_16x16x32_bf16 a[72:75], v[168:171], a[232:235], a[72:75]
    v_exp_f32 v246, v82
    v_mfma_f32_16x16x32_bf16 a[72:75], v[184:187], a[248:251], a[72:75]
    v_exp_f32 v247, v83
    v_cvt_f32_i32 v221, v221
    v_mfma_f32_16x16x32_bf16 a[76:79], v[184:187], a[252:255], a[76:79]
    ds_read_b128 a[220:223], v252 offset:7168
    v_mov_b64 v[192:193], v[196:197]
    v_mfma_f32_16x16x32_bf16 a[76:79], v[168:171], a[236:239], a[76:79]
    v_exp_f32 v248, v84
    v_mfma_f32_16x16x32_bf16 a[108:111], v[172:175], a[236:239], a[108:111]
    v_exp_f32 v249, v85
    v_mul_f32_dpp v220, v232, v220 row_newbcast:4 row_mask:0xf bank_mask:0xf
    v_mfma_f32_16x16x32_bf16 a[108:111], v[188:191], a[252:255], a[108:111]
    v_perm_b32 v169, v247, v246, s4
    v_perm_b32 v168, v245, v244, s4
    v_mfma_f32_16x16x32_bf16 a[104:107], v[188:191], a[248:251], a[104:107]
    v_exp_f32 v250, v86
    v_mfma_f32_16x16x32_bf16 a[104:107], v[172:175], a[232:235], a[104:107]
    v_exp_f32 v251, v87
    v_mul_f32_dpp v221, v232, v221 row_newbcast:4 row_mask:0xf bank_mask:0xf
    v_mfma_f32_16x16x32_bf16 a[100:103], v[172:175], a[228:231], a[100:103]
    v_perm_b32 v171, v251, v250, s4
    v_perm_b32 v170, v249, v248, s4
    v_mfma_f32_16x16x32_bf16 a[100:103], v[188:191], a[244:247], a[100:103]
    v_exp_f32 v244, v88
    v_mfma_f32_16x16x32_bf16 a[96:99], v[188:191], a[240:243], a[96:99]
    v_exp_f32 v245, v89
    v_subrev_f32_dpp v220, v233, v220 row_newbcast:4 row_mask:0xf bank_mask:0xf
    v_mfma_f32_16x16x32_bf16 a[96:99], v[172:175], a[224:227], a[96:99]
    v_mov_b64 v[194:195], v[198:199]
    v_subrev_f32_dpp v221, v233, v221 row_newbcast:4 row_mask:0xf bank_mask:0xf
    v_mfma_f32_16x16x32_bf16 a[0:3], v[160:163], a[224:227], a[0:3]
    v_exp_f32 v246, v90
    v_mfma_f32_16x16x32_bf16 a[0:3], v[176:179], a[240:243], a[0:3]
    v_exp_f32 v247, v91
    v_cvt_f32_i32 v222, v222
    v_mfma_f32_16x16x32_bf16 a[4:7], v[176:179], a[244:247], a[4:7]
    v_perm_b32 v173, v247, v246, s4
    v_perm_b32 v172, v245, v244, s4
    v_mfma_f32_16x16x32_bf16 a[4:7], v[160:163], a[228:231], a[4:7]
    v_exp_f32 v248, v92
    v_mfma_f32_16x16x32_bf16 a[8:11], v[160:163], a[232:235], a[8:11]
    v_exp_f32 v249, v93
    v_cvt_f32_i32 v223, v223
    v_mfma_f32_16x16x32_bf16 a[8:11], v[176:179], a[248:251], a[8:11]
    v_perm_b32 v174, v249, v248, s4
    v_mul_f32_dpp v222, v232, v222 row_newbcast:5 row_mask:0xf bank_mask:0xf
    v_mfma_f32_16x16x32_bf16 a[12:15], v[176:179], a[252:255], a[12:15]
    v_exp_f32 v250, v94
    v_mfma_f32_16x16x32_bf16 a[12:15], v[160:163], a[236:239], a[12:15]
    v_exp_f32 v251, v95
    v_mul_f32_dpp v223, v232, v223 row_newbcast:5 row_mask:0xf bank_mask:0xf
    v_mfma_f32_16x16x32_bf16 a[44:47], v[164:167], a[236:239], a[44:47]
    v_perm_b32 v175, v251, v250, s4
    v_subrev_f32_dpp v222, v233, v222 row_newbcast:5 row_mask:0xf bank_mask:0xf
    v_mfma_f32_16x16x32_bf16 a[44:47], v[180:183], a[252:255], a[44:47]
    v_subrev_f32_dpp v223, v233, v223 row_newbcast:5 row_mask:0xf bank_mask:0xf
    v_cvt_pk_bf16_f32 v216, v216, v218
    v_smfmac_f32_16x16x64_bf16 v[192:195], v[144:147], v[152:159], v255
    v_cvt_pk_bf16_f32 v218, v220, v222
    v_cvt_pk_bf16_f32 v220, v217, v219
    v_cvt_pk_bf16_f32 v222, v221, v223
    v_smfmac_f32_16x16x64_bf16 v[192:195], v[148:151], v[168:175], v255
    v_cvt_f32_i32 v224, v224
    v_cvt_f32_i32 v225, v225
    v_mfma_f32_16x16x32_bf16 a[40:43], v[180:183], a[248:251], a[40:43]
    s_waitcnt vmcnt(15) lgkmcnt(0)
    s_barrier
    v_mfma_f32_16x16x32_bf16 a[40:43], v[164:167], a[232:235], a[40:43]
    v_mul_f32_dpp v224, v232, v224 row_newbcast:2 row_mask:0xf bank_mask:0xf
    v_mul_f32_dpp v225, v232, v225 row_newbcast:2 row_mask:0xf bank_mask:0xf
    v_subrev_f32_dpp v224, v233, v224 row_newbcast:2 row_mask:0xf bank_mask:0xf
    v_mfma_f32_16x16x32_bf16 a[36:39], v[164:167], a[228:231], a[36:39]
    v_subrev_f32_dpp v225, v233, v225 row_newbcast:2 row_mask:0xf bank_mask:0xf
    v_cvt_f32_i32 v226, v226
    v_mfma_f32_16x16x32_bf16 a[36:39], v[180:183], a[244:247], a[36:39]
    v_cvt_f32_i32 v227, v227
    v_mul_f32_dpp v226, v232, v226 row_newbcast:3 row_mask:0xf bank_mask:0xf
    v_mfma_f32_16x16x32_bf16 a[32:35], v[180:183], a[240:243], a[32:35]
    v_cmp_lt_f32_e64 vcc, s72, v192
    v_mul_f32_dpp v227, v232, v227 row_newbcast:3 row_mask:0xf bank_mask:0xf
    v_subrev_f32_dpp v226, v233, v226 row_newbcast:3 row_mask:0xf bank_mask:0xf
    v_mfma_f32_16x16x32_bf16 a[32:35], v[164:167], a[224:227], a[32:35]
    v_subrev_f32_dpp v227, v233, v227 row_newbcast:3 row_mask:0xf bank_mask:0xf
    s_cbranch_vccnz L_rare_r0_2
L_join_r0_2:
    v_mfma_f32_16x16x32_bf16 v[64:67], a[192:195], a[128:131], v[128:131]
    v_exp_f32 v244, v96
    v_mfma_f32_16x16x32_bf16 v[64:67], a[196:199], a[132:135], v[64:67]
    ds_read_b128 a[224:227], v14 offset:40960
    v_add_u32 v2, s75, v2
    v_cvt_pk_bf16_f32 v217, v224, v226
    v_mfma_f32_16x16x32_bf16 v[64:67], a[200:203], a[136:139], v[64:67]
    v_exp_f32 v245, v97
    v_mfma_f32_16x16x32_bf16 v[64:67], a[204:207], a[140:143], v[64:67]
    ds_read_b128 a[228:231], v253 offset:40960
    v_perm_b32 v236, v245, v244, s4
    v_mfma_f32_16x16x32_bf16 v[72:75], a[204:207], a[156:159], v[132:135]
    v_exp_f32 v246, v98
    v_cvt_pk_bf16_f32 v221, v225, v227
    v_mfma_f32_16x16x32_bf16 v[72:75], a[200:203], a[152:155], v[72:75]
    ds_read_b128 a[232:235], v254 offset:40960
    v_cvt_f32_i32 v228, v228
    v_mfma_f32_16x16x32_bf16 v[72:75], a[196:199], a[148:151], v[72:75]
    v_exp_f32 v247, v99
    v_mfma_f32_16x16x32_bf16 v[72:75], a[192:195], a[144:147], v[72:75]
    ds_read_b128 a[236:239], v234 offset:40960
    v_perm_b32 v237, v247, v246, s4
    v_cvt_f32_i32 v229, v229
    v_mfma_f32_16x16x32_bf16 v[80:83], a[192:195], a[160:163], v[136:139]
    v_exp_f32 v248, v100
    v_mfma_f32_16x16x32_bf16 v[80:83], a[196:199], a[164:167], v[80:83]
    ds_read_b128 a[240:243], v14 offset:45056
    v_mul_f32_dpp v228, v232, v228 row_newbcast:6 row_mask:0xf bank_mask:0xf
    v_mfma_f32_16x16x32_bf16 v[80:83], a[200:203], a[168:171], v[80:83]
    v_exp_f32 v249, v101
    v_mul_f32_dpp v229, v232, v229 row_newbcast:6 row_mask:0xf bank_mask:0xf
    v_mfma_f32_16x16x32_bf16 v[80:83], a[204:207], a[172:175], v[80:83]
    ds_read_b128 a[244:247], v253 offset:45056
    v_perm_b32 v238, v249, v248, s4
    v_mfma_f32_16x16x32_bf16 v[88:91], a[204:207], a[188:191], v[140:143]
    v_exp_f32 v250, v102
    v_mfma_f32_16x16x32_bf16 v[88:91], a[200:203], a[184:187], v[88:91]
    ds_read_b128 a[248:251], v254 offset:45056
    s_add_u32 m0, s73, 0
    v_subrev_f32_dpp v228, v233, v228 row_newbcast:6 row_mask:0xf bank_mask:0xf
    v_mfma_f32_16x16x32_bf16 v[88:91], a[196:199], a[180:183], v[88:91]
    v_exp_f32 v251, v103
    v_mfma_f32_16x16x32_bf16 v[88:91], a[192:195], a[176:179], v[88:91]
    ds_read_b128 a[252:255], v234 offset:45056
    v_perm_b32 v239, v251, v250, s4
    v_mfma_f32_16x16x32_bf16 v[92:95], a[208:211], a[176:179], v[140:143]
    v_exp_f32 v244, v104
    v_subrev_f32_dpp v229, v233, v229 row_newbcast:6 row_mask:0xf bank_mask:0xf
    v_mfma_f32_16x16x32_bf16 v[92:95], a[212:215], a[180:183], v[92:95]
    buffer_load_dwordx4 v2, s[24:27], s67 offen offset:0 sc1 lds
    v_cvt_f32_i32 v230, v230
    v_mfma_f32_16x16x32_bf16 v[92:95], a[216:219], a[184:187], v[92:95]
    v_exp_f32 v245, v105
    v_mfma_f32_16x16x32_bf16 v[92:95], a[220:223], a[188:191], v[92:95]
    ds_read_b128 a[192:195], v252 offset:8192
    v_perm_b32 v240, v245, v244, s4
    v_cvt_f32_i32 v231, v231
    v_mfma_f32_16x16x32_bf16 v[84:87], a[220:223], a[172:175], v[136:139]
    v_exp_f32 v246, v106
    v_mfma_f32_16x16x32_bf16 v[84:87], a[216:219], a[168:171], v[84:87]
    buffer_load_dwordx4 v2, s[24:27], s67 offen offset:1024 sc1 lds
    v_mul_f32_dpp v230, v232, v230 row_newbcast:7 row_mask:0xf bank_mask:0xf
    v_mfma_f32_16x16x32_bf16 v[84:87], a[212:215], a[164:167], v[84:87]
    v_exp_f32 v247, v107
    v_mul_f32_dpp v231, v232, v231 row_newbcast:7 row_mask:0xf bank_mask:0xf
    v_mfma_f32_16x16x32_bf16 v[84:87], a[208:211], a[160:163], v[84:87]
    ds_read_b128 a[196:199], v252 offset:9216
    v_perm_b32 v241, v247, v246, s4
    v_mfma_f32_16x16x32_bf16 v[76:79], a[208:211], a[144:147], v[132:135]
    v_exp_f32 v248, v108
    v_mfma_f32_16x16x32_bf16 v[76:79], a[212:215], a[148:151], v[76:79]
    buffer_load_dwordx4 v2, s[24:27], s67 offen offset:2048 sc1 lds
    v_subrev_f32_dpp v230, v233, v230 row_newbcast:7 row_mask:0xf bank_mask:0xf
    v_subrev_f32_dpp v231, v233, v231 row_newbcast:7 row_mask:0xf bank_mask:0xf
    v_mfma_f32_16x16x32_bf16 v[76:79], a[216:219], a[152:155], v[76:79]
    v_exp_f32 v249, v109
    v_mfma_f32_16x16x32_bf16 v[76:79], a[220:223], a[156:159], v[76:79]
    ds_read_b128 a[200:203], v252 offset:10240
    v_perm_b32 v242, v249, v248, s4
    v_mfma_f32_16x16x32_bf16 v[68:71], a[220:223], a[140:143], v[128:131]
    v_exp_f32 v250, v110
    v_cvt_pk_bf16_f32 v219, v228, v230
    v_mfma_f32_16x16x32_bf16 v[68:71], a[216:219], a[136:139], v[68:71]
    buffer_load_dwordx4 v2, s[24:27], s67 offen offset:3072 sc1 lds
    s_waitcnt lgkmcnt(3)
    v_mfma_f32_16x16x32_bf16 v[68:71], a[212:215], a[132:135], v[68:71]
    v_exp_f32 v251, v111
    v_mfma_f32_16x16x32_bf16 v[68:71], a[208:211], a[128:131], v[68:71]
    ds_read_b128 a[204:207], v252 offset:11264
    v_perm_b32 v243, v251, v250, s4
    v_cvt_pk_bf16_f32 v223, v229, v231
    v_mfma_f32_16x16x32_bf16 a[80:83], v[184:187], a[224:227], a[80:83]
    v_exp_f32 v244, v112
    v_mfma_f32_16x16x32_bf16 a[80:83], v[168:171], a[240:243], a[80:83]
    ds_read_b128 a[208:211], v252 offset:12288
    buffer_store_dwordx4 v[216:219], v0, s[24:27], s80 offen offset:0 sc1
    v_mfma_f32_16x16x32_bf16 a[84:87], v[168:171], a[244:247], a[84:87]
    v_exp_f32 v245, v113
    s_add_u32 s80, s80, 4096
    v_mfma_f32_16x16x32_bf16 a[84:87], v[184:187], a[228:231], a[84:87]
    ds_read_b128 a[212:215], v252 offset:13312
    ds_read_b128 a[216:219], v252 offset:14336
    v_mfma_f32_16x16x32_bf16 a[88:91], v[184:187], a[232:235], a[88:91]
    v_exp_f32 v246, v114
    v_mfma_f32_16x16x32_bf16 a[88:91], v[168:171], a[248:251], a[88:91]
    buffer_load_dwordx2 v[6:7], v3, s[24:27], s83 offen sc1
    v_exp_f32 v247, v115
    v_mfma_f32_16x16x32_bf16 a[92:95], v[168:171], a[252:255], a[92:95]
    ds_read_b128 a[220:223], v252 offset:15360
    v_mov_b64 v[196:197], v[192:193]
    v_mfma_f32_16x16x32_bf16 a[92:95], v[184:187], a[236:239], a[92:95]
    v_exp_f32 v248, v116
    v_mfma_f32_16x16x32_bf16 a[124:127], v[188:191], a[236:239], a[124:127]
    buffer_store_dwordx4 v[220:223], v0, s[24:27], s80 offen offset:0 sc1
    v_exp_f32 v249, v117
    v_mfma_f32_16x16x32_bf16 a[124:127], v[172:175], a[252:255], a[124:127]
    v_perm_b32 v185, v247, v246, s4
    v_perm_b32 v184, v245, v244, s4
    v_mfma_f32_16x16x32_bf16 a[120:123], v[172:175], a[248:251], a[120:123]
    v_exp_f32 v250, v118
    v_mfma_f32_16x16x32_bf16 a[120:123], v[188:191], a[232:235], a[120:123]
    v_exp_f32 v251, v119
    s_add_u32 s80, s80, 0x1ff000
    v_mfma_f32_16x16x32_bf16 a[116:119], v[188:191], a[228:231], a[116:119]
    v_perm_b32 v187, v251, v250, s4
    v_perm_b32 v186, v249, v248, s4
    v_mfma_f32_16x16x32_bf16 a[116:119], v[172:175], a[244:247], a[116:119]
    v_exp_f32 v244, v120
    v_mfma_f32_16x16x32_bf16 a[112:115], v[172:175], a[240:243], a[112:115]
    buffer_load_dwordx4 v[16:19], v8, s[28:31], s5 offen offset:0
    v_exp_f32 v245, v121
    v_mfma_f32_16x16x32_bf16 a[112:115], v[188:191], a[224:227], a[112:115]
    v_mov_b64 v[198:199], v[194:195]
    v_mfma_f32_16x16x32_bf16 a[16:19], v[176:179], a[224:227], a[16:19]
    v_exp_f32 v246, v122
    v_mfma_f32_16x16x32_bf16 a[16:19], v[152:155], a[240:243], a[16:19]
    v_exp_f32 v247, v123
    v_mfma_f32_16x16x32_bf16 a[20:23], v[152:155], a[244:247], a[20:23]
    v_perm_b32 v189, v247, v246, s4
    v_perm_b32 v188, v245, v244, s4
    v_mfma_f32_16x16x32_bf16 a[20:23], v[176:179], a[228:231], a[20:23]
    v_exp_f32 v248, v124
    v_mfma_f32_16x16x32_bf16 a[24:27], v[176:179], a[232:235], a[24:27]
    buffer_load_dwordx4 v[20:23], v8, s[28:31], s5 offen offset:16
    v_exp_f32 v249, v125
    v_mfma_f32_16x16x32_bf16 a[24:27], v[152:155], a[248:251], a[24:27]
    v_perm_b32 v190, v249, v248, s4
    v_mfma_f32_16x16x32_bf16 a[28:31], v[152:155], a[252:255], a[28:31]
    v_exp_f32_e64 v250, v126
    v_mfma_f32_16x16x32_bf16 a[28:31], v[176:179], a[236:239], a[28:31]
    v_exp_f32_e64 v251, v127
    v_mfma_f32_16x16x32_bf16 a[60:63], v[180:183], a[236:239], a[60:63]
    buffer_load_dwordx4 v[24:27], v8, s[28:31], s5 offen offset:256
    v_perm_b32 v191, v251, v250, s4
    v_mfma_f32_16x16x32_bf16 a[60:63], v[156:159], a[252:255], a[60:63]
    v_smfmac_f32_16x16x64_bf16 v[196:199], v[144:147], v[236:243], v255
    v_smfmac_f32_16x16x64_bf16 v[196:199], v[148:151], v[184:191], v255
    v_mfma_f32_16x16x32_bf16 a[56:59], v[156:159], a[248:251], a[56:59]
    s_waitcnt vmcnt(16) lgkmcnt(0)
    s_barrier
    v_mfma_f32_16x16x32_bf16 a[56:59], v[180:183], a[232:235], a[56:59]
    buffer_load_dwordx4 v[28:31], v8, s[28:31], s5 offen offset:272
    v_mfma_f32_16x16x32_bf16 a[52:55], v[180:183], a[228:231], a[52:55]
    v_mfma_f32_16x16x32_bf16 a[52:55], v[156:159], a[244:247], a[52:55]
    v_mfma_f32_16x16x32_bf16 a[48:51], v[156:159], a[240:243], a[48:51]
    v_cmp_lt_f32_e64 vcc, s72, v196
    v_mfma_f32_16x16x32_bf16 a[48:51], v[180:183], a[224:227], a[48:51]
    buffer_load_dwordx2 v[200:201], v10, s[32:35], s7 offen
    s_cbranch_vccnz L_rare_r0_3
L_join_r0_3:
    v_mfma_f32_16x16x32_bf16 v[96:99], a[192:195], a[128:131], v[128:131]
    v_exp_f32 v244, v64
    v_mfma_f32_16x16x32_bf16 v[96:99], a[196:199], a[132:135], v[96:99]
    ds_read_b128 a[224:227], v14 offset:49152
    s_waitcnt vmcnt(6)
    v_cmp_ne_u64 vcc, v[6:7], v[4:5]
    v_mfma_f32_16x16x32_bf16 v[96:99], a[200:203], a[136:139], v[96:99]
    v_exp_f32 v245, v65
    v_mfma_f32_16x16x32_bf16 v[96:99], a[204:207], a[140:143], v[96:99]
    ds_read_b128 a[228:231], v253 offset:49152
    v_perm_b32 v160, v245, v244, s4
    v_mfma_f32_16x16x32_bf16 v[104:107], a[204:207], a[156:159], v[132:135]
    v_exp_f32 v246, v66
    v_mfma_f32_16x16x32_bf16 v[104:107], a[200:203], a[152:155], v[104:107]
    ds_read_b128 a[232:235], v254 offset:49152
    s_cbranch_vccnz L_spin_r0k
L_spinret_r0k:
    v_mfma_f32_16x16x32_bf16 v[104:107], a[196:199], a[148:151], v[104:107]
    v_exp_f32 v247, v67
    v_mfma_f32_16x16x32_bf16 v[104:107], a[192:195], a[144:147], v[104:107]
    ds_read_b128 a[236:239], v234 offset:49152
    v_perm_b32 v161, v247, v246, s4
    v_mfma_f32_16x16x32_bf16 v[112:115], a[192:195], a[160:163], v[136:139]
    v_exp_f32 v248, v68
    v_mfma_f32_16x16x32_bf16 v[112:115], a[196:199], a[164:167], v[112:115]
    ds_read_b128 a[240:243], v14 offset:53248
    buffer_load_dwordx2 v[202:203], v10, s[36:39], s7 offen
    v_mfma_f32_16x16x32_bf16 v[112:115], a[200:203], a[168:171], v[112:115]
    v_exp_f32 v249, v69
    v_mfma_f32_16x16x32_bf16 v[112:115], a[204:207], a[172:175], v[112:115]
    ds_read_b128 a[244:247], v253 offset:53248
    v_perm_b32 v162, v249, v248, s4
    v_mfma_f32_16x16x32_bf16 v[120:123], a[204:207], a[188:191], v[140:143]
    v_exp_f32 v250, v70
    v_mfma_f32_16x16x32_bf16 v[120:123], a[200:203], a[184:187], v[120:123]
    ds_read_b128 a[248:251], v254 offset:53248
    s_add_u32 m0, s73, 8192
    v_mfma_f32_16x16x32_bf16 v[120:123], a[196:199], a[180:183], v[120:123]
    v_exp_f32 v251, v71
    v_mfma_f32_16x16x32_bf16 v[120:123], a[192:195], a[176:179], v[120:123]
    ds_read_b128 a[252:255], v234 offset:53248
    v_perm_b32 v163, v251, v250, s4
    v_mfma_f32_16x16x32_bf16 v[124:127], a[208:211], a[176:179], v[140:143]
    v_exp_f32 v244, v72
    v_mfma_f32_16x16x32_bf16 v[124:127], a[212:215], a[180:183], v[124:127]
    buffer_load_dwordx4 v2, s[24:27], s68 offen offset:0 sc1 lds
    s_waitcnt vmcnt(19)
    v_cmp_ne_u64_e64 s[14:15], v[52:53], v[60:61]
    v_mfma_f32_16x16x32_bf16 v[124:127], a[216:219], a[184:187], v[124:127]
    v_exp_f32 v245, v73
    v_mfma_f32_16x16x32_bf16 v[124:127], a[220:223], a[188:191], v[124:127]
    ds_read_b128 a[192:195], v252 offset:16384
    v_perm_b32 v164, v245, v244, s4
    v_mfma_f32_16x16x32_bf16 v[116:119], a[220:223], a[172:175], v[136:139]
    v_exp_f32 v246, v74
    v_mfma_f32_16x16x32_bf16 v[116:119], a[216:219], a[168:171], v[116:119]
    buffer_load_dwordx4 v2, s[24:27], s68 offen offset:1024 sc1 lds
    v_cmp_ne_u64_e64 s[94:95], v[54:55], v[62:63]
    v_mfma_f32_16x16x32_bf16 v[116:119], a[212:215], a[164:167], v[116:119]
    v_exp_f32 v247, v75
    v_mfma_f32_16x16x32_bf16 v[116:119], a[208:211], a[160:163], v[116:119]
    ds_read_b128 a[196:199], v252 offset:17408
    v_perm_b32 v165, v247, v246, s4
    v_mfma_f32_16x16x32_bf16 v[108:111], a[208:211], a[144:147], v[132:135]
    v_exp_f32 v248, v76
    v_mfma_f32_16x16x32_bf16 v[108:111], a[212:215], a[148:151], v[108:111]
    buffer_load_dwordx4 v2, s[24:27], s68 offen offset:2048 sc1 lds
    s_nop 0
    v_mfma_f32_16x16x32_bf16 v[108:111], a[216:219], a[152:155], v[108:111]
    v_exp_f32 v249, v77
    v_mfma_f32_16x16x32_bf16 v[108:111], a[220:223], a[156:159], v[108:111]
    ds_read_b128 a[200:203], v252 offset:18432
    v_perm_b32 v166, v249, v248, s4
    v_mfma_f32_16x16x32_bf16 v[100:103], a[220:223], a[140:143], v[128:131]
    v_exp_f32 v250, v78
    v_mfma_f32_16x16x32_bf16 v[100:103], a[216:219], a[136:139], v[100:103]
    buffer_load_dwordx4 v2, s[24:27], s68 offen offset:3072 sc1 lds
    s_waitcnt lgkmcnt(3)
    v_mfma_f32_16x16x32_bf16 v[100:103], a[212:215], a[132:135], v[100:103]
    v_exp_f32 v251, v79
    v_mfma_f32_16x16x32_bf16 v[100:103], a[208:211], a[128:131], v[100:103]
    ds_read_b128 a[204:207], v252 offset:19456
    v_perm_b32 v167, v251, v250, s4
    v_mfma_f32_16x16x32_bf16 a[64:67], v[168:171], a[224:227], a[64:67]
    v_exp_f32 v244, v80
    v_mfma_f32_16x16x32_bf16 a[64:67], v[184:187], a[240:243], a[64:67]
    ds_read_b128 a[208:211], v252 offset:20480
    buffer_load_dwordx4 v[48:51], v9, s[40:43], s6 offen offset:0
    s_add_u32 s83, s83, 512
    v_mfma_f32_16x16x32_bf16 a[68:71], v[184:187], a[244:247], a[68:71]
    v_exp_f32 v245, v81
    v_mfma_f32_16x16x32_bf16 a[68:71], v[168:171], a[228:231], a[68:71]
    ds_read_b128 a[212:215], v252 offset:21504
    ds_read_b128 a[216:219], v252 offset:22528
    v_mfma_f32_16x16x32_bf16 a[72:75], v[168:171], a[232:235], a[72:75]
    v_exp_f32 v246, v82
    v_mfma_f32_16x16x32_bf16 a[72:75], v[184:187], a[248:251], a[72:75]
    v_exp_f32 v247, v83
    v_mfma_f32_16x16x32_bf16 a[76:79], v[184:187], a[252:255], a[76:79]
    ds_read_b128 a[220:223], v252 offset:23552
    v_mov_b64 v[192:193], v[196:197]
    v_mfma_f32_16x16x32_bf16 a[76:79], v[168:171], a[236:239], a[76:79]
    v_exp_f32 v248, v84
    v_mfma_f32_16x16x32_bf16 a[108:111], v[172:175], a[236:239], a[108:111]
    v_exp_f32 v249, v85
    v_mfma_f32_16x16x32_bf16 a[108:111], v[188:191], a[252:255], a[108:111]
    v_perm_b32 v169, v247, v246, s4
    v_perm_b32 v168, v245, v244, s4
    v_mfma_f32_16x16x32_bf16 a[104:107], v[188:191], a[248:251], a[104:107]
    v_exp_f32 v250, v86
    v_mfma_f32_16x16x32_bf16 a[104:107], v[172:175], a[232:235], a[104:107]
    v_exp_f32 v251, v87
    v_mfma_f32_16x16x32_bf16 a[100:103], v[172:175], a[228:231], a[100:103]
    v_perm_b32 v171, v251, v250, s4
    v_perm_b32 v170, v249, v248, s4
    v_mfma_f32_16x16x32_bf16 a[100:103], v[188:191], a[244:247], a[100:103]
    v_exp_f32 v244, v88
    v_mfma_f32_16x16x32_bf16 a[96:99], v[188:191], a[240:243], a[96:99]
    v_exp_f32 v245, v89
    v_mfma_f32_16x16x32_bf16 a[96:99], v[172:175], a[224:227], a[96:99]
    buffer_load_dwordx4 v[56:59], v9, s[44:47], s6 offen offset:0
    v_mov_b64 v[194:195], v[198:199]
    v_mfma_f32_16x16x32_bf16 a[0:3], v[152:155], a[224:227], a[0:3]
    v_exp_f32 v246, v90
    v_mfma_f32_16x16x32_bf16 a[0:3], v[236:239], a[240:243], a[0:3]
    v_exp_f32 v247, v91
    v_mfma_f32_16x16x32_bf16 a[4:7], v[236:239], a[244:247], a[4:7]
    v_perm_b32 v173, v247, v246, s4
    v_perm_b32 v172, v245, v244, s4
    v_mfma_f32_16x16x32_bf16 a[4:7], v[152:155], a[228:231], a[4:7]
    v_exp_f32 v248, v92
    v_mfma_f32_16x16x32_bf16 a[8:11], v[152:155], a[232:235], a[8:11]
    v_exp_f32 v249, v93
    v_mfma_f32_16x16x32_bf16 a[8:11], v[236:239], a[248:251], a[8:11]
    v_perm_b32 v174, v249, v248, s4
    v_mfma_f32_16x16x32_bf16 a[12:15], v[236:239], a[252:255], a[12:15]
    v_exp_f32 v250, v94
    v_mfma_f32_16x16x32_bf16 a[12:15], v[152:155], a[236:239], a[12:15]
    v_exp_f32 v251, v95
    v_mfma_f32_16x16x32_bf16 a[44:47], v[156:159], a[236:239], a[44:47]
    v_perm_b32 v175, v251, v250, s4
    v_mfma_f32_16x16x32_bf16 a[44:47], v[240:243], a[252:255], a[44:47]
    s_add_u32 s5, s5, 0x20000
    s_and_b32 s5, s5, 0xfffff
    v_smfmac_f32_16x16x64_bf16 v[192:195], v[144:147], v[160:167], v255
    s_lshr_b32 s6, s5, 1
    s_lshr_b32 s7, s5, 6
    v_smfmac_f32_16x16x64_bf16 v[192:195], v[148:151], v[168:175], v255
    buffer_load_ushort v232, v12, s[52:55], s78 offen
    v_mfma_f32_16x16x32_bf16 a[40:43], v[240:243], a[248:251], a[40:43]
    s_waitcnt vmcnt(13) lgkmcnt(0)
    s_barrier
    v_mfma_f32_16x16x32_bf16 a[40:43], v[156:159], a[232:235], a[40:43]
    buffer_load_ushort v233, v12, s[56:59], s78 offen
    v_mfma_f32_16x16x32_bf16 a[36:39], v[156:159], a[228:231], a[36:39]
    s_or_b64 s[14:15], s[14:15], s[94:95]
    s_cbranch_scc1 L_bad
L_bad_ret:
    v_mfma_f32_16x16x32_bf16 a[36:39], v[240:243], a[244:247], a[36:39]
    buffer_load_dwordx2 v[216:217], v11, s[48:51], s77 offen offset:0
    v_mfma_f32_16x16x32_bf16 a[32:35], v[240:243], a[240:243], a[32:35]
    v_cmp_lt_f32_e64 vcc, s72, v192
    v_mfma_f32_16x16x32_bf16 a[32:35], v[156:159], a[224:227], a[32:35]
    buffer_load_dwordx2 v[218:219], v11, s[48:51], s77 offen offset:512
    s_cbranch_vccnz L_rare_r0_4
L_join_r0_4:
    v_mfma_f32_16x16x32_bf16 v[64:67], a[192:195], a[128:131], v[128:131]
    v_exp_f32 v244, v96
    v_mfma_f32_16x16x32_bf16 v[64:67], a[196:199], a[132:135], v[64:67]
    ds_read_b128 a[224:227], v14 offset:57344
    buffer_store_dwordx2 v[4:5], v13, s[24:27], s82 offen sc1
    s_add_u32 s82, s82, 512
    v_mfma_f32_16x16x32_bf16 v[64:67], a[200:203], a[136:139], v[64:67]
    v_exp_f32 v245, v97
    v_mfma_f32_16x16x32_bf16 v[64:67], a[204:207], a[140:143], v[64:67]
    ds_read_b128 a[228:231], v253 offset:57344
    buffer_load_dwordx2 v[224:225], v11, s[48:51], s77 offen offset:1024
    v_perm_b32 v176, v245, v244, s4
    v_mfma_f32_16x16x32_bf16 v[72:75], a[204:207], a[156:159], v[132:135]
    v_exp_f32 v246, v98
    v_mfma_f32_16x16x32_bf16 v[72:75], a[200:203], a[152:155], v[72:75]
    ds_read_b128 a[232:235], v254 offset:57344
    buffer_load_dwordx2 v[226:227], v11, s[48:51], s77 offen offset:1536
    s_waitcnt vmcnt(15)
    v_mfma_f32_16x16x32_bf16 v[72:75], a[196:199], a[148:151], v[72:75]
    v_exp_f32 v247, v99
    v_mfma_f32_16x16x32_bf16 v[72:75], a[192:195], a[144:147], v[72:75]
    ds_read_b128 a[236:239], v234 offset:57344
    buffer_load_dwordx2 v[220:221], v11, s[48:51], s77 offen offset:2048
    v_perm_b32 v177, v247, v246, s4
    v_mfma_f32_16x16x32_bf16 v[80:83], a[192:195], a[160:163], v[136:139]
    v_exp_f32 v248, v100
    v_mfma_f32_16x16x32_bf16 v[80:83], a[196:199], a[164:167], v[80:83]
    ds_read_b128 a[240:243], v14 offset:61440
    buffer_load_dwordx2 v[222:223], v11, s[48:51], s77 offen offset:2560
    v_cvt_f32_i32 v32, v16
    v_mfma_f32_16x16x32_bf16 v[80:83], a[200:203], a[168:171], v[80:83]
    v_exp_f32 v249, v101
    v_mfma_f32_16x16x32_bf16 v[80:83], a[204:207], a[172:175], v[80:83]
    ds_read_b128 a[244:247], v253 offset:61440
    buffer_load_dwordx2 v[228:229], v11, s[48:51], s77 offen offset:3072
    v_perm_b32 v178, v249, v248, s4
    v_mfma_f32_16x16x32_bf16 v[88:91], a[204:207], a[188:191], v[140:143]
    v_exp_f32 v250, v102
    v_mfma_f32_16x16x32_bf16 v[88:91], a[200:203], a[184:187], v[88:91]
    ds_read_b128 a[248:251], v254 offset:61440
    buffer_load_dwordx2 v[230:231], v11, s[48:51], s77 offen offset:3584
    s_add_u32 m0, s73, 16384
    v_mfma_f32_16x16x32_bf16 v[88:91], a[196:199], a[180:183], v[88:91]
    v_exp_f32 v251, v103
    v_mfma_f32_16x16x32_bf16 v[88:91], a[192:195], a[176:179], v[88:91]
    ds_read_b128 a[252:255], v234 offset:61440
    v_perm_b32 v179, v251, v250, s4
    v_cvt_f32_i32 v33, v17
    v_mfma_f32_16x16x32_bf16 v[92:95], a[208:211], a[176:179], v[140:143]
    v_exp_f32 v244, v104
    v_mfma_f32_16x16x32_bf16 v[92:95], a[212:215], a[180:183], v[92:95]
    buffer_load_dwordx4 v2, s[24:27], s69 offen offset:0 sc1 lds
    s_add_u32 s77, s77, 0x20000
    s_and_b32 s77, s77, 0xfffff
    v_mfma_f32_16x16x32_bf16 v[92:95], a[216:219], a[184:187], v[92:95]
    v_exp_f32 v245, v105
    v_mfma_f32_16x16x32_bf16 v[92:95], a[220:223], a[188:191], v[92:95]
    ds_read_b128 a[192:195], v252 offset:24576
    v_perm_b32 v180, v245, v244, s4
    s_lshr_b32 s78, s77, 6
    v_mfma_f32_16x16x32_bf16 v[84:87], a[220:223], a[172:175], v[136:139]
    v_exp_f32 v246, v106
    v_mfma_f32_16x16x32_bf16 v[84:87], a[216:219], a[168:171], v[84:87]
    buffer_load_dwordx4 v2, s[24:27], s69 offen offset:1024 sc1 lds
    v_cvt_f32_i32 v34, v18
    v_cvt_f32_i32 v35, v19
    v_mfma_f32_16x16x32_bf16 v[84:87], a[212:215], a[164:167], v[84:87]
    v_exp_f32 v247, v107
    v_mfma_f32_16x16x32_bf16 v[84:87], a[208:211], a[160:163], v[84:87]
    ds_read_b128 a[196:199], v252 offset:25600
    v_perm_b32 v181, v247, v246, s4
    v_cvt_f32_i32 v36, v20
    v_mfma_f32_16x16x32_bf16 v[76:79], a[208:211], a[144:147], v[132:135]
    v_exp_f32 v248, v108
    v_mfma_f32_16x16x32_bf16 v[76:79], a[212:215], a[148:151], v[76:79]
    buffer_load_dwordx4 v2, s[24:27], s69 offen offset:2048 sc1 lds
    v_cvt_f32_i32 v37, v21
    v_cvt_f32_i32 v38, v22
    v_mfma_f32_16x16x32_bf16 v[76:79], a[216:219], a[152:155], v[76:79]
    v_exp_f32 v249, v109
    v_mfma_f32_16x16x32_bf16 v[76:79], a[220:223], a[156:159], v[76:79]
    ds_read_b128 a[200:203], v252 offset:26624
    v_perm_b32 v182, v249, v248, s4
    v_cvt_f32_i32 v39, v23
    v_mfma_f32_16x16x32_bf16 v[68:71], a[220:223], a[140:143], v[128:131]
    v_exp_f32 v250, v110
    v_mfma_f32_16x16x32_bf16 v[68:71], a[216:219], a[136:139], v[68:71]
    buffer_load_dwordx4 v2, s[24:27], s69 offen offset:3072 sc1 lds
    s_waitcnt lgkmcnt(3)
    v_cvt_f32_i32 v40, v24
    v_mfma_f32_16x16x32_bf16 v[68:71], a[212:215], a[132:135], v[68:71]
    v_exp_f32 v251, v111
    v_mfma_f32_16x16x32_bf16 v[68:71], a[208:211], a[128:131], v[68:71]
    ds_read_b128 a[204:207], v252 offset:27648
    v_perm_b32 v183, v251, v250, s4
    v_cvt_f32_i32 v41, v25
    v_mfma_f32_16x16x32_bf16 a[80:83], v[184:187], a[224:227], a[80:83]
    v_exp_f32 v244, v112
    v_mfma_f32_16x16x32_bf16 a[80:83], v[168:171], a[240:243], a[80:83]
    ds_read_b128 a[208:211], v252 offset:28672
    v_cvt_f32_i32 v42, v26
    v_cvt_f32_i32 v43, v27
    v_mfma_f32_16x16x32_bf16 a[84:87], v[168:171], a[244:247], a[84:87]
    v_exp_f32 v245, v113
    v_mfma_f32_16x16x32_bf16 a[84:87], v[184:187], a[228:231], a[84:87]
    ds_read_b128 a[212:215], v252 offset:29696
    ds_read_b128 a[216:219], v252 offset:30720
    v_cvt_f32_i32 v44, v28
    v_mfma_f32_16x16x32_bf16 a[88:91], v[184:187], a[232:235], a[88:91]
    v_exp_f32 v246, v114
    v_mfma_f32_16x16x32_bf16 a[88:91], v[168:171], a[248:251], a[88:91]
    v_exp_f32 v247, v115
    v_cvt_f32_i32 v45, v29
    v_mfma_f32_16x16x32_bf16 a[92:95], v[168:171], a[252:255], a[92:95]
    ds_read_b128 a[220:223], v252 offset:31744
    v_mov_b64 v[196:197], v[192:193]
    v_mfma_f32_16x16x32_bf16 a[92:95], v[184:187], a[236:239], a[92:95]
    v_exp_f32 v248, v116
    v_cvt_f32_i32 v46, v30
    v_mfma_f32_16x16x32_bf16 a[124:127], v[188:191], a[236:239], a[124:127]
    v_exp_f32 v249, v117
    v_mfma_f32_16x16x32_bf16 a[124:127], v[172:175], a[252:255], a[124:127]
    v_perm_b32 v185, v247, v246, s4
    v_perm_b32 v184, v245, v244, s4
    v_cvt_f32_i32 v47, v31
    v_mfma_f32_16x16x32_bf16 a[120:123], v[172:175], a[248:251], a[120:123]
    v_exp_f32 v250, v118
    v_mfma_f32_16x16x32_bf16 a[120:123], v[188:191], a[232:235], a[120:123]
    v_exp_f32 v251, v119
    s_waitcnt vmcnt(15)
    v_mfma_f32_16x16x32_bf16 a[116:119], v[188:191], a[228:231], a[116:119]
    v_perm_b32 v187, v251, v250, s4
    v_perm_b32 v186, v249, v248, s4
    v_mfma_f32_16x16x32_bf16 a[116:119], v[172:175], a[244:247], a[116:119]
    v_exp_f32 v244, v120
    v_perm_b32 v200, v200, v200, s87
    v_mfma_f32_16x16x32_bf16 a[112:115], v[172:175], a[240:243], a[112:115]
    v_exp_f32 v245, v121
    v_mfma_f32_16x16x32_bf16 a[112:115], v[188:191], a[224:227], a[112:115]
    v_mov_b64 v[198:199], v[194:195]
    v_perm_b32 v201, v201, v201, s87
    v_perm_b32 v202, v202, v202, s87
    v_mfma_f32_16x16x32_bf16 a[16:19], v[236:239], a[224:227], a[16:19]
    v_exp_f32 v246, v122
    v_mfma_f32_16x16x32_bf16 a[16:19], v[160:163], a[240:243], a[16:19]
    v_exp_f32 v247, v123
    v_perm_b32 v203, v203, v203, s87
    v_mfma_f32_16x16x32_bf16 a[20:23], v[160:163], a[244:247], a[20:23]
    v_perm_b32 v189, v247, v246, s4
    v_perm_b32 v188, v245, v244, s4
    v_mfma_f32_16x16x32_bf16 a[20:23], v[236:239], a[228:231], a[20:23]
    v_exp_f32 v248, v124
    v_mul_f32 v200, s85, v200
    v_mfma_f32_16x16x32_bf16 a[24:27], v[236:239], a[232:235], a[24:27]
    v_exp_f32 v249, v125
    v_mfma_f32_16x16x32_bf16 a[24:27], v[160:163], a[248:251], a[24:27]
    v_perm_b32 v190, v249, v248, s4
    v_mul_f32 v201, s85, v201
    v_mul_f32_e64 v202, -v202, v200
    v_mfma_f32_16x16x32_bf16 a[28:31], v[160:163], a[252:255], a[28:31]
    v_exp_f32 v250, v126
    v_mfma_f32_16x16x32_bf16 a[28:31], v[236:239], a[236:239], a[28:31]
    v_exp_f32 v251, v127
    v_mul_f32_e64 v203, -v203, v201
L_stop_first3:
L_stop3:
    s_cbranch_execz L_stop7
    v_mfma_f32_16x16x32_bf16 a[60:63], v[240:243], a[236:239], a[60:63]
    v_perm_b32 v191, v251, v250, s4
    v_fma_f32 v32, v32, v200, v202
    v_mfma_f32_16x16x32_bf16 a[60:63], v[164:167], a[252:255], a[60:63]
    v_fma_f32 v40, v40, v201, v203
    v_lshlrev_b32 v212, 16, v48
    v_lshlrev_b32 v214, 16, v56
    v_smfmac_f32_16x16x64_bf16 v[196:199], v[144:147], v[176:183], v255
    v_fma_f32 v204, v32, v212, s62
    v_fma_f32 v208, v40, v212, s62
    v_smfmac_f32_16x16x64_bf16 v[196:199], v[148:151], v[184:191], v255
    v_fma_f32 v204, -v40, v214, v204
    v_fma_f32 v208, v32, v214, v208
    v_fma_f32 v33, v33, v200, v202
    v_mfma_f32_16x16x32_bf16 a[56:59], v[164:167], a[248:251], a[56:59]
    s_waitcnt vmcnt(30) lgkmcnt(0)
    s_barrier
    v_mfma_f32_16x16x32_bf16 a[56:59], v[240:243], a[232:235], a[56:59]
    v_fma_f32 v41, v41, v201, v203
    v_and_b32 v212, s86, v48
    v_and_b32 v214, s86, v56
    v_mfma_f32_16x16x32_bf16 a[52:55], v[240:243], a[228:231], a[52:55]
    v_fma_f32 v205, v33, v212, s62
    v_fma_f32 v209, v41, v212, s62
    v_mfma_f32_16x16x32_bf16 a[52:55], v[164:167], a[244:247], a[52:55]
    v_fma_f32 v205, -v41, v214, v205
    v_fma_f32 v209, v33, v214, v209
    v_fma_f32 v34, v34, v200, v202
    v_mfma_f32_16x16x32_bf16 a[48:51], v[164:167], a[240:243], a[48:51]
    v_cmp_lt_f32 vcc, s72, v196
    v_fma_f32 v42, v42, v201, v203
    v_mfma_f32_16x16x32_bf16 a[48:51], v[240:243], a[224:227], a[48:51]
    v_lshlrev_b32 v212, 16, v49
    v_lshlrev_b32 v214, 16, v57
    s_cbranch_vccnz L_rare_r0_5
L_join_r0_5:
    v_mfma_f32_16x16x32_bf16 v[96:99], a[192:195], a[128:131], v[128:131]
    v_exp_f32 v244, v64
    v_mfma_f32_16x16x32_bf16 v[96:99], a[196:199], a[132:135], v[96:99]
    ds_read_b128 a[224:227], v14 offset:32768
    v_add_u32 v2, s76, v2
    v_fma_f32 v206, v34, v212, s62
    v_mfma_f32_16x16x32_bf16 v[96:99], a[200:203], a[136:139], v[96:99]
    v_exp_f32 v245, v65
    v_mfma_f32_16x16x32_bf16 v[96:99], a[204:207], a[140:143], v[96:99]
    ds_read_b128 a[228:231], v253 offset:32768
    v_perm_b32 v152, v245, v244, s4
    v_fma_f32 v210, v42, v212, s62
    v_mfma_f32_16x16x32_bf16 v[104:107], a[204:207], a[156:159], v[132:135]
    v_exp_f32 v246, v66
    v_mfma_f32_16x16x32_bf16 v[104:107], a[200:203], a[152:155], v[104:107]
    ds_read_b128 a[232:235], v254 offset:32768
    v_fma_f32 v206, -v42, v214, v206
    v_fma_f32 v210, v34, v214, v210
    v_mfma_f32_16x16x32_bf16 v[104:107], a[196:199], a[148:151], v[104:107]
    v_exp_f32 v247, v67
    v_mfma_f32_16x16x32_bf16 v[104:107], a[192:195], a[144:147], v[104:107]
    ds_read_b128 a[236:239], v234 offset:32768
    v_perm_b32 v153, v247, v246, s4
    v_fma_f32 v35, v35, v200, v202
    v_mfma_f32_16x16x32_bf16 v[112:115], a[192:195], a[160:163], v[136:139]
    v_exp_f32 v248, v68
    v_mfma_f32_16x16x32_bf16 v[112:115], a[196:199], a[164:167], v[112:115]
    ds_read_b128 a[240:243], v14 offset:36864
    v_fma_f32 v43, v43, v201, v203
    v_and_b32 v212, s86, v49
    v_mfma_f32_16x16x32_bf16 v[112:115], a[200:203], a[168:171], v[112:115]
    v_exp_f32 v249, v69
    v_mfma_f32_16x16x32_bf16 v[112:115], a[204:207], a[172:175], v[112:115]
    ds_read_b128 a[244:247], v253 offset:36864
    v_perm_b32 v154, v249, v248, s4
    v_and_b32 v214, s86, v57
    v_mfma_f32_16x16x32_bf16 v[120:123], a[204:207], a[188:191], v[140:143]
    v_exp_f32 v250, v70
    v_mfma_f32_16x16x32_bf16 v[120:123], a[200:203], a[184:187], v[120:123]
    ds_read_b128 a[248:251], v254 offset:36864
    s_add_u32 m0, s73, 24576
    v_fma_f32 v207, v35, v212, s62
    v_mfma_f32_16x16x32_bf16 v[120:123], a[196:199], a[180:183], v[120:123]
    v_exp_f32 v251, v71
    v_mfma_f32_16x16x32_bf16 v[120:123], a[192:195], a[176:179], v[120:123]
    ds_read_b128 a[252:255], v234 offset:36864
    v_perm_b32 v155, v251, v250, s4
    v_fma_f32 v211, v43, v212, s62
    v_mfma_f32_16x16x32_bf16 v[124:127], a[208:211], a[176:179], v[140:143]
    v_exp_f32 v244, v72
    v_mfma_f32_16x16x32_bf16 v[124:127], a[212:215], a[180:183], v[124:127]
    buffer_load_dwordx4 v2, s[24:27], s70 offen offset:0 sc1 lds
    v_fma_f32 v207, -v43, v214, v207
    v_fma_f32 v211, v35, v214, v211
    v_mfma_f32_16x16x32_bf16 v[124:127], a[216:219], a[184:187], v[124:127]
    v_exp_f32 v245, v73
    v_mfma_f32_16x16x32_bf16 v[124:127], a[220:223], a[188:191], v[124:127]
    ds_read_b128 a[192:195], v252 offset:0
    v_perm_b32 v156, v245, v244, s4
    v_cvt_pk_bf16_f32 v32, v204, v205
    v_mfma_f32_16x16x32_bf16 v[116:119], a[220:223], a[172:175], v[136:139]
    v_exp_f32 v246, v74
    v_mfma_f32_16x16x32_bf16 v[116:119], a[216:219], a[168:171], v[116:119]
    buffer_load_dwordx4 v2, s[24:27], s70 offen offset:1024 sc1 lds
    v_cvt_pk_bf16_f32 v33, v206, v207
    v_cvt_pk_bf16_f32 v34, v208, v209
    v_mfma_f32_16x16x32_bf16 v[116:119], a[212:215], a[164:167], v[116:119]
    v_exp_f32 v247, v75
    v_mfma_f32_16x16x32_bf16 v[116:119], a[208:211], a[160:163], v[116:119]
    ds_read_b128 a[196:199], v252 offset:1024
    v_perm_b32 v157, v247, v246, s4
    v_cvt_pk_bf16_f32 v35, v210, v211
    v_mfma_f32_16x16x32_bf16 v[108:111], a[208:211], a[144:147], v[132:135]
    v_exp_f32 v248, v76
    v_mfma_f32_16x16x32_bf16 v[108:111], a[212:215], a[148:151], v[108:111]
    buffer_load_dwordx4 v2, s[24:27], s70 offen offset:2048 sc1 lds
    v_fma_f32 v36, v36, v200, v202
    v_fma_f32 v44, v44, v201, v203
    v_mfma_f32_16x16x32_bf16 v[108:111], a[216:219], a[152:155], v[108:111]
    v_exp_f32 v249, v77
    v_mfma_f32_16x16x32_bf16 v[108:111], a[220:223], a[156:159], v[108:111]
    ds_read_b128 a[200:203], v252 offset:2048
    v_perm_b32 v158, v249, v248, s4
    v_lshlrev_b32 v212, 16, v50
    v_mfma_f32_16x16x32_bf16 v[100:103], a[220:223], a[140:143], v[128:131]
    v_exp_f32 v250, v78
    v_mfma_f32_16x16x32_bf16 v[100:103], a[216:219], a[136:139], v[100:103]
    buffer_load_dwordx4 v2, s[24:27], s70 offen offset:3072 sc1 lds
    s_waitcnt lgkmcnt(3)
    v_lshlrev_b32 v214, 16, v58
    v_mfma_f32_16x16x32_bf16 v[100:103], a[212:215], a[132:135], v[100:103]
    v_exp_f32 v251, v79
    v_mfma_f32_16x16x32_bf16 v[100:103], a[208:211], a[128:131], v[100:103]
    ds_read_b128 a[204:207], v252 offset:3072
    v_perm_b32 v159, v251, v250, s4
    v_fma_f32 v204, v36, v212, s62
    v_mfma_f32_16x16x32_bf16 a[64:67], v[168:171], a[224:227], a[64:67]
    v_exp_f32 v244, v80
    v_mfma_f32_16x16x32_bf16 a[64:67], v[184:187], a[240:243], a[64:67]
    ds_read_b128 a[208:211], v252 offset:4096
    v_fma_f32 v208, v44, v212, s62
    v_fma_f32 v204, -v44, v214, v204
    v_mfma_f32_16x16x32_bf16 a[68:71], v[184:187], a[244:247], a[68:71]
    v_exp_f32 v245, v81
    v_mfma_f32_16x16x32_bf16 a[68:71], v[168:171], a[228:231], a[68:71]
    ds_read_b128 a[212:215], v252 offset:5120
    ds_read_b128 a[216:219], v252 offset:6144
    buffer_load_dwordx2 v[6:7], v3, s[24:27], s84 offen sc1
    v_mfma_f32_16x16x32_bf16 a[72:75], v[168:171], a[232:235], a[72:75]
    v_exp_f32 v246, v82
    v_mfma_f32_16x16x32_bf16 a[72:75], v[184:187], a[248:251], a[72:75]
    v_exp_f32 v247, v83
    v_fma_f32 v208, v36, v214, v208
    v_mfma_f32_16x16x32_bf16 a[76:79], v[184:187], a[252:255], a[76:79]
    ds_read_b128 a[220:223], v252 offset:7168
    v_mov_b64 v[192:193], v[196:197]
    v_mfma_f32_16x16x32_bf16 a[76:79], v[168:171], a[236:239], a[76:79]
    v_exp_f32 v248, v84
    v_fma_f32 v37, v37, v200, v202
    v_mfma_f32_16x16x32_bf16 a[108:111], v[172:175], a[236:239], a[108:111]
    v_exp_f32 v249, v85
    v_mfma_f32_16x16x32_bf16 a[108:111], v[188:191], a[252:255], a[108:111]
    v_perm_b32 v169, v247, v246, s4
    v_perm_b32 v168, v245, v244, s4
    v_fma_f32 v45, v45, v201, v203
    v_mfma_f32_16x16x32_bf16 a[104:107], v[188:191], a[248:251], a[104:107]
    v_exp_f32 v250, v86
    v_mfma_f32_16x16x32_bf16 a[104:107], v[172:175], a[232:235], a[104:107]
    v_exp_f32 v251, v87
    v_and_b32 v212, s86, v50
    v_mfma_f32_16x16x32_bf16 a[100:103], v[172:175], a[228:231], a[100:103]
    v_perm_b32 v171, v251, v250, s4
    v_perm_b32 v170, v249, v248, s4
    v_mfma_f32_16x16x32_bf16 a[100:103], v[188:191], a[244:247], a[100:103]
    v_exp_f32 v244, v88
    v_and_b32 v214, s86, v58
    v_mfma_f32_16x16x32_bf16 a[96:99], v[188:191], a[240:243], a[96:99]
    v_exp_f32 v245, v89
    v_mfma_f32_16x16x32_bf16 a[96:99], v[172:175], a[224:227], a[96:99]
    v_mov_b64 v[194:195], v[198:199]
    v_fma_f32 v205, v37, v212, s62
    v_fma_f32 v209, v45, v212, s62
    v_mfma_f32_16x16x32_bf16 a[0:3], v[160:163], a[224:227], a[0:3]
    v_exp_f32 v246, v90
    v_mfma_f32_16x16x32_bf16 a[0:3], v[176:179], a[240:243], a[0:3]
    v_exp_f32 v247, v91
    v_fma_f32 v205, -v45, v214, v205
    v_mfma_f32_16x16x32_bf16 a[4:7], v[176:179], a[244:247], a[4:7]
    v_perm_b32 v173, v247, v246, s4
    v_perm_b32 v172, v245, v244, s4
    v_mfma_f32_16x16x32_bf16 a[4:7], v[160:163], a[228:231], a[4:7]
    v_exp_f32 v248, v92
    v_fma_f32 v209, v37, v214, v209
    v_mfma_f32_16x16x32_bf16 a[8:11], v[160:163], a[232:235], a[8:11]
    v_exp_f32 v249, v93
    v_mfma_f32_16x16x32_bf16 a[8:11], v[176:179], a[248:251], a[8:11]
    v_perm_b32 v174, v249, v248, s4
    v_fma_f32 v38, v38, v200, v202
    v_fma_f32 v46, v46, v201, v203
    v_mfma_f32_16x16x32_bf16 a[12:15], v[176:179], a[252:255], a[12:15]
    v_exp_f32 v250, v94
    v_mfma_f32_16x16x32_bf16 a[12:15], v[160:163], a[236:239], a[12:15]
    v_exp_f32 v251, v95
    v_lshlrev_b32 v212, 16, v51
    v_mfma_f32_16x16x32_bf16 a[44:47], v[164:167], a[236:239], a[44:47]
    v_perm_b32 v175, v251, v250, s4
    v_lshlrev_b32 v214, 16, v59
    v_mfma_f32_16x16x32_bf16 a[44:47], v[180:183], a[252:255], a[44:47]
    v_fma_f32 v206, v38, v212, s62
    v_fma_f32 v210, v46, v212, s62
    v_fma_f32 v206, -v46, v214, v206
    v_smfmac_f32_16x16x64_bf16 v[192:195], v[144:147], v[152:159], v255
    v_fma_f32 v210, v38, v214, v210
    v_fma_f32 v39, v39, v200, v202
    v_smfmac_f32_16x16x64_bf16 v[192:195], v[148:151], v[168:175], v255
    v_fma_f32 v47, v47, v201, v203
    v_and_b32 v212, s86, v51
    v_and_b32 v214, s86, v59
    v_mfma_f32_16x16x32_bf16 a[40:43], v[180:183], a[248:251], a[40:43]
    s_waitcnt vmcnt(22) lgkmcnt(0)
    s_barrier
    v_mfma_f32_16x16x32_bf16 a[40:43], v[164:167], a[232:235], a[40:43]
    v_fma_f32 v207, v39, v212, s62
    v_fma_f32 v211, v47, v212, s62
    v_fma_f32 v207, -v47, v214, v207
    v_mfma_f32_16x16x32_bf16 a[36:39], v[164:167], a[228:231], a[36:39]
    v_fma_f32 v211, v39, v214, v211
    v_cvt_pk_bf16_f32 v36, v204, v205
    v_mfma_f32_16x16x32_bf16 a[36:39], v[180:183], a[244:247], a[36:39]
    v_cvt_pk_bf16_f32 v37, v206, v207
    v_cvt_pk_bf16_f32 v38, v208, v209
    v_cvt_pk_bf16_f32 v39, v210, v211
    v_mfma_f32_16x16x32_bf16 a[32:35], v[180:183], a[240:243], a[32:35]
    buffer_store_dwordx4 v[32:35], v0, s[24:27], s79 offen offset:0 sc1
    v_cmp_lt_f32 vcc, s72, v192
    v_mfma_f32_16x16x32_bf16 a[32:35], v[164:167], a[224:227], a[32:35]
    s_cbranch_vccnz L_rare_r0_6
L_join_r0_6:
    v_mfma_f32_16x16x32_bf16 v[64:67], a[192:195], a[128:131], v[128:131]
    v_exp_f32 v244, v96
    v_mfma_f32_16x16x32_bf16 v[64:67], a[196:199], a[132:135], v[64:67]
    ds_read_b128 a[224:227], v14 offset:40960
    s_waitcnt vmcnt(1)
    v_cmp_ne_u64 vcc, v[6:7], v[4:5]
    v_mfma_f32_16x16x32_bf16 v[64:67], a[200:203], a[136:139], v[64:67]
    v_exp_f32_e64 v245, v97
    v_mfma_f32_16x16x32_bf16 v[64:67], a[204:207], a[140:143], v[64:67]
    ds_read_b128 a[228:231], v253 offset:40960
    v_perm_b32 v236, v245, v244, s4
    s_cbranch_vccnz L_spin_r0v
L_spinret_r0v:
    v_mfma_f32_16x16x32_bf16 v[72:75], a[204:207], a[156:159], v[132:135]
    v_exp_f32 v246, v98
    v_mfma_f32_16x16x32_bf16 v[72:75], a[200:203], a[152:155], v[72:75]
    ds_read_b128 a[232:235], v254 offset:40960
    v_add_u32 v2, s13, v2
    v_mfma_f32_16x16x32_bf16 v[72:75], a[196:199], a[148:151], v[72:75]
    v_exp_f32 v247, v99
    v_mfma_f32_16x16x32_bf16 v[72:75], a[192:195], a[144:147], v[72:75]
    ds_read_b128 a[236:239], v234 offset:40960
    buffer_store_dwordx4 v[36:39], v0, s[24:27], s79 offen offset:1024 sc1
    v_perm_b32 v237, v247, v246, s4
    v_mfma_f32_16x16x32_bf16 v[80:83], a[192:195], a[160:163], v[136:139]
    v_exp_f32 v248, v100
    v_mfma_f32_16x16x32_bf16 v[80:83], a[196:199], a[164:167], v[80:83]
    ds_read_b128 a[240:243], v14 offset:45056
    s_add_u32 s79, s79, 0x200000
    s_add_u32 s84, s84, 512
    v_mfma_f32_16x16x32_bf16 v[80:83], a[200:203], a[168:171], v[80:83]
    v_exp_f32 v249, v101
    v_mfma_f32_16x16x32_bf16 v[80:83], a[204:207], a[172:175], v[80:83]
    ds_read_b128 a[244:247], v253 offset:45056
    v_perm_b32 v238, v249, v248, s4
    v_mfma_f32_16x16x32_bf16 v[88:91], a[204:207], a[188:191], v[140:143]
    v_exp_f32 v250, v102
    v_mfma_f32_16x16x32_bf16 v[88:91], a[200:203], a[184:187], v[88:91]
    ds_read_b128 a[248:251], v254 offset:45056
    s_add_u32 m0, s73, 0
    v_mfma_f32_16x16x32_bf16 v[88:91], a[196:199], a[180:183], v[88:91]
    v_exp_f32 v251, v103
    v_mfma_f32_16x16x32_bf16 v[88:91], a[192:195], a[176:179], v[88:91]
    ds_read_b128 a[252:255], v234 offset:45056
    v_perm_b32 v239, v251, v250, s4
    v_mfma_f32_16x16x32_bf16 v[92:95], a[208:211], a[176:179], v[140:143]
    v_exp_f32 v244, v104
    v_mfma_f32_16x16x32_bf16 v[92:95], a[212:215], a[180:183], v[92:95]
    buffer_load_dwordx4 v2, s[24:27], s71 offen offset:0 sc1 lds
    v_mfma_f32_16x16x32_bf16 v[92:95], a[216:219], a[184:187], v[92:95]
    v_exp_f32 v245, v105
    v_mfma_f32_16x16x32_bf16 v[92:95], a[220:223], a[188:191], v[92:95]
    ds_read_b128 a[192:195], v252 offset:8192
    v_perm_b32 v240, v245, v244, s4
    v_mfma_f32_16x16x32_bf16 v[84:87], a[220:223], a[172:175], v[136:139]
    v_exp_f32 v246, v106
    v_mfma_f32_16x16x32_bf16 v[84:87], a[216:219], a[168:171], v[84:87]
    buffer_load_dwordx4 v2, s[24:27], s71 offen offset:1024 sc1 lds
    v_mfma_f32_16x16x32_bf16 v[84:87], a[212:215], a[164:167], v[84:87]
    v_exp_f32 v247, v107
    v_mfma_f32_16x16x32_bf16 v[84:87], a[208:211], a[160:163], v[84:87]
    ds_read_b128 a[196:199], v252 offset:9216
    v_perm_b32 v241, v247, v246, s4
    v_mfma_f32_16x16x32_bf16 v[76:79], a[208:211], a[144:147], v[132:135]
    v_exp_f32 v248, v108
    v_mfma_f32_16x16x32_bf16 v[76:79], a[212:215], a[148:151], v[76:79]
    buffer_load_dwordx4 v2, s[24:27], s71 offen offset:2048 sc1 lds
    v_mfma_f32_16x16x32_bf16 v[76:79], a[216:219], a[152:155], v[76:79]
    v_exp_f32 v249, v109
    v_mfma_f32_16x16x32_bf16 v[76:79], a[220:223], a[156:159], v[76:79]
    ds_read_b128 a[200:203], v252 offset:10240
    v_perm_b32 v242, v249, v248, s4
    v_mfma_f32_16x16x32_bf16 v[68:71], a[220:223], a[140:143], v[128:131]
    v_exp_f32 v250, v110
    v_mfma_f32_16x16x32_bf16 v[68:71], a[216:219], a[136:139], v[68:71]
    buffer_load_dwordx4 v2, s[24:27], s71 offen offset:3072 sc1 lds
    s_waitcnt lgkmcnt(3)
    v_mfma_f32_16x16x32_bf16 v[68:71], a[212:215], a[132:135], v[68:71]
    v_exp_f32 v251, v111
    v_mfma_f32_16x16x32_bf16 v[68:71], a[208:211], a[128:131], v[68:71]
    ds_read_b128 a[204:207], v252 offset:11264
    v_perm_b32 v243, v251, v250, s4
    v_mfma_f32_16x16x32_bf16 a[80:83], v[184:187], a[224:227], a[80:83]
    v_exp_f32 v244, v112
    v_mfma_f32_16x16x32_bf16 a[80:83], v[168:171], a[240:243], a[80:83]
    ds_read_b128 a[208:211], v252 offset:12288
    v_mfma_f32_16x16x32_bf16 a[84:87], v[168:171], a[244:247], a[84:87]
    v_exp_f32 v245, v113
    v_mfma_f32_16x16x32_bf16 a[84:87], v[184:187], a[228:231], a[84:87]
    ds_read_b128 a[212:215], v252 offset:13312
    ds_read_b128 a[216:219], v252 offset:14336
    v_lshlrev_b32 v213, 4, v1
    v_mfma_f32_16x16x32_bf16 a[88:91], v[184:187], a[232:235], a[88:91]
    v_exp_f32 v246, v114
    v_mfma_f32_16x16x32_bf16 a[88:91], v[168:171], a[248:251], a[88:91]
    v_exp_f32 v247, v115
    v_mov_b32 v215, 1
    v_mfma_f32_16x16x32_bf16 a[92:95], v[168:171], a[252:255], a[92:95]
    ds_read_b128 a[220:223], v252 offset:15360
    v_mov_b64 v[196:197], v[192:193]
    v_mfma_f32_16x16x32_bf16 a[92:95], v[184:187], a[236:239], a[92:95]
    v_exp_f32 v248, v116
    v_mfma_f32_16x16x32_bf16 a[124:127], v[188:191], a[236:239], a[124:127]
    v_exp_f32 v249, v117
    v_mfma_f32_16x16x32_bf16 a[124:127], v[172:175], a[252:255], a[124:127]
    v_perm_b32 v185, v247, v246, s4
    v_perm_b32 v184, v245, v244, s4
    v_mfma_f32_16x16x32_bf16 a[120:123], v[172:175], a[248:251], a[120:123]
    v_exp_f32 v250, v118
    v_mfma_f32_16x16x32_bf16 a[120:123], v[188:191], a[232:235], a[120:123]
    v_exp_f32 v251, v119
    v_mfma_f32_16x16x32_bf16 a[116:119], v[188:191], a[228:231], a[116:119]
    v_perm_b32 v187, v251, v250, s4
    v_perm_b32 v186, v249, v248, s4
    v_mfma_f32_16x16x32_bf16 a[116:119], v[172:175], a[244:247], a[116:119]
    v_exp_f32 v244, v120
    v_mfma_f32_16x16x32_bf16 a[112:115], v[172:175], a[240:243], a[112:115]
    v_exp_f32 v245, v121
    v_mfma_f32_16x16x32_bf16 a[112:115], v[188:191], a[224:227], a[112:115]
    v_mov_b64 v[198:199], v[194:195]
    s_lshr_b32 s14, s90, 20
    s_lshl4_add_u32 s14, s14, 8
    v_mfma_f32_16x16x32_bf16 a[16:19], v[176:179], a[224:227], a[16:19]
    v_exp_f32 v246, v122
    v_mfma_f32_16x16x32_bf16 a[16:19], v[152:155], a[240:243], a[16:19]
    v_exp_f32 v247, v123
    v_mfma_f32_16x16x32_bf16 a[20:23], v[152:155], a[244:247], a[20:23]
    v_perm_b32 v189, v247, v246, s4
    v_perm_b32 v188, v245, v244, s4
    v_mfma_f32_16x16x32_bf16 a[20:23], v[176:179], a[228:231], a[20:23]
    v_exp_f32 v248, v124
    v_mfma_f32_16x16x32_bf16 a[24:27], v[176:179], a[232:235], a[24:27]
    v_exp_f32 v249, v125
    v_mfma_f32_16x16x32_bf16 a[24:27], v[152:155], a[248:251], a[24:27]
    v_perm_b32 v190, v249, v248, s4
    s_bfe_u32 s15, s90, 0x10013
    s_add_u32 s14, s14, s15
    v_mfma_f32_16x16x32_bf16 a[28:31], v[152:155], a[252:255], a[28:31]
    v_exp_f32 v250, v126
    v_mfma_f32_16x16x32_bf16 a[28:31], v[176:179], a[236:239], a[28:31]
    v_exp_f32 v251, v127
    v_mfma_f32_16x16x32_bf16 a[60:63], v[180:183], a[236:239], a[60:63]
    v_perm_b32 v191, v251, v250, s4
    v_mfma_f32_16x16x32_bf16 a[60:63], v[156:159], a[252:255], a[60:63]
    s_or_b32 s15, s97, s96
    s_cselect_b32 s14, 0x7ff00000, s14
    v_smfmac_f32_16x16x64_bf16 v[196:199], v[144:147], v[236:243], v255
    buffer_store_byte v215, v213, s[8:11], s14 offen sc1
    v_smfmac_f32_16x16x64_bf16 v[196:199], v[148:151], v[184:191], v255
    v_mfma_f32_16x16x32_bf16 a[56:59], v[156:159], a[248:251], a[56:59]
    s_waitcnt vmcnt(12) lgkmcnt(0)
    s_barrier
    v_mfma_f32_16x16x32_bf16 a[56:59], v[180:183], a[232:235], a[56:59]
    v_mfma_f32_16x16x32_bf16 a[52:55], v[180:183], a[228:231], a[52:55]
    v_mfma_f32_16x16x32_bf16 a[52:55], v[156:159], a[244:247], a[52:55]
    v_mfma_f32_16x16x32_bf16 a[48:51], v[156:159], a[240:243], a[48:51]
    s_nop 0
    v_cmp_lt_f32 vcc, s72, v196
    v_mfma_f32_16x16x32_bf16 a[48:51], v[180:183], a[224:227], a[48:51]
    s_cbranch_vccnz L_rare_r0_7
L_join_r0_7:
    s_mov_b32 s74, 5
    s_nop 0
    s_nop 0
    s_nop 0
    s_nop 0
    s_nop 0
    s_nop 0
    s_nop 0
    s_nop 0
    s_nop 0
    s_nop 0
    s_nop 0
    s_nop 0
    s_nop 0
    s_nop 0
L_loop_rl:
    v_mfma_f32_16x16x32_bf16 v[96:99], a[192:195], a[128:131], v[128:131]
    v_exp_f32 v244, v64
    v_mfma_f32_16x16x32_bf16 v[96:99], a[196:199], a[132:135], v[96:99]
    ds_read_b128 a[224:227], v14 offset:49152
    s_waitcnt vmcnt(15)
    v_lshlrev_b32 v232, 16, v232
    v_mfma_f32_16x16x32_bf16 v[96:99], a[200:203], a[136:139], v[96:99]
    v_exp_f32 v245, v65
    v_mfma_f32_16x16x32_bf16 v[96:99], a[204:207], a[140:143], v[96:99]
    ds_read_b128 a[228:231], v253 offset:49152
    v_perm_b32 v160, v245, v244, s4
    v_mfma_f32_16x16x32_bf16 v[104:107], a[204:207], a[156:159], v[132:135]
    v_exp_f32 v246, v66
    v_mfma_f32_16x16x32_bf16 v[104:107], a[200:203], a[152:155], v[104:107]
    ds_read_b128 a[232:235], v254 offset:49152
    v_lshlrev_b32 v233, 16, v233
    v_mfma_f32_16x16x32_bf16 v[104:107], a[196:199], a[148:151], v[104:107]
    v_exp_f32 v247, v67
    v_mfma_f32_16x16x32_bf16 v[104:107], a[192:195], a[144:147], v[104:107]
    ds_read_b128 a[236:239], v234 offset:49152
    v_perm_b32 v161, v247, v246, s4
    v_mfma_f32_16x16x32_bf16 v[112:115], a[192:195], a[160:163], v[136:139]
    v_exp_f32 v248, v68
    v_mfma_f32_16x16x32_bf16 v[112:115], a[196:199], a[164:167], v[112:115]
    ds_read_b128 a[240:243], v14 offset:53248
    v_fma_f32 v233, v233, v232, -s63
    v_mfma_f32_16x16x32_bf16 v[112:115], a[200:203], a[168:171], v[112:115]
    v_exp_f32 v249, v69
    v_mfma_f32_16x16x32_bf16 v[112:115], a[204:207], a[172:175], v[112:115]
    ds_read_b128 a[244:247], v253 offset:53248
    v_perm_b32 v162, v249, v248, s4
    v_mfma_f32_16x16x32_bf16 v[120:123], a[204:207], a[188:191], v[140:143]
    v_exp_f32 v250, v70
    v_mfma_f32_16x16x32_bf16 v[120:123], a[200:203], a[184:187], v[120:123]
    ds_read_b128 a[248:251], v254 offset:53248
    s_add_u32 m0, s73, 8192
    v_mfma_f32_16x16x32_bf16 v[120:123], a[196:199], a[180:183], v[120:123]
    v_exp_f32 v251, v71
    v_mfma_f32_16x16x32_bf16 v[120:123], a[192:195], a[176:179], v[120:123]
    ds_read_b128 a[252:255], v234 offset:53248
    v_perm_b32 v163, v251, v250, s4
    v_mfma_f32_16x16x32_bf16 v[124:127], a[208:211], a[176:179], v[140:143]
    v_exp_f32 v244, v72
    v_mfma_f32_16x16x32_bf16 v[124:127], a[212:215], a[180:183], v[124:127]
    buffer_load_dwordx4 v2, s[24:27], s64 offen offset:0 sc1 lds
    v_cvt_f32_i32 v216, v216
    v_cvt_f32_i32 v217, v217
    v_mfma_f32_16x16x32_bf16 v[124:127], a[216:219], a[184:187], v[124:127]
    v_exp_f32 v245, v73
    v_mfma_f32_16x16x32_bf16 v[124:127], a[220:223], a[188:191], v[124:127]
    ds_read_b128 a[192:195], v252 offset:16384
    v_perm_b32 v164, v245, v244, s4
    v_mfma_f32_16x16x32_bf16 v[116:119], a[220:223], a[172:175], v[136:139]
    v_exp_f32 v246, v74
    v_mfma_f32_16x16x32_bf16 v[116:119], a[216:219], a[168:171], v[116:119]
    buffer_load_dwordx4 v2, s[24:27], s64 offen offset:1024 sc1 lds
    v_mul_f32_dpp v216, v232, v216 row_newbcast:0 row_mask:0xf bank_mask:0xf
    v_mfma_f32_16x16x32_bf16 v[116:119], a[212:215], a[164:167], v[116:119]
    v_exp_f32 v247, v75
    v_mfma_f32_16x16x32_bf16 v[116:119], a[208:211], a[160:163], v[116:119]
    ds_read_b128 a[196:199], v252 offset:17408
    v_perm_b32 v165, v247, v246, s4
    v_mfma_f32_16x16x32_bf16 v[108:111], a[208:211], a[144:147], v[132:135]
    v_exp_f32 v248, v76
    v_mfma_f32_16x16x32_bf16 v[108:111], a[212:215], a[148:151], v[108:111]
    buffer_load_dwordx4 v2, s[24:27], s64 offen offset:2048 sc1 lds
    v_mul_f32_dpp v217, v232, v217 row_newbcast:0 row_mask:0xf bank_mask:0xf
    v_mfma_f32_16x16x32_bf16 v[108:111], a[216:219], a[152:155], v[108:111]
    v_exp_f32 v249, v77
    v_mfma_f32_16x16x32_bf16 v[108:111], a[220:223], a[156:159], v[108:111]
    ds_read_b128 a[200:203], v252 offset:18432
    v_perm_b32 v166, v249, v248, s4
    v_mfma_f32_16x16x32_bf16 v[100:103], a[220:223], a[140:143], v[128:131]
    v_exp_f32 v250, v78
    v_mfma_f32_16x16x32_bf16 v[100:103], a[216:219], a[136:139], v[100:103]
    buffer_load_dwordx4 v2, s[24:27], s64 offen offset:3072 sc1 lds
    s_waitcnt lgkmcnt(3)
    v_mfma_f32_16x16x32_bf16 v[100:103], a[212:215], a[132:135], v[100:103]
    v_exp_f32 v251, v79
    v_mfma_f32_16x16x32_bf16 v[100:103], a[208:211], a[128:131], v[100:103]
    ds_read_b128 a[204:207], v252 offset:19456
    v_perm_b32 v167, v251, v250, s4
    v_mfma_f32_16x16x32_bf16 a[64:67], v[168:171], a[224:227], a[64:67]
    v_exp_f32 v244, v80
    v_mfma_f32_16x16x32_bf16 a[64:67], v[184:187], a[240:243], a[64:67]
    ds_read_b128 a[208:211], v252 offset:20480
    v_subrev_f32_dpp v216, v233, v216 row_newbcast:0 row_mask:0xf bank_mask:0xf
    v_subrev_f32_dpp v217, v233, v217 row_newbcast:0 row_mask:0xf bank_mask:0xf
    v_mfma_f32_16x16x32_bf16 a[68:71], v[184:187], a[244:247], a[68:71]
    v_exp_f32 v245, v81
    v_mfma_f32_16x16x32_bf16 a[68:71], v[168:171], a[228:231], a[68:71]
    ds_read_b128 a[212:215], v252 offset:21504
    ds_read_b128 a[216:219], v252 offset:22528
    v_mfma_f32_16x16x32_bf16 a[72:75], v[168:171], a[232:235], a[72:75]
    v_exp_f32 v246, v82
    v_mfma_f32_16x16x32_bf16 a[72:75], v[184:187], a[248:251], a[72:75]
    v_exp_f32 v247, v83
    v_mfma_f32_16x16x32_bf16 a[76:79], v[184:187], a[252:255], a[76:79]
    ds_read_b128 a[220:223], v252 offset:23552
    v_mov_b64 v[192:193], v[196:197]
    v_mfma_f32_16x16x32_bf16 a[76:79], v[168:171], a[236:239], a[76:79]
    v_exp_f32 v248, v84
    v_mfma_f32_16x16x32_bf16 a[108:111], v[172:175], a[236:239], a[108:111]
    v_exp_f32 v249, v85
    v_mfma_f32_16x16x32_bf16 a[108:111], v[188:191], a[252:255], a[108:111]
    v_perm_b32 v169, v247, v246, s4
    v_perm_b32 v168, v245, v244, s4
    v_mfma_f32_16x16x32_bf16 a[104:107], v[188:191], a[248:251], a[104:107]
    v_exp_f32 v250, v86
    v_mfma_f32_16x16x32_bf16 a[104:107], v[172:175], a[232:235], a[104:107]
    v_exp_f32 v251, v87
    v_mfma_f32_16x16x32_bf16 a[100:103], v[172:175], a[228:231], a[100:103]
    v_perm_b32 v171, v251, v250, s4
    v_perm_b32 v170, v249, v248, s4
    v_mfma_f32_16x16x32_bf16 a[100:103], v[188:191], a[244:247], a[100:103]
    v_exp_f32 v244, v88
    v_mfma_f32_16x16x32_bf16 a[96:99], v[188:191], a[240:243], a[96:99]
    v_exp_f32 v245, v89
    v_mfma_f32_16x16x32_bf16 a[96:99], v[172:175], a[224:227], a[96:99]
    buffer_load_dwordx4 v[16:19], v8, s[28:31], s5 offen offset:0
    v_mov_b64 v[194:195], v[198:199]
    v_mfma_f32_16x16x32_bf16 a[0:3], v[152:155], a[224:227], a[0:3]
    v_exp_f32 v246, v90
    v_mfma_f32_16x16x32_bf16 a[0:3], v[236:239], a[240:243], a[0:3]
    v_exp_f32 v247, v91
    v_cvt_f32_i32 v218, v218
    v_mfma_f32_16x16x32_bf16 a[4:7], v[236:239], a[244:247], a[4:7]
    v_perm_b32 v173, v247, v246, s4
    v_perm_b32 v172, v245, v244, s4
    v_mfma_f32_16x16x32_bf16 a[4:7], v[152:155], a[228:231], a[4:7]
    v_exp_f32 v248, v92
    v_mfma_f32_16x16x32_bf16 a[8:11], v[152:155], a[232:235], a[8:11]
    v_exp_f32 v249, v93
    v_mfma_f32_16x16x32_bf16 a[8:11], v[236:239], a[248:251], a[8:11]
    buffer_load_dwordx4 v[20:23], v8, s[28:31], s5 offen offset:16
    v_perm_b32 v174, v249, v248, s4
    v_mfma_f32_16x16x32_bf16 a[12:15], v[236:239], a[252:255], a[12:15]
    v_exp_f32 v250, v94
    v_mfma_f32_16x16x32_bf16 a[12:15], v[152:155], a[236:239], a[12:15]
    v_exp_f32 v251, v95
    v_mfma_f32_16x16x32_bf16 a[44:47], v[156:159], a[236:239], a[44:47]
    v_perm_b32 v175, v251, v250, s4
    v_cvt_f32_i32 v219, v219
    v_mfma_f32_16x16x32_bf16 a[44:47], v[240:243], a[252:255], a[44:47]
    buffer_load_dwordx4 v[24:27], v8, s[28:31], s5 offen offset:256
    v_mul_f32_dpp v218, v232, v218 row_newbcast:1 row_mask:0xf bank_mask:0xf
    v_smfmac_f32_16x16x64_bf16 v[192:195], v[144:147], v[160:167], v255
    v_mul_f32_dpp v219, v232, v219 row_newbcast:1 row_mask:0xf bank_mask:0xf
    v_subrev_f32_dpp v218, v233, v218 row_newbcast:1 row_mask:0xf bank_mask:0xf
    v_smfmac_f32_16x16x64_bf16 v[192:195], v[148:151], v[168:175], v255
    v_subrev_f32_dpp v219, v233, v219 row_newbcast:1 row_mask:0xf bank_mask:0xf
    v_cvt_f32_i32 v220, v220
    v_mfma_f32_16x16x32_bf16 a[40:43], v[240:243], a[248:251], a[40:43]
    s_waitcnt vmcnt(7) lgkmcnt(0)
    s_barrier
    v_mfma_f32_16x16x32_bf16 a[40:43], v[156:159], a[232:235], a[40:43]
    buffer_load_dwordx4 v[28:31], v8, s[28:31], s5 offen offset:272
    v_cvt_f32_i32 v221, v221
    v_mfma_f32_16x16x32_bf16 a[36:39], v[156:159], a[228:231], a[36:39]
    v_mul_f32_dpp v220, v232, v220 row_newbcast:4 row_mask:0xf bank_mask:0xf
    v_mul_f32_dpp v221, v232, v221 row_newbcast:4 row_mask:0xf bank_mask:0xf
    v_mfma_f32_16x16x32_bf16 a[36:39], v[240:243], a[244:247], a[36:39]
    v_subrev_f32_dpp v220, v233, v220 row_newbcast:4 row_mask:0xf bank_mask:0xf
    v_subrev_f32_dpp v221, v233, v221 row_newbcast:4 row_mask:0xf bank_mask:0xf
    v_mfma_f32_16x16x32_bf16 a[32:35], v[240:243], a[240:243], a[32:35]
    v_cmp_lt_f32 vcc, s72, v192
    v_cvt_f32_i32 v222, v222
    v_mfma_f32_16x16x32_bf16 a[32:35], v[156:159], a[224:227], a[32:35]
    buffer_load_dwordx2 v[200:201], v10, s[32:35], s7 offen
    v_cvt_f32_i32 v223, v223
    s_cbranch_vccnz L_rare_rl_0
L_join_rl_0:
    v_mfma_f32_16x16x32_bf16 v[64:67], a[192:195], a[128:131], v[128:131]
    v_exp_f32 v244, v96
    v_mfma_f32_16x16x32_bf16 v[64:67], a[196:199], a[132:135], v[64:67]
    ds_read_b128 a[224:227], v14 offset:57344
    buffer_store_dwordx2 v[4:5], v13, s[24:27], s81 offen sc1
    s_add_u32 s81, s81, 512
    v_mfma_f32_16x16x32_bf16 v[64:67], a[200:203], a[136:139], v[64:67]
    v_exp_f32 v245, v97
    v_mfma_f32_16x16x32_bf16 v[64:67], a[204:207], a[140:143], v[64:67]
    ds_read_b128 a[228:231], v253 offset:57344
    v_perm_b32 v176, v245, v244, s4
    v_mfma_f32_16x16x32_bf16 v[72:75], a[204:207], a[156:159], v[132:135]
    v_exp_f32 v246, v98
    v_mfma_f32_16x16x32_bf16 v[72:75], a[200:203], a[152:155], v[72:75]
    ds_read_b128 a[232:235], v254 offset:57344
    buffer_load_dwordx2 v[202:203], v10, s[36:39], s7 offen
    v_mfma_f32_16x16x32_bf16 v[72:75], a[196:199], a[148:151], v[72:75]
    v_exp_f32 v247, v99
    v_mfma_f32_16x16x32_bf16 v[72:75], a[192:195], a[144:147], v[72:75]
    ds_read_b128 a[236:239], v234 offset:57344
    v_perm_b32 v177, v247, v246, s4
    v_mfma_f32_16x16x32_bf16 v[80:83], a[192:195], a[160:163], v[136:139]
    v_exp_f32 v248, v100
    v_mfma_f32_16x16x32_bf16 v[80:83], a[196:199], a[164:167], v[80:83]
    ds_read_b128 a[240:243], v14 offset:61440
L_stop4:
    s_cbranch_execz L_stop8
    buffer_load_dwordx4 v[48:51], v9, s[40:43], s6 offen offset:0
    v_mfma_f32_16x16x32_bf16 v[80:83], a[200:203], a[168:171], v[80:83]
    v_exp_f32 v249, v101
    v_mfma_f32_16x16x32_bf16 v[80:83], a[204:207], a[172:175], v[80:83]
    ds_read_b128 a[244:247], v253 offset:61440
    v_perm_b32 v178, v249, v248, s4
    v_mfma_f32_16x16x32_bf16 v[88:91], a[204:207], a[188:191], v[140:143]
    v_exp_f32 v250, v102
    v_mfma_f32_16x16x32_bf16 v[88:91], a[200:203], a[184:187], v[88:91]
    ds_read_b128 a[248:251], v254 offset:61440
    s_add_u32 m0, s73, 16384
    v_mfma_f32_16x16x32_bf16 v[88:91], a[196:199], a[180:183], v[88:91]
    v_exp_f32 v251, v103
    v_mfma_f32_16x16x32_bf16 v[88:91], a[192:195], a[176:179], v[88:91]
    ds_read_b128 a[252:255], v234 offset:61440
    v_perm_b32 v179, v251, v250, s4
    v_mfma_f32_16x16x32_bf16 v[92:95], a[208:211], a[176:179], v[140:143]
    v_exp_f32 v244, v104
    v_mfma_f32_16x16x32_bf16 v[92:95], a[212:215], a[180:183], v[92:95]
    buffer_load_dwordx4 v2, s[24:27], s65 offen offset:0 sc1 lds
    v_mul_f32_dpp v222, v232, v222 row_newbcast:5 row_mask:0xf bank_mask:0xf
    v_mul_f32_dpp v223, v232, v223 row_newbcast:5 row_mask:0xf bank_mask:0xf
    v_mfma_f32_16x16x32_bf16 v[92:95], a[216:219], a[184:187], v[92:95]
    v_exp_f32 v245, v105
    v_mfma_f32_16x16x32_bf16 v[92:95], a[220:223], a[188:191], v[92:95]
    ds_read_b128 a[192:195], v252 offset:24576
    v_perm_b32 v180, v245, v244, s4
    v_mfma_f32_16x16x32_bf16 v[84:87], a[220:223], a[172:175], v[136:139]
    v_exp_f32 v246, v106
    v_mfma_f32_16x16x32_bf16 v[84:87], a[216:219], a[168:171], v[84:87]
    buffer_load_dwordx4 v2, s[24:27], s65 offen offset:1024 sc1 lds
    v_subrev_f32_dpp v222, v233, v222 row_newbcast:5 row_mask:0xf bank_mask:0xf
    v_mfma_f32_16x16x32_bf16 v[84:87], a[212:215], a[164:167], v[84:87]
    v_exp_f32 v247, v107
    v_mfma_f32_16x16x32_bf16 v[84:87], a[208:211], a[160:163], v[84:87]
    ds_read_b128 a[196:199], v252 offset:25600
    v_perm_b32 v181, v247, v246, s4
    v_mfma_f32_16x16x32_bf16 v[76:79], a[208:211], a[144:147], v[132:135]
    v_exp_f32 v248, v108
    v_mfma_f32_16x16x32_bf16 v[76:79], a[212:215], a[148:151], v[76:79]
    buffer_load_dwordx4 v2, s[24:27], s65 offen offset:2048 sc1 lds
    v_subrev_f32_dpp v223, v233, v223 row_newbcast:5 row_mask:0xf bank_mask:0xf
    v_mfma_f32_16x16x32_bf16 v[76:79], a[216:219], a[152:155], v[76:79]
    v_exp_f32 v249, v109
    v_mfma_f32_16x16x32_bf16 v[76:79], a[220:223], a[156:159], v[76:79]
    ds_read_b128 a[200:203], v252 offset:26624
    v_perm_b32 v182, v249, v248, s4
    v_mfma_f32_16x16x32_bf16 v[68:71], a[220:223], a[140:143], v[128:131]
    v_exp_f32 v250, v110
    v_mfma_f32_16x16x32_bf16 v[68:71], a[216:219], a[136:139], v[68:71]
    buffer_load_dwordx4 v2, s[24:27], s65 offen offset:3072 sc1 lds
    s_waitcnt lgkmcnt(3)
    v_mfma_f32_16x16x32_bf16 v[68:71], a[212:215], a[132:135], v[68:71]
    v_exp_f32 v251, v111
    v_mfma_f32_16x16x32_bf16 v[68:71], a[208:211], a[128:131], v[68:71]
    ds_read_b128 a[204:207], v252 offset:27648
    v_perm_b32 v183, v251, v250, s4
    v_mfma_f32_16x16x32_bf16 a[80:83], v[184:187], a[224:227], a[80:83]
    v_exp_f32 v244, v112
    v_mfma_f32_16x16x32_bf16 a[80:83], v[168:171], a[240:243], a[80:83]
    ds_read_b128 a[208:211], v252 offset:28672
    buffer_load_dwordx4 v[56:59], v9, s[44:47], s6 offen offset:0
    v_cvt_pk_bf16_f32 v216, v216, v218
    v_mfma_f32_16x16x32_bf16 a[84:87], v[168:171], a[244:247], a[84:87]
    v_exp_f32 v245, v113
    v_mfma_f32_16x16x32_bf16 a[84:87], v[184:187], a[228:231], a[84:87]
    ds_read_b128 a[212:215], v252 offset:29696
    ds_read_b128 a[216:219], v252 offset:30720
    v_mfma_f32_16x16x32_bf16 a[88:91], v[184:187], a[232:235], a[88:91]
    v_exp_f32 v246, v114
    v_mfma_f32_16x16x32_bf16 a[88:91], v[168:171], a[248:251], a[88:91]
    v_exp_f32 v247, v115
    v_mfma_f32_16x16x32_bf16 a[92:95], v[168:171], a[252:255], a[92:95]
    ds_read_b128 a[220:223], v252 offset:31744
    v_mov_b64 v[196:197], v[192:193]
    v_mfma_f32_16x16x32_bf16 a[92:95], v[184:187], a[236:239], a[92:95]
    v_exp_f32 v248, v116
    v_mfma_f32_16x16x32_bf16 a[124:127], v[188:191], a[236:239], a[124:127]
    v_exp_f32 v249, v117
    v_mfma_f32_16x16x32_bf16 a[124:127], v[172:175], a[252:255], a[124:127]
    v_perm_b32 v185, v247, v246, s4
    v_perm_b32 v184, v245, v244, s4
    v_mfma_f32_16x16x32_bf16 a[120:123], v[172:175], a[248:251], a[120:123]
    v_exp_f32 v250, v118
    v_mfma_f32_16x16x32_bf16 a[120:123], v[188:191], a[232:235], a[120:123]
    v_exp_f32 v251, v119
    v_mfma_f32_16x16x32_bf16 a[116:119], v[188:191], a[228:231], a[116:119]
    v_perm_b32 v187, v251, v250, s4
    v_perm_b32 v186, v249, v248, s4
    v_mfma_f32_16x16x32_bf16 a[116:119], v[172:175], a[244:247], a[116:119]
    v_exp_f32 v244, v120
    v_mfma_f32_16x16x32_bf16 a[112:115], v[172:175], a[240:243], a[112:115]
    v_exp_f32 v245, v121
    v_mfma_f32_16x16x32_bf16 a[112:115], v[188:191], a[224:227], a[112:115]
    v_mov_b64 v[198:199], v[194:195]
    v_cvt_pk_bf16_f32 v218, v220, v222
    v_mfma_f32_16x16x32_bf16 a[16:19], v[236:239], a[224:227], a[16:19]
    v_exp_f32 v246, v122
    v_mfma_f32_16x16x32_bf16 a[16:19], v[160:163], a[240:243], a[16:19]
    v_exp_f32 v247, v123
    v_cvt_pk_bf16_f32 v220, v217, v219
    v_mfma_f32_16x16x32_bf16 a[20:23], v[160:163], a[244:247], a[20:23]
    v_perm_b32 v189, v247, v246, s4
    v_perm_b32 v188, v245, v244, s4
    v_mfma_f32_16x16x32_bf16 a[20:23], v[236:239], a[228:231], a[20:23]
    v_exp_f32 v248, v124
    v_mfma_f32_16x16x32_bf16 a[24:27], v[236:239], a[232:235], a[24:27]
    v_exp_f32 v249, v125
    v_mfma_f32_16x16x32_bf16 a[24:27], v[160:163], a[248:251], a[24:27]
    v_perm_b32 v190, v249, v248, s4
    v_cvt_pk_bf16_f32 v222, v221, v223
    v_mfma_f32_16x16x32_bf16 a[28:31], v[160:163], a[252:255], a[28:31]
    v_exp_f32 v250, v126
    v_mfma_f32_16x16x32_bf16 a[28:31], v[236:239], a[236:239], a[28:31]
    v_exp_f32 v251, v127
    v_mfma_f32_16x16x32_bf16 a[60:63], v[240:243], a[236:239], a[60:63]
    v_perm_b32 v191, v251, v250, s4
    v_cvt_f32_i32 v224, v224
    v_mfma_f32_16x16x32_bf16 a[60:63], v[164:167], a[252:255], a[60:63]
    s_add_u32 s5, s5, 0x20000
    s_and_b32 s5, s5, 0xfffff
    v_smfmac_f32_16x16x64_bf16 v[196:199], v[144:147], v[176:183], v255
    s_lshr_b32 s6, s5, 1
    s_lshr_b32 s7, s5, 6
    v_smfmac_f32_16x16x64_bf16 v[196:199], v[148:151], v[184:191], v255
    v_cvt_f32_i32 v225, v225
    v_mul_f32_dpp v224, v232, v224 row_newbcast:2 row_mask:0xf bank_mask:0xf
    v_mfma_f32_16x16x32_bf16 a[56:59], v[164:167], a[248:251], a[56:59]
    s_waitcnt vmcnt(18) lgkmcnt(0)
    s_barrier
    v_mfma_f32_16x16x32_bf16 a[56:59], v[240:243], a[232:235], a[56:59]
    v_mul_f32_dpp v225, v232, v225 row_newbcast:2 row_mask:0xf bank_mask:0xf
    v_subrev_f32_dpp v224, v233, v224 row_newbcast:2 row_mask:0xf bank_mask:0xf
    v_mfma_f32_16x16x32_bf16 a[52:55], v[240:243], a[228:231], a[52:55]
    v_subrev_f32_dpp v225, v233, v225 row_newbcast:2 row_mask:0xf bank_mask:0xf
    v_cvt_f32_i32_e64 v226, v226
    v_mfma_f32_16x16x32_bf16 a[52:55], v[164:167], a[244:247], a[52:55]
    v_cvt_f32_i32_e64 v227, v227
    v_mul_f32_dpp v226, v232, v226 row_newbcast:3 row_mask:0xf bank_mask:0xf
    v_mfma_f32_16x16x32_bf16 a[48:51], v[164:167], a[240:243], a[48:51]
    v_cmp_lt_f32_e64 vcc, s72, v196
    v_mul_f32_dpp v227, v232, v227 row_newbcast:3 row_mask:0xf bank_mask:0xf
    v_mfma_f32_16x16x32_bf16 a[48:51], v[240:243], a[224:227], a[48:51]
    v_subrev_f32_dpp v226, v233, v226 row_newbcast:3 row_mask:0xf bank_mask:0xf
    v_subrev_f32_dpp v227, v233, v227 row_newbcast:3 row_mask:0xf bank_mask:0xf
    s_cbranch_vccnz L_rare_rl_1
L_join_rl_1:
    v_mfma_f32_16x16x32_bf16 v[96:99], a[192:195], a[128:131], v[128:131]
    v_exp_f32 v244, v64
    v_mfma_f32_16x16x32_bf16 v[96:99], a[196:199], a[132:135], v[96:99]
    ds_read_b128 a[224:227], v14 offset:32768
    v_cvt_pk_bf16_f32 v217, v224, v226
    v_cvt_pk_bf16_f32 v221, v225, v227
    v_mfma_f32_16x16x32_bf16 v[96:99], a[200:203], a[136:139], v[96:99]
    v_exp_f32 v245, v65
    v_mfma_f32_16x16x32_bf16 v[96:99], a[204:207], a[140:143], v[96:99]
    ds_read_b128 a[228:231], v253 offset:32768
    v_perm_b32 v152, v245, v244, s4
    v_mfma_f32_16x16x32_bf16 v[104:107], a[204:207], a[156:159], v[132:135]
    v_exp_f32 v246, v66
    v_mfma_f32_16x16x32_bf16 v[104:107], a[200:203], a[152:155], v[104:107]
    ds_read_b128 a[232:235], v254 offset:32768
    v_cvt_f32_i32 v228, v228
    v_mfma_f32_16x16x32_bf16 v[104:107], a[196:199], a[148:151], v[104:107]
    v_exp_f32 v247, v67
    v_mfma_f32_16x16x32_bf16 v[104:107], a[192:195], a[144:147], v[104:107]
    ds_read_b128 a[236:239], v234 offset:32768
    v_perm_b32 v153, v247, v246, s4
    v_mfma_f32_16x16x32_bf16 v[112:115], a[192:195], a[160:163], v[136:139]
    v_exp_f32 v248, v68
    v_mfma_f32_16x16x32_bf16 v[112:115], a[196:199], a[164:167], v[112:115]
    ds_read_b128 a[240:243], v14 offset:36864
    v_cvt_f32_i32 v229, v229
    v_mfma_f32_16x16x32_bf16 v[112:115], a[200:203], a[168:171], v[112:115]
    v_exp_f32 v249, v69
    v_mfma_f32_16x16x32_bf16 v[112:115], a[204:207], a[172:175], v[112:115]
    ds_read_b128 a[244:247], v253 offset:36864
    v_perm_b32 v154, v249, v248, s4
    v_mfma_f32_16x16x32_bf16 v[120:123], a[204:207], a[188:191], v[140:143]
    v_exp_f32 v250, v70
    v_mfma_f32_16x16x32_bf16 v[120:123], a[200:203], a[184:187], v[120:123]
    ds_read_b128 a[248:251], v254 offset:36864
    s_add_u32 m0, s73, 24576
    v_mfma_f32_16x16x32_bf16 v[120:123], a[196:199], a[180:183], v[120:123]
    v_exp_f32 v251, v71
    v_mfma_f32_16x16x32_bf16 v[120:123], a[192:195], a[176:179], v[120:123]
    ds_read_b128 a[252:255], v234 offset:36864
    v_perm_b32 v155, v251, v250, s4
    v_mfma_f32_16x16x32_bf16 v[124:127], a[208:211], a[176:179], v[140:143]
    v_exp_f32 v244, v72
    v_mfma_f32_16x16x32_bf16 v[124:127], a[212:215], a[180:183], v[124:127]
    buffer_load_dwordx4 v2, s[24:27], s66 offen offset:0 sc1 lds
    v_mul_f32_dpp v228, v232, v228 row_newbcast:6 row_mask:0xf bank_mask:0xf
    v_mul_f32_dpp v229, v232, v229 row_newbcast:6 row_mask:0xf bank_mask:0xf
    v_mfma_f32_16x16x32_bf16 v[124:127], a[216:219], a[184:187], v[124:127]
    v_exp_f32 v245, v73
    v_mfma_f32_16x16x32_bf16 v[124:127], a[220:223], a[188:191], v[124:127]
    ds_read_b128 a[192:195], v252 offset:0
    v_perm_b32 v156, v245, v244, s4
    v_mfma_f32_16x16x32_bf16 v[116:119], a[220:223], a[172:175], v[136:139]
    v_exp_f32 v246, v74
    v_mfma_f32_16x16x32_bf16 v[116:119], a[216:219], a[168:171], v[116:119]
    buffer_load_dwordx4 v2, s[24:27], s66 offen offset:1024 sc1 lds
    v_subrev_f32_dpp v228, v233, v228 row_newbcast:6 row_mask:0xf bank_mask:0xf
    v_mfma_f32_16x16x32_bf16 v[116:119], a[212:215], a[164:167], v[116:119]
    v_exp_f32 v247, v75
    v_mfma_f32_16x16x32_bf16 v[116:119], a[208:211], a[160:163], v[116:119]
    ds_read_b128 a[196:199], v252 offset:1024
    v_perm_b32 v157, v247, v246, s4
    v_mfma_f32_16x16x32_bf16 v[108:111], a[208:211], a[144:147], v[132:135]
    v_exp_f32 v248, v76
    v_mfma_f32_16x16x32_bf16 v[108:111], a[212:215], a[148:151], v[108:111]
    buffer_load_dwordx4 v2, s[24:27], s66 offen offset:2048 sc1 lds
    v_subrev_f32_dpp v229, v233, v229 row_newbcast:6 row_mask:0xf bank_mask:0xf
    v_mfma_f32_16x16x32_bf16 v[108:111], a[216:219], a[152:155], v[108:111]
    v_exp_f32 v249, v77
    v_mfma_f32_16x16x32_bf16 v[108:111], a[220:223], a[156:159], v[108:111]
    ds_read_b128 a[200:203], v252 offset:2048
    v_perm_b32 v158, v249, v248, s4
    v_mfma_f32_16x16x32_bf16 v[100:103], a[220:223], a[140:143], v[128:131]
    v_exp_f32 v250, v78
    v_mfma_f32_16x16x32_bf16 v[100:103], a[216:219], a[136:139], v[100:103]
    buffer_load_dwordx4 v2, s[24:27], s66 offen offset:3072 sc1 lds
    s_waitcnt lgkmcnt(3)
    v_mfma_f32_16x16x32_bf16 v[100:103], a[212:215], a[132:135], v[100:103]
    v_exp_f32 v251, v79
    v_mfma_f32_16x16x32_bf16 v[100:103], a[208:211], a[128:131], v[100:103]
    ds_read_b128 a[204:207], v252 offset:3072
    v_perm_b32 v159, v251, v250, s4
    v_mfma_f32_16x16x32_bf16 a[64:67], v[168:171], a[224:227], a[64:67]
    v_exp_f32 v244, v80
    v_mfma_f32_16x16x32_bf16 a[64:67], v[184:187], a[240:243], a[64:67]
    ds_read_b128 a[208:211], v252 offset:4096
    v_cvt_f32_i32 v230, v230
    v_cvt_f32_i32 v231, v231
    v_mfma_f32_16x16x32_bf16 a[68:71], v[184:187], a[244:247], a[68:71]
    v_exp_f32 v245, v81
    v_mfma_f32_16x16x32_bf16 a[68:71], v[168:171], a[228:231], a[68:71]
    ds_read_b128 a[212:215], v252 offset:5120
    ds_read_b128 a[216:219], v252 offset:6144
    v_mfma_f32_16x16x32_bf16 a[72:75], v[168:171], a[232:235], a[72:75]
    v_exp_f32 v246, v82
    v_mfma_f32_16x16x32_bf16 a[72:75], v[184:187], a[248:251], a[72:75]
    v_exp_f32 v247, v83
    v_mfma_f32_16x16x32_bf16 a[76:79], v[184:187], a[252:255], a[76:79]
    ds_read_b128 a[220:223], v252 offset:7168
    v_mov_b64 v[192:193], v[196:197]
    v_mfma_f32_16x16x32_bf16 a[76:79], v[168:171], a[236:239], a[76:79]
    v_exp_f32 v248, v84
    v_mfma_f32_16x16x32_bf16 a[108:111], v[172:175], a[236:239], a[108:111]
    v_exp_f32 v249, v85
    v_mfma_f32_16x16x32_bf16 a[108:111], v[188:191], a[252:255], a[108:111]
    v_perm_b32 v169, v247, v246, s4
    v_perm_b32 v168, v245, v244, s4
    v_mfma_f32_16x16x32_bf16 a[104:107], v[188:191], a[248:251], a[104:107]
    v_exp_f32 v250, v86
    v_mfma_f32_16x16x32_bf16 a[104:107], v[172:175], a[232:235], a[104:107]
    v_exp_f32 v251, v87
    v_mfma_f32_16x16x32_bf16 a[100:103], v[172:175], a[228:231], a[100:103]
    v_perm_b32 v171, v251, v250, s4
    v_perm_b32 v170, v249, v248, s4
    v_mfma_f32_16x16x32_bf16 a[100:103], v[188:191], a[244:247], a[100:103]
    v_exp_f32 v244, v88
    v_mfma_f32_16x16x32_bf16 a[96:99], v[188:191], a[240:243], a[96:99]
    v_exp_f32 v245, v89
    v_mfma_f32_16x16x32_bf16 a[96:99], v[172:175], a[224:227], a[96:99]
    v_mov_b64 v[194:195], v[198:199]
    v_mul_f32_dpp v230, v232, v230 row_newbcast:7 row_mask:0xf bank_mask:0xf
    v_mfma_f32_16x16x32_bf16 a[0:3], v[160:163], a[224:227], a[0:3]
    v_exp_f32 v246, v90
    v_mfma_f32_16x16x32_bf16 a[0:3], v[176:179], a[240:243], a[0:3]
    v_exp_f32 v247, v91
    v_mul_f32_dpp v231, v232, v231 row_newbcast:7 row_mask:0xf bank_mask:0xf
    v_mfma_f32_16x16x32_bf16 a[4:7], v[176:179], a[244:247], a[4:7]
    v_perm_b32 v173, v247, v246, s4
    v_perm_b32 v172, v245, v244, s4
    v_mfma_f32_16x16x32_bf16 a[4:7], v[160:163], a[228:231], a[4:7]
    v_exp_f32 v248, v92
    v_mfma_f32_16x16x32_bf16 a[8:11], v[160:163], a[232:235], a[8:11]
    v_exp_f32 v249, v93
    v_mfma_f32_16x16x32_bf16 a[8:11], v[176:179], a[248:251], a[8:11]
    v_perm_b32 v174, v249, v248, s4
    v_subrev_f32_dpp v230, v233, v230 row_newbcast:7 row_mask:0xf bank_mask:0xf
    v_mfma_f32_16x16x32_bf16 a[12:15], v[176:179], a[252:255], a[12:15]
    v_exp_f32 v250, v94
    v_mfma_f32_16x16x32_bf16 a[12:15], v[160:163], a[236:239], a[12:15]
    v_exp_f32 v251, v95
    v_mfma_f32_16x16x32_bf16 a[44:47], v[164:167], a[236:239], a[44:47]
    v_perm_b32 v175, v251, v250, s4
    v_subrev_f32_dpp v231, v233, v231 row_newbcast:7 row_mask:0xf bank_mask:0xf
    v_mfma_f32_16x16x32_bf16 a[44:47], v[180:183], a[252:255], a[44:47]
    v_cvt_pk_bf16_f32 v219, v228, v230
    v_cvt_pk_bf16_f32 v223, v229, v231
    v_smfmac_f32_16x16x64_bf16 v[192:195], v[144:147], v[152:159], v255
    buffer_store_dwordx4 v[216:219], v0, s[24:27], s80 offen offset:0 sc1
    s_add_u32 s80, s80, 4096
    v_smfmac_f32_16x16x64_bf16 v[192:195], v[148:151], v[168:175], v255
    s_waitcnt vmcnt(14)
    v_cvt_f32_i32 v32, v16
    v_mfma_f32_16x16x32_bf16 a[40:43], v[180:183], a[248:251], a[40:43]
    s_waitcnt vmcnt(18) lgkmcnt(0)
    s_barrier
    v_mfma_f32_16x16x32_bf16 a[40:43], v[164:167], a[232:235], a[40:43]
    v_cvt_f32_i32 v33, v17
    v_cvt_f32_i32 v34, v18
    v_mfma_f32_16x16x32_bf16 a[36:39], v[164:167], a[228:231], a[36:39]
    buffer_store_dwordx4 v[220:223], v0, s[24:27], s80 offen offset:0 sc1
    s_add_u32 s80, s80, 0x1ff000
    v_mfma_f32_16x16x32_bf16 a[36:39], v[180:183], a[244:247], a[36:39]
    v_cvt_f32_i32 v35, v19
    v_cvt_f32_i32 v36, v20
    v_mfma_f32_16x16x32_bf16 a[32:35], v[180:183], a[240:243], a[32:35]
    v_cmp_lt_f32 vcc, s72, v192
    v_cvt_f32_i32 v37, v21
    v_mfma_f32_16x16x32_bf16 a[32:35], v[164:167], a[224:227], a[32:35]
    v_cvt_f32_i32 v38, v22
    v_cvt_f32_i32 v39, v23
    s_cbranch_vccnz L_rare_rl_2
L_join_rl_2:
    v_mfma_f32_16x16x32_bf16 v[64:67], a[192:195], a[128:131], v[128:131]
    v_exp_f32 v244, v96
    v_mfma_f32_16x16x32_bf16 v[64:67], a[196:199], a[132:135], v[64:67]
    ds_read_b128 a[224:227], v14 offset:40960
    v_add_u32 v2, s75, v2
    v_cvt_f32_i32 v40, v24
    v_mfma_f32_16x16x32_bf16 v[64:67], a[200:203], a[136:139], v[64:67]
    v_exp_f32 v245, v97
    v_mfma_f32_16x16x32_bf16 v[64:67], a[204:207], a[140:143], v[64:67]
    ds_read_b128 a[228:231], v253 offset:40960
    v_perm_b32 v236, v245, v244, s4
    v_mfma_f32_16x16x32_bf16 v[72:75], a[204:207], a[156:159], v[132:135]
    v_exp_f32 v246, v98
    v_mfma_f32_16x16x32_bf16 v[72:75], a[200:203], a[152:155], v[72:75]
    ds_read_b128 a[232:235], v254 offset:40960
    buffer_load_dwordx2 v[6:7], v3, s[24:27], s83 offen sc1
    v_mfma_f32_16x16x32_bf16 v[72:75], a[196:199], a[148:151], v[72:75]
    v_exp_f32 v247, v99
    v_mfma_f32_16x16x32_bf16 v[72:75], a[192:195], a[144:147], v[72:75]
    ds_read_b128 a[236:239], v234 offset:40960
    v_perm_b32 v237, v247, v246, s4
    v_mfma_f32_16x16x32_bf16 v[80:83], a[192:195], a[160:163], v[136:139]
    v_exp_f32 v248, v100
    v_mfma_f32_16x16x32_bf16 v[80:83], a[196:199], a[164:167], v[80:83]
    ds_read_b128 a[240:243], v14 offset:45056
    v_cvt_f32_i32 v41, v25
    v_mfma_f32_16x16x32_bf16 v[80:83], a[200:203], a[168:171], v[80:83]
    v_exp_f32 v249, v101
    v_mfma_f32_16x16x32_bf16 v[80:83], a[204:207], a[172:175], v[80:83]
    ds_read_b128 a[244:247], v253 offset:45056
    v_perm_b32 v238, v249, v248, s4
    v_mfma_f32_16x16x32_bf16 v[88:91], a[204:207], a[188:191], v[140:143]
    v_exp_f32 v250, v102
    v_mfma_f32_16x16x32_bf16 v[88:91], a[200:203], a[184:187], v[88:91]
    ds_read_b128 a[248:251], v254 offset:45056
    s_add_u32 m0, s73, 0
    v_mfma_f32_16x16x32_bf16 v[88:91], a[196:199], a[180:183], v[88:91]
    v_exp_f32 v251, v103
    v_mfma_f32_16x16x32_bf16 v[88:91], a[192:195], a[176:179], v[88:91]
    ds_read_b128 a[252:255], v234 offset:45056
    v_perm_b32 v239, v251, v250, s4
    v_mfma_f32_16x16x32_bf16 v[92:95], a[208:211], a[176:179], v[140:143]
    v_exp_f32 v244, v104
    v_mfma_f32_16x16x32_bf16 v[92:95], a[212:215], a[180:183], v[92:95]
    buffer_load_dwordx4 v2, s[24:27], s67 offen offset:0 sc1 lds
    v_cvt_f32_i32 v42, v26
    v_cvt_f32_i32 v43, v27
    v_mfma_f32_16x16x32_bf16 v[92:95], a[216:219], a[184:187], v[92:95]
    v_exp_f32 v245, v105
    v_mfma_f32_16x16x32_bf16 v[92:95], a[220:223], a[188:191], v[92:95]
    ds_read_b128 a[192:195], v252 offset:8192
    v_perm_b32 v240, v245, v244, s4
    v_mfma_f32_16x16x32_bf16 v[84:87], a[220:223], a[172:175], v[136:139]
    v_exp_f32 v246, v106
    v_mfma_f32_16x16x32_bf16 v[84:87], a[216:219], a[168:171], v[84:87]
    buffer_load_dwordx4 v2, s[24:27], s67 offen offset:1024 sc1 lds
    v_cvt_f32_i32 v44, v28
    v_mfma_f32_16x16x32_bf16 v[84:87], a[212:215], a[164:167], v[84:87]
    v_exp_f32 v247, v107
    v_mfma_f32_16x16x32_bf16 v[84:87], a[208:211], a[160:163], v[84:87]
    ds_read_b128 a[196:199], v252 offset:9216
    v_perm_b32 v241, v247, v246, s4
    v_mfma_f32_16x16x32_bf16 v[76:79], a[208:211], a[144:147], v[132:135]
    v_exp_f32 v248, v108
    v_mfma_f32_16x16x32_bf16 v[76:79], a[212:215], a[148:151], v[76:79]
    buffer_load_dwordx4 v2, s[24:27], s67 offen offset:2048 sc1 lds
    v_cvt_f32_i32 v45, v29
    v_mfma_f32_16x16x32_bf16 v[76:79], a[216:219], a[152:155], v[76:79]
    v_exp_f32 v249, v109
    v_mfma_f32_16x16x32_bf16 v[76:79], a[220:223], a[156:159], v[76:79]
    ds_read_b128 a[200:203], v252 offset:10240
    v_perm_b32 v242, v249, v248, s4
    v_mfma_f32_16x16x32_bf16 v[68:71], a[220:223], a[140:143], v[128:131]
    v_exp_f32 v250, v110
    v_mfma_f32_16x16x32_bf16 v[68:71], a[216:219], a[136:139], v[68:71]
    buffer_load_dwordx4 v2, s[24:27], s67 offen offset:3072 sc1 lds
    s_waitcnt lgkmcnt(3)
    v_mfma_f32_16x16x32_bf16 v[68:71], a[212:215], a[132:135], v[68:71]
    v_exp_f32 v251, v111
    v_mfma_f32_16x16x32_bf16 v[68:71], a[208:211], a[128:131], v[68:71]
    ds_read_b128 a[204:207], v252 offset:11264
    v_perm_b32 v243, v251, v250, s4
    v_mfma_f32_16x16x32_bf16 a[80:83], v[184:187], a[224:227], a[80:83]
    v_exp_f32 v244, v112
    v_mfma_f32_16x16x32_bf16 a[80:83], v[168:171], a[240:243], a[80:83]
    ds_read_b128 a[208:211], v252 offset:12288
    v_cvt_f32_i32 v46, v30
    v_cvt_f32_i32 v47, v31
    v_mfma_f32_16x16x32_bf16 a[84:87], v[168:171], a[244:247], a[84:87]
    v_exp_f32 v245, v113
    v_mfma_f32_16x16x32_bf16 a[84:87], v[184:187], a[228:231], a[84:87]
    ds_read_b128 a[212:215], v252 offset:13312
    ds_read_b128 a[216:219], v252 offset:14336
    v_mfma_f32_16x16x32_bf16 a[88:91], v[184:187], a[232:235], a[88:91]
    v_exp_f32 v246, v114
    v_mfma_f32_16x16x32_bf16 a[88:91], v[168:171], a[248:251], a[88:91]
    v_exp_f32 v247, v115
    v_mfma_f32_16x16x32_bf16 a[92:95], v[168:171], a[252:255], a[92:95]
    ds_read_b128 a[220:223], v252 offset:15360
    v_mov_b64 v[196:197], v[192:193]
    v_mfma_f32_16x16x32_bf16 a[92:95], v[184:187], a[236:239], a[92:95]
    v_exp_f32 v248, v116
    v_mfma_f32_16x16x32_bf16 a[124:127], v[188:191], a[236:239], a[124:127]
    v_exp_f32 v249, v117
    v_mfma_f32_16x16x32_bf16 a[124:127], v[172:175], a[252:255], a[124:127]
    v_perm_b32 v185, v247, v246, s4
    v_perm_b32 v184, v245, v244, s4
    v_mfma_f32_16x16x32_bf16 a[120:123], v[172:175], a[248:251], a[120:123]
    v_exp_f32 v250, v118
    v_mfma_f32_16x16x32_bf16 a[120:123], v[188:191], a[232:235], a[120:123]
    v_exp_f32 v251, v119
    v_mfma_f32_16x16x32_bf16 a[116:119], v[188:191], a[228:231], a[116:119]
    v_perm_b32 v187, v251, v250, s4
    v_perm_b32 v186, v249, v248, s4
    v_mfma_f32_16x16x32_bf16 a[116:119], v[172:175], a[244:247], a[116:119]
    v_exp_f32 v244, v120
    v_mfma_f32_16x16x32_bf16 a[112:115], v[172:175], a[240:243], a[112:115]
    v_exp_f32 v245, v121
    v_mfma_f32_16x16x32_bf16 a[112:115], v[188:191], a[224:227], a[112:115]
    v_mov_b64 v[198:199], v[194:195]
    s_waitcnt vmcnt(11)
    v_mfma_f32_16x16x32_bf16 a[16:19], v[176:179], a[224:227], a[16:19]
    v_exp_f32 v246, v122
    v_mfma_f32_16x16x32_bf16 a[16:19], v[152:155], a[240:243], a[16:19]
    v_exp_f32 v247, v123
    v_perm_b32 v200, v200, v200, s87
    v_mfma_f32_16x16x32_bf16 a[20:23], v[152:155], a[244:247], a[20:23]
    v_perm_b32 v189, v247, v246, s4
    v_perm_b32 v188, v245, v244, s4
    v_mfma_f32_16x16x32_bf16 a[20:23], v[176:179], a[228:231], a[20:23]
    v_exp_f32 v248, v124
    v_mfma_f32_16x16x32_bf16 a[24:27], v[176:179], a[232:235], a[24:27]
    v_exp_f32 v249, v125
    v_mfma_f32_16x16x32_bf16 a[24:27], v[152:155], a[248:251], a[24:27]
    v_perm_b32 v190, v249, v248, s4
    v_perm_b32 v201, v201, v201, s87
    v_mfma_f32_16x16x32_bf16 a[28:31], v[152:155], a[252:255], a[28:31]
    v_exp_f32 v250, v126
    v_mfma_f32_16x16x32_bf16 a[28:31], v[176:179], a[236:239], a[28:31]
    v_exp_f32 v251, v127
    v_mfma_f32_16x16x32_bf16 a[60:63], v[180:183], a[236:239], a[60:63]
    v_perm_b32 v191, v251, v250, s4
    v_perm_b32 v202, v202, v202, s87
    v_mfma_f32_16x16x32_bf16 a[60:63], v[156:159], a[252:255], a[60:63]
    v_perm_b32 v203, v203, v203, s87
    v_mul_f32 v200, s85, v200
    v_smfmac_f32_16x16x64_bf16 v[196:199], v[144:147], v[236:243], v255
    v_mul_f32 v201, s85, v201
    v_mul_f32_e64 v202, -v202, v200
    v_smfmac_f32_16x16x64_bf16 v[196:199], v[148:151], v[184:191], v255
    v_mul_f32_e64 v203, -v203, v201
    v_fma_f32 v32, v32, v200, v202
    v_mfma_f32_16x16x32_bf16 a[56:59], v[156:159], a[248:251], a[56:59]
    s_waitcnt vmcnt(5) lgkmcnt(0)
    s_barrier
    v_mfma_f32_16x16x32_bf16 a[56:59], v[180:183], a[232:235], a[56:59]
    v_fma_f32 v40, v40, v201, v203
    v_lshlrev_b32 v212, 16, v48
    v_mfma_f32_16x16x32_bf16 a[52:55], v[180:183], a[228:231], a[52:55]
    v_lshlrev_b32 v214, 16, v56
    v_fma_f32 v204, v32, v212, s62
    v_mfma_f32_16x16x32_bf16 a[52:55], v[156:159], a[244:247], a[52:55]
    v_fma_f32 v208, v40, v212, s62
    v_fma_f32 v204, -v40, v214, v204
    v_mfma_f32_16x16x32_bf16 a[48:51], v[156:159], a[240:243], a[48:51]
    v_cmp_lt_f32 vcc, s72, v196
    v_fma_f32 v208, v32, v214, v208
    v_mfma_f32_16x16x32_bf16 a[48:51], v[180:183], a[224:227], a[48:51]
    v_fma_f32 v33, v33, v200, v202
    v_fma_f32 v41, v41, v201, v203
    s_cbranch_vccnz L_rare_rl_3
L_join_rl_3:
    v_mfma_f32_16x16x32_bf16 v[96:99], a[192:195], a[128:131], v[128:131]
    v_exp_f32 v244, v64
    v_mfma_f32_16x16x32_bf16 v[96:99], a[196:199], a[132:135], v[96:99]
    ds_read_b128 a[224:227], v14 offset:49152
    s_waitcnt vmcnt(4)
    v_cmp_ne_u64 vcc, v[6:7], v[4:5]
    v_mfma_f32_16x16x32_bf16 v[96:99], a[200:203], a[136:139], v[96:99]
    v_exp_f32 v245, v65
    v_mfma_f32_16x16x32_bf16 v[96:99], a[204:207], a[140:143], v[96:99]
    ds_read_b128 a[228:231], v253 offset:49152
    v_perm_b32 v160, v245, v244, s4
    v_mfma_f32_16x16x32_bf16 v[104:107], a[204:207], a[156:159], v[132:135]
    v_exp_f32 v246, v66
    v_mfma_f32_16x16x32_bf16 v[104:107], a[200:203], a[152:155], v[104:107]
    ds_read_b128 a[232:235], v254 offset:49152
    s_cbranch_vccnz L_spin_rlk
L_spinret_rlk:
    v_mfma_f32_16x16x32_bf16 v[104:107], a[196:199], a[148:151], v[104:107]
    v_exp_f32 v247, v67
    v_mfma_f32_16x16x32_bf16 v[104:107], a[192:195], a[144:147], v[104:107]
    ds_read_b128 a[236:239], v234 offset:49152
    v_perm_b32 v161, v247, v246, s4
    v_mfma_f32_16x16x32_bf16 v[112:115], a[192:195], a[160:163], v[136:139]
    v_exp_f32 v248, v68
    v_mfma_f32_16x16x32_bf16 v[112:115], a[196:199], a[164:167], v[112:115]
    ds_read_b128 a[240:243], v14 offset:53248
    buffer_store_dwordx2 v[4:5], v13, s[24:27], s82 offen sc1
    v_mfma_f32_16x16x32_bf16 v[112:115], a[200:203], a[168:171], v[112:115]
    v_exp_f32 v249, v69
    v_mfma_f32_16x16x32_bf16 v[112:115], a[204:207], a[172:175], v[112:115]
    ds_read_b128 a[244:247], v253 offset:53248
    v_perm_b32 v162, v249, v248, s4
    v_mfma_f32_16x16x32_bf16 v[120:123], a[204:207], a[188:191], v[140:143]
    v_exp_f32 v250, v70
    v_mfma_f32_16x16x32_bf16 v[120:123], a[200:203], a[184:187], v[120:123]
    ds_read_b128 a[248:251], v254 offset:53248
    s_add_u32 m0, s73, 8192
    v_mfma_f32_16x16x32_bf16 v[120:123], a[196:199], a[180:183], v[120:123]
    v_exp_f32 v251, v71
    v_mfma_f32_16x16x32_bf16 v[120:123], a[192:195], a[176:179], v[120:123]
    ds_read_b128 a[252:255], v234 offset:53248
    v_perm_b32 v163, v251, v250, s4
    v_mfma_f32_16x16x32_bf16 v[124:127], a[208:211], a[176:179], v[140:143]
    v_exp_f32 v244, v72
    v_mfma_f32_16x16x32_bf16 v[124:127], a[212:215], a[180:183], v[124:127]
    buffer_load_dwordx4 v2, s[24:27], s68 offen offset:0 sc1 lds
    s_add_u32 s82, s82, 512
    s_add_u32 s83, s83, 512
    v_mfma_f32_16x16x32_bf16 v[124:127], a[216:219], a[184:187], v[124:127]
    v_exp_f32 v245, v73
    v_mfma_f32_16x16x32_bf16 v[124:127], a[220:223], a[188:191], v[124:127]
    ds_read_b128 a[192:195], v252 offset:16384
    v_perm_b32 v164, v245, v244, s4
    v_mfma_f32_16x16x32_bf16 v[116:119], a[220:223], a[172:175], v[136:139]
    v_exp_f32 v246, v74
    v_mfma_f32_16x16x32_bf16 v[116:119], a[216:219], a[168:171], v[116:119]
    buffer_load_dwordx4 v2, s[24:27], s68 offen offset:1024 sc1 lds
    v_and_b32 v212, s86, v48
    v_mfma_f32_16x16x32_bf16 v[116:119], a[212:215], a[164:167], v[116:119]
    v_exp_f32 v247, v75
    v_mfma_f32_16x16x32_bf16 v[116:119], a[208:211], a[160:163], v[116:119]
    ds_read_b128 a[196:199], v252 offset:17408
    v_perm_b32 v165, v247, v246, s4
    v_mfma_f32_16x16x32_bf16 v[108:111], a[208:211], a[144:147], v[132:135]
    v_exp_f32 v248, v76
    v_mfma_f32_16x16x32_bf16 v[108:111], a[212:215], a[148:151], v[108:111]
    buffer_load_dwordx4 v2, s[24:27], s68 offen offset:2048 sc1 lds
    v_and_b32 v214, s86, v56
    v_mfma_f32_16x16x32_bf16 v[108:111], a[216:219], a[152:155], v[108:111]
    v_exp_f32 v249, v77
    v_mfma_f32_16x16x32_bf16 v[108:111], a[220:223], a[156:159], v[108:111]
    ds_read_b128 a[200:203], v252 offset:18432
    v_perm_b32 v166, v249, v248, s4
    v_mfma_f32_16x16x32_bf16 v[100:103], a[220:223], a[140:143], v[128:131]
    v_exp_f32 v250, v78
    v_mfma_f32_16x16x32_bf16 v[100:103], a[216:219], a[136:139], v[100:103]
    buffer_load_dwordx4 v2, s[24:27], s68 offen offset:3072 sc1 lds
    s_waitcnt lgkmcnt(3)
    v_mfma_f32_16x16x32_bf16 v[100:103], a[212:215], a[132:135], v[100:103]
    v_exp_f32 v251, v79
    v_mfma_f32_16x16x32_bf16 v[100:103], a[208:211], a[128:131], v[100:103]
    ds_read_b128 a[204:207], v252 offset:19456
    v_perm_b32 v167, v251, v250, s4
    v_mfma_f32_16x16x32_bf16 a[64:67], v[168:171], a[224:227], a[64:67]
    v_exp_f32 v244, v80
    v_mfma_f32_16x16x32_bf16 a[64:67], v[184:187], a[240:243], a[64:67]
    ds_read_b128 a[208:211], v252 offset:20480
    v_fma_f32 v205, v33, v212, s62
    v_fma_f32 v209, v41, v212, s62
    v_mfma_f32_16x16x32_bf16 a[68:71], v[184:187], a[244:247], a[68:71]
    v_exp_f32 v245, v81
    v_mfma_f32_16x16x32_bf16 a[68:71], v[168:171], a[228:231], a[68:71]
    ds_read_b128 a[212:215], v252 offset:21504
    ds_read_b128 a[216:219], v252 offset:22528
    v_mfma_f32_16x16x32_bf16 a[72:75], v[168:171], a[232:235], a[72:75]
    v_exp_f32 v246, v82
    v_mfma_f32_16x16x32_bf16 a[72:75], v[184:187], a[248:251], a[72:75]
    v_exp_f32 v247, v83
    v_mfma_f32_16x16x32_bf16 a[76:79], v[184:187], a[252:255], a[76:79]
    ds_read_b128 a[220:223], v252 offset:23552
    v_mov_b64 v[192:193], v[196:197]
    v_mfma_f32_16x16x32_bf16 a[76:79], v[168:171], a[236:239], a[76:79]
    v_exp_f32 v248, v84
    v_mfma_f32_16x16x32_bf16 a[108:111], v[172:175], a[236:239], a[108:111]
    v_exp_f32 v249, v85
    v_mfma_f32_16x16x32_bf16 a[108:111], v[188:191], a[252:255], a[108:111]
    v_perm_b32 v169, v247, v246, s4
    v_perm_b32 v168, v245, v244, s4
    v_mfma_f32_16x16x32_bf16 a[104:107], v[188:191], a[248:251], a[104:107]
    v_exp_f32 v250, v86
    v_mfma_f32_16x16x32_bf16 a[104:107], v[172:175], a[232:235], a[104:107]
L_stop5:
    s_cbranch_execz L_stop9
    v_exp_f32 v251, v87
    v_mfma_f32_16x16x32_bf16 a[100:103], v[172:175], a[228:231], a[100:103]
    v_perm_b32 v171, v251, v250, s4
    v_perm_b32 v170, v249, v248, s4
    v_mfma_f32_16x16x32_bf16 a[100:103], v[188:191], a[244:247], a[100:103]
    v_exp_f32 v244, v88
    v_mfma_f32_16x16x32_bf16 a[96:99], v[188:191], a[240:243], a[96:99]
    v_exp_f32 v245, v89
    v_mfma_f32_16x16x32_bf16 a[96:99], v[172:175], a[224:227], a[96:99]
    buffer_load_ushort v232, v12, s[52:55], s78 offen
    v_mov_b64 v[194:195], v[198:199]
    v_mfma_f32_16x16x32_bf16 a[0:3], v[152:155], a[224:227], a[0:3]
    v_exp_f32 v246, v90
    v_mfma_f32_16x16x32_bf16 a[0:3], v[236:239], a[240:243], a[0:3]
    buffer_load_ushort v233, v12, s[56:59], s78 offen
    v_exp_f32 v247, v91
    v_mfma_f32_16x16x32_bf16 a[4:7], v[236:239], a[244:247], a[4:7]
    v_perm_b32 v173, v247, v246, s4
    v_perm_b32 v172, v245, v244, s4
    v_mfma_f32_16x16x32_bf16 a[4:7], v[152:155], a[228:231], a[4:7]
    v_exp_f32 v248, v92
    v_mfma_f32_16x16x32_bf16 a[8:11], v[152:155], a[232:235], a[8:11]
    v_exp_f32 v249, v93
    v_mfma_f32_16x16x32_bf16 a[8:11], v[236:239], a[248:251], a[8:11]
    buffer_load_dwordx2 v[216:217], v11, s[48:51], s77 offen offset:0
    v_perm_b32 v174, v249, v248, s4
    v_mfma_f32_16x16x32_bf16 a[12:15], v[236:239], a[252:255], a[12:15]
    v_exp_f32 v250, v94
    v_mfma_f32_16x16x32_bf16 a[12:15], v[152:155], a[236:239], a[12:15]
    v_exp_f32 v251, v95
    v_mfma_f32_16x16x32_bf16 a[44:47], v[156:159], a[236:239], a[44:47]
    buffer_load_dwordx2 v[218:219], v11, s[48:51], s77 offen offset:512
    v_perm_b32 v175, v251, v250, s4
    v_mfma_f32_16x16x32_bf16 a[44:47], v[240:243], a[252:255], a[44:47]
    v_fma_f32 v205, -v41, v214, v205
    v_fma_f32 v209, v33, v214, v209
    v_smfmac_f32_16x16x64_bf16 v[192:195], v[144:147], v[160:167], v255
    buffer_load_dwordx2 v[224:225], v11, s[48:51], s77 offen offset:1024
    v_fma_f32 v34, v34, v200, v202
    v_smfmac_f32_16x16x64_bf16 v[192:195], v[148:151], v[168:175], v255
    v_fma_f32 v42, v42, v201, v203
    v_lshlrev_b32 v212, 16, v49
    v_mfma_f32_16x16x32_bf16 a[40:43], v[240:243], a[248:251], a[40:43]
    s_waitcnt vmcnt(17) lgkmcnt(0)
    s_barrier
    v_mfma_f32_16x16x32_bf16 a[40:43], v[156:159], a[232:235], a[40:43]
    buffer_load_dwordx2 v[226:227], v11, s[48:51], s77 offen offset:1536
    v_lshlrev_b32 v214, 16, v57
    v_mfma_f32_16x16x32_bf16 a[36:39], v[156:159], a[228:231], a[36:39]
    v_fma_f32 v206, v34, v212, s62
    v_fma_f32 v210, v42, v212, s62
    v_mfma_f32_16x16x32_bf16 a[36:39], v[240:243], a[244:247], a[36:39]
    buffer_load_dwordx2 v[220:221], v11, s[48:51], s77 offen offset:2048
    v_fma_f32 v206, -v42, v214, v206
    v_mfma_f32_16x16x32_bf16 a[32:35], v[240:243], a[240:243], a[32:35]
    v_cmp_lt_f32 vcc, s72, v192
    v_fma_f32 v210, v34, v214, v210
    v_mfma_f32_16x16x32_bf16 a[32:35], v[156:159], a[224:227], a[32:35]
    buffer_load_dwordx2 v[222:223], v11, s[48:51], s77 offen offset:2560
    v_fma_f32 v35, v35, v200, v202
    s_cbranch_vccnz L_rare_rl_4
L_join_rl_4:
    v_mfma_f32_16x16x32_bf16 v[64:67], a[192:195], a[128:131], v[128:131]
    v_exp_f32 v244, v96
    v_mfma_f32_16x16x32_bf16 v[64:67], a[196:199], a[132:135], v[64:67]
    ds_read_b128 a[224:227], v14 offset:57344
    buffer_load_dwordx2 v[228:229], v11, s[48:51], s77 offen offset:3072
    v_fma_f32 v43, v43, v201, v203
    v_mfma_f32_16x16x32_bf16 v[64:67], a[200:203], a[136:139], v[64:67]
    v_exp_f32 v245, v97
    v_mfma_f32_16x16x32_bf16 v[64:67], a[204:207], a[140:143], v[64:67]
    ds_read_b128 a[228:231], v253 offset:57344
    v_perm_b32 v176, v245, v244, s4
    v_mfma_f32_16x16x32_bf16 v[72:75], a[204:207], a[156:159], v[132:135]
    v_exp_f32 v246, v98
    v_mfma_f32_16x16x32_bf16 v[72:75], a[200:203], a[152:155], v[72:75]
    ds_read_b128 a[232:235], v254 offset:57344
    buffer_load_dwordx2 v[230:231], v11, s[48:51], s77 offen offset:3584
    v_mfma_f32_16x16x32_bf16 v[72:75], a[196:199], a[148:151], v[72:75]
    v_exp_f32 v247, v99
    v_mfma_f32_16x16x32_bf16 v[72:75], a[192:195], a[144:147], v[72:75]
    ds_read_b128 a[236:239], v234 offset:57344
    v_perm_b32 v177, v247, v246, s4
    v_mfma_f32_16x16x32_bf16 v[80:83], a[192:195], a[160:163], v[136:139]
    v_exp_f32 v248, v100
    v_mfma_f32_16x16x32_bf16 v[80:83], a[196:199], a[164:167], v[80:83]
    ds_read_b128 a[240:243], v14 offset:61440
    v_and_b32 v212, s86, v49
    v_mfma_f32_16x16x32_bf16 v[80:83], a[200:203], a[168:171], v[80:83]
    v_exp_f32 v249, v101
    v_mfma_f32_16x16x32_bf16 v[80:83], a[204:207], a[172:175], v[80:83]
    ds_read_b128 a[244:247], v253 offset:61440
    v_perm_b32 v178, v249, v248, s4
    v_mfma_f32_16x16x32_bf16 v[88:91], a[204:207], a[188:191], v[140:143]
    v_exp_f32 v250, v102
    v_mfma_f32_16x16x32_bf16 v[88:91], a[200:203], a[184:187], v[88:91]
    ds_read_b128 a[248:251], v254 offset:61440
    s_add_u32 m0, s73, 16384
    v_mfma_f32_16x16x32_bf16 v[88:91], a[196:199], a[180:183], v[88:91]
    v_exp_f32 v251, v103
    v_mfma_f32_16x16x32_bf16 v[88:91], a[192:195], a[176:179], v[88:91]
    ds_read_b128 a[252:255], v234 offset:61440
    v_perm_b32 v179, v251, v250, s4
    v_mfma_f32_16x16x32_bf16 v[92:95], a[208:211], a[176:179], v[140:143]
    v_exp_f32 v244, v104
    v_mfma_f32_16x16x32_bf16 v[92:95], a[212:215], a[180:183], v[92:95]
    buffer_load_dwordx4 v2, s[24:27], s69 offen offset:0 sc1 lds
    s_add_u32 s77, s77, 0x20000
    s_and_b32 s77, s77, 0xfffff
    v_mfma_f32_16x16x32_bf16 v[92:95], a[216:219], a[184:187], v[92:95]
    v_exp_f32 v245, v105
    v_mfma_f32_16x16x32_bf16 v[92:95], a[220:223], a[188:191], v[92:95]
    ds_read_b128 a[192:195], v252 offset:24576
    v_perm_b32 v180, v245, v244, s4
    v_mfma_f32_16x16x32_bf16 v[84:87], a[220:223], a[172:175], v[136:139]
    v_exp_f32 v246, v106
    v_mfma_f32_16x16x32_bf16 v[84:87], a[216:219], a[168:171], v[84:87]
    buffer_load_dwordx4 v2, s[24:27], s69 offen offset:1024 sc1 lds
    s_lshr_b32 s78, s77, 6
    v_mfma_f32_16x16x32_bf16 v[84:87], a[212:215], a[164:167], v[84:87]
    v_exp_f32 v247, v107
    v_mfma_f32_16x16x32_bf16 v[84:87], a[208:211], a[160:163], v[84:87]
    ds_read_b128 a[196:199], v252 offset:25600
    v_perm_b32 v181, v247, v246, s4
    v_mfma_f32_16x16x32_bf16 v[76:79], a[208:211], a[144:147], v[132:135]
    v_exp_f32 v248, v108
    v_mfma_f32_16x16x32_bf16 v[76:79], a[212:215], a[148:151], v[76:79]
    buffer_load_dwordx4 v2, s[24:27], s69 offen offset:2048 sc1 lds
    v_and_b32 v214, s86, v57
    v_mfma_f32_16x16x32_bf16 v[76:79], a[216:219], a[152:155], v[76:79]
    v_exp_f32 v249, v109
    v_mfma_f32_16x16x32_bf16 v[76:79], a[220:223], a[156:159], v[76:79]
    ds_read_b128 a[200:203], v252 offset:26624
    v_perm_b32 v182, v249, v248, s4
    v_mfma_f32_16x16x32_bf16 v[68:71], a[220:223], a[140:143], v[128:131]
    v_exp_f32 v250, v110
    v_mfma_f32_16x16x32_bf16 v[68:71], a[216:219], a[136:139], v[68:71]
    buffer_load_dwordx4 v2, s[24:27], s69 offen offset:3072 sc1 lds
    s_waitcnt lgkmcnt(3)
    v_mfma_f32_16x16x32_bf16 v[68:71], a[212:215], a[132:135], v[68:71]
    v_exp_f32 v251, v111
    v_mfma_f32_16x16x32_bf16 v[68:71], a[208:211], a[128:131], v[68:71]
    ds_read_b128 a[204:207], v252 offset:27648
    v_perm_b32 v183, v251, v250, s4
    v_mfma_f32_16x16x32_bf16 a[80:83], v[184:187], a[224:227], a[80:83]
    v_exp_f32 v244, v112
    v_mfma_f32_16x16x32_bf16 a[80:83], v[168:171], a[240:243], a[80:83]
    ds_read_b128 a[208:211], v252 offset:28672
    v_fma_f32 v207, v35, v212, s62
    v_fma_f32 v211, v43, v212, s62
    v_mfma_f32_16x16x32_bf16 a[84:87], v[168:171], a[244:247], a[84:87]
    v_exp_f32 v245, v113
    v_mfma_f32_16x16x32_bf16 a[84:87], v[184:187], a[228:231], a[84:87]
    ds_read_b128 a[212:215], v252 offset:29696
    ds_read_b128 a[216:219], v252 offset:30720
    v_mfma_f32_16x16x32_bf16 a[88:91], v[184:187], a[232:235], a[88:91]
    v_exp_f32 v246, v114
    v_mfma_f32_16x16x32_bf16 a[88:91], v[168:171], a[248:251], a[88:91]
    v_exp_f32 v247, v115
    v_mfma_f32_16x16x32_bf16 a[92:95], v[168:171], a[252:255], a[92:95]
    ds_read_b128 a[220:223], v252 offset:31744
    v_mov_b64 v[196:197], v[192:193]
    v_mfma_f32_16x16x32_bf16 a[92:95], v[184:187], a[236:239], a[92:95]
    v_exp_f32 v248, v116
    v_mfma_f32_16x16x32_bf16 a[124:127], v[188:191], a[236:239], a[124:127]
    v_exp_f32 v249, v117
    v_mfma_f32_16x16x32_bf16 a[124:127], v[172:175], a[252:255], a[124:127]
    v_perm_b32 v185, v247, v246, s4
    v_perm_b32 v184, v245, v244, s4
    v_mfma_f32_16x16x32_bf16 a[120:123], v[172:175], a[248:251], a[120:123]
    v_exp_f32 v250, v118
    v_mfma_f32_16x16x32_bf16 a[120:123], v[188:191], a[232:235], a[120:123]
    v_exp_f32 v251, v119
    v_mfma_f32_16x16x32_bf16 a[116:119], v[188:191], a[228:231], a[116:119]
    v_perm_b32 v187, v251, v250, s4
    v_perm_b32 v186, v249, v248, s4
    v_mfma_f32_16x16x32_bf16 a[116:119], v[172:175], a[244:247], a[116:119]
    v_exp_f32 v244, v120
    v_mfma_f32_16x16x32_bf16 a[112:115], v[172:175], a[240:243], a[112:115]
    v_exp_f32 v245, v121
    v_mfma_f32_16x16x32_bf16 a[112:115], v[188:191], a[224:227], a[112:115]
    v_mov_b64 v[198:199], v[194:195]
    v_fma_f32 v207, -v43, v214, v207
    v_mfma_f32_16x16x32_bf16 a[16:19], v[236:239], a[224:227], a[16:19]
    v_exp_f32 v246, v122
    v_mfma_f32_16x16x32_bf16 a[16:19], v[160:163], a[240:243], a[16:19]
    v_exp_f32 v247, v123
    v_fma_f32 v211, v35, v214, v211
    v_mfma_f32_16x16x32_bf16 a[20:23], v[160:163], a[244:247], a[20:23]
    v_perm_b32 v189, v247, v246, s4
    v_perm_b32 v188, v245, v244, s4
    v_mfma_f32_16x16x32_bf16 a[20:23], v[236:239], a[228:231], a[20:23]
    v_exp_f32 v248, v124
    v_mfma_f32_16x16x32_bf16 a[24:27], v[236:239], a[232:235], a[24:27]
    v_exp_f32 v249, v125
    v_mfma_f32_16x16x32_bf16 a[24:27], v[160:163], a[248:251], a[24:27]
    v_perm_b32 v190, v249, v248, s4
    v_cvt_pk_bf16_f32 v32, v204, v205
    v_mfma_f32_16x16x32_bf16 a[28:31], v[160:163], a[252:255], a[28:31]
    v_exp_f32 v250, v126
    v_mfma_f32_16x16x32_bf16 a[28:31], v[236:239], a[236:239], a[28:31]
    v_exp_f32 v251, v127
    v_mfma_f32_16x16x32_bf16 a[60:63], v[240:243], a[236:239], a[60:63]
    v_perm_b32 v191, v251, v250, s4
    v_cvt_pk_bf16_f32 v33, v206, v207
    v_mfma_f32_16x16x32_bf16 a[60:63], v[164:167], a[252:255], a[60:63]
    v_cvt_pk_bf16_f32 v34, v208, v209
    v_cvt_pk_bf16_f32 v35, v210, v211
    v_smfmac_f32_16x16x64_bf16 v[196:199], v[144:147], v[176:183], v255
    v_fma_f32 v36, v36, v200, v202
    v_fma_f32 v44, v44, v201, v203
    v_smfmac_f32_16x16x64_bf16 v[196:199], v[148:151], v[184:191], v255
    v_lshlrev_b32 v212, 16, v50
    v_lshlrev_b32 v214, 16, v58
    v_mfma_f32_16x16x32_bf16 a[56:59], v[164:167], a[248:251], a[56:59]
    s_waitcnt vmcnt(19) lgkmcnt(0)
    s_barrier
    v_mfma_f32_16x16x32_bf16 a[56:59], v[240:243], a[232:235], a[56:59]
    v_fma_f32 v204, v36, v212, s62
    v_fma_f32 v208, v44, v212, s62
    v_mfma_f32_16x16x32_bf16 a[52:55], v[240:243], a[228:231], a[52:55]
    v_fma_f32 v204, -v44, v214, v204
    v_fma_f32 v208, v36, v214, v208
    v_mfma_f32_16x16x32_bf16 a[52:55], v[164:167], a[244:247], a[52:55]
    v_fma_f32 v37, v37, v200, v202
    v_fma_f32 v45, v45, v201, v203
    v_mfma_f32_16x16x32_bf16 a[48:51], v[164:167], a[240:243], a[48:51]
    v_cmp_lt_f32 vcc, s72, v196
    v_and_b32 v212, s86, v50
    v_mfma_f32_16x16x32_bf16 a[48:51], v[240:243], a[224:227], a[48:51]
    v_and_b32 v214, s86, v58
    v_fma_f32 v205, v37, v212, s62
    s_cbranch_vccnz L_rare_rl_5
L_join_rl_5:
    v_mfma_f32_16x16x32_bf16 v[96:99], a[192:195], a[128:131], v[128:131]
    v_exp_f32 v244, v64
    v_mfma_f32_16x16x32_bf16 v[96:99], a[196:199], a[132:135], v[96:99]
    ds_read_b128 a[224:227], v14 offset:32768
    v_add_u32 v2, s76, v2
    v_fma_f32 v209, v45, v212, s62
    v_mfma_f32_16x16x32_bf16 v[96:99], a[200:203], a[136:139], v[96:99]
    v_exp_f32 v245, v65
    v_mfma_f32_16x16x32_bf16 v[96:99], a[204:207], a[140:143], v[96:99]
    ds_read_b128 a[228:231], v253 offset:32768
    v_perm_b32 v152, v245, v244, s4
    v_mfma_f32_16x16x32_bf16 v[104:107], a[204:207], a[156:159], v[132:135]
    v_exp_f32 v246, v66
    v_mfma_f32_16x16x32_bf16 v[104:107], a[200:203], a[152:155], v[104:107]
    ds_read_b128 a[232:235], v254 offset:32768
    buffer_load_dwordx2 v[6:7], v3, s[24:27], s84 offen sc1
    v_mfma_f32_16x16x32_bf16 v[104:107], a[196:199], a[148:151], v[104:107]
    v_exp_f32 v247, v67
    v_mfma_f32_16x16x32_bf16 v[104:107], a[192:195], a[144:147], v[104:107]
    ds_read_b128 a[236:239], v234 offset:32768
    v_perm_b32 v153, v247, v246, s4
    v_mfma_f32_16x16x32_bf16 v[112:115], a[192:195], a[160:163], v[136:139]
    v_exp_f32 v248, v68
    v_mfma_f32_16x16x32_bf16 v[112:115], a[196:199], a[164:167], v[112:115]
    ds_read_b128 a[240:243], v14 offset:36864
    v_fma_f32 v205, -v45, v214, v205
    v_mfma_f32_16x16x32_bf16 v[112:115], a[200:203], a[168:171], v[112:115]
    v_exp_f32 v249, v69
    v_mfma_f32_16x16x32_bf16 v[112:115], a[204:207], a[172:175], v[112:115]
    ds_read_b128 a[244:247], v253 offset:36864
    v_perm_b32 v154, v249, v248, s4
    v_mfma_f32_16x16x32_bf16 v[120:123], a[204:207], a[188:191], v[140:143]
    v_exp_f32 v250, v70
    v_mfma_f32_16x16x32_bf16 v[120:123], a[200:203], a[184:187], v[120:123]
    ds_read_b128 a[248:251], v254 offset:36864
    s_add_u32 m0, s73, 24576
    v_mfma_f32_16x16x32_bf16 v[120:123], a[196:199], a[180:183], v[120:123]
    v_exp_f32 v251, v71
    v_mfma_f32_16x16x32_bf16 v[120:123], a[192:195], a[176:179], v[120:123]
    ds_read_b128 a[252:255], v234 offset:36864
    v_perm_b32 v155, v251, v250, s4
    v_mfma_f32_16x16x32_bf16 v[124:127], a[208:211], a[176:179], v[140:143]
    v_exp_f32 v244, v72
    v_mfma_f32_16x16x32_bf16 v[124:127], a[212:215], a[180:183], v[124:127]
    buffer_load_dwordx4 v2, s[24:27], s70 offen offset:0 sc1 lds
    v_fma_f32 v209, v37, v214, v209
    v_fma_f32 v38, v38, v200, v202
    v_mfma_f32_16x16x32_bf16 v[124:127], a[216:219], a[184:187], v[124:127]
    v_exp_f32 v245, v73
    v_mfma_f32_16x16x32_bf16 v[124:127], a[220:223], a[188:191], v[124:127]
    ds_read_b128 a[192:195], v252 offset:0
    v_perm_b32 v156, v245, v244, s4
    v_mfma_f32_16x16x32_bf16 v[116:119], a[220:223], a[172:175], v[136:139]
    v_exp_f32 v246, v74
    v_mfma_f32_16x16x32_bf16 v[116:119], a[216:219], a[168:171], v[116:119]
    buffer_load_dwordx4 v2, s[24:27], s70 offen offset:1024 sc1 lds
    v_fma_f32 v46, v46, v201, v203
    v_mfma_f32_16x16x32_bf16 v[116:119], a[212:215], a[164:167], v[116:119]
    v_exp_f32 v247, v75
    v_mfma_f32_16x16x32_bf16 v[116:119], a[208:211], a[160:163], v[116:119]
    ds_read_b128 a[196:199], v252 offset:1024
    v_perm_b32 v157, v247, v246, s4
    v_mfma_f32_16x16x32_bf16 v[108:111], a[208:211], a[144:147], v[132:135]
    v_exp_f32 v248, v76
    v_mfma_f32_16x16x32_bf16 v[108:111], a[212:215], a[148:151], v[108:111]
    buffer_load_dwordx4 v2, s[24:27], s70 offen offset:2048 sc1 lds
    v_lshlrev_b32 v212, 16, v51
    v_mfma_f32_16x16x32_bf16 v[108:111], a[216:219], a[152:155], v[108:111]
    v_exp_f32 v249, v77
    v_mfma_f32_16x16x32_bf16 v[108:111], a[220:223], a[156:159], v[108:111]
    ds_read_b128 a[200:203], v252 offset:2048
    v_perm_b32 v158, v249, v248, s4
    v_mfma_f32_16x16x32_bf16 v[100:103], a[220:223], a[140:143], v[128:131]
    v_exp_f32 v250, v78
    v_mfma_f32_16x16x32_bf16 v[100:103], a[216:219], a[136:139], v[100:103]
    buffer_load_dwordx4 v2, s[24:27], s70 offen offset:3072 sc1 lds
    s_waitcnt lgkmcnt(3)
    v_mfma_f32_16x16x32_bf16 v[100:103], a[212:215], a[132:135], v[100:103]
    v_exp_f32 v251, v79
    v_mfma_f32_16x16x32_bf16 v[100:103], a[208:211], a[128:131], v[100:103]
    ds_read_b128 a[204:207], v252 offset:3072
    v_perm_b32 v159, v251, v250, s4
    v_mfma_f32_16x16x32_bf16 a[64:67], v[168:171], a[224:227], a[64:67]
    v_exp_f32 v244, v80
    v_mfma_f32_16x16x32_bf16 a[64:67], v[184:187], a[240:243], a[64:67]
    ds_read_b128 a[208:211], v252 offset:4096
    v_lshlrev_b32 v214, 16, v59
    v_fma_f32 v206, v38, v212, s62
    v_mfma_f32_16x16x32_bf16 a[68:71], v[184:187], a[244:247], a[68:71]
    v_exp_f32 v245, v81
    v_mfma_f32_16x16x32_bf16 a[68:71], v[168:171], a[228:231], a[68:71]
    ds_read_b128 a[212:215], v252 offset:5120
    ds_read_b128 a[216:219], v252 offset:6144
    v_mfma_f32_16x16x32_bf16 a[72:75], v[168:171], a[232:235], a[72:75]
    v_exp_f32 v246, v82
    v_mfma_f32_16x16x32_bf16 a[72:75], v[184:187], a[248:251], a[72:75]
    v_exp_f32 v247, v83
    v_mfma_f32_16x16x32_bf16 a[76:79], v[184:187], a[252:255], a[76:79]
    ds_read_b128 a[220:223], v252 offset:7168
    v_mov_b64 v[192:193], v[196:197]
    v_mfma_f32_16x16x32_bf16 a[76:79], v[168:171], a[236:239], a[76:79]
    v_exp_f32 v248, v84
    v_mfma_f32_16x16x32_bf16 a[108:111], v[172:175], a[236:239], a[108:111]
    v_exp_f32 v249, v85
    v_mfma_f32_16x16x32_bf16 a[108:111], v[188:191], a[252:255], a[108:111]
    v_perm_b32 v169, v247, v246, s4
    v_perm_b32 v168, v245, v244, s4
    v_mfma_f32_16x16x32_bf16 a[104:107], v[188:191], a[248:251], a[104:107]
    v_exp_f32 v250, v86
    v_mfma_f32_16x16x32_bf16 a[104:107], v[172:175], a[232:235], a[104:107]
    v_exp_f32 v251, v87
    v_mfma_f32_16x16x32_bf16 a[100:103], v[172:175], a[228:231], a[100:103]
    v_perm_b32 v171, v251, v250, s4
    v_perm_b32 v170, v249, v248, s4
    v_mfma_f32_16x16x32_bf16 a[100:103], v[188:191], a[244:247], a[100:103]
    v_exp_f32 v244, v88
    v_mfma_f32_16x16x32_bf16 a[96:99], v[188:191], a[240:243], a[96:99]
    v_exp_f32 v245, v89
    v_mfma_f32_16x16x32_bf16 a[96:99], v[172:175], a[224:227], a[96:99]
    v_mov_b64 v[194:195], v[198:199]
    v_fma_f32 v210, v46, v212, s62
    v_mfma_f32_16x16x32_bf16 a[0:3], v[160:163], a[224:227], a[0:3]
    v_exp_f32 v246, v90
    v_mfma_f32_16x16x32_bf16 a[0:3], v[176:179], a[240:243], a[0:3]
    v_exp_f32 v247, v91
    v_fma_f32 v206, -v46, v214, v206
    v_mfma_f32_16x16x32_bf16 a[4:7], v[176:179], a[244:247], a[4:7]
    v_perm_b32 v173, v247, v246, s4
    v_perm_b32 v172, v245, v244, s4
    v_mfma_f32_16x16x32_bf16 a[4:7], v[160:163], a[228:231], a[4:7]
    v_exp_f32 v248, v92
    v_mfma_f32_16x16x32_bf16 a[8:11], v[160:163], a[232:235], a[8:11]
    v_exp_f32 v249, v93
    v_mfma_f32_16x16x32_bf16 a[8:11], v[176:179], a[248:251], a[8:11]
    v_perm_b32 v174, v249, v248, s4
    v_fma_f32 v210, v38, v214, v210
    v_mfma_f32_16x16x32_bf16 a[12:15], v[176:179], a[252:255], a[12:15]
    v_exp_f32 v250, v94
    v_mfma_f32_16x16x32_bf16 a[12:15], v[160:163], a[236:239], a[12:15]
    v_exp_f32 v251, v95
    v_mfma_f32_16x16x32_bf16 a[44:47], v[164:167], a[236:239], a[44:47]
    v_perm_b32 v175, v251, v250, s4
    v_fma_f32 v39, v39, v200, v202
    v_mfma_f32_16x16x32_bf16 a[44:47], v[180:183], a[252:255], a[44:47]
    v_fma_f32 v47, v47, v201, v203
    v_and_b32_e64 v212, s86, v51
    v_smfmac_f32_16x16x64_bf16 v[192:195], v[144:147], v[152:159], v255
    v_and_b32_e64 v214, s86, v59
    v_fma_f32 v207, v39, v212, s62
    v_smfmac_f32_16x16x64_bf16 v[192:195], v[148:151], v[168:175], v255
    v_fma_f32 v211, v47, v212, s62
    v_fma_f32 v207, -v47, v214, v207
    v_mfma_f32_16x16x32_bf16 a[40:43], v[180:183], a[248:251], a[40:43]
    s_waitcnt vmcnt(19) lgkmcnt(0)
    s_barrier
    v_mfma_f32_16x16x32_bf16 a[40:43], v[164:167], a[232:235], a[40:43]
    v_fma_f32 v211, v39, v214, v211
    v_cvt_pk_bf16_f32 v36, v204, v205
    v_mfma_f32_16x16x32_bf16 a[36:39], v[164:167], a[228:231], a[36:39]
    v_cvt_pk_bf16_f32 v37, v206, v207
    v_cvt_pk_bf16_f32 v38, v208, v209
    v_mfma_f32_16x16x32_bf16 a[36:39], v[180:183], a[244:247], a[36:39]
    v_cvt_pk_bf16_f32 v39, v210, v211
    v_mfma_f32_16x16x32_bf16 a[32:35], v[180:183], a[240:243], a[32:35]
    v_cmp_lt_f32_e64 vcc, s72, v192
    v_mfma_f32_16x16x32_bf16 a[32:35], v[164:167], a[224:227], a[32:35]
    s_cbranch_vccnz L_rare_rl_6
L_join_rl_6:
    v_mfma_f32_16x16x32_bf16 v[64:67], a[192:195], a[128:131], v[128:131]
    v_exp_f32 v244, v96
    v_mfma_f32_16x16x32_bf16 v[64:67], a[196:199], a[132:135], v[64:67]
    ds_read_b128 a[224:227], v14 offset:40960
    s_waitcnt vmcnt(4)
    v_cmp_ne_u64 vcc, v[6:7], v[4:5]
    v_mfma_f32_16x16x32_bf16 v[64:67], a[200:203], a[136:139], v[64:67]
    v_exp_f32 v245, v97
    v_mfma_f32_16x16x32_bf16 v[64:67], a[204:207], a[140:143], v[64:67]
    ds_read_b128 a[228:231], v253 offset:40960
    v_perm_b32 v236, v245, v244, s4
    v_mfma_f32_16x16x32_bf16 v[72:75], a[204:207], a[156:159], v[132:135]
    v_exp_f32 v246, v98
    v_mfma_f32_16x16x32_bf16 v[72:75], a[200:203], a[152:155], v[72:75]
    ds_read_b128 a[232:235], v254 offset:40960
    s_cbranch_vccnz L_spin_rlv
L_spinret_rlv:
    v_mfma_f32_16x16x32_bf16 v[72:75], a[196:199], a[148:151], v[72:75]
    v_exp_f32 v247, v99
    v_mfma_f32_16x16x32_bf16 v[72:75], a[192:195], a[144:147], v[72:75]
    ds_read_b128 a[236:239], v234 offset:40960
    v_perm_b32 v237, v247, v246, s4
    v_mfma_f32_16x16x32_bf16 v[80:83], a[192:195], a[160:163], v[136:139]
    v_exp_f32 v248, v100
    v_mfma_f32_16x16x32_bf16 v[80:83], a[196:199], a[164:167], v[80:83]
    ds_read_b128 a[240:243], v14 offset:45056
    v_add_u32 v2, s13, v2
    v_mfma_f32_16x16x32_bf16 v[80:83], a[200:203], a[168:171], v[80:83]
    v_exp_f32 v249, v101
    v_mfma_f32_16x16x32_bf16 v[80:83], a[204:207], a[172:175], v[80:83]
    ds_read_b128 a[244:247], v253 offset:45056
    v_perm_b32 v238, v249, v248, s4
    v_mfma_f32_16x16x32_bf16 v[88:91], a[204:207], a[188:191], v[140:143]
    v_exp_f32 v250, v102
    v_mfma_f32_16x16x32_bf16 v[88:91], a[200:203], a[184:187], v[88:91]
    ds_read_b128 a[248:251], v254 offset:45056
    s_add_u32 m0, s73, 0
    v_mfma_f32_16x16x32_bf16 v[88:91], a[196:199], a[180:183], v[88:91]
    v_exp_f32 v251, v103
    v_mfma_f32_16x16x32_bf16 v[88:91], a[192:195], a[176:179], v[88:91]
    ds_read_b128 a[252:255], v234 offset:45056
    v_perm_b32 v239, v251, v250, s4
    v_mfma_f32_16x16x32_bf16 v[92:95], a[208:211], a[176:179], v[140:143]
    v_exp_f32 v244, v104
    v_mfma_f32_16x16x32_bf16 v[92:95], a[212:215], a[180:183], v[92:95]
    buffer_load_dwordx4 v2, s[24:27], s71 offen offset:0 sc1 lds
    s_add_u32 s84, s84, 512
    v_mfma_f32_16x16x32_bf16 v[92:95], a[216:219], a[184:187], v[92:95]
    v_exp_f32 v245, v105
    v_mfma_f32_16x16x32_bf16 v[92:95], a[220:223], a[188:191], v[92:95]
    ds_read_b128 a[192:195], v252 offset:8192
    v_perm_b32 v240, v245, v244, s4
    v_mfma_f32_16x16x32_bf16 v[84:87], a[220:223], a[172:175], v[136:139]
    v_exp_f32 v246, v106
    v_mfma_f32_16x16x32_bf16 v[84:87], a[216:219], a[168:171], v[84:87]
    buffer_load_dwordx4 v2, s[24:27], s71 offen offset:1024 sc1 lds
    v_mfma_f32_16x16x32_bf16 v[84:87], a[212:215], a[164:167], v[84:87]
    v_exp_f32 v247, v107
    v_mfma_f32_16x16x32_bf16 v[84:87], a[208:211], a[160:163], v[84:87]
    ds_read_b128 a[196:199], v252 offset:9216
    v_perm_b32 v241, v247, v246, s4
    v_mfma_f32_16x16x32_bf16 v[76:79], a[208:211], a[144:147], v[132:135]
    v_exp_f32 v248, v108
    v_mfma_f32_16x16x32_bf16 v[76:79], a[212:215], a[148:151], v[76:79]
    buffer_load_dwordx4 v2, s[24:27], s71 offen offset:2048 sc1 lds
    v_mfma_f32_16x16x32_bf16 v[76:79], a[216:219], a[152:155], v[76:79]
    v_exp_f32 v249, v109
    v_mfma_f32_16x16x32_bf16 v[76:79], a[220:223], a[156:159], v[76:79]
    ds_read_b128 a[200:203], v252 offset:10240
    v_perm_b32 v242, v249, v248, s4
    v_mfma_f32_16x16x32_bf16 v[68:71], a[220:223], a[140:143], v[128:131]
    v_exp_f32 v250, v110
    v_mfma_f32_16x16x32_bf16 v[68:71], a[216:219], a[136:139], v[68:71]
    buffer_load_dwordx4 v2, s[24:27], s71 offen offset:3072 sc1 lds
    s_waitcnt lgkmcnt(3)
    v_mfma_f32_16x16x32_bf16 v[68:71], a[212:215], a[132:135], v[68:71]
    v_exp_f32 v251, v111
    v_mfma_f32_16x16x32_bf16 v[68:71], a[208:211], a[128:131], v[68:71]
    ds_read_b128 a[204:207], v252 offset:11264
    v_perm_b32 v243, v251, v250, s4
    v_mfma_f32_16x16x32_bf16 a[80:83], v[184:187], a[224:227], a[80:83]
    v_exp_f32 v244, v112
    v_mfma_f32_16x16x32_bf16 a[80:83], v[168:171], a[240:243], a[80:83]
    ds_read_b128 a[208:211], v252 offset:12288
    buffer_store_dwordx4 v[32:35], v0, s[24:27], s79 offen offset:0 sc1
    v_mfma_f32_16x16x32_bf16 a[84:87], v[168:171], a[244:247], a[84:87]
    v_exp_f32 v245, v113
    v_mfma_f32_16x16x32_bf16 a[84:87], v[184:187], a[228:231], a[84:87]
    ds_read_b128 a[212:215], v252 offset:13312
    ds_read_b128 a[216:219], v252 offset:14336
    v_mfma_f32_16x16x32_bf16 a[88:91], v[184:187], a[232:235], a[88:91]
    v_exp_f32 v246, v114
    v_mfma_f32_16x16x32_bf16 a[88:91], v[168:171], a[248:251], a[88:91]
    v_exp_f32 v247, v115
    v_mfma_f32_16x16x32_bf16 a[92:95], v[168:171], a[252:255], a[92:95]
    ds_read_b128 a[220:223], v252 offset:15360
    v_mov_b64 v[196:197], v[192:193]
    v_mfma_f32_16x16x32_bf16 a[92:95], v[184:187], a[236:239], a[92:95]
    v_exp_f32 v248, v116
    v_mfma_f32_16x16x32_bf16 a[124:127], v[188:191], a[236:239], a[124:127]
    v_exp_f32 v249, v117
    v_mfma_f32_16x16x32_bf16 a[124:127], v[172:175], a[252:255], a[124:127]
    v_perm_b32 v185, v247, v246, s4
    v_perm_b32 v184, v245, v244, s4
    v_mfma_f32_16x16x32_bf16 a[120:123], v[172:175], a[248:251], a[120:123]
    v_exp_f32 v250, v118
    v_mfma_f32_16x16x32_bf16 a[120:123], v[188:191], a[232:235], a[120:123]
    v_exp_f32 v251, v119
    v_mfma_f32_16x16x32_bf16 a[116:119], v[188:191], a[228:231], a[116:119]
    v_perm_b32 v187, v251, v250, s4
    v_perm_b32 v186, v249, v248, s4
    v_mfma_f32_16x16x32_bf16 a[116:119], v[172:175], a[244:247], a[116:119]
    v_exp_f32 v244, v120
    v_mfma_f32_16x16x32_bf16 a[112:115], v[172:175], a[240:243], a[112:115]
    v_exp_f32 v245, v121
    v_mfma_f32_16x16x32_bf16 a[112:115], v[188:191], a[224:227], a[112:115]
    buffer_store_dwordx4 v[36:39], v0, s[24:27], s79 offen offset:1024 sc1
    v_mov_b64 v[198:199], v[194:195]
    v_mfma_f32_16x16x32_bf16 a[16:19], v[176:179], a[224:227], a[16:19]
    v_exp_f32 v246, v122
    v_mfma_f32_16x16x32_bf16 a[16:19], v[152:155], a[240:243], a[16:19]
    v_exp_f32 v247, v123
    s_add_u32 s79, s79, 0x200000
    v_mfma_f32_16x16x32_bf16 a[20:23], v[152:155], a[244:247], a[20:23]
    v_perm_b32 v189, v247, v246, s4
    v_perm_b32 v188, v245, v244, s4
    v_mfma_f32_16x16x32_bf16 a[20:23], v[176:179], a[228:231], a[20:23]
    v_exp_f32 v248, v124
    v_mfma_f32_16x16x32_bf16 a[24:27], v[176:179], a[232:235], a[24:27]
    v_exp_f32 v249, v125
    v_mfma_f32_16x16x32_bf16 a[24:27], v[152:155], a[248:251], a[24:27]
    v_perm_b32 v190, v249, v248, s4
    v_mfma_f32_16x16x32_bf16 a[28:31], v[152:155], a[252:255], a[28:31]
    v_exp_f32 v250, v126
    v_mfma_f32_16x16x32_bf16 a[28:31], v[176:179], a[236:239], a[28:31]
    v_exp_f32 v251, v127
    v_mfma_f32_16x16x32_bf16 a[60:63], v[180:183], a[236:239], a[60:63]
    v_perm_b32 v191, v251, v250, s4
    v_mfma_f32_16x16x32_bf16 a[60:63], v[156:159], a[252:255], a[60:63]
    v_smfmac_f32_16x16x64_bf16 v[196:199], v[144:147], v[236:243], v255
    v_smfmac_f32_16x16x64_bf16 v[196:199], v[148:151], v[184:191], v255
    v_mfma_f32_16x16x32_bf16 a[56:59], v[156:159], a[248:251], a[56:59]
    s_waitcnt vmcnt(11) lgkmcnt(0)
    s_barrier
    v_mfma_f32_16x16x32_bf16 a[56:59], v[180:183], a[232:235], a[56:59]
    v_mfma_f32_16x16x32_bf16 a[52:55], v[180:183], a[228:231], a[52:55]
    v_mfma_f32_16x16x32_bf16 a[52:55], v[156:159], a[244:247], a[52:55]
    v_mfma_f32_16x16x32_bf16 a[48:51], v[156:159], a[240:243], a[48:51]
    s_nop 0
    v_cmp_lt_f32 vcc, s72, v196
    v_mfma_f32_16x16x32_bf16 a[48:51], v[180:183], a[224:227], a[48:51]
    s_cbranch_vccnz L_rare_rl_7
L_join_rl_7:
    s_sub_u32 s74, s74, 1
    s_cmp_lg_u32 s74, 0
    s_cbranch_scc1 L_loop_rl
    v_mfma_f32_16x16x32_bf16 v[96:99], a[192:195], a[128:131], v[128:131]
    v_exp_f32 v244, v64
    v_mfma_f32_16x16x32_bf16 v[96:99], a[196:199], a[132:135], v[96:99]
    ds_read_b128 a[224:227], v14 offset:49152
    s_waitcnt vmcnt(15)
    v_mfma_f32_16x16x32_bf16 v[96:99], a[200:203], a[136:139], v[96:99]
    v_exp_f32 v245, v65
    v_mfma_f32_16x16x32_bf16 v[96:99], a[204:207], a[140:143], v[96:99]
    ds_read_b128 a[228:231], v253 offset:49152
    v_perm_b32 v160, v245, v244, s4
    v_mfma_f32_16x16x32_bf16 v[104:107], a[204:207], a[156:159], v[132:135]
    v_exp_f32 v246, v66
    v_mfma_f32_16x16x32_bf16 v[104:107], a[200:203], a[152:155], v[104:107]
    ds_read_b128 a[232:235], v254 offset:49152
    v_lshlrev_b32 v232, 16, v232
    v_mfma_f32_16x16x32_bf16 v[104:107], a[196:199], a[148:151], v[104:107]
    v_exp_f32 v247, v67
    v_mfma_f32_16x16x32_bf16 v[104:107], a[192:195], a[144:147], v[104:107]
    ds_read_b128 a[236:239], v234 offset:49152
    v_perm_b32 v161, v247, v246, s4
    v_mfma_f32_16x16x32_bf16 v[112:115], a[192:195], a[160:163], v[136:139]
    v_exp_f32 v248, v68
    v_mfma_f32_16x16x32_bf16 v[112:115], a[196:199], a[164:167], v[112:115]
    ds_read_b128 a[240:243], v14 offset:53248
    v_lshlrev_b32 v233, 16, v233
    v_mfma_f32_16x16x32_bf16 v[112:115], a[200:203], a[168:171], v[112:115]
    v_exp_f32 v249, v69
    v_mfma_f32_16x16x32_bf16 v[112:115], a[204:207], a[172:175], v[112:115]
    ds_read_b128 a[244:247], v253 offset:53248
    v_perm_b32 v162, v249, v248, s4
    v_mfma_f32_16x16x32_bf16 v[120:123], a[204:207], a[188:191], v[140:143]
    v_exp_f32 v250, v70
    v_mfma_f32_16x16x32_bf16 v[120:123], a[200:203], a[184:187], v[120:123]
    ds_read_b128 a[248:251], v254 offset:53248
    s_add_u32 m0, s73, 8192
    v_mfma_f32_16x16x32_bf16 v[120:123], a[196:199], a[180:183], v[120:123]
    v_exp_f32 v251, v71
    v_mfma_f32_16x16x32_bf16 v[120:123], a[192:195], a[176:179], v[120:123]
    ds_read_b128 a[252:255], v234 offset:53248
L_stop6:
    s_cbranch_execz L_stop10
    v_perm_b32 v163, v251, v250, s4
    v_mfma_f32_16x16x32_bf16 v[124:127], a[208:211], a[176:179], v[140:143]
    v_exp_f32 v244, v72
    v_mfma_f32_16x16x32_bf16 v[124:127], a[212:215], a[180:183], v[124:127]
    buffer_load_dwordx4 v2, s[24:27], s64 offen offset:0 sc1 lds
    v_fma_f32 v233, v233, v232, -s63
    v_mfma_f32_16x16x32_bf16 v[124:127], a[216:219], a[184:187], v[124:127]
    v_exp_f32 v245, v73
    v_mfma_f32_16x16x32_bf16 v[124:127], a[220:223], a[188:191], v[124:127]
    ds_read_b128 a[192:195], v252 offset:16384
    v_perm_b32 v164, v245, v244, s4
    v_mfma_f32_16x16x32_bf16 v[116:119], a[220:223], a[172:175], v[136:139]
    v_exp_f32 v246, v74
    v_mfma_f32_16x16x32_bf16 v[116:119], a[216:219], a[168:171], v[116:119]
    buffer_load_dwordx4 v2, s[24:27], s64 offen offset:1024 sc1 lds
    v_cvt_f32_i32 v216, v216
    v_mfma_f32_16x16x32_bf16 v[116:119], a[212:215], a[164:167], v[116:119]
    v_exp_f32 v247, v75
    v_mfma_f32_16x16x32_bf16 v[116:119], a[208:211], a[160:163], v[116:119]
    ds_read_b128 a[196:199], v252 offset:17408
    v_perm_b32 v165, v247, v246, s4
    v_mfma_f32_16x16x32_bf16 v[108:111], a[208:211], a[144:147], v[132:135]
    v_exp_f32 v248, v76
    v_mfma_f32_16x16x32_bf16 v[108:111], a[212:215], a[148:151], v[108:111]
    buffer_load_dwordx4 v2, s[24:27], s64 offen offset:2048 sc1 lds
    v_cvt_f32_i32 v217, v217
    v_mfma_f32_16x16x32_bf16 v[108:111], a[216:219], a[152:155], v[108:111]
    v_exp_f32 v249, v77
    v_mfma_f32_16x16x32_bf16 v[108:111], a[220:223], a[156:159], v[108:111]
    ds_read_b128 a[200:203], v252 offset:18432
    v_perm_b32 v166, v249, v248, s4
    v_mfma_f32_16x16x32_bf16 v[100:103], a[220:223], a[140:143], v[128:131]
    v_exp_f32 v250, v78
    v_mfma_f32_16x16x32_bf16 v[100:103], a[216:219], a[136:139], v[100:103]
    buffer_load_dwordx4 v2, s[24:27], s64 offen offset:3072 sc1 lds
    s_waitcnt lgkmcnt(3)
    v_mfma_f32_16x16x32_bf16 v[100:103], a[212:215], a[132:135], v[100:103]
    v_exp_f32 v251, v79
    v_mfma_f32_16x16x32_bf16 v[100:103], a[208:211], a[128:131], v[100:103]
    ds_read_b128 a[204:207], v252 offset:19456
    v_perm_b32 v167, v251, v250, s4
    v_mfma_f32_16x16x32_bf16 a[64:67], v[168:171], a[224:227], a[64:67]
    v_exp_f32 v244, v80
    v_mfma_f32_16x16x32_bf16 a[64:67], v[184:187], a[240:243], a[64:67]
    ds_read_b128 a[208:211], v252 offset:20480
    v_mul_f32_dpp v216, v232, v216 row_newbcast:0 row_mask:0xf bank_mask:0xf
    v_mfma_f32_16x16x32_bf16 a[68:71], v[184:187], a[244:247], a[68:71]
    v_exp_f32 v245, v81
    v_mfma_f32_16x16x32_bf16 a[68:71], v[168:171], a[228:231], a[68:71]
    ds_read_b128 a[212:215], v252 offset:21504
    ds_read_b128 a[216:219], v252 offset:22528
    v_mfma_f32_16x16x32_bf16 a[72:75], v[168:171], a[232:235], a[72:75]
    v_exp_f32 v246, v82
    v_mfma_f32_16x16x32_bf16 a[72:75], v[184:187], a[248:251], a[72:75]
    v_exp_f32 v247, v83
    v_mfma_f32_16x16x32_bf16 a[76:79], v[184:187], a[252:255], a[76:79]
    ds_read_b128 a[220:223], v252 offset:23552
    v_mov_b64 v[192:193], v[196:197]
    v_mfma_f32_16x16x32_bf16 a[76:79], v[168:171], a[236:239], a[76:79]
    v_exp_f32 v248, v84
    v_mfma_f32_16x16x32_bf16 a[108:111], v[172:175], a[236:239], a[108:111]
    v_exp_f32 v249, v85
    v_mfma_f32_16x16x32_bf16 a[108:111], v[188:191], a[252:255], a[108:111]
    v_perm_b32 v169, v247, v246, s4
    v_perm_b32 v168, v245, v244, s4
    v_mfma_f32_16x16x32_bf16 a[104:107], v[188:191], a[248:251], a[104:107]
    v_exp_f32 v250, v86
    v_mfma_f32_16x16x32_bf16 a[104:107], v[172:175], a[232:235], a[104:107]
    v_exp_f32 v251, v87
    v_mfma_f32_16x16x32_bf16 a[100:103], v[172:175], a[228:231], a[100:103]
    v_perm_b32 v171, v251, v250, s4
    v_perm_b32 v170, v249, v248, s4
    v_mfma_f32_16x16x32_bf16 a[100:103], v[188:191], a[244:247], a[100:103]
    v_exp_f32 v244, v88
    v_mfma_f32_16x16x32_bf16 a[96:99], v[188:191], a[240:243], a[96:99]
    v_exp_f32 v245, v89
    v_mfma_f32_16x16x32_bf16 a[96:99], v[172:175], a[224:227], a[96:99]
    v_mov_b64 v[194:195], v[198:199]
    v_mul_f32_dpp v217, v232, v217 row_newbcast:0 row_mask:0xf bank_mask:0xf
    v_mfma_f32_16x16x32_bf16 a[0:3], v[152:155], a[224:227], a[0:3]
    v_exp_f32 v246, v90
    v_mfma_f32_16x16x32_bf16 a[0:3], v[236:239], a[240:243], a[0:3]
    v_exp_f32 v247, v91
    v_mfma_f32_16x16x32_bf16 a[4:7], v[236:239], a[244:247], a[4:7]
    v_perm_b32 v173, v247, v246, s4
    v_perm_b32 v172, v245, v244, s4
    v_mfma_f32_16x16x32_bf16 a[4:7], v[152:155], a[228:231], a[4:7]
    v_exp_f32 v248, v92
    v_mfma_f32_16x16x32_bf16 a[8:11], v[152:155], a[232:235], a[8:11]
    v_exp_f32 v249, v93
    v_mfma_f32_16x16x32_bf16 a[8:11], v[236:239], a[248:251], a[8:11]
    v_perm_b32 v174, v249, v248, s4
    v_subrev_f32_dpp v216, v233, v216 row_newbcast:0 row_mask:0xf bank_mask:0xf
    v_mfma_f32_16x16x32_bf16 a[12:15], v[236:239], a[252:255], a[12:15]
    v_exp_f32 v250, v94
    v_mfma_f32_16x16x32_bf16 a[12:15], v[152:155], a[236:239], a[12:15]
    v_exp_f32 v251, v95
    v_mfma_f32_16x16x32_bf16 a[44:47], v[156:159], a[236:239], a[44:47]
    v_perm_b32 v175, v251, v250, s4
    v_subrev_f32_dpp v217, v233, v217 row_newbcast:0 row_mask:0xf bank_mask:0xf
    v_mfma_f32_16x16x32_bf16 a[44:47], v[240:243], a[252:255], a[44:47]
    v_cvt_f32_i32 v218, v218
    v_cvt_f32_i32 v219, v219
    v_smfmac_f32_16x16x64_bf16 v[192:195], v[144:147], v[160:167], v255
    v_mul_f32_dpp v218, v232, v218 row_newbcast:1 row_mask:0xf bank_mask:0xf
    v_mul_f32_dpp v219, v232, v219 row_newbcast:1 row_mask:0xf bank_mask:0xf
    v_smfmac_f32_16x16x64_bf16 v[192:195], v[148:151], v[168:175], v255
    v_subrev_f32_dpp v218, v233, v218 row_newbcast:1 row_mask:0xf bank_mask:0xf
    v_subrev_f32_dpp v219, v233, v219 row_newbcast:1 row_mask:0xf bank_mask:0xf
    v_mfma_f32_16x16x32_bf16 a[40:43], v[240:243], a[248:251], a[40:43]
    s_waitcnt vmcnt(4) lgkmcnt(0)
    s_barrier
    v_mfma_f32_16x16x32_bf16 a[40:43], v[156:159], a[232:235], a[40:43]
    v_cvt_f32_i32 v220, v220
    v_cvt_f32_i32 v221, v221
    v_mfma_f32_16x16x32_bf16 a[36:39], v[156:159], a[228:231], a[36:39]
    v_mul_f32_dpp v220, v232, v220 row_newbcast:4 row_mask:0xf bank_mask:0xf
    v_mul_f32_dpp v221, v232, v221 row_newbcast:4 row_mask:0xf bank_mask:0xf
    v_mfma_f32_16x16x32_bf16 a[36:39], v[240:243], a[244:247], a[36:39]
    v_subrev_f32_dpp v220, v233, v220 row_newbcast:4 row_mask:0xf bank_mask:0xf
    v_subrev_f32_dpp v221, v233, v221 row_newbcast:4 row_mask:0xf bank_mask:0xf
    v_mfma_f32_16x16x32_bf16 a[32:35], v[240:243], a[240:243], a[32:35]
    v_cmp_lt_f32 vcc, s72, v192
    v_cvt_f32_i32 v222, v222
    v_mfma_f32_16x16x32_bf16 a[32:35], v[156:159], a[224:227], a[32:35]
    v_cvt_f32_i32_e64 v223, v223
    s_cbranch_vccnz L_rare_r6_0
L_join_r6_0:
    v_mfma_f32_16x16x32_bf16 v[64:67], a[192:195], a[128:131], v[128:131]
    v_exp_f32 v244, v96
    v_mfma_f32_16x16x32_bf16 v[64:67], a[196:199], a[132:135], v[64:67]
    ds_read_b128 a[224:227], v14 offset:57344
    buffer_store_dwordx2 v[4:5], v13, s[24:27], s81 offen sc1
    v_mfma_f32_16x16x32_bf16 v[64:67], a[200:203], a[136:139], v[64:67]
    v_exp_f32 v245, v97
    v_mfma_f32_16x16x32_bf16 v[64:67], a[204:207], a[140:143], v[64:67]
    ds_read_b128 a[228:231], v253 offset:57344
    v_perm_b32 v176, v245, v244, s4
    v_mfma_f32_16x16x32_bf16 v[72:75], a[204:207], a[156:159], v[132:135]
    v_exp_f32 v246, v98
    v_mfma_f32_16x16x32_bf16 v[72:75], a[200:203], a[152:155], v[72:75]
    ds_read_b128 a[232:235], v254 offset:57344
    s_add_u32 s81, s81, 512
    v_mfma_f32_16x16x32_bf16 v[72:75], a[196:199], a[148:151], v[72:75]
    v_exp_f32 v247, v99
    v_mfma_f32_16x16x32_bf16 v[72:75], a[192:195], a[144:147], v[72:75]
    ds_read_b128 a[236:239], v234 offset:57344
    v_perm_b32 v177, v247, v246, s4
    v_mfma_f32_16x16x32_bf16 v[80:83], a[192:195], a[160:163], v[136:139]
    v_exp_f32 v248, v100
    v_mfma_f32_16x16x32_bf16 v[80:83], a[196:199], a[164:167], v[80:83]
    ds_read_b128 a[240:243], v14 offset:61440
    v_mul_f32_dpp v222, v232, v222 row_newbcast:5 row_mask:0xf bank_mask:0xf
    v_mfma_f32_16x16x32_bf16 v[80:83], a[200:203], a[168:171], v[80:83]
    v_exp_f32 v249, v101
    v_mfma_f32_16x16x32_bf16 v[80:83], a[204:207], a[172:175], v[80:83]
    ds_read_b128 a[244:247], v253 offset:61440
    v_perm_b32 v178, v249, v248, s4
    v_mfma_f32_16x16x32_bf16 v[88:91], a[204:207], a[188:191], v[140:143]
    v_exp_f32 v250, v102
    v_mfma_f32_16x16x32_bf16 v[88:91], a[200:203], a[184:187], v[88:91]
    ds_read_b128 a[248:251], v254 offset:61440
    s_add_u32 m0, s73, 16384
    v_mfma_f32_16x16x32_bf16 v[88:91], a[196:199], a[180:183], v[88:91]
    v_exp_f32 v251, v103
    v_mfma_f32_16x16x32_bf16 v[88:91], a[192:195], a[176:179], v[88:91]
    ds_read_b128 a[252:255], v234 offset:61440
    v_perm_b32 v179, v251, v250, s4
    v_mfma_f32_16x16x32_bf16 v[92:95], a[208:211], a[176:179], v[140:143]
    v_exp_f32 v244, v104
    v_mfma_f32_16x16x32_bf16 v[92:95], a[212:215], a[180:183], v[92:95]
    buffer_load_dwordx4 v2, s[24:27], s65 offen offset:0 sc1 lds
    v_mul_f32_dpp v223, v232, v223 row_newbcast:5 row_mask:0xf bank_mask:0xf
    v_mfma_f32_16x16x32_bf16 v[92:95], a[216:219], a[184:187], v[92:95]
    v_exp_f32 v245, v105
    v_mfma_f32_16x16x32_bf16 v[92:95], a[220:223], a[188:191], v[92:95]
    ds_read_b128 a[192:195], v252 offset:24576
    v_perm_b32 v180, v245, v244, s4
    v_mfma_f32_16x16x32_bf16 v[84:87], a[220:223], a[172:175], v[136:139]
    v_exp_f32 v246, v106
    v_mfma_f32_16x16x32_bf16 v[84:87], a[216:219], a[168:171], v[84:87]
    buffer_load_dwordx4 v2, s[24:27], s65 offen offset:1024 sc1 lds
    v_subrev_f32_dpp v222, v233, v222 row_newbcast:5 row_mask:0xf bank_mask:0xf
    v_mfma_f32_16x16x32_bf16 v[84:87], a[212:215], a[164:167], v[84:87]
    v_exp_f32 v247, v107
    v_mfma_f32_16x16x32_bf16 v[84:87], a[208:211], a[160:163], v[84:87]
    ds_read_b128 a[196:199], v252 offset:25600
    v_perm_b32 v181, v247, v246, s4
    v_mfma_f32_16x16x32_bf16 v[76:79], a[208:211], a[144:147], v[132:135]
    v_exp_f32 v248, v108
    v_mfma_f32_16x16x32_bf16 v[76:79], a[212:215], a[148:151], v[76:79]
    buffer_load_dwordx4 v2, s[24:27], s65 offen offset:2048 sc1 lds
    v_subrev_f32_dpp v223, v233, v223 row_newbcast:5 row_mask:0xf bank_mask:0xf
    v_mfma_f32_16x16x32_bf16 v[76:79], a[216:219], a[152:155], v[76:79]
    v_exp_f32 v249, v109
    v_mfma_f32_16x16x32_bf16 v[76:79], a[220:223], a[156:159], v[76:79]
    ds_read_b128 a[200:203], v252 offset:26624
    v_perm_b32 v182, v249, v248, s4
    v_mfma_f32_16x16x32_bf16 v[68:71], a[220:223], a[140:143], v[128:131]
    v_exp_f32 v250, v110
    v_mfma_f32_16x16x32_bf16 v[68:71], a[216:219], a[136:139], v[68:71]
    buffer_load_dwordx4 v2, s[24:27], s65 offen offset:3072 sc1 lds
    s_waitcnt lgkmcnt(3)
    v_mfma_f32_16x16x32_bf16 v[68:71], a[212:215], a[132:135], v[68:71]
    v_exp_f32 v251, v111
    v_mfma_f32_16x16x32_bf16 v[68:71], a[208:211], a[128:131], v[68:71]
    ds_read_b128 a[204:207], v252 offset:27648
    v_perm_b32 v183, v251, v250, s4
    v_mfma_f32_16x16x32_bf16 a[80:83], v[184:187], a[224:227], a[80:83]
    v_exp_f32 v244, v112
    v_mfma_f32_16x16x32_bf16 a[80:83], v[168:171], a[240:243], a[80:83]
    ds_read_b128 a[208:211], v252 offset:28672
    v_cvt_pk_bf16_f32 v216, v216, v218
    v_mfma_f32_16x16x32_bf16 a[84:87], v[168:171], a[244:247], a[84:87]
    v_exp_f32 v245, v113
    v_mfma_f32_16x16x32_bf16 a[84:87], v[184:187], a[228:231], a[84:87]
    ds_read_b128 a[212:215], v252 offset:29696
    ds_read_b128 a[216:219], v252 offset:30720
    v_mfma_f32_16x16x32_bf16 a[88:91], v[184:187], a[232:235], a[88:91]
    v_exp_f32 v246, v114
    v_mfma_f32_16x16x32_bf16 a[88:91], v[168:171], a[248:251], a[88:91]
    v_exp_f32 v247, v115
    v_mfma_f32_16x16x32_bf16 a[92:95], v[168:171], a[252:255], a[92:95]
    ds_read_b128 a[220:223], v252 offset:31744
    v_mov_b64 v[196:197], v[192:193]
    v_mfma_f32_16x16x32_bf16 a[92:95], v[184:187], a[236:239], a[92:95]
    v_exp_f32 v248, v116
    v_mfma_f32_16x16x32_bf16 a[124:127], v[188:191], a[236:239], a[124:127]
    v_exp_f32 v249, v117
    v_mfma_f32_16x16x32_bf16 a[124:127], v[172:175], a[252:255], a[124:127]
    v_perm_b32 v185, v247, v246, s4
    v_perm_b32 v184, v245, v244, s4
    v_mfma_f32_16x16x32_bf16 a[120:123], v[172:175], a[248:251], a[120:123]
    v_exp_f32 v250, v118
    v_mfma_f32_16x16x32_bf16 a[120:123], v[188:191], a[232:235], a[120:123]
    v_exp_f32 v251, v119
    v_mfma_f32_16x16x32_bf16 a[116:119], v[188:191], a[228:231], a[116:119]
    v_perm_b32 v187, v251, v250, s4
    v_perm_b32 v186, v249, v248, s4
    v_mfma_f32_16x16x32_bf16 a[116:119], v[172:175], a[244:247], a[116:119]
    v_exp_f32 v244, v120
    v_mfma_f32_16x16x32_bf16 a[112:115], v[172:175], a[240:243], a[112:115]
    v_exp_f32 v245, v121
    v_mfma_f32_16x16x32_bf16 a[112:115], v[188:191], a[224:227], a[112:115]
    v_mov_b64 v[198:199], v[194:195]
    v_cvt_pk_bf16_f32 v218, v220, v222
    v_mfma_f32_16x16x32_bf16 a[16:19], v[236:239], a[224:227], a[16:19]
    v_exp_f32 v246, v122
    v_mfma_f32_16x16x32_bf16 a[16:19], v[160:163], a[240:243], a[16:19]
    v_exp_f32 v247, v123
    v_mfma_f32_16x16x32_bf16 a[20:23], v[160:163], a[244:247], a[20:23]
    v_perm_b32 v189, v247, v246, s4
    v_perm_b32 v188, v245, v244, s4
    v_mfma_f32_16x16x32_bf16 a[20:23], v[236:239], a[228:231], a[20:23]
    v_exp_f32 v248, v124
    v_mfma_f32_16x16x32_bf16 a[24:27], v[236:239], a[232:235], a[24:27]
    v_exp_f32 v249, v125
    v_mfma_f32_16x16x32_bf16 a[24:27], v[160:163], a[248:251], a[24:27]
    v_perm_b32 v190, v249, v248, s4
    v_cvt_pk_bf16_f32 v220, v217, v219
    v_mfma_f32_16x16x32_bf16 a[28:31], v[160:163], a[252:255], a[28:31]
    v_exp_f32 v250, v126
    v_mfma_f32_16x16x32_bf16 a[28:31], v[236:239], a[236:239], a[28:31]
    v_exp_f32 v251, v127
    v_mfma_f32_16x16x32_bf16 a[60:63], v[240:243], a[236:239], a[60:63]
    v_perm_b32 v191, v251, v250, s4
    v_cvt_pk_bf16_f32 v222, v221, v223
    v_mfma_f32_16x16x32_bf16 a[60:63], v[164:167], a[252:255], a[60:63]
    v_cvt_f32_i32 v224, v224
    v_cvt_f32_i32 v225, v225
    v_smfmac_f32_16x16x64_bf16 v[196:199], v[144:147], v[176:183], v255
    v_mul_f32_dpp v224, v232, v224 row_newbcast:2 row_mask:0xf bank_mask:0xf
    v_mul_f32_dpp v225, v232, v225 row_newbcast:2 row_mask:0xf bank_mask:0xf
    v_smfmac_f32_16x16x64_bf16 v[196:199], v[148:151], v[184:191], v255
    v_subrev_f32_dpp v224, v233, v224 row_newbcast:2 row_mask:0xf bank_mask:0xf
    v_subrev_f32_dpp v225, v233, v225 row_newbcast:2 row_mask:0xf bank_mask:0xf
    v_mfma_f32_16x16x32_bf16 a[56:59], v[164:167], a[248:251], a[56:59]
    s_waitcnt vmcnt(11) lgkmcnt(0)
    s_barrier
    v_mfma_f32_16x16x32_bf16 a[56:59], v[240:243], a[232:235], a[56:59]
    v_cvt_f32_i32 v226, v226
    v_cvt_f32_i32 v227, v227
    v_mfma_f32_16x16x32_bf16 a[52:55], v[240:243], a[228:231], a[52:55]
    v_mul_f32_dpp v226, v232, v226 row_newbcast:3 row_mask:0xf bank_mask:0xf
    v_mul_f32_dpp v227, v232, v227 row_newbcast:3 row_mask:0xf bank_mask:0xf
    v_mfma_f32_16x16x32_bf16 a[52:55], v[164:167], a[244:247], a[52:55]
    v_subrev_f32_dpp v226, v233, v226 row_newbcast:3 row_mask:0xf bank_mask:0xf
    v_subrev_f32_dpp v227, v233, v227 row_newbcast:3 row_mask:0xf bank_mask:0xf
    v_mfma_f32_16x16x32_bf16 a[48:51], v[164:167], a[240:243], a[48:51]
    v_cmp_lt_f32 vcc, s72, v196
    v_cvt_pk_bf16_f32 v217, v224, v226
    v_mfma_f32_16x16x32_bf16 a[48:51], v[240:243], a[224:227], a[48:51]
    v_cvt_pk_bf16_f32 v221, v225, v227
    s_cbranch_vccnz L_rare_r6_1
L_join_r6_1:
    v_mfma_f32_16x16x32_bf16 v[96:99], a[192:195], a[128:131], v[128:131]
    v_exp_f32 v244, v64
    v_mfma_f32_16x16x32_bf16 v[96:99], a[196:199], a[132:135], v[96:99]
    ds_read_b128 a[224:227], v14 offset:32768
    v_cvt_f32_i32 v228, v228
    v_mfma_f32_16x16x32_bf16 v[96:99], a[200:203], a[136:139], v[96:99]
    v_exp_f32 v245, v65
    v_mfma_f32_16x16x32_bf16 v[96:99], a[204:207], a[140:143], v[96:99]
    ds_read_b128 a[228:231], v253 offset:32768
    v_perm_b32 v152, v245, v244, s4
    v_mfma_f32_16x16x32_bf16 v[104:107], a[204:207], a[156:159], v[132:135]
    v_exp_f32 v246, v66
    v_mfma_f32_16x16x32_bf16 v[104:107], a[200:203], a[152:155], v[104:107]
    ds_read_b128 a[232:235], v254 offset:32768
    v_cvt_f32_i32 v229, v229
    v_mfma_f32_16x16x32_bf16 v[104:107], a[196:199], a[148:151], v[104:107]
    v_exp_f32 v247, v67
    v_mfma_f32_16x16x32_bf16 v[104:107], a[192:195], a[144:147], v[104:107]
    ds_read_b128 a[236:239], v234 offset:32768
    v_perm_b32 v153, v247, v246, s4
    v_mfma_f32_16x16x32_bf16 v[112:115], a[192:195], a[160:163], v[136:139]
    v_exp_f32 v248, v68
    v_mfma_f32_16x16x32_bf16 v[112:115], a[196:199], a[164:167], v[112:115]
    ds_read_b128 a[240:243], v14 offset:36864
    v_mul_f32_dpp v228, v232, v228 row_newbcast:6 row_mask:0xf bank_mask:0xf
    v_mfma_f32_16x16x32_bf16 v[112:115], a[200:203], a[168:171], v[112:115]
    v_exp_f32 v249, v69
    v_mfma_f32_16x16x32_bf16 v[112:115], a[204:207], a[172:175], v[112:115]
    ds_read_b128 a[244:247], v253 offset:36864
    v_perm_b32 v154, v249, v248, s4
    v_mfma_f32_16x16x32_bf16 v[120:123], a[204:207], a[188:191], v[140:143]
    v_exp_f32 v250, v70
    v_mfma_f32_16x16x32_bf16 v[120:123], a[200:203], a[184:187], v[120:123]
    ds_read_b128 a[248:251], v254 offset:36864
    s_add_u32 m0, s73, 24576
    v_mfma_f32_16x16x32_bf16 v[120:123], a[196:199], a[180:183], v[120:123]
    v_exp_f32 v251, v71
    v_mfma_f32_16x16x32_bf16 v[120:123], a[192:195], a[176:179], v[120:123]
    ds_read_b128 a[252:255], v234 offset:36864
    v_perm_b32 v155, v251, v250, s4
    v_mfma_f32_16x16x32_bf16 v[124:127], a[208:211], a[176:179], v[140:143]
    v_exp_f32 v244, v72
    v_mfma_f32_16x16x32_bf16 v[124:127], a[212:215], a[180:183], v[124:127]
    buffer_load_dwordx4 v2, s[24:27], s66 offen offset:0 sc1 lds
    v_mul_f32_dpp v229, v232, v229 row_newbcast:6 row_mask:0xf bank_mask:0xf
    v_mfma_f32_16x16x32_bf16 v[124:127], a[216:219], a[184:187], v[124:127]
    v_exp_f32 v245, v73
    v_mfma_f32_16x16x32_bf16 v[124:127], a[220:223], a[188:191], v[124:127]
    ds_read_b128 a[192:195], v252 offset:0
    v_perm_b32 v156, v245, v244, s4
    v_mfma_f32_16x16x32_bf16 v[116:119], a[220:223], a[172:175], v[136:139]
    v_exp_f32 v246, v74
    v_mfma_f32_16x16x32_bf16 v[116:119], a[216:219], a[168:171], v[116:119]
    buffer_load_dwordx4 v2, s[24:27], s66 offen offset:1024 sc1 lds
    v_subrev_f32_dpp v228, v233, v228 row_newbcast:6 row_mask:0xf bank_mask:0xf
    v_mfma_f32_16x16x32_bf16 v[116:119], a[212:215], a[164:167], v[116:119]
    v_exp_f32 v247, v75
    v_mfma_f32_16x16x32_bf16 v[116:119], a[208:211], a[160:163], v[116:119]
    ds_read_b128 a[196:199], v252 offset:1024
    v_perm_b32 v157, v247, v246, s4
    v_mfma_f32_16x16x32_bf16 v[108:111], a[208:211], a[144:147], v[132:135]
    v_exp_f32 v248, v76
    v_mfma_f32_16x16x32_bf16 v[108:111], a[212:215], a[148:151], v[108:111]
    buffer_load_dwordx4 v2, s[24:27], s66 offen offset:2048 sc1 lds
    v_subrev_f32_dpp v229, v233, v229 row_newbcast:6 row_mask:0xf bank_mask:0xf
    v_mfma_f32_16x16x32_bf16 v[108:111], a[216:219], a[152:155], v[108:111]
    v_exp_f32 v249, v77
    v_mfma_f32_16x16x32_bf16 v[108:111], a[220:223], a[156:159], v[108:111]
    ds_read_b128 a[200:203], v252 offset:2048
    v_perm_b32 v158, v249, v248, s4
    v_mfma_f32_16x16x32_bf16 v[100:103], a[220:223], a[140:143], v[128:131]
    v_exp_f32 v250, v78
    v_mfma_f32_16x16x32_bf16 v[100:103], a[216:219], a[136:139], v[100:103]
    buffer_load_dwordx4 v2, s[24:27], s66 offen offset:3072 sc1 lds
    s_waitcnt lgkmcnt(3)
    v_mfma_f32_16x16x32_bf16 v[100:103], a[212:215], a[132:135], v[100:103]
    v_exp_f32 v251, v79
    v_mfma_f32_16x16x32_bf16 v[100:103], a[208:211], a[128:131], v[100:103]
    ds_read_b128 a[204:207], v252 offset:3072
    v_perm_b32 v159, v251, v250, s4
    v_mfma_f32_16x16x32_bf16 a[64:67], v[168:171], a[224:227], a[64:67]
    v_exp_f32 v244, v80
    v_mfma_f32_16x16x32_bf16 a[64:67], v[184:187], a[240:243], a[64:67]
    ds_read_b128 a[208:211], v252 offset:4096
    v_cvt_f32_i32 v230, v230
    v_mfma_f32_16x16x32_bf16 a[68:71], v[184:187], a[244:247], a[68:71]
    v_exp_f32 v245, v81
    v_mfma_f32_16x16x32_bf16 a[68:71], v[168:171], a[228:231], a[68:71]
    ds_read_b128 a[212:215], v252 offset:5120
    ds_read_b128 a[216:219], v252 offset:6144
    v_mfma_f32_16x16x32_bf16 a[72:75], v[168:171], a[232:235], a[72:75]
    v_exp_f32 v246, v82
    v_mfma_f32_16x16x32_bf16 a[72:75], v[184:187], a[248:251], a[72:75]
    v_exp_f32 v247, v83
    v_mfma_f32_16x16x32_bf16 a[76:79], v[184:187], a[252:255], a[76:79]
    ds_read_b128 a[220:223], v252 offset:7168
    v_mov_b64 v[192:193], v[196:197]
    v_mfma_f32_16x16x32_bf16 a[76:79], v[168:171], a[236:239], a[76:79]
    v_exp_f32 v248, v84
    v_mfma_f32_16x16x32_bf16 a[108:111], v[172:175], a[236:239], a[108:111]
    v_exp_f32 v249, v85
    v_mfma_f32_16x16x32_bf16 a[108:111], v[188:191], a[252:255], a[108:111]
    v_perm_b32 v169, v247, v246, s4
    v_perm_b32 v168, v245, v244, s4
    v_mfma_f32_16x16x32_bf16 a[104:107], v[188:191], a[248:251], a[104:107]
    v_exp_f32 v250, v86
    v_mfma_f32_16x16x32_bf16 a[104:107], v[172:175], a[232:235], a[104:107]
    v_exp_f32 v251, v87
    v_mfma_f32_16x16x32_bf16 a[100:103], v[172:175], a[228:231], a[100:103]
    v_perm_b32 v171, v251, v250, s4
    v_perm_b32 v170, v249, v248, s4
    v_mfma_f32_16x16x32_bf16 a[100:103], v[188:191], a[244:247], a[100:103]
    v_exp_f32 v244, v88
    v_mfma_f32_16x16x32_bf16 a[96:99], v[188:191], a[240:243], a[96:99]
    v_exp_f32 v245, v89
    v_mfma_f32_16x16x32_bf16 a[96:99], v[172:175], a[224:227], a[96:99]
    v_mov_b64 v[194:195], v[198:199]
    v_cvt_f32_i32 v231, v231
    v_mfma_f32_16x16x32_bf16 a[0:3], v[160:163], a[224:227], a[0:3]
    v_exp_f32 v246, v90
    v_mfma_f32_16x16x32_bf16 a[0:3], v[176:179], a[240:243], a[0:3]
    v_exp_f32 v247, v91
    v_mfma_f32_16x16x32_bf16 a[4:7], v[176:179], a[244:247], a[4:7]
    v_perm_b32 v173, v247, v246, s4
    v_perm_b32 v172, v245, v244, s4
    v_mfma_f32_16x16x32_bf16 a[4:7], v[160:163], a[228:231], a[4:7]
    v_exp_f32 v248, v92
    v_mfma_f32_16x16x32_bf16 a[8:11], v[160:163], a[232:235], a[8:11]
    v_exp_f32 v249, v93
    v_mfma_f32_16x16x32_bf16 a[8:11], v[176:179], a[248:251], a[8:11]
    v_perm_b32 v174, v249, v248, s4
    v_mul_f32_dpp v230, v232, v230 row_newbcast:7 row_mask:0xf bank_mask:0xf
    v_mfma_f32_16x16x32_bf16 a[12:15], v[176:179], a[252:255], a[12:15]
    v_exp_f32 v250, v94
    v_mfma_f32_16x16x32_bf16 a[12:15], v[160:163], a[236:239], a[12:15]
    v_exp_f32_e64 v251, v95
    v_mfma_f32_16x16x32_bf16 a[44:47], v[164:167], a[236:239], a[44:47]
    v_perm_b32 v175, v251, v250, s4
    v_mul_f32_dpp v231, v232, v231 row_newbcast:7 row_mask:0xf bank_mask:0xf
    v_mfma_f32_16x16x32_bf16 a[44:47], v[180:183], a[252:255], a[44:47]
    v_subrev_f32_dpp v230, v233, v230 row_newbcast:7 row_mask:0xf bank_mask:0xf
    v_subrev_f32_dpp v231, v233, v231 row_newbcast:7 row_mask:0xf bank_mask:0xf
    v_smfmac_f32_16x16x64_bf16 v[192:195], v[144:147], v[152:159], v255
    v_cvt_pk_bf16_f32 v219, v228, v230
    v_cvt_pk_bf16_f32 v223, v229, v231
    v_smfmac_f32_16x16x64_bf16 v[192:195], v[148:151], v[168:175], v255
    buffer_store_dwordx4 v[216:219], v0, s[24:27], s80 offen offset:0 sc1
    s_add_u32 s80, s80, 4096
    v_mfma_f32_16x16x32_bf16 a[40:43], v[180:183], a[248:251], a[40:43]
    s_waitcnt vmcnt(10) lgkmcnt(0)
    s_barrier
    v_mfma_f32_16x16x32_bf16 a[40:43], v[164:167], a[232:235], a[40:43]
    v_mfma_f32_16x16x32_bf16 a[36:39], v[164:167], a[228:231], a[36:39]
    v_mfma_f32_16x16x32_bf16 a[36:39], v[180:183], a[244:247], a[36:39]
    buffer_store_dwordx4 v[220:223], v0, s[24:27], s80 offen offset:0 sc1
    s_add_u32 s80, s80, 0x1ff000
    v_mfma_f32_16x16x32_bf16 a[32:35], v[180:183], a[240:243], a[32:35]
    v_cmp_lt_f32_e64 vcc, s72, v192
    v_mfma_f32_16x16x32_bf16 a[32:35], v[164:167], a[224:227], a[32:35]
    s_cbranch_vccnz L_rare_r6_2
L_join_r6_2:
    v_mfma_f32_16x16x32_bf16 v[64:67], a[192:195], a[128:131], v[128:131]
    v_exp_f32 v244, v96
    v_mfma_f32_16x16x32_bf16 v[64:67], a[196:199], a[132:135], v[64:67]
    ds_read_b128 a[224:227], v14 offset:40960
    v_add_u32 v2, s75, v2
    v_mfma_f32_16x16x32_bf16 v[64:67], a[200:203], a[136:139], v[64:67]
    v_exp_f32 v245, v97
    v_mfma_f32_16x16x32_bf16 v[64:67], a[204:207], a[140:143], v[64:67]
    ds_read_b128 a[228:231], v253 offset:40960
    v_perm_b32 v236, v245, v244, s4
    v_mfma_f32_16x16x32_bf16 v[72:75], a[204:207], a[156:159], v[132:135]
    v_exp_f32 v246, v98
    v_mfma_f32_16x16x32_bf16 v[72:75], a[200:203], a[152:155], v[72:75]
    ds_read_b128 a[232:235], v254 offset:40960
    buffer_load_dwordx2 v[6:7], v3, s[24:27], s83 offen sc1
    v_mfma_f32_16x16x32_bf16 v[72:75], a[196:199], a[148:151], v[72:75]
    v_exp_f32 v247, v99
    v_mfma_f32_16x16x32_bf16 v[72:75], a[192:195], a[144:147], v[72:75]
    ds_read_b128 a[236:239], v234 offset:40960
    v_perm_b32 v237, v247, v246, s4
    v_mfma_f32_16x16x32_bf16 v[80:83], a[192:195], a[160:163], v[136:139]
    v_exp_f32 v248, v100
    v_mfma_f32_16x16x32_bf16 v[80:83], a[196:199], a[164:167], v[80:83]
    ds_read_b128 a[240:243], v14 offset:45056
    v_mfma_f32_16x16x32_bf16 v[80:83], a[200:203], a[168:171], v[80:83]
    v_exp_f32 v249, v101
    v_mfma_f32_16x16x32_bf16 v[80:83], a[204:207], a[172:175], v[80:83]
    ds_read_b128 a[244:247], v253 offset:45056
    v_perm_b32 v238, v249, v248, s4
    v_mfma_f32_16x16x32_bf16 v[88:91], a[204:207], a[188:191], v[140:143]
    v_exp_f32 v250, v102
    v_mfma_f32_16x16x32_bf16 v[88:91], a[200:203], a[184:187], v[88:91]
    ds_read_b128 a[248:251], v254 offset:45056
    s_add_u32 m0, s73, 0
    v_mfma_f32_16x16x32_bf16 v[88:91], a[196:199], a[180:183], v[88:91]
    v_exp_f32 v251, v103
    v_mfma_f32_16x16x32_bf16 v[88:91], a[192:195], a[176:179], v[88:91]
    ds_read_b128 a[252:255], v234 offset:45056
    v_perm_b32 v239, v251, v250, s4
    v_mfma_f32_16x16x32_bf16 v[92:95], a[208:211], a[176:179], v[140:143]
    v_exp_f32 v244, v104
    v_mfma_f32_16x16x32_bf16 v[92:95], a[212:215], a[180:183], v[92:95]
    buffer_load_dwordx4 v2, s[24:27], s67 offen offset:0 sc1 lds
    v_mfma_f32_16x16x32_bf16 v[92:95], a[216:219], a[184:187], v[92:95]
    v_exp_f32 v245, v105
    v_mfma_f32_16x16x32_bf16 v[92:95], a[220:223], a[188:191], v[92:95]
    ds_read_b128 a[192:195], v252 offset:8192
    v_perm_b32 v240, v245, v244, s4
    v_mfma_f32_16x16x32_bf16 v[84:87], a[220:223], a[172:175], v[136:139]
    v_exp_f32 v246, v106
    v_mfma_f32_16x16x32_bf16 v[84:87], a[216:219], a[168:171], v[84:87]
    buffer_load_dwordx4 v2, s[24:27], s67 offen offset:1024 sc1 lds
    v_mfma_f32_16x16x32_bf16 v[84:87], a[212:215], a[164:167], v[84:87]
    v_exp_f32 v247, v107
    v_mfma_f32_16x16x32_bf16 v[84:87], a[208:211], a[160:163], v[84:87]
    ds_read_b128 a[196:199], v252 offset:9216
    v_perm_b32 v241, v247, v246, s4
    v_mfma_f32_16x16x32_bf16 v[76:79], a[208:211], a[144:147], v[132:135]
    v_exp_f32 v248, v108
    v_mfma_f32_16x16x32_bf16 v[76:79], a[212:215], a[148:151], v[76:79]
    buffer_load_dwordx4 v2, s[24:27], s67 offen offset:2048 sc1 lds
    v_mfma_f32_16x16x32_bf16 v[76:79], a[216:219], a[152:155], v[76:79]
    v_exp_f32 v249, v109
    v_mfma_f32_16x16x32_bf16 v[76:79], a[220:223], a[156:159], v[76:79]
    ds_read_b128 a[200:203], v252 offset:10240
    v_perm_b32 v242, v249, v248, s4
    v_mfma_f32_16x16x32_bf16 v[68:71], a[220:223], a[140:143], v[128:131]
    v_exp_f32 v250, v110
    v_mfma_f32_16x16x32_bf16 v[68:71], a[216:219], a[136:139], v[68:71]
    buffer_load_dwordx4 v2, s[24:27], s67 offen offset:3072 sc1 lds
    s_waitcnt lgkmcnt(3)
    v_mfma_f32_16x16x32_bf16 v[68:71], a[212:215], a[132:135], v[68:71]
    v_exp_f32 v251, v111
    v_mfma_f32_16x16x32_bf16 v[68:71], a[208:211], a[128:131], v[68:71]
    ds_read_b128 a[204:207], v252 offset:11264
    v_perm_b32 v243, v251, v250, s4
    v_mfma_f32_16x16x32_bf16 a[80:83], v[184:187], a[224:227], a[80:83]
    v_exp_f32 v244, v112
    v_mfma_f32_16x16x32_bf16 a[80:83], v[168:171], a[240:243], a[80:83]
    ds_read_b128 a[208:211], v252 offset:12288
    v_mfma_f32_16x16x32_bf16 a[84:87], v[168:171], a[244:247], a[84:87]
    v_exp_f32 v245, v113
    v_mfma_f32_16x16x32_bf16 a[84:87], v[184:187], a[228:231], a[84:87]
    ds_read_b128 a[212:215], v252 offset:13312
    ds_read_b128 a[216:219], v252 offset:14336
    v_mfma_f32_16x16x32_bf16 a[88:91], v[184:187], a[232:235], a[88:91]
    v_exp_f32 v246, v114
    v_mfma_f32_16x16x32_bf16 a[88:91], v[168:171], a[248:251], a[88:91]
    v_exp_f32 v247, v115
    v_mfma_f32_16x16x32_bf16 a[92:95], v[168:171], a[252:255], a[92:95]
    ds_read_b128 a[220:223], v252 offset:15360
    v_mov_b64 v[196:197], v[192:193]
    v_mfma_f32_16x16x32_bf16 a[92:95], v[184:187], a[236:239], a[92:95]
    v_exp_f32 v248, v116
    v_mfma_f32_16x16x32_bf16 a[124:127], v[188:191], a[236:239], a[124:127]
    v_exp_f32 v249, v117
    v_mfma_f32_16x16x32_bf16 a[124:127], v[172:175], a[252:255], a[124:127]
    v_perm_b32 v185, v247, v246, s4
    v_perm_b32 v184, v245, v244, s4
    v_mfma_f32_16x16x32_bf16 a[120:123], v[172:175], a[248:251], a[120:123]
    v_exp_f32 v250, v118
    v_mfma_f32_16x16x32_bf16 a[120:123], v[188:191], a[232:235], a[120:123]
    v_exp_f32 v251, v119
    v_mfma_f32_16x16x32_bf16 a[116:119], v[188:191], a[228:231], a[116:119]
    v_perm_b32 v187, v251, v250, s4
    v_perm_b32 v186, v249, v248, s4
    v_mfma_f32_16x16x32_bf16 a[116:119], v[172:175], a[244:247], a[116:119]
    v_exp_f32 v244, v120
    v_mfma_f32_16x16x32_bf16 a[112:115], v[172:175], a[240:243], a[112:115]
    v_exp_f32 v245, v121
    v_mfma_f32_16x16x32_bf16 a[112:115], v[188:191], a[224:227], a[112:115]
    v_mov_b64 v[198:199], v[194:195]
    v_mfma_f32_16x16x32_bf16 a[16:19], v[176:179], a[224:227], a[16:19]
    v_exp_f32 v246, v122
    v_mfma_f32_16x16x32_bf16 a[16:19], v[152:155], a[240:243], a[16:19]
    v_exp_f32 v247, v123
    v_mfma_f32_16x16x32_bf16 a[20:23], v[152:155], a[244:247], a[20:23]
    v_perm_b32 v189, v247, v246, s4
    v_perm_b32 v188, v245, v244, s4
    v_mfma_f32_16x16x32_bf16 a[20:23], v[176:179], a[228:231], a[20:23]
    v_exp_f32 v248, v124
    v_mfma_f32_16x16x32_bf16 a[24:27], v[176:179], a[232:235], a[24:27]
    v_exp_f32 v249, v125
    v_mfma_f32_16x16x32_bf16 a[24:27], v[152:155], a[248:251], a[24:27]
    v_perm_b32 v190, v249, v248, s4
    v_mfma_f32_16x16x32_bf16 a[28:31], v[152:155], a[252:255], a[28:31]
    v_exp_f32 v250, v126
    v_mfma_f32_16x16x32_bf16 a[28:31], v[176:179], a[236:239], a[28:31]
    v_exp_f32 v251, v127
    v_mfma_f32_16x16x32_bf16 a[60:63], v[180:183], a[236:239], a[60:63]
    v_perm_b32 v191, v251, v250, s4
    v_mfma_f32_16x16x32_bf16 a[60:63], v[156:159], a[252:255], a[60:63]
    v_smfmac_f32_16x16x64_bf16 v[196:199], v[144:147], v[236:243], v255
    v_smfmac_f32_16x16x64_bf16 v[196:199], v[148:151], v[184:191], v255
    v_mfma_f32_16x16x32_bf16 a[56:59], v[156:159], a[248:251], a[56:59]
    s_waitcnt vmcnt(5) lgkmcnt(0)
    s_barrier
    v_mfma_f32_16x16x32_bf16 a[56:59], v[180:183], a[232:235], a[56:59]
    v_mfma_f32_16x16x32_bf16 a[52:55], v[180:183], a[228:231], a[52:55]
L_stop7:
    s_cbranch_execz L_tour_end
    v_mfma_f32_16x16x32_bf16 a[52:55], v[156:159], a[244:247], a[52:55]
    v_mfma_f32_16x16x32_bf16 a[48:51], v[156:159], a[240:243], a[48:51]
    s_nop 0
    v_cmp_lt_f32 vcc, s72, v196
    v_mfma_f32_16x16x32_bf16 a[48:51], v[180:183], a[224:227], a[48:51]
    s_cbranch_vccnz L_rare_r6_3
L_join_r6_3:
    v_mfma_f32_16x16x32_bf16 v[96:99], a[192:195], a[128:131], v[128:131]
    v_exp_f32 v244, v64
    v_mfma_f32_16x16x32_bf16 v[96:99], a[196:199], a[132:135], v[96:99]
    ds_read_b128 a[224:227], v14 offset:49152
    s_waitcnt vmcnt(4)
    v_mfma_f32_16x16x32_bf16 v[96:99], a[200:203], a[136:139], v[96:99]
    v_exp_f32 v245, v65
    v_mfma_f32_16x16x32_bf16 v[96:99], a[204:207], a[140:143], v[96:99]
    ds_read_b128 a[228:231], v253 offset:49152
    v_perm_b32 v160, v245, v244, s4
    v_mfma_f32_16x16x32_bf16 v[104:107], a[204:207], a[156:159], v[132:135]
    v_exp_f32 v246, v66
    v_mfma_f32_16x16x32_bf16 v[104:107], a[200:203], a[152:155], v[104:107]
    ds_read_b128 a[232:235], v254 offset:49152
    v_cmp_ne_u64 vcc, v[6:7], v[4:5]
    v_mfma_f32_16x16x32_bf16 v[104:107], a[196:199], a[148:151], v[104:107]
    v_exp_f32 v247, v67
    v_mfma_f32_16x16x32_bf16 v[104:107], a[192:195], a[144:147], v[104:107]
    ds_read_b128 a[236:239], v234 offset:49152
    v_perm_b32 v161, v247, v246, s4
    v_mfma_f32_16x16x32_bf16 v[112:115], a[192:195], a[160:163], v[136:139]
    v_exp_f32 v248, v68
    v_mfma_f32_16x16x32_bf16 v[112:115], a[196:199], a[164:167], v[112:115]
    ds_read_b128 a[240:243], v14 offset:53248
    s_cbranch_vccnz L_spin_r6k
L_spinret_r6k:
    v_mfma_f32_16x16x32_bf16 v[112:115], a[200:203], a[168:171], v[112:115]
    v_exp_f32 v249, v69
    v_mfma_f32_16x16x32_bf16 v[112:115], a[204:207], a[172:175], v[112:115]
    ds_read_b128 a[244:247], v253 offset:53248
    v_perm_b32 v162, v249, v248, s4
    v_mfma_f32_16x16x32_bf16 v[120:123], a[204:207], a[188:191], v[140:143]
    v_exp_f32 v250, v70
    v_mfma_f32_16x16x32_bf16 v[120:123], a[200:203], a[184:187], v[120:123]
    ds_read_b128 a[248:251], v254 offset:53248
    s_add_u32 m0, s73, 8192
    v_mfma_f32_16x16x32_bf16 v[120:123], a[196:199], a[180:183], v[120:123]
    v_exp_f32 v251, v71
    v_mfma_f32_16x16x32_bf16 v[120:123], a[192:195], a[176:179], v[120:123]
    ds_read_b128 a[252:255], v234 offset:53248
    v_perm_b32 v163, v251, v250, s4
    v_mfma_f32_16x16x32_bf16 v[124:127], a[208:211], a[176:179], v[140:143]
    v_exp_f32 v244, v72
    v_mfma_f32_16x16x32_bf16 v[124:127], a[212:215], a[180:183], v[124:127]
    buffer_load_dwordx4 v2, s[24:27], s68 offen offset:0 sc1 lds
    v_mfma_f32_16x16x32_bf16 v[124:127], a[216:219], a[184:187], v[124:127]
    v_exp_f32 v245, v73
    v_mfma_f32_16x16x32_bf16 v[124:127], a[220:223], a[188:191], v[124:127]
    ds_read_b128 a[192:195], v252 offset:16384
    v_perm_b32 v164, v245, v244, s4
    v_mfma_f32_16x16x32_bf16 v[116:119], a[220:223], a[172:175], v[136:139]
    v_exp_f32 v246, v74
    v_mfma_f32_16x16x32_bf16 v[116:119], a[216:219], a[168:171], v[116:119]
    buffer_load_dwordx4 v2, s[24:27], s68 offen offset:1024 sc1 lds
    v_mfma_f32_16x16x32_bf16 v[116:119], a[212:215], a[164:167], v[116:119]
    v_exp_f32 v247, v75
    v_mfma_f32_16x16x32_bf16 v[116:119], a[208:211], a[160:163], v[116:119]
    ds_read_b128 a[196:199], v252 offset:17408
    v_perm_b32 v165, v247, v246, s4
    v_mfma_f32_16x16x32_bf16 v[108:111], a[208:211], a[144:147], v[132:135]
    v_exp_f32 v248, v76
    v_mfma_f32_16x16x32_bf16 v[108:111], a[212:215], a[148:151], v[108:111]
    buffer_load_dwordx4 v2, s[24:27], s68 offen offset:2048 sc1 lds
    v_mfma_f32_16x16x32_bf16 v[108:111], a[216:219], a[152:155], v[108:111]
    v_exp_f32 v249, v77
    v_mfma_f32_16x16x32_bf16 v[108:111], a[220:223], a[156:159], v[108:111]
    ds_read_b128 a[200:203], v252 offset:18432
    v_perm_b32 v166, v249, v248, s4
    v_mfma_f32_16x16x32_bf16 v[100:103], a[220:223], a[140:143], v[128:131]
    v_exp_f32 v250, v78
    v_mfma_f32_16x16x32_bf16 v[100:103], a[216:219], a[136:139], v[100:103]
    buffer_load_dwordx4 v2, s[24:27], s68 offen offset:3072 sc1 lds
    s_waitcnt lgkmcnt(3)
    v_mfma_f32_16x16x32_bf16 v[100:103], a[212:215], a[132:135], v[100:103]
    v_exp_f32 v251, v79
    v_mfma_f32_16x16x32_bf16 v[100:103], a[208:211], a[128:131], v[100:103]
    ds_read_b128 a[204:207], v252 offset:19456
    v_perm_b32 v167, v251, v250, s4
    v_mfma_f32_16x16x32_bf16 a[64:67], v[168:171], a[224:227], a[64:67]
    v_exp_f32 v244, v80
    v_mfma_f32_16x16x32_bf16 a[64:67], v[184:187], a[240:243], a[64:67]
    ds_read_b128 a[208:211], v252 offset:20480
    buffer_store_dwordx2 v[4:5], v13, s[24:27], s82 offen sc1
    v_mfma_f32_16x16x32_bf16 a[68:71], v[184:187], a[244:247], a[68:71]
    v_exp_f32 v245, v81
    v_mfma_f32_16x16x32_bf16 a[68:71], v[168:171], a[228:231], a[68:71]
    ds_read_b128 a[212:215], v252 offset:21504
    ds_read_b128 a[216:219], v252 offset:22528
    v_mfma_f32_16x16x32_bf16 a[72:75], v[168:171], a[232:235], a[72:75]
    v_exp_f32 v246, v82
    v_mfma_f32_16x16x32_bf16 a[72:75], v[184:187], a[248:251], a[72:75]
    v_exp_f32 v247, v83
    v_mfma_f32_16x16x32_bf16 a[76:79], v[184:187], a[252:255], a[76:79]
    ds_read_b128 a[220:223], v252 offset:23552
    v_mov_b64 v[192:193], v[196:197]
    v_mfma_f32_16x16x32_bf16 a[76:79], v[168:171], a[236:239], a[76:79]
    v_exp_f32 v248, v84
    v_mfma_f32_16x16x32_bf16 a[108:111], v[172:175], a[236:239], a[108:111]
    v_exp_f32 v249, v85
    v_mfma_f32_16x16x32_bf16 a[108:111], v[188:191], a[252:255], a[108:111]
    v_perm_b32 v169, v247, v246, s4
    v_perm_b32 v168, v245, v244, s4
    v_mfma_f32_16x16x32_bf16 a[104:107], v[188:191], a[248:251], a[104:107]
    v_exp_f32 v250, v86
    v_mfma_f32_16x16x32_bf16 a[104:107], v[172:175], a[232:235], a[104:107]
    v_exp_f32 v251, v87
    v_mfma_f32_16x16x32_bf16 a[100:103], v[172:175], a[228:231], a[100:103]
    v_perm_b32 v171, v251, v250, s4
    v_perm_b32 v170, v249, v248, s4
    v_mfma_f32_16x16x32_bf16 a[100:103], v[188:191], a[244:247], a[100:103]
    v_exp_f32 v244, v88
    v_mfma_f32_16x16x32_bf16 a[96:99], v[188:191], a[240:243], a[96:99]
    v_exp_f32 v245, v89
    v_mfma_f32_16x16x32_bf16 a[96:99], v[172:175], a[224:227], a[96:99]
    v_mov_b64 v[194:195], v[198:199]
    s_add_u32 s82, s82, 512
    v_mfma_f32_16x16x32_bf16 a[0:3], v[152:155], a[224:227], a[0:3]
    v_exp_f32 v246, v90
    v_mfma_f32_16x16x32_bf16 a[0:3], v[236:239], a[240:243], a[0:3]
    v_exp_f32 v247, v91
    v_mfma_f32_16x16x32_bf16 a[4:7], v[236:239], a[244:247], a[4:7]
    v_perm_b32 v173, v247, v246, s4
    v_perm_b32 v172, v245, v244, s4
    v_mfma_f32_16x16x32_bf16 a[4:7], v[152:155], a[228:231], a[4:7]
    v_exp_f32 v248, v92
    v_mfma_f32_16x16x32_bf16 a[8:11], v[152:155], a[232:235], a[8:11]
    v_exp_f32 v249, v93
    v_mfma_f32_16x16x32_bf16 a[8:11], v[236:239], a[248:251], a[8:11]
    v_perm_b32 v174, v249, v248, s4
    s_add_u32 s83, s83, 512
    v_mfma_f32_16x16x32_bf16 a[12:15], v[236:239], a[252:255], a[12:15]
    v_exp_f32 v250, v94
    v_mfma_f32_16x16x32_bf16 a[12:15], v[152:155], a[236:239], a[12:15]
    v_exp_f32 v251, v95
    v_mfma_f32_16x16x32_bf16 a[44:47], v[156:159], a[236:239], a[44:47]
    v_perm_b32 v175, v251, v250, s4
    v_mfma_f32_16x16x32_bf16 a[44:47], v[240:243], a[252:255], a[44:47]
    v_smfmac_f32_16x16x64_bf16 v[192:195], v[144:147], v[160:167], v255
    v_smfmac_f32_16x16x64_bf16 v[192:195], v[148:151], v[168:175], v255
    v_mfma_f32_16x16x32_bf16 a[40:43], v[240:243], a[248:251], a[40:43]
    s_waitcnt vmcnt(12) lgkmcnt(0)
    s_barrier
    v_mfma_f32_16x16x32_bf16 a[40:43], v[156:159], a[232:235], a[40:43]
    v_mfma_f32_16x16x32_bf16 a[36:39], v[156:159], a[228:231], a[36:39]
    v_mfma_f32_16x16x32_bf16 a[36:39], v[240:243], a[244:247], a[36:39]
    v_mfma_f32_16x16x32_bf16 a[32:35], v[240:243], a[240:243], a[32:35]
    s_nop 0
    v_cmp_lt_f32 vcc, s72, v192
    v_mfma_f32_16x16x32_bf16 a[32:35], v[156:159], a[224:227], a[32:35]
    s_cbranch_vccnz L_rare_r6_4
L_join_r6_4:
    v_mfma_f32_16x16x32_bf16 v[64:67], a[192:195], a[128:131], v[128:131]
    v_exp_f32 v244, v96
    v_mfma_f32_16x16x32_bf16 v[64:67], a[196:199], a[132:135], v[64:67]
    ds_read_b128 a[224:227], v14 offset:57344
    v_mfma_f32_16x16x32_bf16 v[64:67], a[200:203], a[136:139], v[64:67]
    v_exp_f32 v245, v97
    v_mfma_f32_16x16x32_bf16 v[64:67], a[204:207], a[140:143], v[64:67]
    ds_read_b128 a[228:231], v253 offset:57344
    v_perm_b32 v176, v245, v244, s4
    v_mfma_f32_16x16x32_bf16 v[72:75], a[204:207], a[156:159], v[132:135]
    v_exp_f32 v246, v98
    v_mfma_f32_16x16x32_bf16 v[72:75], a[200:203], a[152:155], v[72:75]
    ds_read_b128 a[232:235], v254 offset:57344
    v_mfma_f32_16x16x32_bf16 v[72:75], a[196:199], a[148:151], v[72:75]
    v_exp_f32 v247, v99
    v_mfma_f32_16x16x32_bf16 v[72:75], a[192:195], a[144:147], v[72:75]
    ds_read_b128 a[236:239], v234 offset:57344
    v_perm_b32 v177, v247, v246, s4
    v_mfma_f32_16x16x32_bf16 v[80:83], a[192:195], a[160:163], v[136:139]
    v_exp_f32 v248, v100
    v_mfma_f32_16x16x32_bf16 v[80:83], a[196:199], a[164:167], v[80:83]
    ds_read_b128 a[240:243], v14 offset:61440
    v_mfma_f32_16x16x32_bf16 v[80:83], a[200:203], a[168:171], v[80:83]
    v_exp_f32 v249, v101
    v_mfma_f32_16x16x32_bf16 v[80:83], a[204:207], a[172:175], v[80:83]
    ds_read_b128 a[244:247], v253 offset:61440
    v_perm_b32 v178, v249, v248, s4
    v_mfma_f32_16x16x32_bf16 v[88:91], a[204:207], a[188:191], v[140:143]
    v_exp_f32 v250, v102
    v_mfma_f32_16x16x32_bf16 v[88:91], a[200:203], a[184:187], v[88:91]
    ds_read_b128 a[248:251], v254 offset:61440
    s_add_u32 m0, s73, 16384
    v_mfma_f32_16x16x32_bf16 v[88:91], a[196:199], a[180:183], v[88:91]
    v_exp_f32 v251, v103
    v_mfma_f32_16x16x32_bf16 v[88:91], a[192:195], a[176:179], v[88:91]
    ds_read_b128 a[252:255], v234 offset:61440
    v_perm_b32 v179, v251, v250, s4
    v_mfma_f32_16x16x32_bf16 v[92:95], a[208:211], a[176:179], v[140:143]
    v_exp_f32 v244, v104
    v_mfma_f32_16x16x32_bf16 v[92:95], a[212:215], a[180:183], v[92:95]
    buffer_load_dwordx4 v2, s[24:27], s69 offen offset:0 sc1 lds
    v_mfma_f32_16x16x32_bf16 v[92:95], a[216:219], a[184:187], v[92:95]
    v_exp_f32 v245, v105
    v_mfma_f32_16x16x32_bf16 v[92:95], a[220:223], a[188:191], v[92:95]
    ds_read_b128 a[192:195], v252 offset:24576
    v_perm_b32 v180, v245, v244, s4
    v_mfma_f32_16x16x32_bf16 v[84:87], a[220:223], a[172:175], v[136:139]
    v_exp_f32 v246, v106
    v_mfma_f32_16x16x32_bf16 v[84:87], a[216:219], a[168:171], v[84:87]
    buffer_load_dwordx4 v2, s[24:27], s69 offen offset:1024 sc1 lds
    v_mfma_f32_16x16x32_bf16 v[84:87], a[212:215], a[164:167], v[84:87]
    v_exp_f32 v247, v107
    v_mfma_f32_16x16x32_bf16 v[84:87], a[208:211], a[160:163], v[84:87]
    ds_read_b128 a[196:199], v252 offset:25600
    v_perm_b32 v181, v247, v246, s4
    v_mfma_f32_16x16x32_bf16 v[76:79], a[208:211], a[144:147], v[132:135]
    v_exp_f32 v248, v108
    v_mfma_f32_16x16x32_bf16 v[76:79], a[212:215], a[148:151], v[76:79]
    buffer_load_dwordx4 v2, s[24:27], s69 offen offset:2048 sc1 lds
    v_mfma_f32_16x16x32_bf16 v[76:79], a[216:219], a[152:155], v[76:79]
    v_exp_f32 v249, v109
    v_mfma_f32_16x16x32_bf16 v[76:79], a[220:223], a[156:159], v[76:79]
    ds_read_b128 a[200:203], v252 offset:26624
    v_perm_b32 v182, v249, v248, s4
    v_mfma_f32_16x16x32_bf16 v[68:71], a[220:223], a[140:143], v[128:131]
    v_exp_f32 v250, v110
    v_mfma_f32_16x16x32_bf16 v[68:71], a[216:219], a[136:139], v[68:71]
    buffer_load_dwordx4 v2, s[24:27], s69 offen offset:3072 sc1 lds
    s_waitcnt lgkmcnt(3)
    v_mfma_f32_16x16x32_bf16 v[68:71], a[212:215], a[132:135], v[68:71]
    v_exp_f32 v251, v111
    v_mfma_f32_16x16x32_bf16 v[68:71], a[208:211], a[128:131], v[68:71]
    ds_read_b128 a[204:207], v252 offset:27648
    v_perm_b32 v183, v251, v250, s4
    v_mfma_f32_16x16x32_bf16 a[80:83], v[184:187], a[224:227], a[80:83]
    v_exp_f32 v244, v112
    v_mfma_f32_16x16x32_bf16 a[80:83], v[168:171], a[240:243], a[80:83]
    ds_read_b128 a[208:211], v252 offset:28672
    v_mfma_f32_16x16x32_bf16 a[84:87], v[168:171], a[244:247], a[84:87]
    v_exp_f32 v245, v113
    v_mfma_f32_16x16x32_bf16 a[84:87], v[184:187], a[228:231], a[84:87]
    ds_read_b128 a[212:215], v252 offset:29696
    ds_read_b128 a[216:219], v252 offset:30720
    v_mfma_f32_16x16x32_bf16 a[88:91], v[184:187], a[232:235], a[88:91]
    v_exp_f32 v246, v114
    v_mfma_f32_16x16x32_bf16 a[88:91], v[168:171], a[248:251], a[88:91]
    v_exp_f32 v247, v115
    v_mfma_f32_16x16x32_bf16 a[92:95], v[168:171], a[252:255], a[92:95]
    ds_read_b128 a[220:223], v252 offset:31744
    v_mov_b64 v[196:197], v[192:193]
    v_mfma_f32_16x16x32_bf16 a[92:95], v[184:187], a[236:239], a[92:95]
    v_exp_f32 v248, v116
    v_mfma_f32_16x16x32_bf16 a[124:127], v[188:191], a[236:239], a[124:127]
    v_exp_f32 v249, v117
    v_mfma_f32_16x16x32_bf16 a[124:127], v[172:175], a[252:255], a[124:127]
    v_perm_b32 v185, v247, v246, s4
    v_perm_b32 v184, v245, v244, s4
    v_mfma_f32_16x16x32_bf16 a[120:123], v[172:175], a[248:251], a[120:123]
    v_exp_f32 v250, v118
    v_mfma_f32_16x16x32_bf16 a[120:123], v[188:191], a[232:235], a[120:123]
    v_exp_f32 v251, v119
    v_mfma_f32_16x16x32_bf16 a[116:119], v[188:191], a[228:231], a[116:119]
    v_perm_b32 v187, v251, v250, s4
    v_perm_b32 v186, v249, v248, s4
    v_mfma_f32_16x16x32_bf16 a[116:119], v[172:175], a[244:247], a[116:119]
    v_exp_f32 v244, v120
    v_mfma_f32_16x16x32_bf16 a[112:115], v[172:175], a[240:243], a[112:115]
    v_exp_f32 v245, v121
    v_mfma_f32_16x16x32_bf16 a[112:115], v[188:191], a[224:227], a[112:115]
    v_mov_b64 v[198:199], v[194:195]
    v_mfma_f32_16x16x32_bf16 a[16:19], v[236:239], a[224:227], a[16:19]
    v_exp_f32 v246, v122
    v_mfma_f32_16x16x32_bf16 a[16:19], v[160:163], a[240:243], a[16:19]
    v_exp_f32 v247, v123
    v_mfma_f32_16x16x32_bf16 a[20:23], v[160:163], a[244:247], a[20:23]
    v_perm_b32 v189, v247, v246, s4
    v_perm_b32 v188, v245, v244, s4
    v_mfma_f32_16x16x32_bf16 a[20:23], v[236:239], a[228:231], a[20:23]
    v_exp_f32 v248, v124
    v_mfma_f32_16x16x32_bf16 a[24:27], v[236:239], a[232:235], a[24:27]
    v_exp_f32 v249, v125
    v_mfma_f32_16x16x32_bf16 a[24:27], v[160:163], a[248:251], a[24:27]
    v_perm_b32 v190, v249, v248, s4
    v_mfma_f32_16x16x32_bf16 a[28:31], v[160:163], a[252:255], a[28:31]
    v_exp_f32 v250, v126
    v_mfma_f32_16x16x32_bf16 a[28:31], v[236:239], a[236:239], a[28:31]
    v_exp_f32_e64 v251, v127
    v_mfma_f32_16x16x32_bf16 a[60:63], v[240:243], a[236:239], a[60:63]
    v_perm_b32 v191, v251, v250, s4
    v_mfma_f32_16x16x32_bf16 a[60:63], v[164:167], a[252:255], a[60:63]
    v_smfmac_f32_16x16x64_bf16 v[196:199], v[144:147], v[176:183], v255
    v_smfmac_f32_16x16x64_bf16 v[196:199], v[148:151], v[184:191], v255
    v_mfma_f32_16x16x32_bf16 a[56:59], v[164:167], a[248:251], a[56:59]
    s_waitcnt vmcnt(9) lgkmcnt(0)
    s_barrier
    v_mfma_f32_16x16x32_bf16 a[56:59], v[240:243], a[232:235], a[56:59]
    v_mfma_f32_16x16x32_bf16 a[52:55], v[240:243], a[228:231], a[52:55]
    v_mfma_f32_16x16x32_bf16 a[52:55], v[164:167], a[244:247], a[52:55]
    v_mfma_f32_16x16x32_bf16 a[48:51], v[164:167], a[240:243], a[48:51]
    s_nop 0
    v_cmp_lt_f32_e64 vcc, s72, v196
    v_mfma_f32_16x16x32_bf16 a[48:51], v[240:243], a[224:227], a[48:51]
    s_cbranch_vccnz L_rare_r6_5
L_join_r6_5:
    v_mfma_f32_16x16x32_bf16 v[96:99], a[192:195], a[128:131], v[128:131]
    v_exp_f32 v244, v64
    v_mfma_f32_16x16x32_bf16 v[96:99], a[196:199], a[132:135], v[96:99]
    ds_read_b128 a[224:227], v14 offset:32768
    v_add_u32 v2, s76, v2
    v_mfma_f32_16x16x32_bf16 v[96:99], a[200:203], a[136:139], v[96:99]
    v_exp_f32 v245, v65
    v_mfma_f32_16x16x32_bf16 v[96:99], a[204:207], a[140:143], v[96:99]
    ds_read_b128 a[228:231], v253 offset:32768
    v_perm_b32 v152, v245, v244, s4
    v_mfma_f32_16x16x32_bf16 v[104:107], a[204:207], a[156:159], v[132:135]
    v_exp_f32 v246, v66
    v_mfma_f32_16x16x32_bf16 v[104:107], a[200:203], a[152:155], v[104:107]
    ds_read_b128 a[232:235], v254 offset:32768
    buffer_load_dwordx2 v[6:7], v3, s[24:27], s84 offen sc1
    v_mfma_f32_16x16x32_bf16 v[104:107], a[196:199], a[148:151], v[104:107]
    v_exp_f32 v247, v67
    v_mfma_f32_16x16x32_bf16 v[104:107], a[192:195], a[144:147], v[104:107]
    ds_read_b128 a[236:239], v234 offset:32768
    v_perm_b32 v153, v247, v246, s4
    v_mfma_f32_16x16x32_bf16 v[112:115], a[192:195], a[160:163], v[136:139]
    v_exp_f32 v248, v68
    v_mfma_f32_16x16x32_bf16 v[112:115], a[196:199], a[164:167], v[112:115]
    ds_read_b128 a[240:243], v14 offset:36864
    v_mfma_f32_16x16x32_bf16 v[112:115], a[200:203], a[168:171], v[112:115]
    v_exp_f32 v249, v69
    v_mfma_f32_16x16x32_bf16 v[112:115], a[204:207], a[172:175], v[112:115]
    ds_read_b128 a[244:247], v253 offset:36864
    v_perm_b32 v154, v249, v248, s4
    v_mfma_f32_16x16x32_bf16 v[120:123], a[204:207], a[188:191], v[140:143]
    v_exp_f32 v250, v70
    v_mfma_f32_16x16x32_bf16 v[120:123], a[200:203], a[184:187], v[120:123]
    ds_read_b128 a[248:251], v254 offset:36864
    s_add_u32 m0, s73, 24576
    v_mfma_f32_16x16x32_bf16 v[120:123], a[196:199], a[180:183], v[120:123]
    v_exp_f32 v251, v71
    v_mfma_f32_16x16x32_bf16 v[120:123], a[192:195], a[176:179], v[120:123]
    ds_read_b128 a[252:255], v234 offset:36864
    v_perm_b32 v155, v251, v250, s4
    v_mfma_f32_16x16x32_bf16 v[124:127], a[208:211], a[176:179], v[140:143]
    v_exp_f32 v244, v72
    v_mfma_f32_16x16x32_bf16 v[124:127], a[212:215], a[180:183], v[124:127]
    buffer_load_dwordx4 v2, s[24:27], s70 offen offset:0 sc1 lds
    v_mfma_f32_16x16x32_bf16 v[124:127], a[216:219], a[184:187], v[124:127]
    v_exp_f32 v245, v73
    v_mfma_f32_16x16x32_bf16 v[124:127], a[220:223], a[188:191], v[124:127]
    ds_read_b128 a[192:195], v252 offset:0
    v_perm_b32 v156, v245, v244, s4
    v_mfma_f32_16x16x32_bf16 v[116:119], a[220:223], a[172:175], v[136:139]
    v_exp_f32 v246, v74
    v_mfma_f32_16x16x32_bf16 v[116:119], a[216:219], a[168:171], v[116:119]
    buffer_load_dwordx4 v2, s[24:27], s70 offen offset:1024 sc1 lds
    v_mfma_f32_16x16x32_bf16 v[116:119], a[212:215], a[164:167], v[116:119]
    v_exp_f32 v247, v75
    v_mfma_f32_16x16x32_bf16 v[116:119], a[208:211], a[160:163], v[116:119]
    ds_read_b128 a[196:199], v252 offset:1024
    v_perm_b32 v157, v247, v246, s4
    v_mfma_f32_16x16x32_bf16 v[108:111], a[208:211], a[144:147], v[132:135]
    v_exp_f32 v248, v76
    v_mfma_f32_16x16x32_bf16 v[108:111], a[212:215], a[148:151], v[108:111]
    buffer_load_dwordx4 v2, s[24:27], s70 offen offset:2048 sc1 lds
    v_mfma_f32_16x16x32_bf16 v[108:111], a[216:219], a[152:155], v[108:111]
    v_exp_f32 v249, v77
    v_mfma_f32_16x16x32_bf16 v[108:111], a[220:223], a[156:159], v[108:111]
    ds_read_b128 a[200:203], v252 offset:2048
    v_perm_b32 v158, v249, v248, s4
    v_mfma_f32_16x16x32_bf16 v[100:103], a[220:223], a[140:143], v[128:131]
    v_exp_f32 v250, v78
    v_mfma_f32_16x16x32_bf16 v[100:103], a[216:219], a[136:139], v[100:103]
    buffer_load_dwordx4 v2, s[24:27], s70 offen offset:3072 sc1 lds
    s_waitcnt lgkmcnt(3)
    v_mfma_f32_16x16x32_bf16 v[100:103], a[212:215], a[132:135], v[100:103]
    v_exp_f32 v251, v79
    v_mfma_f32_16x16x32_bf16 v[100:103], a[208:211], a[128:131], v[100:103]
    ds_read_b128 a[204:207], v252 offset:3072
    v_perm_b32 v159, v251, v250, s4
    v_mfma_f32_16x16x32_bf16 a[64:67], v[168:171], a[224:227], a[64:67]
    v_exp_f32 v244, v80
    v_mfma_f32_16x16x32_bf16 a[64:67], v[184:187], a[240:243], a[64:67]
    ds_read_b128 a[208:211], v252 offset:4096
    v_mfma_f32_16x16x32_bf16 a[68:71], v[184:187], a[244:247], a[68:71]
    v_exp_f32 v245, v81
    v_mfma_f32_16x16x32_bf16 a[68:71], v[168:171], a[228:231], a[68:71]
    ds_read_b128 a[212:215], v252 offset:5120
    ds_read_b128 a[216:219], v252 offset:6144
    v_mfma_f32_16x16x32_bf16 a[72:75], v[168:171], a[232:235], a[72:75]
    v_exp_f32 v246, v82
    v_mfma_f32_16x16x32_bf16 a[72:75], v[184:187], a[248:251], a[72:75]
    v_exp_f32 v247, v83
    v_mfma_f32_16x16x32_bf16 a[76:79], v[184:187], a[252:255], a[76:79]
    ds_read_b128 a[220:223], v252 offset:7168
    v_mov_b64 v[192:193], v[196:197]
    v_mfma_f32_16x16x32_bf16 a[76:79], v[168:171], a[236:239], a[76:79]
    v_exp_f32 v248, v84
    v_mfma_f32_16x16x32_bf16 a[108:111], v[172:175], a[236:239], a[108:111]
    v_exp_f32 v249, v85
    v_mfma_f32_16x16x32_bf16 a[108:111], v[188:191], a[252:255], a[108:111]
    v_perm_b32 v169, v247, v246, s4
    v_perm_b32 v168, v245, v244, s4
    v_mfma_f32_16x16x32_bf16 a[104:107], v[188:191], a[248:251], a[104:107]
    v_exp_f32 v250, v86
    v_mfma_f32_16x16x32_bf16 a[104:107], v[172:175], a[232:235], a[104:107]
    v_exp_f32 v251, v87
    v_mfma_f32_16x16x32_bf16 a[100:103], v[172:175], a[228:231], a[100:103]
    v_perm_b32 v171, v251, v250, s4
    v_perm_b32 v170, v249, v248, s4
    v_mfma_f32_16x16x32_bf16 a[100:103], v[188:191], a[244:247], a[100:103]
    v_exp_f32 v244, v88
    v_mfma_f32_16x16x32_bf16 a[96:99], v[188:191], a[240:243], a[96:99]
    v_exp_f32 v245, v89
    v_mfma_f32_16x16x32_bf16 a[96:99], v[172:175], a[224:227], a[96:99]
    v_mov_b64 v[194:195], v[198:199]
    v_mfma_f32_16x16x32_bf16 a[0:3], v[160:163], a[224:227], a[0:3]
    v_exp_f32 v246, v90
    v_mfma_f32_16x16x32_bf16 a[0:3], v[176:179], a[240:243], a[0:3]
    v_exp_f32 v247, v91
    v_mfma_f32_16x16x32_bf16 a[4:7], v[176:179], a[244:247], a[4:7]
    v_perm_b32 v173, v247, v246, s4
    v_perm_b32 v172, v245, v244, s4
    v_mfma_f32_16x16x32_bf16 a[4:7], v[160:163], a[228:231], a[4:7]
    v_exp_f32 v248, v92
    v_mfma_f32_16x16x32_bf16 a[8:11], v[160:163], a[232:235], a[8:11]
    v_exp_f32 v249, v93
    v_mfma_f32_16x16x32_bf16 a[8:11], v[176:179], a[248:251], a[8:11]
    v_perm_b32 v174, v249, v248, s4
    v_mfma_f32_16x16x32_bf16 a[12:15], v[176:179], a[252:255], a[12:15]
    v_exp_f32 v250, v94
    v_mfma_f32_16x16x32_bf16 a[12:15], v[160:163], a[236:239], a[12:15]
    v_exp_f32 v251, v95
    v_mfma_f32_16x16x32_bf16 a[44:47], v[164:167], a[236:239], a[44:47]
    v_perm_b32 v175, v251, v250, s4
    v_mfma_f32_16x16x32_bf16 a[44:47], v[180:183], a[252:255], a[44:47]
    v_smfmac_f32_16x16x64_bf16 v[192:195], v[144:147], v[152:159], v255
    v_smfmac_f32_16x16x64_bf16 v[192:195], v[148:151], v[168:175], v255
    v_mfma_f32_16x16x32_bf16 a[40:43], v[180:183], a[248:251], a[40:43]
    s_waitcnt vmcnt(10) lgkmcnt(0)
    s_barrier
    v_mfma_f32_16x16x32_bf16 a[40:43], v[164:167], a[232:235], a[40:43]
    v_mfma_f32_16x16x32_bf16 a[36:39], v[164:167], a[228:231], a[36:39]
    v_mfma_f32_16x16x32_bf16 a[36:39], v[180:183], a[244:247], a[36:39]
    v_mfma_f32_16x16x32_bf16 a[32:35], v[180:183], a[240:243], a[32:35]
    s_nop 0
    v_cmp_lt_f32 vcc, s72, v192
    v_mfma_f32_16x16x32_bf16 a[32:35], v[164:167], a[224:227], a[32:35]
    s_cbranch_vccnz L_rare_r6_6
L_join_r6_6:
    v_mfma_f32_16x16x32_bf16 v[64:67], a[192:195], a[128:131], v[128:131]
    v_exp_f32 v244, v96
    v_mfma_f32_16x16x32_bf16 v[64:67], a[196:199], a[132:135], v[64:67]
    ds_read_b128 a[224:227], v14 offset:40960
    s_waitcnt vmcnt(4)
    v_mfma_f32_16x16x32_bf16 v[64:67], a[200:203], a[136:139], v[64:67]
    v_exp_f32 v245, v97
    v_mfma_f32_16x16x32_bf16 v[64:67], a[204:207], a[140:143], v[64:67]
    ds_read_b128 a[228:231], v253 offset:40960
    v_perm_b32 v236, v245, v244, s4
    v_mfma_f32_16x16x32_bf16 v[72:75], a[204:207], a[156:159], v[132:135]
    v_exp_f32 v246, v98
    v_mfma_f32_16x16x32_bf16 v[72:75], a[200:203], a[152:155], v[72:75]
    ds_read_b128 a[232:235], v254 offset:40960
    v_cmp_ne_u64 vcc, v[6:7], v[4:5]
    v_mfma_f32_16x16x32_bf16 v[72:75], a[196:199], a[148:151], v[72:75]
    v_exp_f32 v247, v99
    v_mfma_f32_16x16x32_bf16 v[72:75], a[192:195], a[144:147], v[72:75]
    ds_read_b128 a[236:239], v234 offset:40960
    v_perm_b32 v237, v247, v246, s4
    v_mfma_f32_16x16x32_bf16 v[80:83], a[192:195], a[160:163], v[136:139]
    v_exp_f32 v248, v100
    v_mfma_f32_16x16x32_bf16 v[80:83], a[196:199], a[164:167], v[80:83]
    ds_read_b128 a[240:243], v14 offset:45056
    s_cbranch_vccnz L_spin_r6v
L_spinret_r6v:
    v_mfma_f32_16x16x32_bf16 v[80:83], a[200:203], a[168:171], v[80:83]
    v_exp_f32 v249, v101
    v_mfma_f32_16x16x32_bf16 v[80:83], a[204:207], a[172:175], v[80:83]
    ds_read_b128 a[244:247], v253 offset:45056
    v_perm_b32 v238, v249, v248, s4
    v_mfma_f32_16x16x32_bf16 v[88:91], a[204:207], a[188:191], v[140:143]
    v_exp_f32 v250, v102
    v_mfma_f32_16x16x32_bf16 v[88:91], a[200:203], a[184:187], v[88:91]
    ds_read_b128 a[248:251], v254 offset:45056
    s_add_u32 m0, s73, 0
    v_mfma_f32_16x16x32_bf16 v[88:91], a[196:199], a[180:183], v[88:91]
    v_exp_f32 v251, v103
    v_mfma_f32_16x16x32_bf16 v[88:91], a[192:195], a[176:179], v[88:91]
    ds_read_b128 a[252:255], v234 offset:45056
    v_perm_b32 v239, v251, v250, s4
    v_add_u32 v2, s13, v2
    v_mfma_f32_16x16x32_bf16 v[92:95], a[208:211], a[176:179], v[140:143]
    v_exp_f32 v244, v104
    v_mfma_f32_16x16x32_bf16 v[92:95], a[212:215], a[180:183], v[92:95]
    buffer_load_dwordx4 v2, s[24:27], s71 offen offset:0 sc1 lds
    s_add_u32 s84, s84, 512
    v_mfma_f32_16x16x32_bf16 v[92:95], a[216:219], a[184:187], v[92:95]
    v_exp_f32 v245, v105
    v_mfma_f32_16x16x32_bf16 v[92:95], a[220:223], a[188:191], v[92:95]
    ds_read_b128 a[192:195], v252 offset:8192
    v_perm_b32 v240, v245, v244, s4
    v_mfma_f32_16x16x32_bf16 v[84:87], a[220:223], a[172:175], v[136:139]
    v_exp_f32 v246, v106
    v_mfma_f32_16x16x32_bf16 v[84:87], a[216:219], a[168:171], v[84:87]
    buffer_load_dwordx4 v2, s[24:27], s71 offen offset:1024 sc1 lds
    v_mfma_f32_16x16x32_bf16 v[84:87], a[212:215], a[164:167], v[84:87]
    v_exp_f32 v247, v107
    v_mfma_f32_16x16x32_bf16 v[84:87], a[208:211], a[160:163], v[84:87]
    ds_read_b128 a[196:199], v252 offset:9216
    v_perm_b32 v241, v247, v246, s4
    v_mfma_f32_16x16x32_bf16 v[76:79], a[208:211], a[144:147], v[132:135]
    v_exp_f32 v248, v108
    v_mfma_f32_16x16x32_bf16 v[76:79], a[212:215], a[148:151], v[76:79]
    buffer_load_dwordx4 v2, s[24:27], s71 offen offset:2048 sc1 lds
    v_mfma_f32_16x16x32_bf16 v[76:79], a[216:219], a[152:155], v[76:79]
    v_exp_f32 v249, v109
    v_mfma_f32_16x16x32_bf16 v[76:79], a[220:223], a[156:159], v[76:79]
    ds_read_b128 a[200:203], v252 offset:10240
    v_perm_b32 v242, v249, v248, s4
    v_mfma_f32_16x16x32_bf16 v[68:71], a[220:223], a[140:143], v[128:131]
    v_exp_f32 v250, v110
    v_mfma_f32_16x16x32_bf16 v[68:71], a[216:219], a[136:139], v[68:71]
    buffer_load_dwordx4 v2, s[24:27], s71 offen offset:3072 sc1 lds
    s_waitcnt lgkmcnt(3)
    v_mfma_f32_16x16x32_bf16 v[68:71], a[212:215], a[132:135], v[68:71]
    v_exp_f32 v251, v111
    v_mfma_f32_16x16x32_bf16 v[68:71], a[208:211], a[128:131], v[68:71]
    ds_read_b128 a[204:207], v252 offset:11264
    v_perm_b32 v243, v251, v250, s4
    v_mfma_f32_16x16x32_bf16 a[80:83], v[184:187], a[224:227], a[80:83]
    v_exp_f32 v244, v112
    v_mfma_f32_16x16x32_bf16 a[80:83], v[168:171], a[240:243], a[80:83]
    ds_read_b128 a[208:211], v252 offset:12288
    v_mfma_f32_16x16x32_bf16 a[84:87], v[168:171], a[244:247], a[84:87]
    v_exp_f32 v245, v113
    v_mfma_f32_16x16x32_bf16 a[84:87], v[184:187], a[228:231], a[84:87]
    ds_read_b128 a[212:215], v252 offset:13312
    ds_read_b128 a[216:219], v252 offset:14336
    v_mfma_f32_16x16x32_bf16 a[88:91], v[184:187], a[232:235], a[88:91]
    v_exp_f32 v246, v114
    v_mfma_f32_16x16x32_bf16 a[88:91], v[168:171], a[248:251], a[88:91]
    v_exp_f32 v247, v115
    v_mfma_f32_16x16x32_bf16 a[92:95], v[168:171], a[252:255], a[92:95]
    ds_read_b128 a[220:223], v252 offset:15360
    v_mov_b64 v[196:197], v[192:193]
    v_mfma_f32_16x16x32_bf16 a[92:95], v[184:187], a[236:239], a[92:95]
    v_exp_f32 v248, v116
    v_mfma_f32_16x16x32_bf16 a[124:127], v[188:191], a[236:239], a[124:127]
    v_exp_f32 v249, v117
    v_mfma_f32_16x16x32_bf16 a[124:127], v[172:175], a[252:255], a[124:127]
    v_perm_b32 v185, v247, v246, s4
    v_perm_b32 v184, v245, v244, s4
    v_mfma_f32_16x16x32_bf16 a[120:123], v[172:175], a[248:251], a[120:123]
    v_exp_f32 v250, v118
    v_mfma_f32_16x16x32_bf16 a[120:123], v[188:191], a[232:235], a[120:123]
    v_exp_f32 v251, v119
    v_mfma_f32_16x16x32_bf16 a[116:119], v[188:191], a[228:231], a[116:119]
    v_perm_b32 v187, v251, v250, s4
    v_perm_b32 v186, v249, v248, s4
    v_mfma_f32_16x16x32_bf16 a[116:119], v[172:175], a[244:247], a[116:119]
    v_exp_f32 v244, v120
    v_mfma_f32_16x16x32_bf16 a[112:115], v[172:175], a[240:243], a[112:115]
    v_exp_f32 v245, v121
    v_mfma_f32_16x16x32_bf16 a[112:115], v[188:191], a[224:227], a[112:115]
    v_mov_b64 v[198:199], v[194:195]
    v_mfma_f32_16x16x32_bf16 a[16:19], v[176:179], a[224:227], a[16:19]
    v_exp_f32 v246, v122
    v_mfma_f32_16x16x32_bf16 a[16:19], v[152:155], a[240:243], a[16:19]
    v_exp_f32 v247, v123
    v_mfma_f32_16x16x32_bf16 a[20:23], v[152:155], a[244:247], a[20:23]
    v_perm_b32 v189, v247, v246, s4
    v_perm_b32 v188, v245, v244, s4
    v_mfma_f32_16x16x32_bf16 a[20:23], v[176:179], a[228:231], a[20:23]
    v_exp_f32 v248, v124
    v_mfma_f32_16x16x32_bf16 a[24:27], v[176:179], a[232:235], a[24:27]
    v_exp_f32 v249, v125
    v_mfma_f32_16x16x32_bf16 a[24:27], v[152:155], a[248:251], a[24:27]
    v_perm_b32 v190, v249, v248, s4
    v_mfma_f32_16x16x32_bf16 a[28:31], v[152:155], a[252:255], a[28:31]
    v_exp_f32 v250, v126
    v_mfma_f32_16x16x32_bf16 a[28:31], v[176:179], a[236:239], a[28:31]
    v_exp_f32 v251, v127
    v_mfma_f32_16x16x32_bf16 a[60:63], v[180:183], a[236:239], a[60:63]
    v_perm_b32 v191, v251, v250, s4
    v_mfma_f32_16x16x32_bf16 a[60:63], v[156:159], a[252:255], a[60:63]
    v_smfmac_f32_16x16x64_bf16 v[196:199], v[144:147], v[236:243], v255
    v_smfmac_f32_16x16x64_bf16 v[196:199], v[148:151], v[184:191], v255
    v_mfma_f32_16x16x32_bf16 a[56:59], v[156:159], a[248:251], a[56:59]
    s_waitcnt vmcnt(9) lgkmcnt(0)
    s_barrier
    v_mfma_f32_16x16x32_bf16 a[56:59], v[180:183], a[232:235], a[56:59]
    v_mfma_f32_16x16x32_bf16 a[52:55], v[180:183], a[228:231], a[52:55]
    v_mfma_f32_16x16x32_bf16 a[52:55], v[156:159], a[244:247], a[52:55]
    v_mfma_f32_16x16x32_bf16 a[48:51], v[156:159], a[240:243], a[48:51]
    s_nop 0
    v_cmp_lt_f32 vcc, s72, v196
    v_mfma_f32_16x16x32_bf16 a[48:51], v[180:183], a[224:227], a[48:51]
    s_cbranch_vccnz L_rare_r6_7
L_join_r6_7:
    v_mfma_f32_16x16x32_bf16 v[96:99], a[192:195], a[128:131], v[128:131]
    v_exp_f32 v244, v64
    v_mfma_f32_16x16x32_bf16 v[96:99], a[196:199], a[132:135], v[96:99]
    ds_read_b128 a[224:227], v14 offset:49152
    v_mfma_f32_16x16x32_bf16 v[96:99], a[200:203], a[136:139], v[96:99]
    v_exp_f32 v245, v65
    v_mfma_f32_16x16x32_bf16 v[96:99], a[204:207], a[140:143], v[96:99]
L_stop8:
    s_cbranch_execz L_tour_end
    ds_read_b128 a[228:231], v253 offset:49152
    v_perm_b32 v160, v245, v244, s4
    v_mfma_f32_16x16x32_bf16 v[104:107], a[204:207], a[156:159], v[132:135]
    v_exp_f32 v246, v66
    v_mfma_f32_16x16x32_bf16 v[104:107], a[200:203], a[152:155], v[104:107]
    ds_read_b128 a[232:235], v254 offset:49152
    v_mfma_f32_16x16x32_bf16 v[104:107], a[196:199], a[148:151], v[104:107]
    v_exp_f32 v247, v67
    v_mfma_f32_16x16x32_bf16 v[104:107], a[192:195], a[144:147], v[104:107]
    ds_read_b128 a[236:239], v234 offset:49152
    v_perm_b32 v161, v247, v246, s4
    v_mfma_f32_16x16x32_bf16 v[112:115], a[192:195], a[160:163], v[136:139]
    v_exp_f32 v248, v68
    v_mfma_f32_16x16x32_bf16 v[112:115], a[196:199], a[164:167], v[112:115]
    ds_read_b128 a[240:243], v14 offset:53248
    v_mfma_f32_16x16x32_bf16 v[112:115], a[200:203], a[168:171], v[112:115]
    v_exp_f32 v249, v69
    v_mfma_f32_16x16x32_bf16 v[112:115], a[204:207], a[172:175], v[112:115]
    ds_read_b128 a[244:247], v253 offset:53248
    v_perm_b32 v162, v249, v248, s4
    v_mfma_f32_16x16x32_bf16 v[120:123], a[204:207], a[188:191], v[140:143]
    v_exp_f32 v250, v70
    v_mfma_f32_16x16x32_bf16 v[120:123], a[200:203], a[184:187], v[120:123]
    ds_read_b128 a[248:251], v254 offset:53248
    s_add_u32 m0, s73, 8192
    v_mfma_f32_16x16x32_bf16 v[120:123], a[196:199], a[180:183], v[120:123]
    v_exp_f32 v251, v71
    v_mfma_f32_16x16x32_bf16 v[120:123], a[192:195], a[176:179], v[120:123]
    ds_read_b128 a[252:255], v234 offset:53248
    v_perm_b32 v163, v251, v250, s4
    v_mfma_f32_16x16x32_bf16 v[124:127], a[208:211], a[176:179], v[140:143]
    v_exp_f32 v244, v72
    v_mfma_f32_16x16x32_bf16 v[124:127], a[212:215], a[180:183], v[124:127]
    buffer_load_dwordx4 v2, s[24:27], s64 offen offset:0 sc1 lds
    v_mfma_f32_16x16x32_bf16 v[124:127], a[216:219], a[184:187], v[124:127]
    v_exp_f32 v245, v73
    v_mfma_f32_16x16x32_bf16 v[124:127], a[220:223], a[188:191], v[124:127]
    ds_read_b128 a[192:195], v252 offset:16384
    v_perm_b32 v164, v245, v244, s4
    v_mfma_f32_16x16x32_bf16 v[116:119], a[220:223], a[172:175], v[136:139]
    v_exp_f32 v246, v74
    v_mfma_f32_16x16x32_bf16 v[116:119], a[216:219], a[168:171], v[116:119]
    buffer_load_dwordx4 v2, s[24:27], s64 offen offset:1024 sc1 lds
    v_mfma_f32_16x16x32_bf16 v[116:119], a[212:215], a[164:167], v[116:119]
    v_exp_f32 v247, v75
    v_mfma_f32_16x16x32_bf16 v[116:119], a[208:211], a[160:163], v[116:119]
    ds_read_b128 a[196:199], v252 offset:17408
    v_perm_b32 v165, v247, v246, s4
    v_mfma_f32_16x16x32_bf16 v[108:111], a[208:211], a[144:147], v[132:135]
    v_exp_f32 v248, v76
    v_mfma_f32_16x16x32_bf16 v[108:111], a[212:215], a[148:151], v[108:111]
    buffer_load_dwordx4 v2, s[24:27], s64 offen offset:2048 sc1 lds
    v_mfma_f32_16x16x32_bf16 v[108:111], a[216:219], a[152:155], v[108:111]
    v_exp_f32 v249, v77
    v_mfma_f32_16x16x32_bf16 v[108:111], a[220:223], a[156:159], v[108:111]
    ds_read_b128 a[200:203], v252 offset:18432
    v_perm_b32 v166, v249, v248, s4
    v_mfma_f32_16x16x32_bf16 v[100:103], a[220:223], a[140:143], v[128:131]
    v_exp_f32 v250, v78
    v_mfma_f32_16x16x32_bf16 v[100:103], a[216:219], a[136:139], v[100:103]
    buffer_load_dwordx4 v2, s[24:27], s64 offen offset:3072 sc1 lds
    s_waitcnt lgkmcnt(3)
    v_mfma_f32_16x16x32_bf16 v[100:103], a[212:215], a[132:135], v[100:103]
    v_exp_f32 v251, v79
    v_mfma_f32_16x16x32_bf16 v[100:103], a[208:211], a[128:131], v[100:103]
    ds_read_b128 a[204:207], v252 offset:19456
    v_perm_b32 v167, v251, v250, s4
    v_mfma_f32_16x16x32_bf16 a[64:67], v[168:171], a[224:227], a[64:67]
    v_exp_f32 v244, v80
    v_mfma_f32_16x16x32_bf16 a[64:67], v[184:187], a[240:243], a[64:67]
    ds_read_b128 a[208:211], v252 offset:20480
    v_mfma_f32_16x16x32_bf16 a[68:71], v[184:187], a[244:247], a[68:71]
    v_exp_f32 v245, v81
    v_mfma_f32_16x16x32_bf16 a[68:71], v[168:171], a[228:231], a[68:71]
    ds_read_b128 a[212:215], v252 offset:21504
    ds_read_b128 a[216:219], v252 offset:22528
    v_mfma_f32_16x16x32_bf16 a[72:75], v[168:171], a[232:235], a[72:75]
    v_exp_f32 v246, v82
    v_mfma_f32_16x16x32_bf16 a[72:75], v[184:187], a[248:251], a[72:75]
    v_exp_f32 v247, v83
    v_mfma_f32_16x16x32_bf16 a[76:79], v[184:187], a[252:255], a[76:79]
    ds_read_b128 a[220:223], v252 offset:23552
    v_mov_b64 v[192:193], v[196:197]
    v_mfma_f32_16x16x32_bf16 a[76:79], v[168:171], a[236:239], a[76:79]
    v_exp_f32 v248, v84
    v_mfma_f32_16x16x32_bf16 a[108:111], v[172:175], a[236:239], a[108:111]
    v_exp_f32 v249, v85
    v_mfma_f32_16x16x32_bf16 a[108:111], v[188:191], a[252:255], a[108:111]
    v_perm_b32 v169, v247, v246, s4
    v_perm_b32 v168, v245, v244, s4
    v_mfma_f32_16x16x32_bf16 a[104:107], v[188:191], a[248:251], a[104:107]
    v_exp_f32 v250, v86
    v_mfma_f32_16x16x32_bf16 a[104:107], v[172:175], a[232:235], a[104:107]
    v_exp_f32 v251, v87
    v_mfma_f32_16x16x32_bf16 a[100:103], v[172:175], a[228:231], a[100:103]
    v_perm_b32 v171, v251, v250, s4
    v_perm_b32 v170, v249, v248, s4
    v_mfma_f32_16x16x32_bf16 a[100:103], v[188:191], a[244:247], a[100:103]
    v_exp_f32 v244, v88
    v_mfma_f32_16x16x32_bf16 a[96:99], v[188:191], a[240:243], a[96:99]
    v_exp_f32 v245, v89
    v_mfma_f32_16x16x32_bf16 a[96:99], v[172:175], a[224:227], a[96:99]
    v_mov_b64 v[194:195], v[198:199]
    v_mfma_f32_16x16x32_bf16 a[0:3], v[152:155], a[224:227], a[0:3]
    v_exp_f32 v246, v90
    v_mfma_f32_16x16x32_bf16 a[0:3], v[236:239], a[240:243], a[0:3]
    v_exp_f32 v247, v91
    v_mfma_f32_16x16x32_bf16 a[4:7], v[236:239], a[244:247], a[4:7]
    v_perm_b32 v173, v247, v246, s4
    v_perm_b32 v172, v245, v244, s4
    v_mfma_f32_16x16x32_bf16 a[4:7], v[152:155], a[228:231], a[4:7]
    v_exp_f32 v248, v92
    v_mfma_f32_16x16x32_bf16 a[8:11], v[152:155], a[232:235], a[8:11]
    v_exp_f32 v249, v93
    v_mfma_f32_16x16x32_bf16 a[8:11], v[236:239], a[248:251], a[8:11]
    v_perm_b32 v174, v249, v248, s4
    v_mfma_f32_16x16x32_bf16 a[12:15], v[236:239], a[252:255], a[12:15]
    v_exp_f32 v250, v94
    v_mfma_f32_16x16x32_bf16 a[12:15], v[152:155], a[236:239], a[12:15]
    v_exp_f32 v251, v95
    v_mfma_f32_16x16x32_bf16 a[44:47], v[156:159], a[236:239], a[44:47]
    v_perm_b32 v175, v251, v250, s4
    v_mfma_f32_16x16x32_bf16 a[44:47], v[240:243], a[252:255], a[44:47]
    v_smfmac_f32_16x16x64_bf16 v[192:195], v[144:147], v[160:167], v255
    v_smfmac_f32_16x16x64_bf16 v[192:195], v[148:151], v[168:175], v255
    v_mfma_f32_16x16x32_bf16 a[40:43], v[240:243], a[248:251], a[40:43]
    s_waitcnt vmcnt(8) lgkmcnt(0)
    s_barrier
    v_mfma_f32_16x16x32_bf16 a[40:43], v[156:159], a[232:235], a[40:43]
    v_mfma_f32_16x16x32_bf16 a[36:39], v[156:159], a[228:231], a[36:39]
    v_mfma_f32_16x16x32_bf16 a[36:39], v[240:243], a[244:247], a[36:39]
    v_mfma_f32_16x16x32_bf16 a[32:35], v[240:243], a[240:243], a[32:35]
    s_nop 0
    v_cmp_lt_f32 vcc, s72, v192
    v_mfma_f32_16x16x32_bf16 a[32:35], v[156:159], a[224:227], a[32:35]
    s_cbranch_vccnz L_rare_r7_0
L_join_r7_0:
    v_mfma_f32_16x16x32_bf16 v[64:67], a[192:195], a[128:131], v[128:131]
    v_exp_f32 v244, v96
    v_mfma_f32_16x16x32_bf16 v[64:67], a[196:199], a[132:135], v[64:67]
    ds_read_b128 a[224:227], v14 offset:57344
    v_mfma_f32_16x16x32_bf16 v[64:67], a[200:203], a[136:139], v[64:67]
    v_exp_f32 v245, v97
    v_mfma_f32_16x16x32_bf16 v[64:67], a[204:207], a[140:143], v[64:67]
    ds_read_b128 a[228:231], v253 offset:57344
    v_perm_b32 v176, v245, v244, s4
    v_mfma_f32_16x16x32_bf16 v[72:75], a[204:207], a[156:159], v[132:135]
    v_exp_f32 v246, v98
    v_mfma_f32_16x16x32_bf16 v[72:75], a[200:203], a[152:155], v[72:75]
    ds_read_b128 a[232:235], v254 offset:57344
    v_mfma_f32_16x16x32_bf16 v[72:75], a[196:199], a[148:151], v[72:75]
    v_exp_f32 v247, v99
    v_mfma_f32_16x16x32_bf16 v[72:75], a[192:195], a[144:147], v[72:75]
    ds_read_b128 a[236:239], v234 offset:57344
    v_perm_b32 v177, v247, v246, s4
    v_mfma_f32_16x16x32_bf16 v[80:83], a[192:195], a[160:163], v[136:139]
    v_exp_f32 v248, v100
    v_mfma_f32_16x16x32_bf16 v[80:83], a[196:199], a[164:167], v[80:83]
    ds_read_b128 a[240:243], v14 offset:61440
    v_mfma_f32_16x16x32_bf16 v[80:83], a[200:203], a[168:171], v[80:83]
    v_exp_f32 v249, v101
    v_mfma_f32_16x16x32_bf16 v[80:83], a[204:207], a[172:175], v[80:83]
    ds_read_b128 a[244:247], v253 offset:61440
    v_perm_b32 v178, v249, v248, s4
    v_mfma_f32_16x16x32_bf16 v[88:91], a[204:207], a[188:191], v[140:143]
    v_exp_f32 v250, v102
    v_mfma_f32_16x16x32_bf16 v[88:91], a[200:203], a[184:187], v[88:91]
    ds_read_b128 a[248:251], v254 offset:61440
    s_add_u32 m0, s73, 16384
    v_mfma_f32_16x16x32_bf16 v[88:91], a[196:199], a[180:183], v[88:91]
    v_exp_f32 v251, v103
    v_mfma_f32_16x16x32_bf16 v[88:91], a[192:195], a[176:179], v[88:91]
    ds_read_b128 a[252:255], v234 offset:61440
    v_perm_b32 v179, v251, v250, s4
    v_mfma_f32_16x16x32_bf16 v[92:95], a[208:211], a[176:179], v[140:143]
    v_exp_f32 v244, v104
    v_mfma_f32_16x16x32_bf16 v[92:95], a[212:215], a[180:183], v[92:95]
    buffer_load_dwordx4 v2, s[24:27], s65 offen offset:0 sc1 lds
    v_mfma_f32_16x16x32_bf16 v[92:95], a[216:219], a[184:187], v[92:95]
    v_exp_f32 v245, v105
    v_mfma_f32_16x16x32_bf16 v[92:95], a[220:223], a[188:191], v[92:95]
    ds_read_b128 a[192:195], v252 offset:24576
    v_perm_b32 v180, v245, v244, s4
    v_mfma_f32_16x16x32_bf16 v[84:87], a[220:223], a[172:175], v[136:139]
    v_exp_f32 v246, v106
    v_mfma_f32_16x16x32_bf16 v[84:87], a[216:219], a[168:171], v[84:87]
    buffer_load_dwordx4 v2, s[24:27], s65 offen offset:1024 sc1 lds
    v_mfma_f32_16x16x32_bf16 v[84:87], a[212:215], a[164:167], v[84:87]
    v_exp_f32 v247, v107
    v_mfma_f32_16x16x32_bf16 v[84:87], a[208:211], a[160:163], v[84:87]
    ds_read_b128 a[196:199], v252 offset:25600
    v_perm_b32 v181, v247, v246, s4
    v_mfma_f32_16x16x32_bf16 v[76:79], a[208:211], a[144:147], v[132:135]
    v_exp_f32 v248, v108
    v_mfma_f32_16x16x32_bf16 v[76:79], a[212:215], a[148:151], v[76:79]
    buffer_load_dwordx4 v2, s[24:27], s65 offen offset:2048 sc1 lds
    v_mfma_f32_16x16x32_bf16 v[76:79], a[216:219], a[152:155], v[76:79]
    v_exp_f32 v249, v109
    v_mfma_f32_16x16x32_bf16 v[76:79], a[220:223], a[156:159], v[76:79]
    ds_read_b128 a[200:203], v252 offset:26624
    v_perm_b32 v182, v249, v248, s4
    v_mfma_f32_16x16x32_bf16 v[68:71], a[220:223], a[140:143], v[128:131]
    v_exp_f32 v250, v110
    v_mfma_f32_16x16x32_bf16 v[68:71], a[216:219], a[136:139], v[68:71]
    buffer_load_dwordx4 v2, s[24:27], s65 offen offset:3072 sc1 lds
    s_waitcnt lgkmcnt(3)
    v_mfma_f32_16x16x32_bf16 v[68:71], a[212:215], a[132:135], v[68:71]
    v_exp_f32 v251, v111
    v_mfma_f32_16x16x32_bf16 v[68:71], a[208:211], a[128:131], v[68:71]
    ds_read_b128 a[204:207], v252 offset:27648
    v_perm_b32 v183, v251, v250, s4
    v_mfma_f32_16x16x32_bf16 a[80:83], v[184:187], a[224:227], a[80:83]
    v_exp_f32 v244, v112
    v_mfma_f32_16x16x32_bf16 a[80:83], v[168:171], a[240:243], a[80:83]
    ds_read_b128 a[208:211], v252 offset:28672
    v_mfma_f32_16x16x32_bf16 a[84:87], v[168:171], a[244:247], a[84:87]
    v_exp_f32 v245, v113
    v_mfma_f32_16x16x32_bf16 a[84:87], v[184:187], a[228:231], a[84:87]
    ds_read_b128 a[212:215], v252 offset:29696
    ds_read_b128 a[216:219], v252 offset:30720
    v_mfma_f32_16x16x32_bf16 a[88:91], v[184:187], a[232:235], a[88:91]
    v_exp_f32 v246, v114
    v_mfma_f32_16x16x32_bf16 a[88:91], v[168:171], a[248:251], a[88:91]
    v_exp_f32 v247, v115
    v_mfma_f32_16x16x32_bf16 a[92:95], v[168:171], a[252:255], a[92:95]
    ds_read_b128 a[220:223], v252 offset:31744
    v_mov_b64 v[196:197], v[192:193]
    v_mfma_f32_16x16x32_bf16 a[92:95], v[184:187], a[236:239], a[92:95]
    v_exp_f32 v248, v116
    v_mfma_f32_16x16x32_bf16 a[124:127], v[188:191], a[236:239], a[124:127]
    v_exp_f32 v249, v117
    v_mfma_f32_16x16x32_bf16 a[124:127], v[172:175], a[252:255], a[124:127]
    v_perm_b32 v185, v247, v246, s4
    v_perm_b32 v184, v245, v244, s4
    v_mfma_f32_16x16x32_bf16 a[120:123], v[172:175], a[248:251], a[120:123]
    v_exp_f32 v250, v118
    v_mfma_f32_16x16x32_bf16 a[120:123], v[188:191], a[232:235], a[120:123]
    v_exp_f32 v251, v119
    v_mfma_f32_16x16x32_bf16 a[116:119], v[188:191], a[228:231], a[116:119]
    v_perm_b32 v187, v251, v250, s4
    v_perm_b32 v186, v249, v248, s4
    v_mfma_f32_16x16x32_bf16 a[116:119], v[172:175], a[244:247], a[116:119]
    v_exp_f32 v244, v120
    v_mfma_f32_16x16x32_bf16 a[112:115], v[172:175], a[240:243], a[112:115]
    v_exp_f32 v245, v121
    v_mfma_f32_16x16x32_bf16 a[112:115], v[188:191], a[224:227], a[112:115]
    v_mov_b64 v[198:199], v[194:195]
    v_mfma_f32_16x16x32_bf16 a[16:19], v[236:239], a[224:227], a[16:19]
    v_exp_f32 v246, v122
    v_mfma_f32_16x16x32_bf16 a[16:19], v[160:163], a[240:243], a[16:19]
    v_exp_f32 v247, v123
    v_mfma_f32_16x16x32_bf16 a[20:23], v[160:163], a[244:247], a[20:23]
    v_perm_b32 v189, v247, v246, s4
    v_perm_b32 v188, v245, v244, s4
    v_mfma_f32_16x16x32_bf16 a[20:23], v[236:239], a[228:231], a[20:23]
    v_exp_f32 v248, v124
    v_mfma_f32_16x16x32_bf16 a[24:27], v[236:239], a[232:235], a[24:27]
    v_exp_f32 v249, v125
    v_mfma_f32_16x16x32_bf16 a[24:27], v[160:163], a[248:251], a[24:27]
    v_perm_b32 v190, v249, v248, s4
    v_mfma_f32_16x16x32_bf16 a[28:31], v[160:163], a[252:255], a[28:31]
    v_exp_f32 v250, v126
    v_mfma_f32_16x16x32_bf16 a[28:31], v[236:239], a[236:239], a[28:31]
    v_exp_f32 v251, v127
    v_mfma_f32_16x16x32_bf16 a[60:63], v[240:243], a[236:239], a[60:63]
    v_perm_b32 v191, v251, v250, s4
    v_mfma_f32_16x16x32_bf16 a[60:63], v[164:167], a[252:255], a[60:63]
    v_smfmac_f32_16x16x64_bf16 v[196:199], v[144:147], v[176:183], v255
    v_smfmac_f32_16x16x64_bf16 v[196:199], v[148:151], v[184:191], v255
    v_mfma_f32_16x16x32_bf16 a[56:59], v[164:167], a[248:251], a[56:59]
    s_waitcnt vmcnt(8) lgkmcnt(0)
    s_barrier
    v_mfma_f32_16x16x32_bf16 a[56:59], v[240:243], a[232:235], a[56:59]
    v_mfma_f32_16x16x32_bf16 a[52:55], v[240:243], a[228:231], a[52:55]
    v_mfma_f32_16x16x32_bf16 a[52:55], v[164:167], a[244:247], a[52:55]
    v_mfma_f32_16x16x32_bf16 a[48:51], v[164:167], a[240:243], a[48:51]
    s_nop 0
    v_cmp_lt_f32 vcc, s72, v196
    v_mfma_f32_16x16x32_bf16 a[48:51], v[240:243], a[224:227], a[48:51]
    s_cbranch_vccnz L_rare_r7_1
L_join_r7_1:
    v_mfma_f32_16x16x32_bf16 v[96:99], a[192:195], a[128:131], v[128:131]
    v_exp_f32 v244, v64
    v_mfma_f32_16x16x32_bf16 v[96:99], a[196:199], a[132:135], v[96:99]
    ds_read_b128 a[224:227], v14 offset:32768
    v_mfma_f32_16x16x32_bf16 v[96:99], a[200:203], a[136:139], v[96:99]
    v_exp_f32 v245, v65
    v_mfma_f32_16x16x32_bf16 v[96:99], a[204:207], a[140:143], v[96:99]
    ds_read_b128 a[228:231], v253 offset:32768
    v_perm_b32 v152, v245, v244, s4
    v_mfma_f32_16x16x32_bf16 v[104:107], a[204:207], a[156:159], v[132:135]
    v_exp_f32 v246, v66
    v_mfma_f32_16x16x32_bf16 v[104:107], a[200:203], a[152:155], v[104:107]
    ds_read_b128 a[232:235], v254 offset:32768
    v_mfma_f32_16x16x32_bf16 v[104:107], a[196:199], a[148:151], v[104:107]
    v_exp_f32 v247, v67
    v_mfma_f32_16x16x32_bf16 v[104:107], a[192:195], a[144:147], v[104:107]
    ds_read_b128 a[236:239], v234 offset:32768
    v_perm_b32 v153, v247, v246, s4
    v_mfma_f32_16x16x32_bf16 v[112:115], a[192:195], a[160:163], v[136:139]
    v_exp_f32 v248, v68
    v_mfma_f32_16x16x32_bf16 v[112:115], a[196:199], a[164:167], v[112:115]
    ds_read_b128 a[240:243], v14 offset:36864
    v_mfma_f32_16x16x32_bf16 v[112:115], a[200:203], a[168:171], v[112:115]
    v_exp_f32 v249, v69
    v_mfma_f32_16x16x32_bf16 v[112:115], a[204:207], a[172:175], v[112:115]
    ds_read_b128 a[244:247], v253 offset:36864
    v_perm_b32 v154, v249, v248, s4
    v_mfma_f32_16x16x32_bf16 v[120:123], a[204:207], a[188:191], v[140:143]
    v_exp_f32 v250, v70
    v_mfma_f32_16x16x32_bf16 v[120:123], a[200:203], a[184:187], v[120:123]
    ds_read_b128 a[248:251], v254 offset:36864
    s_add_u32 m0, s73, 24576
    v_mfma_f32_16x16x32_bf16 v[120:123], a[196:199], a[180:183], v[120:123]
    v_exp_f32 v251, v71
    v_mfma_f32_16x16x32_bf16 v[120:123], a[192:195], a[176:179], v[120:123]
    ds_read_b128 a[252:255], v234 offset:36864
    v_perm_b32 v155, v251, v250, s4
    v_mfma_f32_16x16x32_bf16 v[124:127], a[208:211], a[176:179], v[140:143]
    v_exp_f32 v244, v72
    v_mfma_f32_16x16x32_bf16 v[124:127], a[212:215], a[180:183], v[124:127]
    buffer_load_dwordx4 v2, s[24:27], s66 offen offset:0 sc1 lds
    v_mfma_f32_16x16x32_bf16 v[124:127], a[216:219], a[184:187], v[124:127]
    v_exp_f32 v245, v73
    v_mfma_f32_16x16x32_bf16 v[124:127], a[220:223], a[188:191], v[124:127]
    ds_read_b128 a[192:195], v252 offset:0
    v_perm_b32 v156, v245, v244, s4
    v_mfma_f32_16x16x32_bf16 v[116:119], a[220:223], a[172:175], v[136:139]
    v_exp_f32 v246, v74
    v_mfma_f32_16x16x32_bf16 v[116:119], a[216:219], a[168:171], v[116:119]
    buffer_load_dwordx4 v2, s[24:27], s66 offen offset:1024 sc1 lds
    v_mfma_f32_16x16x32_bf16 v[116:119], a[212:215], a[164:167], v[116:119]
    v_exp_f32 v247, v75
    v_mfma_f32_16x16x32_bf16 v[116:119], a[208:211], a[160:163], v[116:119]
    ds_read_b128 a[196:199], v252 offset:1024
    v_perm_b32 v157, v247, v246, s4
    v_mfma_f32_16x16x32_bf16 v[108:111], a[208:211], a[144:147], v[132:135]
    v_exp_f32 v248, v76
    v_mfma_f32_16x16x32_bf16 v[108:111], a[212:215], a[148:151], v[108:111]
    buffer_load_dwordx4 v2, s[24:27], s66 offen offset:2048 sc1 lds
    v_mfma_f32_16x16x32_bf16 v[108:111], a[216:219], a[152:155], v[108:111]
    v_exp_f32 v249, v77
    v_mfma_f32_16x16x32_bf16 v[108:111], a[220:223], a[156:159], v[108:111]
    ds_read_b128 a[200:203], v252 offset:2048
    v_perm_b32 v158, v249, v248, s4
    v_mfma_f32_16x16x32_bf16 v[100:103], a[220:223], a[140:143], v[128:131]
    v_exp_f32 v250, v78
    v_mfma_f32_16x16x32_bf16 v[100:103], a[216:219], a[136:139], v[100:103]
    buffer_load_dwordx4 v2, s[24:27], s66 offen offset:3072 sc1 lds
    s_waitcnt lgkmcnt(3)
    v_mfma_f32_16x16x32_bf16 v[100:103], a[212:215], a[132:135], v[100:103]
    v_exp_f32 v251, v79
    v_mfma_f32_16x16x32_bf16 v[100:103], a[208:211], a[128:131], v[100:103]
    ds_read_b128 a[204:207], v252 offset:3072
    v_perm_b32 v159, v251, v250, s4
    v_mfma_f32_16x16x32_bf16 a[64:67], v[168:171], a[224:227], a[64:67]
    v_exp_f32 v244, v80
    v_mfma_f32_16x16x32_bf16 a[64:67], v[184:187], a[240:243], a[64:67]
    ds_read_b128 a[208:211], v252 offset:4096
    v_mfma_f32_16x16x32_bf16 a[68:71], v[184:187], a[244:247], a[68:71]
    v_exp_f32 v245, v81
    v_mfma_f32_16x16x32_bf16 a[68:71], v[168:171], a[228:231], a[68:71]
    ds_read_b128 a[212:215], v252 offset:5120
    ds_read_b128 a[216:219], v252 offset:6144
    v_mfma_f32_16x16x32_bf16 a[72:75], v[168:171], a[232:235], a[72:75]
    v_exp_f32 v246, v82
    v_mfma_f32_16x16x32_bf16 a[72:75], v[184:187], a[248:251], a[72:75]
    v_exp_f32 v247, v83
    v_mfma_f32_16x16x32_bf16 a[76:79], v[184:187], a[252:255], a[76:79]
    ds_read_b128 a[220:223], v252 offset:7168
    v_mov_b64 v[192:193], v[196:197]
    v_mfma_f32_16x16x32_bf16 a[76:79], v[168:171], a[236:239], a[76:79]
    v_exp_f32 v248, v84
    v_mfma_f32_16x16x32_bf16 a[108:111], v[172:175], a[236:239], a[108:111]
    v_exp_f32 v249, v85
    v_mfma_f32_16x16x32_bf16 a[108:111], v[188:191], a[252:255], a[108:111]
    v_perm_b32 v169, v247, v246, s4
    v_perm_b32 v168, v245, v244, s4
    v_mfma_f32_16x16x32_bf16 a[104:107], v[188:191], a[248:251], a[104:107]
    v_exp_f32 v250, v86
    v_mfma_f32_16x16x32_bf16 a[104:107], v[172:175], a[232:235], a[104:107]
    v_exp_f32 v251, v87
    v_mfma_f32_16x16x32_bf16 a[100:103], v[172:175], a[228:231], a[100:103]
    v_perm_b32 v171, v251, v250, s4
    v_perm_b32 v170, v249, v248, s4
    v_mfma_f32_16x16x32_bf16 a[100:103], v[188:191], a[244:247], a[100:103]
    v_exp_f32 v244, v88
    v_mfma_f32_16x16x32_bf16 a[96:99], v[188:191], a[240:243], a[96:99]
    v_exp_f32 v245, v89
    v_mfma_f32_16x16x32_bf16 a[96:99], v[172:175], a[224:227], a[96:99]
    v_mov_b64 v[194:195], v[198:199]
    v_mfma_f32_16x16x32_bf16 a[0:3], v[160:163], a[224:227], a[0:3]
    v_exp_f32 v246, v90
    v_mfma_f32_16x16x32_bf16 a[0:3], v[176:179], a[240:243], a[0:3]
    v_exp_f32 v247, v91
    v_mfma_f32_16x16x32_bf16 a[4:7], v[176:179], a[244:247], a[4:7]
    v_perm_b32 v173, v247, v246, s4
    v_perm_b32 v172, v245, v244, s4
    v_mfma_f32_16x16x32_bf16 a[4:7], v[160:163], a[228:231], a[4:7]
    v_exp_f32 v248, v92
    v_mfma_f32_16x16x32_bf16 a[8:11], v[160:163], a[232:235], a[8:11]
    v_exp_f32 v249, v93
    v_mfma_f32_16x16x32_bf16 a[8:11], v[176:179], a[248:251], a[8:11]
    v_perm_b32 v174, v249, v248, s4
    v_mfma_f32_16x16x32_bf16 a[12:15], v[176:179], a[252:255], a[12:15]
    v_exp_f32 v250, v94
    v_mfma_f32_16x16x32_bf16 a[12:15], v[160:163], a[236:239], a[12:15]
    v_exp_f32 v251, v95
    v_mfma_f32_16x16x32_bf16 a[44:47], v[164:167], a[236:239], a[44:47]
    v_perm_b32 v175, v251, v250, s4
    v_mfma_f32_16x16x32_bf16 a[44:47], v[180:183], a[252:255], a[44:47]
    s_add_u32 s93, s66, 0x1000000
    s_cmp_lt_u32 s96, 2
    s_cselect_b32 s67, s93, s67
    s_cselect_b32 s68, 0x7ff00000, s68
    v_smfmac_f32_16x16x64_bf16 v[192:195], v[144:147], v[152:159], v255
    s_add_u32 s93, s65, 0x1000000
    s_cmp_eq_u32 s96, 0
    s_cselect_b32 s68, s93, s68
    v_smfmac_f32_16x16x64_bf16 v[192:195], v[148:151], v[168:175], v255
    v_mfma_f32_16x16x32_bf16 a[40:43], v[180:183], a[248:251], a[40:43]
    s_waitcnt vmcnt(8) lgkmcnt(0)
    s_barrier
    v_mfma_f32_16x16x32_bf16 a[40:43], v[164:167], a[232:235], a[40:43]
    v_mfma_f32_16x16x32_bf16 a[36:39], v[164:167], a[228:231], a[36:39]
    v_mfma_f32_16x16x32_bf16 a[36:39], v[180:183], a[244:247], a[36:39]
    v_mfma_f32_16x16x32_bf16 a[32:35], v[180:183], a[240:243], a[32:35]
    s_nop 0
    v_cmp_lt_f32 vcc, s72, v192
    v_mfma_f32_16x16x32_bf16 a[32:35], v[164:167], a[224:227], a[32:35]
    s_cbranch_vccnz L_rare_r7_2
L_join_r7_2:
    v_mfma_f32_16x16x32_bf16 v[64:67], a[192:195], a[128:131], v[128:131]
    v_exp_f32 v244, v96
    v_mfma_f32_16x16x32_bf16 v[64:67], a[196:199], a[132:135], v[64:67]
    ds_read_b128 a[224:227], v14 offset:40960
    buffer_load_dword v213, v1, s[8:11], 0 offen offset:8 sc1
    v_mfma_f32_16x16x32_bf16 v[64:67], a[200:203], a[136:139], v[64:67]
    v_exp_f32 v245, v97
    v_mfma_f32_16x16x32_bf16 v[64:67], a[204:207], a[140:143], v[64:67]
    ds_read_b128 a[228:231], v253 offset:40960
    v_perm_b32 v236, v245, v244, s4
    v_mfma_f32_16x16x32_bf16 v[72:75], a[204:207], a[156:159], v[132:135]
    v_exp_f32 v246, v98
    v_mfma_f32_16x16x32_bf16 v[72:75], a[200:203], a[152:155], v[72:75]
    ds_read_b128 a[232:235], v254 offset:40960
    v_mfma_f32_16x16x32_bf16 v[72:75], a[196:199], a[148:151], v[72:75]
    v_exp_f32 v247, v99
    v_mfma_f32_16x16x32_bf16 v[72:75], a[192:195], a[144:147], v[72:75]
    ds_read_b128 a[236:239], v234 offset:40960
    v_perm_b32 v237, v247, v246, s4
    v_mfma_f32_16x16x32_bf16 v[80:83], a[192:195], a[160:163], v[136:139]
    v_exp_f32 v248, v100
    v_mfma_f32_16x16x32_bf16 v[80:83], a[196:199], a[164:167], v[80:83]
    ds_read_b128 a[240:243], v14 offset:45056
    v_mfma_f32_16x16x32_bf16 v[80:83], a[200:203], a[168:171], v[80:83]
    v_exp_f32 v249, v101
    v_mfma_f32_16x16x32_bf16 v[80:83], a[204:207], a[172:175], v[80:83]
    ds_read_b128 a[244:247], v253 offset:45056
    v_perm_b32 v238, v249, v248, s4
    v_mfma_f32_16x16x32_bf16 v[88:91], a[204:207], a[188:191], v[140:143]
    v_exp_f32 v250, v102
    v_mfma_f32_16x16x32_bf16 v[88:91], a[200:203], a[184:187], v[88:91]
    ds_read_b128 a[248:251], v254 offset:45056
    s_add_u32 m0, s73, 0
    v_mfma_f32_16x16x32_bf16 v[88:91], a[196:199], a[180:183], v[88:91]
    v_exp_f32 v251, v103
    v_mfma_f32_16x16x32_bf16 v[88:91], a[192:195], a[176:179], v[88:91]
    ds_read_b128 a[252:255], v234 offset:45056
    v_perm_b32 v239, v251, v250, s4
    v_mfma_f32_16x16x32_bf16 v[92:95], a[208:211], a[176:179], v[140:143]
    v_exp_f32 v244, v104
    v_mfma_f32_16x16x32_bf16 v[92:95], a[212:215], a[180:183], v[92:95]
    buffer_load_dwordx4 v2, s[24:27], s67 offen offset:0 sc1 lds
    v_mfma_f32_16x16x32_bf16 v[92:95], a[216:219], a[184:187], v[92:95]
    v_exp_f32 v245, v105
    v_mfma_f32_16x16x32_bf16 v[92:95], a[220:223], a[188:191], v[92:95]
    ds_read_b128 a[192:195], v252 offset:8192
    v_perm_b32 v240, v245, v244, s4
    v_mfma_f32_16x16x32_bf16 v[84:87], a[220:223], a[172:175], v[136:139]
    v_exp_f32 v246, v106
    v_mfma_f32_16x16x32_bf16 v[84:87], a[216:219], a[168:171], v[84:87]
    buffer_load_dwordx4 v2, s[24:27], s67 offen offset:1024 sc1 lds
    v_mfma_f32_16x16x32_bf16 v[84:87], a[212:215], a[164:167], v[84:87]
    v_exp_f32 v247, v107
    v_mfma_f32_16x16x32_bf16 v[84:87], a[208:211], a[160:163], v[84:87]
    ds_read_b128 a[196:199], v252 offset:9216
    v_perm_b32 v241, v247, v246, s4
    v_mfma_f32_16x16x32_bf16 v[76:79], a[208:211], a[144:147], v[132:135]
    v_exp_f32 v248, v108
    v_mfma_f32_16x16x32_bf16 v[76:79], a[212:215], a[148:151], v[76:79]
    buffer_load_dwordx4 v2, s[24:27], s67 offen offset:2048 sc1 lds
    v_mfma_f32_16x16x32_bf16 v[76:79], a[216:219], a[152:155], v[76:79]
    v_exp_f32 v249, v109
    v_mfma_f32_16x16x32_bf16 v[76:79], a[220:223], a[156:159], v[76:79]
    ds_read_b128 a[200:203], v252 offset:10240
    v_perm_b32 v242, v249, v248, s4
    v_mfma_f32_16x16x32_bf16 v[68:71], a[220:223], a[140:143], v[128:131]
    v_exp_f32 v250, v110
    v_mfma_f32_16x16x32_bf16 v[68:71], a[216:219], a[136:139], v[68:71]
    buffer_load_dwordx4 v2, s[24:27], s67 offen offset:3072 sc1 lds
    s_waitcnt lgkmcnt(3)
    v_mfma_f32_16x16x32_bf16 v[68:71], a[212:215], a[132:135], v[68:71]
    v_exp_f32 v251, v111
    v_mfma_f32_16x16x32_bf16 v[68:71], a[208:211], a[128:131], v[68:71]
    ds_read_b128 a[204:207], v252 offset:11264
    v_perm_b32 v243, v251, v250, s4
    v_mfma_f32_16x16x32_bf16 a[80:83], v[184:187], a[224:227], a[80:83]
    v_exp_f32 v244, v112
    v_mfma_f32_16x16x32_bf16 a[80:83], v[168:171], a[240:243], a[80:83]
    ds_read_b128 a[208:211], v252 offset:12288
    v_mfma_f32_16x16x32_bf16 a[84:87], v[168:171], a[244:247], a[84:87]
    v_exp_f32 v245, v113
    v_mfma_f32_16x16x32_bf16 a[84:87], v[184:187], a[228:231], a[84:87]
    ds_read_b128 a[212:215], v252 offset:13312
    ds_read_b128 a[216:219], v252 offset:14336
    v_mfma_f32_16x16x32_bf16 a[88:91], v[184:187], a[232:235], a[88:91]
    v_exp_f32 v246, v114
    v_mfma_f32_16x16x32_bf16 a[88:91], v[168:171], a[248:251], a[88:91]
    v_exp_f32 v247, v115
    v_mfma_f32_16x16x32_bf16 a[92:95], v[168:171], a[252:255], a[92:95]
    ds_read_b128 a[220:223], v252 offset:15360
    v_mov_b64 v[196:197], v[192:193]
    v_mfma_f32_16x16x32_bf16 a[92:95], v[184:187], a[236:239], a[92:95]
    v_exp_f32 v248, v116
    v_mfma_f32_16x16x32_bf16 a[124:127], v[188:191], a[236:239], a[124:127]
    v_exp_f32 v249, v117
    v_mfma_f32_16x16x32_bf16 a[124:127], v[172:175], a[252:255], a[124:127]
    v_perm_b32 v185, v247, v246, s4
    v_perm_b32 v184, v245, v244, s4
    v_mfma_f32_16x16x32_bf16 a[120:123], v[172:175], a[248:251], a[120:123]
    v_exp_f32 v250, v118
    v_mfma_f32_16x16x32_bf16 a[120:123], v[188:191], a[232:235], a[120:123]
    v_exp_f32 v251, v119
    v_mfma_f32_16x16x32_bf16 a[116:119], v[188:191], a[228:231], a[116:119]
    v_perm_b32 v187, v251, v250, s4
    v_perm_b32 v186, v249, v248, s4
    v_mfma_f32_16x16x32_bf16 a[116:119], v[172:175], a[244:247], a[116:119]
    v_exp_f32 v244, v120
    v_mfma_f32_16x16x32_bf16 a[112:115], v[172:175], a[240:243], a[112:115]
    v_exp_f32 v245, v121
    v_mfma_f32_16x16x32_bf16 a[112:115], v[188:191], a[224:227], a[112:115]
    v_mov_b64 v[198:199], v[194:195]
    v_mfma_f32_16x16x32_bf16 a[16:19], v[176:179], a[224:227], a[16:19]
    v_exp_f32 v246, v122
    v_mfma_f32_16x16x32_bf16 a[16:19], v[152:155], a[240:243], a[16:19]
    v_exp_f32 v247, v123
    v_mfma_f32_16x16x32_bf16 a[20:23], v[152:155], a[244:247], a[20:23]
    v_perm_b32 v189, v247, v246, s4
    v_perm_b32 v188, v245, v244, s4
    v_mfma_f32_16x16x32_bf16 a[20:23], v[176:179], a[228:231], a[20:23]
    v_exp_f32 v248, v124
    v_mfma_f32_16x16x32_bf16 a[24:27], v[176:179], a[232:235], a[24:27]
    v_exp_f32 v249, v125
    v_mfma_f32_16x16x32_bf16 a[24:27], v[152:155], a[248:251], a[24:27]
    v_perm_b32 v190, v249, v248, s4
    v_mfma_f32_16x16x32_bf16 a[28:31], v[152:155], a[252:255], a[28:31]
    v_exp_f32 v250, v126
    v_mfma_f32_16x16x32_bf16 a[28:31], v[176:179], a[236:239], a[28:31]
    v_exp_f32 v251, v127
    v_mfma_f32_16x16x32_bf16 a[60:63], v[180:183], a[236:239], a[60:63]
    v_perm_b32 v191, v251, v250, s4
    v_mfma_f32_16x16x32_bf16 a[60:63], v[156:159], a[252:255], a[60:63]
    v_smfmac_f32_16x16x64_bf16 v[196:199], v[144:147], v[236:243], v255
    v_smfmac_f32_16x16x64_bf16 v[196:199], v[148:151], v[184:191], v255
    v_mfma_f32_16x16x32_bf16 a[56:59], v[156:159], a[248:251], a[56:59]
    s_waitcnt vmcnt(9) lgkmcnt(0)
    s_barrier
    v_mfma_f32_16x16x32_bf16 a[56:59], v[180:183], a[232:235], a[56:59]
    v_mfma_f32_16x16x32_bf16 a[52:55], v[180:183], a[228:231], a[52:55]
    v_mfma_f32_16x16x32_bf16 a[52:55], v[156:159], a[244:247], a[52:55]
    v_mfma_f32_16x16x32_bf16 a[48:51], v[156:159], a[240:243], a[48:51]
    s_nop 0
    v_cmp_lt_f32 vcc, s72, v196
    v_mfma_f32_16x16x32_bf16 a[48:51], v[180:183], a[224:227], a[48:51]
    s_cbranch_vccnz L_rare_r7_3
L_join_r7_3:
    v_mfma_f32_16x16x32_bf16 v[96:99], a[192:195], a[128:131], v[128:131]
    v_exp_f32 v244, v64
    v_mfma_f32_16x16x32_bf16 v[96:99], a[196:199], a[132:135], v[96:99]
    ds_read_b128 a[224:227], v14 offset:49152
    s_waitcnt vmcnt(4)
    v_mfma_f32_16x16x32_bf16 v[96:99], a[200:203], a[136:139], v[96:99]
    v_exp_f32 v245, v65
    v_mfma_f32_16x16x32_bf16 v[96:99], a[204:207], a[140:143], v[96:99]
    ds_read_b128 a[228:231], v253 offset:49152
    v_perm_b32 v160, v245, v244, s4
    v_mfma_f32_16x16x32_bf16 v[104:107], a[204:207], a[156:159], v[132:135]
    v_exp_f32 v246, v66
    v_mfma_f32_16x16x32_bf16 v[104:107], a[200:203], a[152:155], v[104:107]
    ds_read_b128 a[232:235], v254 offset:49152
    v_cmp_eq_u32 vcc, 0x101, v213
    v_mfma_f32_16x16x32_bf16 v[104:107], a[196:199], a[148:151], v[104:107]
    v_exp_f32 v247, v67
    v_mfma_f32_16x16x32_bf16 v[104:107], a[192:195], a[144:147], v[104:107]
    ds_read_b128 a[236:239], v234 offset:49152
    v_perm_b32 v161, v247, v246, s4
    v_mfma_f32_16x16x32_bf16 v[112:115], a[192:195], a[160:163], v[136:139]
    v_exp_f32 v248, v68
    v_mfma_f32_16x16x32_bf16 v[112:115], a[196:199], a[164:167], v[112:115]
L_stop9:
    s_cbranch_execz L_tour_end
    ds_read_b128 a[240:243], v14 offset:53248
    s_nop 0
    v_mfma_f32_16x16x32_bf16 v[112:115], a[200:203], a[168:171], v[112:115]
    v_exp_f32 v249, v69
    v_mfma_f32_16x16x32_bf16 v[112:115], a[204:207], a[172:175], v[112:115]
    ds_read_b128 a[244:247], v253 offset:53248
    v_perm_b32 v162, v249, v248, s4
    v_mfma_f32_16x16x32_bf16 v[120:123], a[204:207], a[188:191], v[140:143]
    v_exp_f32 v250, v70
    v_mfma_f32_16x16x32_bf16 v[120:123], a[200:203], a[184:187], v[120:123]
    ds_read_b128 a[248:251], v254 offset:53248
    s_add_u32 m0, s73, 8192
    v_mfma_f32_16x16x32_bf16 v[120:123], a[196:199], a[180:183], v[120:123]
    v_exp_f32 v251, v71
    v_mfma_f32_16x16x32_bf16 v[120:123], a[192:195], a[176:179], v[120:123]
    ds_read_b128 a[252:255], v234 offset:53248
    v_perm_b32 v163, v251, v250, s4
    v_mfma_f32_16x16x32_bf16 v[124:127], a[208:211], a[176:179], v[140:143]
    v_exp_f32 v244, v72
    v_mfma_f32_16x16x32_bf16 v[124:127], a[212:215], a[180:183], v[124:127]
    buffer_load_dwordx4 v2, s[24:27], s68 offen offset:0 sc1 lds
    v_mfma_f32_16x16x32_bf16 v[124:127], a[216:219], a[184:187], v[124:127]
    v_exp_f32 v245, v73
    v_mfma_f32_16x16x32_bf16 v[124:127], a[220:223], a[188:191], v[124:127]
    ds_read_b128 a[192:195], v252 offset:16384
    v_perm_b32 v164, v245, v244, s4
    v_mfma_f32_16x16x32_bf16 v[116:119], a[220:223], a[172:175], v[136:139]
    v_exp_f32 v246, v74
    v_mfma_f32_16x16x32_bf16 v[116:119], a[216:219], a[168:171], v[116:119]
    buffer_load_dwordx4 v2, s[24:27], s68 offen offset:1024 sc1 lds
    v_mfma_f32_16x16x32_bf16 v[116:119], a[212:215], a[164:167], v[116:119]
    v_exp_f32 v247, v75
    v_mfma_f32_16x16x32_bf16 v[116:119], a[208:211], a[160:163], v[116:119]
    ds_read_b128 a[196:199], v252 offset:17408
    v_perm_b32 v165, v247, v246, s4
    v_mfma_f32_16x16x32_bf16 v[108:111], a[208:211], a[144:147], v[132:135]
    v_exp_f32 v248, v76
    v_mfma_f32_16x16x32_bf16 v[108:111], a[212:215], a[148:151], v[108:111]
    buffer_load_dwordx4 v2, s[24:27], s68 offen offset:2048 sc1 lds
    v_mfma_f32_16x16x32_bf16 v[108:111], a[216:219], a[152:155], v[108:111]
    v_exp_f32 v249, v77
    v_mfma_f32_16x16x32_bf16 v[108:111], a[220:223], a[156:159], v[108:111]
    ds_read_b128 a[200:203], v252 offset:18432
    v_perm_b32 v166, v249, v248, s4
    v_mfma_f32_16x16x32_bf16 v[100:103], a[220:223], a[140:143], v[128:131]
    v_exp_f32 v250, v78
    v_mfma_f32_16x16x32_bf16 v[100:103], a[216:219], a[136:139], v[100:103]
    buffer_load_dwordx4 v2, s[24:27], s68 offen offset:3072 sc1 lds
    s_waitcnt lgkmcnt(3)
    v_mfma_f32_16x16x32_bf16 v[100:103], a[212:215], a[132:135], v[100:103]
    v_exp_f32 v251, v79
    v_mfma_f32_16x16x32_bf16 v[100:103], a[208:211], a[128:131], v[100:103]
    ds_read_b128 a[204:207], v252 offset:19456
    v_perm_b32 v167, v251, v250, s4
    v_mfma_f32_16x16x32_bf16 a[64:67], v[168:171], a[224:227], a[64:67]
    v_exp_f32 v244, v80
    v_mfma_f32_16x16x32_bf16 a[64:67], v[184:187], a[240:243], a[64:67]
    ds_read_b128 a[208:211], v252 offset:20480
    v_mfma_f32_16x16x32_bf16 a[68:71], v[184:187], a[244:247], a[68:71]
    v_exp_f32 v245, v81
    v_mfma_f32_16x16x32_bf16 a[68:71], v[168:171], a[228:231], a[68:71]
    ds_read_b128 a[212:215], v252 offset:21504
    ds_read_b128 a[216:219], v252 offset:22528
    v_mfma_f32_16x16x32_bf16 a[72:75], v[168:171], a[232:235], a[72:75]
    v_exp_f32 v246, v82
    v_mfma_f32_16x16x32_bf16 a[72:75], v[184:187], a[248:251], a[72:75]
    v_exp_f32 v247, v83
    v_mfma_f32_16x16x32_bf16 a[76:79], v[184:187], a[252:255], a[76:79]
    ds_read_b128 a[220:223], v252 offset:23552
    v_mov_b64 v[192:193], v[196:197]
    v_mfma_f32_16x16x32_bf16 a[76:79], v[168:171], a[236:239], a[76:79]
    v_exp_f32 v248, v84
    v_mfma_f32_16x16x32_bf16 a[108:111], v[172:175], a[236:239], a[108:111]
    v_exp_f32 v249, v85
    v_mfma_f32_16x16x32_bf16 a[108:111], v[188:191], a[252:255], a[108:111]
    v_perm_b32 v169, v247, v246, s4
    v_perm_b32 v168, v245, v244, s4
    v_mfma_f32_16x16x32_bf16 a[104:107], v[188:191], a[248:251], a[104:107]
    v_exp_f32 v250, v86
    v_mfma_f32_16x16x32_bf16 a[104:107], v[172:175], a[232:235], a[104:107]
    v_exp_f32 v251, v87
    v_mfma_f32_16x16x32_bf16 a[100:103], v[172:175], a[228:231], a[100:103]
    v_perm_b32 v171, v251, v250, s4
    v_perm_b32 v170, v249, v248, s4
    v_mfma_f32_16x16x32_bf16 a[100:103], v[188:191], a[244:247], a[100:103]
    v_exp_f32 v244, v88
    v_mfma_f32_16x16x32_bf16 a[96:99], v[188:191], a[240:243], a[96:99]
    v_exp_f32 v245, v89
    v_mfma_f32_16x16x32_bf16 a[96:99], v[172:175], a[224:227], a[96:99]
    v_mov_b64 v[194:195], v[198:199]
    v_mfma_f32_16x16x32_bf16 a[0:3], v[152:155], a[224:227], a[0:3]
    v_exp_f32 v246, v90
    v_mfma_f32_16x16x32_bf16 a[0:3], v[236:239], a[240:243], a[0:3]
    v_exp_f32 v247, v91
    v_mfma_f32_16x16x32_bf16 a[4:7], v[236:239], a[244:247], a[4:7]
    v_perm_b32 v173, v247, v246, s4
    v_perm_b32 v172, v245, v244, s4
    v_mfma_f32_16x16x32_bf16 a[4:7], v[152:155], a[228:231], a[4:7]
    v_exp_f32 v248, v92
    v_mfma_f32_16x16x32_bf16 a[8:11], v[152:155], a[232:235], a[8:11]
    v_exp_f32 v249, v93
    v_mfma_f32_16x16x32_bf16 a[8:11], v[236:239], a[248:251], a[8:11]
    v_perm_b32 v174, v249, v248, s4
    v_mfma_f32_16x16x32_bf16 a[12:15], v[236:239], a[252:255], a[12:15]
    v_exp_f32 v250, v94
    v_mfma_f32_16x16x32_bf16 a[12:15], v[152:155], a[236:239], a[12:15]
    v_exp_f32 v251, v95
    v_mfma_f32_16x16x32_bf16 a[44:47], v[156:159], a[236:239], a[44:47]
    v_perm_b32 v175, v251, v250, s4
    v_mfma_f32_16x16x32_bf16 a[44:47], v[240:243], a[252:255], a[44:47]
    s_cmp_lg_u64 vcc, 0xffff
    s_cbranch_scc1 L_verdict
L_verdict_ret:
    v_smfmac_f32_16x16x64_bf16 v[192:195], v[144:147], v[160:167], v255
    v_smfmac_f32_16x16x64_bf16 v[192:195], v[148:151], v[168:175], v255
    v_mfma_f32_16x16x32_bf16 a[40:43], v[240:243], a[248:251], a[40:43]
    s_waitcnt vmcnt(9) lgkmcnt(0)
    s_barrier
    v_mfma_f32_16x16x32_bf16 a[40:43], v[156:159], a[232:235], a[40:43]
    v_mfma_f32_16x16x32_bf16 a[36:39], v[156:159], a[228:231], a[36:39]
    v_mfma_f32_16x16x32_bf16 a[36:39], v[240:243], a[244:247], a[36:39]
    v_mfma_f32_16x16x32_bf16 a[32:35], v[240:243], a[240:243], a[32:35]
    s_nop 0
    v_cmp_lt_f32_e64 vcc, s72, v192
    v_mfma_f32_16x16x32_bf16 a[32:35], v[156:159], a[224:227], a[32:35]
    s_cbranch_vccnz L_rare_r7_4
L_join_r7_4:
    v_mfma_f32_16x16x32_bf16 v[64:67], a[192:195], a[128:131], v[128:131]
    ds_read_b128 a[224:227], v14 offset:57344
    v_mov_b64 v[196:197], v[192:193]
    v_mfma_f32_16x16x32_bf16 v[64:67], a[196:199], a[132:135], v[64:67]
    v_exp_f32 v244, v96
    v_mfma_f32_16x16x32_bf16 v[64:67], a[200:203], a[136:139], v[64:67]
    v_exp_f32 v245, v97
    v_mfma_f32_16x16x32_bf16 v[64:67], a[204:207], a[140:143], v[64:67]
    ds_read_b128 a[240:243], v14 offset:61440
    v_mov_b64 v[198:199], v[194:195]
    v_mfma_f32_16x16x32_bf16 v[72:75], a[204:207], a[156:159], v[132:135]
    v_exp_f32 v246, v98
    v_mfma_f32_16x16x32_bf16 v[72:75], a[200:203], a[152:155], v[72:75]
    v_exp_f32 v247, v99
    v_mfma_f32_16x16x32_bf16 v[72:75], a[196:199], a[148:151], v[72:75]
    ds_read_b128 a[244:247], v253 offset:61440
    v_perm_b32 v176, v245, v244, s4
    v_mfma_f32_16x16x32_bf16 v[72:75], a[192:195], a[144:147], v[72:75]
    v_exp_f32 v248, v100
    v_mfma_f32_16x16x32_bf16 v[76:79], a[208:211], a[144:147], v[132:135]
    v_exp_f32 v249, v101
    v_mfma_f32_16x16x32_bf16 v[76:79], a[212:215], a[148:151], v[76:79]
    ds_read_b128 a[228:231], v253 offset:57344
    v_perm_b32 v177, v247, v246, s4
    v_mfma_f32_16x16x32_bf16 v[76:79], a[216:219], a[152:155], v[76:79]
    v_exp_f32 v250, v102
    v_mfma_f32_16x16x32_bf16 v[76:79], a[220:223], a[156:159], v[76:79]
    v_exp_f32 v251, v103
    v_mfma_f32_16x16x32_bf16 v[68:71], a[220:223], a[140:143], v[128:131]
    ds_read_b128 a[232:235], v254 offset:57344
    v_perm_b32 v178, v249, v248, s4
    v_mfma_f32_16x16x32_bf16 v[68:71], a[216:219], a[136:139], v[68:71]
    v_exp_f32 v244, v104
    v_mfma_f32_16x16x32_bf16 v[68:71], a[212:215], a[132:135], v[68:71]
    ds_read_b128 a[248:251], v254 offset:61440
    ds_read_b128 a[252:255], v234 offset:61440
    v_mfma_f32_16x16x32_bf16 v[68:71], a[208:211], a[128:131], v[68:71]
    v_exp_f32 v245, v105
    s_waitcnt lgkmcnt(3)
    v_mfma_f32_16x16x32_bf16 a[16:19], v[236:239], a[224:227], a[16:19]
    ds_read_b128 a[236:239], v234 offset:57344
    v_perm_b32 v179, v251, v250, s4
    v_mfma_f32_16x16x32_bf16 a[16:19], v[160:163], a[240:243], a[16:19]
    v_exp_f32 v246, v106
    v_mfma_f32_16x16x32_bf16 a[20:23], v[160:163], a[244:247], a[20:23]
    v_exp_f32 v247, v107
    v_mfma_f32_16x16x32_bf16 a[20:23], v[236:239], a[228:231], a[20:23]
    ds_read_b128 a[192:195], v252 offset:24576
    v_perm_b32 v180, v245, v244, s4
    s_waitcnt lgkmcnt(2)
    v_mfma_f32_16x16x32_bf16 a[24:27], v[236:239], a[232:235], a[24:27]
    v_exp_f32 v248, v108
    v_mfma_f32_16x16x32_bf16 a[24:27], v[160:163], a[248:251], a[24:27]
    v_exp_f32 v249, v109
    v_mfma_f32_16x16x32_bf16 a[28:31], v[160:163], a[252:255], a[28:31]
    ds_read_b128 a[196:199], v252 offset:25600
    v_perm_b32 v181, v247, v246, s4
    s_waitcnt lgkmcnt(2)
    v_mfma_f32_16x16x32_bf16 a[28:31], v[236:239], a[236:239], a[28:31]
    v_exp_f32 v250, v110
    v_mfma_f32_16x16x32_bf16 a[60:63], v[240:243], a[236:239], a[60:63]
    v_exp_f32 v251, v111
    v_mfma_f32_16x16x32_bf16 a[60:63], v[164:167], a[252:255], a[60:63]
    v_perm_b32 v182, v249, v248, s4
    v_perm_b32 v183, v251, v250, s4
    v_mfma_f32_16x16x32_bf16 a[56:59], v[164:167], a[248:251], a[56:59]
    ds_read_b128 a[200:203], v252 offset:26624
    ds_read_b128 a[204:207], v252 offset:27648
    v_smfmac_f32_16x16x64_bf16 v[196:199], v[144:147], v[176:183], v255
    ds_read_b128 a[208:211], v252 offset:28672
    ds_read_b128 a[212:215], v252 offset:29696
    v_mfma_f32_16x16x32_bf16 a[56:59], v[240:243], a[232:235], a[56:59]
    ds_read_b128 a[216:219], v252 offset:30720
    ds_read_b128 a[220:223], v252 offset:31744
    v_mfma_f32_16x16x32_bf16 a[52:55], v[240:243], a[228:231], a[52:55]
    s_waitcnt vmcnt(4)
    s_barrier
    v_mfma_f32_16x16x32_bf16 a[52:55], v[164:167], a[244:247], a[52:55]
    v_lshrrev_b32 v17, 8, v1
    v_and_b32 v16, 0xf0, v1
    v_mfma_f32_16x16x32_bf16 a[48:51], v[164:167], a[240:243], a[48:51]
    v_cmp_lt_f32_e64 vcc, s72, v196
    v_lshl_add_u32 v16, v17, 10, v16
    v_mfma_f32_16x16x32_bf16 a[48:51], v[240:243], a[224:227], a[48:51]
    s_cbranch_vccnz L_rare_t0
L_join_t0:
    v_lshl_add_u32 v17, v17, 4, s91
    s_waitcnt lgkmcnt(2)
    v_mfma_f32_16x16x32_bf16 v[96:99], a[192:195], a[128:131], v[128:131]
    ds_read_b128 a[224:227], v14 offset:32768
    v_mov_b64 v[192:193], v[196:197]
    v_mfma_f32_16x16x32_bf16 v[96:99], a[196:199], a[132:135], v[96:99]
    v_exp_f32 v244, v64
    v_mfma_f32_16x16x32_bf16 v[96:99], a[200:203], a[136:139], v[96:99]
    v_exp_f32 v245, v65
    v_mfma_f32_16x16x32_bf16 v[96:99], a[204:207], a[140:143], v[96:99]
    ds_read_b128 a[240:243], v14 offset:36864
    v_mov_b64 v[194:195], v[198:199]
    v_mfma_f32_16x16x32_bf16 v[104:107], a[204:207], a[156:159], v[132:135]
    v_exp_f32 v246, v66
    v_mfma_f32_16x16x32_bf16 v[104:107], a[200:203], a[152:155], v[104:107]
    v_exp_f32 v247, v67
    v_mfma_f32_16x16x32_bf16 v[104:107], a[196:199], a[148:151], v[104:107]
    ds_read_b128 a[244:247], v253 offset:36864
    v_perm_b32 v152, v245, v244, s4
    v_mfma_f32_16x16x32_bf16 v[104:107], a[192:195], a[144:147], v[104:107]
    v_exp_f32 v248, v68
    v_mfma_f32_16x16x32_bf16 v[108:111], a[208:211], a[144:147], v[132:135]
    v_exp_f32 v249, v69
    v_mfma_f32_16x16x32_bf16 v[108:111], a[212:215], a[148:151], v[108:111]
    ds_read_b128 a[228:231], v253 offset:32768
    v_perm_b32 v153, v247, v246, s4
    s_waitcnt lgkmcnt(2)
    v_mfma_f32_16x16x32_bf16 v[108:111], a[216:219], a[152:155], v[108:111]
    v_exp_f32 v250, v70
    v_mfma_f32_16x16x32_bf16 v[108:111], a[220:223], a[156:159], v[108:111]
    v_exp_f32 v251, v71
    v_mfma_f32_16x16x32_bf16 v[100:103], a[220:223], a[140:143], v[128:131]
    ds_read_b128 a[232:235], v254 offset:32768
    v_perm_b32 v154, v249, v248, s4
    v_mfma_f32_16x16x32_bf16 v[100:103], a[216:219], a[136:139], v[100:103]
    v_exp_f32 v244, v72
    v_mfma_f32_16x16x32_bf16 v[100:103], a[212:215], a[132:135], v[100:103]
    ds_read_b128 a[248:251], v254 offset:36864
    ds_read_b128 a[252:255], v234 offset:36864
    v_mfma_f32_16x16x32_bf16 v[100:103], a[208:211], a[128:131], v[100:103]
    v_exp_f32 v245, v73
    v_mfma_f32_16x16x32_bf16 a[0:3], v[160:163], a[224:227], a[0:3]
    ds_read_b128 a[236:239], v234 offset:32768
    s_waitcnt vmcnt(0)
    s_barrier
    v_mfma_f32_16x16x32_bf16 a[0:3], v[176:179], a[240:243], a[0:3]
    ds_read_b128 a[192:195], v14 offset:40960
    v_perm_b32 v155, v251, v250, s4
    s_waitcnt lgkmcnt(4)
    v_mfma_f32_16x16x32_bf16 a[4:7], v[176:179], a[244:247], a[4:7]
    v_exp_f32 v246, v74
    v_mfma_f32_16x16x32_bf16 a[4:7], v[160:163], a[228:231], a[4:7]
    v_exp_f32 v247, v75
    v_mfma_f32_16x16x32_bf16 a[8:11], v[160:163], a[232:235], a[8:11]
    ds_read_b128 a[208:211], v14 offset:45056
    v_perm_b32 v156, v245, v244, s4
    s_waitcnt lgkmcnt(3)
    v_mfma_f32_16x16x32_bf16 a[8:11], v[176:179], a[248:251], a[8:11]
    v_exp_f32 v248, v76
    v_mfma_f32_16x16x32_bf16 a[12:15], v[176:179], a[252:255], a[12:15]
    v_exp_f32 v249, v77
    s_waitcnt lgkmcnt(1)
    v_mfma_f32_16x16x32_bf16 a[12:15], v[160:163], a[236:239], a[12:15]
    ds_read_b128 a[212:215], v253 offset:45056
    v_perm_b32 v157, v247, v246, s4
    v_mfma_f32_16x16x32_bf16 a[44:47], v[164:167], a[236:239], a[44:47]
    v_exp_f32 v250, v78
    v_mfma_f32_16x16x32_bf16 a[44:47], v[180:183], a[252:255], a[44:47]
    v_exp_f32 v251, v79
    v_perm_b32 v158, v249, v248, s4
    v_perm_b32 v159, v251, v250, s4
    v_mfma_f32_16x16x32_bf16 a[40:43], v[180:183], a[248:251], a[40:43]
    ds_read_b128 a[196:199], v253 offset:40960
    ds_read_b128 a[200:203], v254 offset:40960
    v_smfmac_f32_16x16x64_bf16 v[192:195], v[144:147], v[152:159], v255
    ds_read_b128 a[216:219], v254 offset:45056
    ds_read_b128 a[220:223], v234 offset:45056
    v_mfma_f32_16x16x32_bf16 a[40:43], v[164:167], a[232:235], a[40:43]
    ds_read_b128 a[204:207], v234 offset:40960
    v_lshrrev_b32_e64 v18, 2, v1
    v_mfma_f32_16x16x32_bf16 a[36:39], v[164:167], a[228:231], a[36:39]
    v_add_u32_e64 v18, s91, v18
    s_lshl_b32 s5, s97, 2
    v_mfma_f32_16x16x32_bf16 a[36:39], v[180:183], a[244:247], a[36:39]
    s_add_u32 s5, s5, s96
    s_lshl_b32 s5, s5, 14
    v_mfma_f32_16x16x32_bf16 a[32:35], v[180:183], a[240:243], a[32:35]
    v_cmp_lt_f32_e64 vcc, s72, v192
    s_add_u32 s5, s5, s90
    v_mfma_f32_16x16x32_bf16 a[32:35], v[164:167], a[224:227], a[32:35]
    s_cbranch_vccnz L_rare_t1
L_join_t1:
    s_xor_b32 s6, s2, s96
    v_mfma_f32_16x16x32_bf16 a[16:19], v[176:179], a[192:195], a[16:19]
    ds_read_b128 a[224:227], v14 offset:8192
    v_mov_b64 v[196:197], v[192:193]
    v_exp_f32 v244, v96
    s_waitcnt lgkmcnt(1)
    v_mfma_f32_16x16x32_bf16 a[16:19], v[152:155], a[208:211], a[16:19]
    ds_read_b128 a[228:231], v253 offset:8192
    v_exp_f32 v245, v97
    v_mov_b64 v[198:199], v[194:195]
    v_mfma_f32_16x16x32_bf16 a[20:23], v[152:155], a[212:215], a[20:23]
    ds_read_b128 a[232:235], v254 offset:8192
    ds_read_b128 a[236:239], v234 offset:8192
    v_exp_f32 v246, v98
    v_mfma_f32_16x16x32_bf16 a[20:23], v[176:179], a[196:199], a[20:23]
    v_exp_f32 v247, v99
    v_perm_b32 v236, v245, v244, s4
    v_mfma_f32_16x16x32_bf16 a[24:27], v[176:179], a[200:203], a[24:27]
    v_exp_f32 v248, v100
    v_mfma_f32_16x16x32_bf16 a[24:27], v[152:155], a[216:219], a[24:27]
    v_exp_f32 v249, v101
    v_perm_b32 v237, v247, v246, s4
    v_mfma_f32_16x16x32_bf16 a[28:31], v[152:155], a[220:223], a[28:31]
    v_exp_f32 v250, v102
    v_mfma_f32_16x16x32_bf16 a[28:31], v[176:179], a[204:207], a[28:31]
    v_exp_f32 v251, v103
    v_perm_b32 v238, v249, v248, s4
    v_mfma_f32_16x16x32_bf16 a[60:63], v[180:183], a[204:207], a[60:63]
    v_exp_f32 v244, v104
    v_mfma_f32_16x16x32_bf16 a[60:63], v[156:159], a[220:223], a[60:63]
    v_exp_f32 v245, v105
    v_perm_b32 v239, v251, v250, s4
    v_mfma_f32_16x16x32_bf16 a[56:59], v[156:159], a[216:219], a[56:59]
    v_exp_f32 v246, v106
    v_mfma_f32_16x16x32_bf16 a[56:59], v[180:183], a[200:203], a[56:59]
    v_exp_f32 v247, v107
    v_perm_b32 v240, v245, v244, s4
    v_mfma_f32_16x16x32_bf16 a[52:55], v[180:183], a[196:199], a[52:55]
    v_exp_f32 v248, v108
    v_mfma_f32_16x16x32_bf16 a[52:55], v[156:159], a[212:215], a[52:55]
    v_exp_f32 v249, v109
    v_perm_b32 v241, v247, v246, s4
    v_mfma_f32_16x16x32_bf16 a[48:51], v[156:159], a[208:211], a[48:51]
    v_exp_f32 v250, v110
    v_mfma_f32_16x16x32_bf16 a[48:51], v[180:183], a[192:195], a[48:51]
    v_exp_f32 v251, v111
    v_perm_b32 v242, v249, v248, s4
    s_waitcnt lgkmcnt(0)
    v_mfma_f32_16x16x32_bf16 a[0:3], v[152:155], a[224:227], a[0:3]
    ds_read_b128 a[192:195], v14 offset:0
    ds_read_b128 a[208:211], v14 offset:4096
    ds_read_b128 a[196:199], v253 offset:0
    v_perm_b32 v243, v251, v250, s4
    v_mfma_f32_16x16x32_bf16 a[4:7], v[152:155], a[228:231], a[4:7]
    ds_read_b128 a[212:215], v253 offset:4096
    ds_read_b128 a[200:203], v254 offset:0
    ds_read_b128 a[216:219], v254 offset:4096
    ds_read_b128 a[204:207], v234 offset:0
    v_mfma_f32_16x16x32_bf16 a[8:11], v[152:155], a[232:235], a[8:11]
    ds_read_b128 a[220:223], v234 offset:4096
    s_and_b32 s6, s6, 3
    v_smfmac_f32_16x16x64_bf16 v[196:199], v[144:147], v[236:243], v255
    s_lshl_b32 s6, s6, 12
    s_add_u32 s5, s5, s6
    v_mfma_f32_16x16x32_bf16 a[12:15], v[152:155], a[236:239], a[12:15]
    v_sub_f32_e64 v232, 0, s63
    v_sub_f32_e64 v233, 0, s63
    v_mfma_f32_16x16x32_bf16 a[44:47], v[156:159], a[236:239], a[44:47]
    v_mfma_f32_16x16x32_bf16 a[40:43], v[156:159], a[232:235], a[40:43]
    v_mfma_f32_16x16x32_bf16 a[36:39], v[156:159], a[228:231], a[36:39]
    v_cmp_lt_f32 vcc, s72, v196
    v_mfma_f32_16x16x32_bf16 a[32:35], v[156:159], a[224:227], a[32:35]
    s_cbranch_vccnz L_rare_t2
L_join_t2:
    s_waitcnt lgkmcnt(0)
    v_mfma_f32_16x16x32_bf16 a[0:3], v[236:239], a[192:195], a[0:3]
    ds_read_b128 a[224:227], v252 offset:16384
    ds_read_b128 a[228:231], v252 offset:17408
    v_mov_b32 v28, v196
    v_mov_b32 v30, v196
    v_mov_b32 v29, v197
    v_mov_b32 v31, v197
    v_permlane16_swap_b32 v28, v30
    s_nop 0
    v_permlane16_swap_b32 v29, v31
    v_add_f32 v28, v28, v30
    v_add_f32 v29, v29, v31
    v_rcp_f32 v28, v28
    v_rcp_f32 v29, v29
    ds_write_b32 v18, v28 offset:0
    ds_write_b32 v18, v29 offset:256
    v_mfma_f32_16x16x32_bf16 a[16:19], v[236:239], a[208:211], a[16:19]
    ds_read_b128 a[232:235], v252 offset:18432
    ds_read_b128 a[236:239], v252 offset:19456
    ds_read_b128 v[128:131], v17 offset:0
    ds_read_b128 v[132:135], v17 offset:256
    v_mfma_f32_16x16x32_bf16 a[4:7], v[236:239], a[196:199], a[4:7]
    ds_read_b128 a[240:243], v252 offset:20480
    ds_read_b128 a[244:247], v252 offset:21504
    v_mfma_f32_16x16x32_bf16 a[20:23], v[236:239], a[212:215], a[20:23]
    ds_read_b128 a[248:251], v252 offset:22528
    ds_read_b128 a[252:255], v252 offset:23552
    v_mfma_f32_16x16x32_bf16 a[8:11], v[236:239], a[200:203], a[8:11]
    v_mfma_f32_16x16x32_bf16 a[24:27], v[236:239], a[216:219], a[24:27]
    v_accvgpr_read_b32 v32, a0
    v_accvgpr_read_b32 v33, a1
    v_accvgpr_read_b32 v34, a2
    v_accvgpr_read_b32 v35, a3
    v_accvgpr_read_b32 v36, a16
    v_accvgpr_read_b32 v37, a17
    v_accvgpr_read_b32 v38, a18
    v_accvgpr_read_b32 v39, a19
    s_waitcnt lgkmcnt(5)
    v_pk_fma_f32 v[32:33], v[32:33], v[128:129], v[232:233]
    v_pk_fma_f32 v[34:35], v[34:35], v[130:131], v[232:233]
    v_pk_fma_f32 v[36:37], v[36:37], v[128:129], v[232:233]
    v_pk_fma_f32 v[38:39], v[38:39], v[130:131], v[232:233]
    v_cvt_pk_bf16_f32 v64, v32, v36
    v_cvt_pk_bf16_f32 v68, v33, v37
    v_cvt_pk_bf16_f32 v72, v34, v38
    v_mfma_f32_16x16x32_bf16 a[12:15], v[236:239], a[204:207], a[12:15]
    v_cvt_pk_bf16_f32 v76, v35, v39
    v_mfma_f32_16x16x32_bf16 a[28:31], v[236:239], a[220:223], a[28:31]
    v_accvgpr_read_b32 v44, a4
    v_accvgpr_read_b32 v45, a5
    v_accvgpr_read_b32 v46, a6
    v_accvgpr_read_b32 v47, a7
    v_accvgpr_read_b32 v48, a20
    v_accvgpr_read_b32 v49, a21
    v_accvgpr_read_b32 v50, a22
    v_accvgpr_read_b32 v51, a23
    v_pk_fma_f32 v[44:45], v[44:45], v[128:129], v[232:233]
    v_pk_fma_f32 v[46:47], v[46:47], v[130:131], v[232:233]
    v_pk_fma_f32 v[48:49], v[48:49], v[128:129], v[232:233]
    v_pk_fma_f32 v[50:51], v[50:51], v[130:131], v[232:233]
    v_cvt_pk_bf16_f32 v65, v44, v48
    v_cvt_pk_bf16_f32 v69, v45, v49
    v_cvt_pk_bf16_f32 v73, v46, v50
    v_cvt_pk_bf16_f32 v77, v47, v51
    v_mfma_f32_16x16x32_bf16 a[32:35], v[240:243], a[192:195], a[32:35]
    v_mfma_f32_16x16x32_bf16 a[48:51], v[240:243], a[208:211], a[48:51]
    v_accvgpr_read_b32 v200, a8
    v_accvgpr_read_b32 v201, a9
    v_accvgpr_read_b32 v202, a10
    v_accvgpr_read_b32 v203, a11
    v_accvgpr_read_b32 v204, a24
    v_accvgpr_read_b32 v205, a25
    v_accvgpr_read_b32 v206, a26
    v_accvgpr_read_b32 v207, a27
    v_pk_fma_f32 v[200:201], v[200:201], v[128:129], v[232:233]
    v_pk_fma_f32 v[202:203], v[202:203], v[130:131], v[232:233]
    v_pk_fma_f32 v[204:205], v[204:205], v[128:129], v[232:233]
    v_pk_fma_f32 v[206:207], v[206:207], v[130:131], v[232:233]
    v_cvt_pk_bf16_f32 v66, v200, v204
    v_cvt_pk_bf16_f32 v70, v201, v205
    v_cvt_pk_bf16_f32 v74, v202, v206
    v_cvt_pk_bf16_f32 v78, v203, v207
    v_mfma_f32_16x16x32_bf16 a[36:39], v[240:243], a[196:199], a[36:39]
    v_mfma_f32_16x16x32_bf16 a[52:55], v[240:243], a[212:215], a[52:55]
    v_accvgpr_read_b32 v212, a12
    v_accvgpr_read_b32 v213, a13
    v_accvgpr_read_b32 v214, a14
    v_accvgpr_read_b32 v215, a15
    v_accvgpr_read_b32 v216, a28
    v_accvgpr_read_b32 v217, a29
    v_accvgpr_read_b32 v218, a30
    v_accvgpr_read_b32 v219, a31
    v_pk_fma_f32 v[212:213], v[212:213], v[128:129], v[232:233]
    v_pk_fma_f32 v[214:215], v[214:215], v[130:131], v[232:233]
    v_pk_fma_f32 v[216:217], v[216:217], v[128:129], v[232:233]
    v_pk_fma_f32 v[218:219], v[218:219], v[130:131], v[232:233]
    v_cvt_pk_bf16_f32 v67, v212, v216
    v_cvt_pk_bf16_f32 v71, v213, v217
    v_cvt_pk_bf16_f32 v75, v214, v218
    v_cvt_pk_bf16_f32 v79, v215, v219
    v_mfma_f32_16x16x32_bf16 a[40:43], v[240:243], a[200:203], a[40:43]
    s_mov_b32 s6, s5
    s_xor_b32 s5, s5, 4096
    v_mfma_f32_16x16x32_bf16 a[56:59], v[240:243], a[216:219], a[56:59]
    buffer_store_dwordx4 v[64:67], v16, s[20:23], s6 offen offset:0 sc1
    v_accvgpr_read_b32 v32, a32
    v_accvgpr_read_b32 v33, a33
    v_accvgpr_read_b32 v34, a34
    v_accvgpr_read_b32 v35, a35
    v_accvgpr_read_b32 v36, a48
    v_accvgpr_read_b32 v37, a49
    v_accvgpr_read_b32 v38, a50
    v_accvgpr_read_b32 v39, a51
    s_waitcnt lgkmcnt(4)
    v_pk_fma_f32 v[32:33], v[32:33], v[132:133], v[232:233]
    v_pk_fma_f32 v[34:35], v[34:35], v[134:135], v[232:233]
    v_pk_fma_f32 v[36:37], v[36:37], v[132:133], v[232:233]
    v_pk_fma_f32 v[38:39], v[38:39], v[134:135], v[232:233]
    v_cvt_pk_bf16_f32 v96, v32, v36
    v_cvt_pk_bf16_f32 v100, v33, v37
    v_mfma_f32_16x16x32_bf16 a[44:47], v[240:243], a[204:207], a[44:47]
    v_cvt_pk_bf16_f32 v104, v34, v38
    v_cvt_pk_bf16_f32 v108, v35, v39
    v_mfma_f32_16x16x32_bf16 a[60:63], v[240:243], a[220:223], a[60:63]
    v_accvgpr_read_b32 v44, a36
    v_accvgpr_read_b32 v45, a37
    v_accvgpr_read_b32 v46, a38
    v_accvgpr_read_b32 v47, a39
    v_accvgpr_read_b32 v48, a52
    v_accvgpr_read_b32 v49, a53
    v_accvgpr_read_b32 v50, a54
    v_accvgpr_read_b32 v51, a55
    v_pk_fma_f32 v[44:45], v[44:45], v[132:133], v[232:233]
    v_pk_fma_f32 v[46:47], v[46:47], v[134:135], v[232:233]
    v_pk_fma_f32 v[48:49], v[48:49], v[132:133], v[232:233]
    v_pk_fma_f32 v[50:51], v[50:51], v[134:135], v[232:233]
    v_cvt_pk_bf16_f32 v97, v44, v48
    v_cvt_pk_bf16_f32 v101, v45, v49
    v_cvt_pk_bf16_f32 v105, v46, v50
    v_cvt_pk_bf16_f32 v109, v47, v51
    s_waitcnt lgkmcnt(0)
    v_mfma_f32_16x16x32_bf16 v[80:83], a[224:227], a[160:163], v[136:139]
    buffer_store_dwordx4 v[68:71], v16, s[20:23], s6 offen offset:256 sc1
    ds_read_b128 a[192:195], v14 offset:57344
    v_mfma_f32_16x16x32_bf16 v[80:83], a[228:231], a[164:167], v[80:83]
    ds_read_b128 a[208:211], v14 offset:61440
    v_mov_b64 v[192:193], v[196:197]
    v_accvgpr_read_b32 v200, a40
    v_accvgpr_read_b32 v201, a41
    v_accvgpr_read_b32 v202, a42
    v_accvgpr_read_b32 v203, a43
    v_accvgpr_read_b32 v204, a56
    v_accvgpr_read_b32 v205, a57
    v_accvgpr_read_b32 v206, a58
    v_accvgpr_read_b32 v207, a59
    v_pk_fma_f32 v[200:201], v[200:201], v[132:133], v[232:233]
    v_pk_fma_f32 v[202:203], v[202:203], v[134:135], v[232:233]
    v_pk_fma_f32 v[204:205], v[204:205], v[132:133], v[232:233]
    v_pk_fma_f32 v[206:207], v[206:207], v[134:135], v[232:233]
    v_cvt_pk_bf16_f32 v98, v200, v204
    v_cvt_pk_bf16_f32 v102, v201, v205
    v_mfma_f32_16x16x32_bf16 v[80:83], a[232:235], a[168:171], v[80:83]
    v_exp_f32 v244, v112
    v_cvt_pk_bf16_f32 v106, v202, v206
    v_cvt_pk_bf16_f32 v110, v203, v207
    v_mfma_f32_16x16x32_bf16 v[80:83], a[236:239], a[172:175], v[80:83]
    v_exp_f32 v245, v113
    v_accvgpr_read_b32 v212, a44
    v_accvgpr_read_b32 v213, a45
    v_accvgpr_read_b32 v214, a46
    v_accvgpr_read_b32 v215, a47
    v_accvgpr_read_b32 v216, a60
    v_accvgpr_read_b32 v217, a61
    v_accvgpr_read_b32 v218, a62
    v_accvgpr_read_b32 v219, a63
    v_pk_fma_f32 v[212:213], v[212:213], v[132:133], v[232:233]
    v_pk_fma_f32 v[214:215], v[214:215], v[134:135], v[232:233]
    v_pk_fma_f32 v[216:217], v[216:217], v[132:133], v[232:233]
    v_pk_fma_f32 v[218:219], v[218:219], v[134:135], v[232:233]
    v_cvt_pk_bf16_f32 v99, v212, v216
    v_cvt_pk_bf16_f32 v103, v213, v217
    v_mfma_f32_16x16x32_bf16 v[88:91], a[236:239], a[188:191], v[140:143]
    buffer_store_dwordx4 v[72:75], v16, s[20:23], s6 offen offset:512 sc1
    v_mov_b64 v[194:195], v[198:199]
    v_cvt_pk_bf16_f32 v107, v214, v218
    v_cvt_pk_bf16_f32 v111, v215, v219
    s_mov_b32 s7, s5
    s_xor_b32 s5, s5, 12288
    v_mfma_f32_16x16x32_bf16 v[88:91], a[232:235], a[184:187], v[88:91]
    v_exp_f32 v246, v114
    v_mfma_f32_16x16x32_bf16 v[88:91], a[228:231], a[180:183], v[88:91]
    v_exp_f32 v247, v115
    v_mfma_f32_16x16x32_bf16 v[88:91], a[224:227], a[176:179], v[88:91]
    ds_read_b128 a[212:215], v253 offset:61440
    v_perm_b32 v56, v245, v244, s4
    v_mfma_f32_16x16x32_bf16 v[92:95], a[240:243], a[176:179], v[140:143]
    buffer_store_dwordx4 v[76:79], v16, s[20:23], s6 offen offset:768 sc1
    ds_read_b128 a[196:199], v253 offset:57344
    v_mfma_f32_16x16x32_bf16 v[92:95], a[244:247], a[180:183], v[92:95]
    v_exp_f32 v248, v116
    v_mfma_f32_16x16x32_bf16 v[92:95], a[248:251], a[184:187], v[92:95]
    v_exp_f32 v249, v117
    v_mfma_f32_16x16x32_bf16 v[92:95], a[252:255], a[188:191], v[92:95]
    ds_read_b128 a[200:203], v254 offset:57344
    v_perm_b32 v57, v247, v246, s4
    v_mfma_f32_16x16x32_bf16 v[84:87], a[252:255], a[172:175], v[136:139]
    buffer_store_dwordx4 v[96:99], v16, s[20:23], s7 offen offset:0 sc1
L_stop10:
    s_cbranch_execz L_tour_end
    ds_read_b128 a[216:219], v254 offset:61440
    v_mfma_f32_16x16x32_bf16 v[84:87], a[248:251], a[168:171], v[84:87]
    v_exp_f32 v250, v118
    v_mfma_f32_16x16x32_bf16 v[84:87], a[244:247], a[164:167], v[84:87]
    v_exp_f32 v251, v119
    v_mfma_f32_16x16x32_bf16 v[84:87], a[240:243], a[160:163], v[84:87]
    ds_read_b128 a[220:223], v234 offset:61440
    v_perm_b32 v58, v249, v248, s4
    s_waitcnt lgkmcnt(3)
    v_mfma_f32_16x16x32_bf16 a[80:83], v[184:187], a[192:195], a[80:83]
    buffer_store_dwordx4 v[100:103], v16, s[20:23], s7 offen offset:256 sc1
    ds_read_b128 a[204:207], v234 offset:57344
    v_mfma_f32_16x16x32_bf16 a[80:83], v[168:171], a[208:211], a[80:83]
    v_exp_f32 v244, v120
    v_mfma_f32_16x16x32_bf16 a[84:87], v[168:171], a[212:215], a[84:87]
    v_exp_f32 v245, v121
    v_mfma_f32_16x16x32_bf16 a[84:87], v[184:187], a[196:199], a[84:87]
    ds_read_b128 a[224:227], v252 offset:24576
    v_perm_b32 v59, v251, v250, s4
    s_waitcnt lgkmcnt(3)
    v_mfma_f32_16x16x32_bf16 a[88:91], v[184:187], a[200:203], a[88:91]
    buffer_store_dwordx4 v[104:107], v16, s[20:23], s7 offen offset:512 sc1
    ds_read_b128 a[228:231], v252 offset:25600
    v_mfma_f32_16x16x32_bf16 a[88:91], v[168:171], a[216:219], a[88:91]
    v_exp_f32 v246, v122
    s_waitcnt lgkmcnt(2)
    v_mfma_f32_16x16x32_bf16 a[92:95], v[168:171], a[220:223], a[92:95]
    v_exp_f32 v247, v123
    v_mfma_f32_16x16x32_bf16 a[92:95], v[184:187], a[204:207], a[92:95]
    ds_read_b128 a[232:235], v252 offset:26624
    v_perm_b32 v60, v245, v244, s4
    v_mfma_f32_16x16x32_bf16 a[124:127], v[188:191], a[204:207], a[124:127]
    buffer_store_dwordx4 v[108:111], v16, s[20:23], s7 offen offset:768 sc1
    ds_read_b128 a[236:239], v252 offset:27648
    v_mfma_f32_16x16x32_bf16 a[124:127], v[172:175], a[220:223], a[124:127]
    v_exp_f32 v248, v124
    v_exp_f32 v249, v125
    v_perm_b32 v61, v247, v246, s4
    v_exp_f32 v250, v126
    v_exp_f32 v251, v127
    v_perm_b32 v62, v249, v248, s4
    v_perm_b32 v63, v251, v250, s4
    v_mfma_f32_16x16x32_bf16 a[120:123], v[172:175], a[216:219], a[120:123]
    ds_read_b128 a[240:243], v252 offset:28672
    ds_read_b128 a[244:247], v252 offset:29696
    v_smfmac_f32_16x16x64_bf16 v[192:195], v[148:151], v[56:63], v255
    ds_read_b128 a[248:251], v252 offset:30720
    ds_read_b128 a[252:255], v252 offset:31744
    v_mfma_f32_16x16x32_bf16 a[120:123], v[188:191], a[200:203], a[120:123]
    v_mfma_f32_16x16x32_bf16 a[116:119], v[188:191], a[196:199], a[116:119]
    v_mfma_f32_16x16x32_bf16 a[116:119], v[172:175], a[212:215], a[116:119]
    v_mfma_f32_16x16x32_bf16 a[112:115], v[172:175], a[208:211], a[112:115]
    s_nop 1
    v_cmp_lt_f32 vcc, s72, v192
    v_mfma_f32_16x16x32_bf16 a[112:115], v[188:191], a[192:195], a[112:115]
    s_cbranch_vccnz L_rare_t3
L_join_t3:
    s_waitcnt lgkmcnt(0)
    v_mfma_f32_16x16x32_bf16 v[112:115], a[224:227], a[160:163], v[136:139]
    ds_read_b128 a[192:195], v14 offset:32768
    v_mov_b64 v[196:197], v[192:193]
    v_mfma_f32_16x16x32_bf16 v[112:115], a[228:231], a[164:167], v[112:115]
    v_exp_f32 v244, v80
    v_mfma_f32_16x16x32_bf16 v[112:115], a[232:235], a[168:171], v[112:115]
    v_exp_f32 v245, v81
    v_mfma_f32_16x16x32_bf16 v[112:115], a[236:239], a[172:175], v[112:115]
    ds_read_b128 a[208:211], v14 offset:36864
    v_mov_b64 v[198:199], v[194:195]
    v_mfma_f32_16x16x32_bf16 v[120:123], a[236:239], a[188:191], v[140:143]
    v_exp_f32 v246, v82
    v_mfma_f32_16x16x32_bf16 v[120:123], a[232:235], a[184:187], v[120:123]
    v_exp_f32 v247, v83
    v_mfma_f32_16x16x32_bf16 v[120:123], a[228:231], a[180:183], v[120:123]
    ds_read_b128 a[212:215], v253 offset:36864
    v_perm_b32 v184, v245, v244, s4
    v_mfma_f32_16x16x32_bf16 v[120:123], a[224:227], a[176:179], v[120:123]
    v_exp_f32 v248, v84
    v_mfma_f32_16x16x32_bf16 v[124:127], a[240:243], a[176:179], v[140:143]
    v_exp_f32 v249, v85
    v_mfma_f32_16x16x32_bf16 v[124:127], a[244:247], a[180:183], v[124:127]
    ds_read_b128 a[196:199], v253 offset:32768
    v_perm_b32 v185, v247, v246, s4
    v_mfma_f32_16x16x32_bf16 v[124:127], a[248:251], a[184:187], v[124:127]
    v_exp_f32 v250, v86
    v_mfma_f32_16x16x32_bf16 v[124:127], a[252:255], a[188:191], v[124:127]
    v_exp_f32 v251, v87
    v_mfma_f32_16x16x32_bf16 v[116:119], a[252:255], a[172:175], v[136:139]
    ds_read_b128 a[200:203], v254 offset:32768
    v_perm_b32 v186, v249, v248, s4
    v_mfma_f32_16x16x32_bf16 v[116:119], a[248:251], a[168:171], v[116:119]
    v_exp_f32 v244, v88
    v_mfma_f32_16x16x32_bf16 v[116:119], a[244:247], a[164:167], v[116:119]
    ds_read_b128 a[216:219], v254 offset:36864
    ds_read_b128 a[220:223], v234 offset:36864
    v_mfma_f32_16x16x32_bf16 v[116:119], a[240:243], a[160:163], v[116:119]
    v_exp_f32 v245, v89
    s_waitcnt lgkmcnt(3)
    v_mfma_f32_16x16x32_bf16 a[64:67], v[168:171], a[192:195], a[64:67]
    ds_read_b128 a[204:207], v234 offset:32768
    v_perm_b32 v187, v251, v250, s4
    v_mfma_f32_16x16x32_bf16 a[64:67], v[56:59], a[208:211], a[64:67]
    v_exp_f32 v246, v90
    v_mfma_f32_16x16x32_bf16 a[68:71], v[56:59], a[212:215], a[68:71]
    v_exp_f32 v247, v91
    v_mfma_f32_16x16x32_bf16 a[68:71], v[168:171], a[196:199], a[68:71]
    ds_read_b128 a[224:227], v14 offset:40960
    v_perm_b32 v188, v245, v244, s4
    s_waitcnt lgkmcnt(2)
    v_mfma_f32_16x16x32_bf16 a[72:75], v[168:171], a[200:203], a[72:75]
    v_exp_f32 v248, v92
    v_mfma_f32_16x16x32_bf16 a[72:75], v[56:59], a[216:219], a[72:75]
    v_exp_f32 v249, v93
    v_mfma_f32_16x16x32_bf16 a[76:79], v[56:59], a[220:223], a[76:79]
    ds_read_b128 a[240:243], v14 offset:45056
    v_perm_b32 v189, v247, v246, s4
    s_waitcnt lgkmcnt(2)
    v_mfma_f32_16x16x32_bf16 a[76:79], v[168:171], a[204:207], a[76:79]
    v_exp_f32 v250, v94
    v_mfma_f32_16x16x32_bf16 a[108:111], v[172:175], a[204:207], a[108:111]
    v_exp_f32 v251, v95
    v_mfma_f32_16x16x32_bf16 a[108:111], v[60:63], a[220:223], a[108:111]
    v_perm_b32 v190, v249, v248, s4
    v_perm_b32 v191, v251, v250, s4
    v_mfma_f32_16x16x32_bf16 a[104:107], v[60:63], a[216:219], a[104:107]
    ds_read_b128 a[244:247], v253 offset:45056
    ds_read_b128 a[228:231], v253 offset:40960
    v_smfmac_f32_16x16x64_bf16 v[196:199], v[148:151], v[184:191], v255
    ds_read_b128 a[232:235], v254 offset:40960
    ds_read_b128 a[248:251], v254 offset:45056
    v_mfma_f32_16x16x32_bf16 a[104:107], v[172:175], a[200:203], a[104:107]
    ds_read_b128 a[252:255], v234 offset:45056
    ds_read_b128 a[236:239], v234 offset:40960
    v_mfma_f32_16x16x32_bf16 a[100:103], v[172:175], a[196:199], a[100:103]
    v_mfma_f32_16x16x32_bf16 a[100:103], v[60:63], a[212:215], a[100:103]
    v_mfma_f32_16x16x32_bf16 a[96:99], v[60:63], a[208:211], a[96:99]
    v_cmp_lt_f32 vcc, s72, v196
    v_mfma_f32_16x16x32_bf16 a[96:99], v[172:175], a[192:195], a[96:99]
    s_cbranch_vccnz L_rare_t4
L_join_t4:
    s_waitcnt lgkmcnt(2)
    v_mfma_f32_16x16x32_bf16 a[80:83], v[56:59], a[224:227], a[80:83]
    ds_read_b128 a[192:195], v14 offset:8192
    v_mov_b64 v[192:193], v[196:197]
    v_exp_f32 v244, v112
    v_mfma_f32_16x16x32_bf16 a[80:83], v[184:187], a[240:243], a[80:83]
    ds_read_b128 a[196:199], v253 offset:8192
    v_exp_f32 v245, v113
    v_mov_b64 v[194:195], v[198:199]
    v_mfma_f32_16x16x32_bf16 a[84:87], v[184:187], a[244:247], a[84:87]
    ds_read_b128 a[200:203], v254 offset:8192
    ds_read_b128 a[204:207], v234 offset:8192
    v_exp_f32 v246, v114
    v_mfma_f32_16x16x32_bf16 a[84:87], v[56:59], a[228:231], a[84:87]
    v_exp_f32 v247, v115
    v_perm_b32 v168, v245, v244, s4
    v_mfma_f32_16x16x32_bf16 a[88:91], v[56:59], a[232:235], a[88:91]
    v_exp_f32 v248, v116
    v_mfma_f32_16x16x32_bf16 a[88:91], v[184:187], a[248:251], a[88:91]
    v_exp_f32 v249, v117
    v_perm_b32 v169, v247, v246, s4
    s_waitcnt lgkmcnt(3)
    v_mfma_f32_16x16x32_bf16 a[92:95], v[184:187], a[252:255], a[92:95]
    v_exp_f32 v250, v118
    v_mfma_f32_16x16x32_bf16 a[92:95], v[56:59], a[236:239], a[92:95]
    v_exp_f32 v251, v119
    v_perm_b32 v170, v249, v248, s4
    v_mfma_f32_16x16x32_bf16 a[124:127], v[60:63], a[236:239], a[124:127]
    v_exp_f32 v244, v120
    v_mfma_f32_16x16x32_bf16 a[124:127], v[188:191], a[252:255], a[124:127]
    v_exp_f32 v245, v121
    v_perm_b32 v171, v251, v250, s4
    v_mfma_f32_16x16x32_bf16 a[120:123], v[188:191], a[248:251], a[120:123]
    v_exp_f32 v246, v122
    v_mfma_f32_16x16x32_bf16 a[120:123], v[60:63], a[232:235], a[120:123]
    v_exp_f32 v247, v123
    v_perm_b32 v172, v245, v244, s4
    v_mfma_f32_16x16x32_bf16 a[116:119], v[60:63], a[228:231], a[116:119]
    v_exp_f32 v248, v124
    v_mfma_f32_16x16x32_bf16 a[116:119], v[188:191], a[244:247], a[116:119]
    v_exp_f32 v249, v125
    v_perm_b32 v173, v247, v246, s4
    v_mfma_f32_16x16x32_bf16 a[112:115], v[188:191], a[240:243], a[112:115]
    v_exp_f32 v250, v126
    v_mfma_f32_16x16x32_bf16 a[112:115], v[60:63], a[224:227], a[112:115]
    v_exp_f32 v251, v127
    v_perm_b32 v174, v249, v248, s4
    v_mfma_f32_16x16x32_bf16 a[64:67], v[184:187], a[192:195], a[64:67]
    ds_read_b128 a[224:227], v14 offset:0
    ds_read_b128 a[240:243], v14 offset:4096
    ds_read_b128 a[228:231], v253 offset:0
    v_perm_b32 v175, v251, v250, s4
    s_waitcnt lgkmcnt(3)
    v_mfma_f32_16x16x32_bf16 a[68:71], v[184:187], a[196:199], a[68:71]
    ds_read_b128 a[244:247], v253 offset:4096
    ds_read_b128 a[232:235], v254 offset:0
    ds_read_b128 a[248:251], v254 offset:4096
    ds_read_b128 a[236:239], v234 offset:0
    v_mfma_f32_16x16x32_bf16 a[72:75], v[184:187], a[200:203], a[72:75]
    ds_read_b128 a[252:255], v234 offset:4096
    v_smfmac_f32_16x16x64_bf16 v[192:195], v[148:151], v[168:175], v255
    v_mfma_f32_16x16x32_bf16 a[76:79], v[184:187], a[204:207], a[76:79]
    v_mfma_f32_16x16x32_bf16 a[108:111], v[188:191], a[204:207], a[108:111]
    v_mfma_f32_16x16x32_bf16 a[104:107], v[188:191], a[200:203], a[104:107]
    v_mfma_f32_16x16x32_bf16 a[100:103], v[188:191], a[196:199], a[100:103]
    s_nop 3
    v_cmp_lt_f32 vcc, s72, v192
    v_mfma_f32_16x16x32_bf16 a[96:99], v[188:191], a[192:195], a[96:99]
    s_cbranch_vccnz L_rare_t5
L_join_t5:
    s_waitcnt lgkmcnt(0)
    v_mfma_f32_16x16x32_bf16 a[64:67], v[168:171], a[224:227], a[64:67]
    v_mov_b32 v28, v194
    v_mov_b32 v30, v194
    v_mov_b32 v29, v195
    v_mov_b32 v31, v195
    v_permlane16_swap_b32 v28, v30
    s_nop 0
    v_permlane16_swap_b32 v29, v31
    v_add_f32 v28, v28, v30
    v_add_f32 v29, v29, v31
    v_rcp_f32 v28, v28
    v_rcp_f32 v29, v29
    ds_write_b32 v18, v28 offset:512
    ds_write_b32 v18, v29 offset:768
    ds_read_b128 v[128:131], v17 offset:512
    ds_read_b128 v[132:135], v17 offset:768
    v_mfma_f32_16x16x32_bf16 a[80:83], v[168:171], a[240:243], a[80:83]
    v_mfma_f32_16x16x32_bf16 a[68:71], v[168:171], a[228:231], a[68:71]
    v_mfma_f32_16x16x32_bf16 a[84:87], v[168:171], a[244:247], a[84:87]
    v_mfma_f32_16x16x32_bf16 a[72:75], v[168:171], a[232:235], a[72:75]
    v_mfma_f32_16x16x32_bf16 a[88:91], v[168:171], a[248:251], a[88:91]
    v_accvgpr_read_b32 v32, a64
    v_accvgpr_read_b32 v33, a65
    v_accvgpr_read_b32 v34, a66
    v_accvgpr_read_b32 v35, a67
    v_accvgpr_read_b32 v36, a80
    v_accvgpr_read_b32 v37, a81
    v_accvgpr_read_b32 v38, a82
    v_accvgpr_read_b32 v39, a83
    s_waitcnt lgkmcnt(1)
    v_pk_fma_f32 v[32:33], v[32:33], v[128:129], v[232:233]
    v_pk_fma_f32 v[34:35], v[34:35], v[130:131], v[232:233]
    v_pk_fma_f32 v[36:37], v[36:37], v[128:129], v[232:233]
    v_pk_fma_f32 v[38:39], v[38:39], v[130:131], v[232:233]
    v_cvt_pk_bf16_f32 v80, v32, v36
    v_cvt_pk_bf16_f32 v84, v33, v37
    v_cvt_pk_bf16_f32 v88, v34, v38
    v_mfma_f32_16x16x32_bf16 a[76:79], v[168:171], a[236:239], a[76:79]
    v_cvt_pk_bf16_f32 v92, v35, v39
    v_mfma_f32_16x16x32_bf16 a[92:95], v[168:171], a[252:255], a[92:95]
    v_accvgpr_read_b32 v44, a68
    v_accvgpr_read_b32 v45, a69
    v_accvgpr_read_b32 v46, a70
    v_accvgpr_read_b32 v47, a71
    v_accvgpr_read_b32 v48, a84
    v_accvgpr_read_b32 v49, a85
    v_accvgpr_read_b32 v50, a86
    v_accvgpr_read_b32 v51, a87
    v_pk_fma_f32 v[44:45], v[44:45], v[128:129], v[232:233]
    v_pk_fma_f32 v[46:47], v[46:47], v[130:131], v[232:233]
    v_pk_fma_f32 v[48:49], v[48:49], v[128:129], v[232:233]
    v_pk_fma_f32 v[50:51], v[50:51], v[130:131], v[232:233]
    v_cvt_pk_bf16_f32 v81, v44, v48
    v_cvt_pk_bf16_f32 v85, v45, v49
    v_cvt_pk_bf16_f32 v89, v46, v50
    v_cvt_pk_bf16_f32 v93, v47, v51
    v_mfma_f32_16x16x32_bf16 a[96:99], v[172:175], a[224:227], a[96:99]
    v_mfma_f32_16x16x32_bf16 a[112:115], v[172:175], a[240:243], a[112:115]
    v_accvgpr_read_b32 v200, a72
    v_accvgpr_read_b32 v201, a73
    v_accvgpr_read_b32 v202, a74
    v_accvgpr_read_b32 v203, a75
    v_accvgpr_read_b32 v204, a88
    v_accvgpr_read_b32 v205, a89
    v_accvgpr_read_b32 v206, a90
    v_accvgpr_read_b32 v207, a91
    v_pk_fma_f32 v[200:201], v[200:201], v[128:129], v[232:233]
    v_pk_fma_f32 v[202:203], v[202:203], v[130:131], v[232:233]
    v_pk_fma_f32 v[204:205], v[204:205], v[128:129], v[232:233]
    v_pk_fma_f32 v[206:207], v[206:207], v[130:131], v[232:233]
    v_cvt_pk_bf16_f32 v82, v200, v204
    v_cvt_pk_bf16_f32 v86, v201, v205
    v_cvt_pk_bf16_f32 v90, v202, v206
    v_cvt_pk_bf16_f32 v94, v203, v207
    v_mfma_f32_16x16x32_bf16 a[100:103], v[172:175], a[228:231], a[100:103]
    v_mfma_f32_16x16x32_bf16 a[116:119], v[172:175], a[244:247], a[116:119]
    v_accvgpr_read_b32 v212, a76
    v_accvgpr_read_b32 v213, a77
    v_accvgpr_read_b32 v214, a78
    v_accvgpr_read_b32 v215, a79
    v_accvgpr_read_b32 v216, a92
    v_accvgpr_read_b32 v217, a93
    v_accvgpr_read_b32 v218, a94
    v_accvgpr_read_b32 v219, a95
    v_pk_fma_f32 v[212:213], v[212:213], v[128:129], v[232:233]
    v_pk_fma_f32 v[214:215], v[214:215], v[130:131], v[232:233]
    v_pk_fma_f32 v[216:217], v[216:217], v[128:129], v[232:233]
    v_pk_fma_f32 v[218:219], v[218:219], v[130:131], v[232:233]
    v_cvt_pk_bf16_f32 v83, v212, v216
    v_cvt_pk_bf16_f32 v87, v213, v217
    v_cvt_pk_bf16_f32 v91, v214, v218
    v_cvt_pk_bf16_f32 v95, v215, v219
    v_mfma_f32_16x16x32_bf16 a[104:107], v[172:175], a[232:235], a[104:107]
    buffer_store_dwordx4 v[80:83], v16, s[20:23], s5 offen offset:0 sc1
    buffer_store_dwordx4 v[84:87], v16, s[20:23], s5 offen offset:256 sc1
    buffer_store_dwordx4 v[88:91], v16, s[20:23], s5 offen offset:512 sc1
    buffer_store_dwordx4 v[92:95], v16, s[20:23], s5 offen offset:768 sc1
    s_xor_b32 s5, s5, 4096
    v_mfma_f32_16x16x32_bf16 a[120:123], v[172:175], a[248:251], a[120:123]
    v_accvgpr_read_b32 v32, a96
    v_accvgpr_read_b32 v33, a97
    v_accvgpr_read_b32 v34, a98
    v_accvgpr_read_b32 v35, a99
    v_accvgpr_read_b32 v36, a112
    v_accvgpr_read_b32 v37, a113
    v_accvgpr_read_b32 v38, a114
    v_accvgpr_read_b32 v39, a115
    s_waitcnt lgkmcnt(0)
    v_pk_fma_f32 v[32:33], v[32:33], v[132:133], v[232:233]
    v_pk_fma_f32 v[34:35], v[34:35], v[134:135], v[232:233]
    v_pk_fma_f32 v[36:37], v[36:37], v[132:133], v[232:233]
    v_pk_fma_f32 v[38:39], v[38:39], v[134:135], v[232:233]
    v_cvt_pk_bf16_f32 v112, v32, v36
    v_cvt_pk_bf16_f32 v116, v33, v37
    v_cvt_pk_bf16_f32 v120, v34, v38
    v_mfma_f32_16x16x32_bf16 a[108:111], v[172:175], a[236:239], a[108:111]
    v_cvt_pk_bf16_f32 v124, v35, v39
    v_mfma_f32_16x16x32_bf16 a[124:127], v[172:175], a[252:255], a[124:127]
    v_accvgpr_read_b32 v44, a100
    v_accvgpr_read_b32 v45, a101
    v_accvgpr_read_b32 v46, a102
    v_accvgpr_read_b32 v47, a103
    v_accvgpr_read_b32 v48, a116
    v_accvgpr_read_b32 v49, a117
    v_accvgpr_read_b32 v50, a118
    v_accvgpr_read_b32 v51, a119
    v_pk_fma_f32 v[44:45], v[44:45], v[132:133], v[232:233]
    v_pk_fma_f32 v[46:47], v[46:47], v[134:135], v[232:233]
    v_pk_fma_f32 v[48:49], v[48:49], v[132:133], v[232:233]
    v_pk_fma_f32 v[50:51], v[50:51], v[134:135], v[232:233]
    v_cvt_pk_bf16_f32 v113, v44, v48
    v_cvt_pk_bf16_f32 v117, v45, v49
    v_cvt_pk_bf16_f32 v121, v46, v50
    v_cvt_pk_bf16_f32 v125, v47, v51
    v_accvgpr_read_b32 v200, a104
    v_accvgpr_read_b32 v201, a105
    v_accvgpr_read_b32 v202, a106
    v_accvgpr_read_b32 v203, a107
    v_accvgpr_read_b32 v204, a120
    v_accvgpr_read_b32 v205, a121
    v_accvgpr_read_b32 v206, a122
    v_accvgpr_read_b32 v207, a123
    v_pk_fma_f32 v[200:201], v[200:201], v[132:133], v[232:233]
    v_pk_fma_f32 v[202:203], v[202:203], v[134:135], v[232:233]
    v_pk_fma_f32 v[204:205], v[204:205], v[132:133], v[232:233]
    v_pk_fma_f32 v[206:207], v[206:207], v[134:135], v[232:233]
    v_cvt_pk_bf16_f32 v114, v200, v204
    v_cvt_pk_bf16_f32 v118, v201, v205
    v_cvt_pk_bf16_f32 v122, v202, v206
    v_cvt_pk_bf16_f32 v126, v203, v207
    v_accvgpr_read_b32 v212, a108
    v_accvgpr_read_b32 v213, a109
    v_accvgpr_read_b32 v214, a110
    v_accvgpr_read_b32 v215, a111
    v_accvgpr_read_b32 v216, a124
    v_accvgpr_read_b32 v217, a125
    v_accvgpr_read_b32 v218, a126
    v_accvgpr_read_b32 v219, a127
    v_pk_fma_f32 v[212:213], v[212:213], v[132:133], v[232:233]
    v_pk_fma_f32 v[214:215], v[214:215], v[134:135], v[232:233]
    v_pk_fma_f32 v[216:217], v[216:217], v[132:133], v[232:233]
    v_pk_fma_f32 v[218:219], v[218:219], v[134:135], v[232:233]
    v_cvt_pk_bf16_f32 v115, v212, v216
    v_cvt_pk_bf16_f32 v119, v213, v217
    v_cvt_pk_bf16_f32 v123, v214, v218
    v_cvt_pk_bf16_f32 v127, v215, v219
    buffer_store_dwordx4 v[112:115], v16, s[20:23], s5 offen offset:0 sc1
    buffer_store_dwordx4 v[116:119], v16, s[20:23], s5 offen offset:256 sc1
    buffer_store_dwordx4 v[120:123], v16, s[20:23], s5 offen offset:512 sc1
    buffer_store_dwordx4 v[124:127], v16, s[20:23], s5 offen offset:768 sc1
    s_xor_b32 s5, s5, 28672
L_done:
    s_endpgm
L_rare_r0_0:
    s_call_b64 s[88:89], L_rare_sub0
    s_branch L_join_r0_0
L_rare_r0_1:
    s_call_b64 s[88:89], L_rare_sub1
    s_branch L_join_r0_1
L_rare_r0_2:
    s_call_b64 s[88:89], L_rare_sub2
    s_branch L_join_r0_2
L_rare_r0_3:
    s_call_b64 s[88:89], L_rare_sub3
    s_branch L_join_r0_3
L_rare_r0_4:
    s_call_b64 s[88:89], L_rare_sub0
    s_branch L_join_r0_4
L_rare_r0_5:
    s_call_b64 s[88:89], L_rare_sub1
    s_branch L_join_r0_5
L_rare_r0_6:
    s_call_b64 s[88:89], L_rare_sub2
    s_branch L_join_r0_6
L_rare_r0_7:
    s_call_b64 s[88:89], L_rare_sub3
    s_branch L_join_r0_7
L_rare_rl_0:
    s_call_b64 s[88:89], L_rare_sub0
    s_branch L_join_rl_0
L_rare_rl_1:
    s_call_b64 s[88:89], L_rare_sub1
    s_branch L_join_rl_1
L_rare_rl_2:
    s_call_b64 s[88:89], L_rare_sub2
    s_branch L_join_rl_2
L_rare_rl_3:
    s_call_b64 s[88:89], L_rare_sub3
    s_branch L_join_rl_3
L_rare_rl_4:
    s_call_b64 s[88:89], L_rare_sub0
    s_branch L_join_rl_4
L_rare_rl_5:
    s_call_b64 s[88:89], L_rare_sub1
    s_branch L_join_rl_5
L_rare_rl_6:
    s_call_b64 s[88:89], L_rare_sub2
    s_branch L_join_rl_6
L_rare_rl_7:
    s_call_b64 s[88:89], L_rare_sub3
    s_branch L_join_rl_7
L_rare_r6_0:
    s_call_b64 s[88:89], L_rare_sub0
    s_branch L_join_r6_0
L_rare_r6_1:
    s_call_b64 s[88:89], L_rare_sub1
    s_branch L_join_r6_1
L_rare_r6_2:
    s_call_b64 s[88:89], L_rare_sub2
    s_branch L_join_r6_2
L_rare_r6_3:
    s_call_b64 s[88:89], L_rare_sub3
    s_branch L_join_r6_3
L_rare_r6_4:
    s_call_b64 s[88:89], L_rare_sub0
    s_branch L_join_r6_4
L_rare_r6_5:
    s_call_b64 s[88:89], L_rare_sub1
    s_branch L_join_r6_5
L_rare_r6_6:
    s_call_b64 s[88:89], L_rare_sub2
    s_branch L_join_r6_6
L_rare_r6_7:
    s_call_b64 s[88:89], L_rare_sub3
    s_branch L_join_r6_7
L_rare_r7_0:
    s_call_b64 s[88:89], L_rare_sub0
    s_branch L_join_r7_0
L_rare_r7_1:
    s_call_b64 s[88:89], L_rare_sub1
    s_branch L_join_r7_1
L_rare_r7_2:
    s_call_b64 s[88:89], L_rare_sub2
    s_branch L_join_r7_2
L_rare_r7_3:
    s_call_b64 s[88:89], L_rare_sub3
    s_branch L_join_r7_3
L_rare_r7_4:
    s_call_b64 s[88:89], L_rare_sub0
    s_branch L_join_r7_4
L_rare_t0:
    s_call_b64 s[88:89], L_rareh_6110
    s_branch L_join_t0
L_rare_t1:
    s_call_b64 s[88:89], L_rareh_6200
    s_branch L_join_t1
L_rare_t2:
    s_call_b64 s[88:89], L_rareh_6310
    s_branch L_join_t2
L_rare_t3:
    s_call_b64 s[88:89], L_rareh_6101
    s_branch L_join_t3
L_rare_t4:
    s_call_b64 s[88:89], L_rareh_6211
    s_branch L_join_t4
L_rare_t5:
    s_call_b64 s[88:89], L_rareh_6301
    s_branch L_join_t5
L_rareh_6101:
    s_nop 15
    v_cndmask_b32_e64 v196, v196, 0, s[98:99]
    v_max3_f32 v244, v112, v113, v114
    v_max3_f32 v244, v244, v115, v116
    v_max3_f32 v244, v244, v117, v118
    v_max_f32 v244, v244, v119
    v_mov_b32 v245, v244
    s_nop 1
    v_permlane16_swap_b32 v244, v245
    s_nop 1
    v_max_f32 v244, v244, v245
    v_mov_b32 v245, v244
    s_nop 1
    v_permlane32_swap_b32 v244, v245
    s_nop 1
    v_max3_f32 v244, v244, v245, 0
    v_ceil_f32 v244, v244
    v_exp_f32_e64 v246, -v244
    s_nop 0
    v_lshlrev_b32 v247, 16, v168
    v_and_b32 v248, s86, v168
    v_mul_f32 v247, v247, v246
    v_mul_f32 v248, v248, v246
    v_perm_b32 v168, v248, v247, s4
    v_lshlrev_b32 v247, 16, v169
    v_and_b32 v248, s86, v169
    v_mul_f32 v247, v247, v246
    v_mul_f32 v248, v248, v246
    v_perm_b32 v169, v248, v247, s4
    v_lshlrev_b32 v247, 16, v170
    v_and_b32 v248, s86, v170
    v_mul_f32 v247, v247, v246
    v_mul_f32 v248, v248, v246
    v_perm_b32 v170, v248, v247, s4
    v_lshlrev_b32 v247, 16, v171
    v_and_b32 v248, s86, v171
    v_mul_f32 v247, v247, v246
    v_mul_f32 v248, v248, v246
    v_perm_b32 v171, v248, v247, s4
    v_sub_f32 v112, v112, v244
    v_sub_f32 v80, v80, v244
    v_sub_f32 v113, v113, v244
    v_sub_f32 v81, v81, v244
    v_sub_f32 v114, v114, v244
    v_sub_f32 v82, v82, v244
    v_sub_f32 v115, v115, v244
    v_sub_f32 v83, v83, v244
    v_sub_f32 v116, v116, v244
    v_sub_f32 v84, v84, v244
    v_sub_f32 v117, v117, v244
    v_sub_f32 v85, v85, v244
    v_sub_f32 v118, v118, v244
    v_sub_f32 v86, v86, v244
    v_sub_f32 v119, v119, v244
    v_sub_f32 v87, v87, v244
    v_sub_f32 v136, v136, v244
    v_sub_f32 v137, v137, v244
    v_sub_f32 v138, v138, v244
    v_sub_f32 v139, v139, v244
    v_mul_f32 v198, v198, v246
    v_lshrrev_b32 v247, 2, v1
    v_add_u32 v247, s91, v247
    ds_write_b32 v247, v246 offset:2048
    s_nop 1
    v_lshrrev_b32 v247, 8, v1
    v_lshl_add_u32 v247, v247, 4, s91
    ds_read_b128 v[248:251], v247 offset:2048
    s_waitcnt lgkmcnt(0)
    v_accvgpr_read_b32 v245, a64
    v_mul_f32 v245, v245, v248
    v_accvgpr_write_b32 a64, v245
    v_accvgpr_read_b32 v245, a65
    v_mul_f32 v245, v245, v249
    v_accvgpr_write_b32 a65, v245
    v_accvgpr_read_b32 v245, a66
    v_mul_f32 v245, v245, v250
    v_accvgpr_write_b32 a66, v245
    v_accvgpr_read_b32 v245, a67
    v_mul_f32 v245, v245, v251
    v_accvgpr_write_b32 a67, v245
    v_accvgpr_read_b32 v245, a68
    v_mul_f32 v245, v245, v248
    v_accvgpr_write_b32 a68, v245
    v_accvgpr_read_b32 v245, a69
    v_mul_f32 v245, v245, v249
    v_accvgpr_write_b32 a69, v245
    v_accvgpr_read_b32 v245, a70
    v_mul_f32 v245, v245, v250
    v_accvgpr_write_b32 a70, v245
    v_accvgpr_read_b32 v245, a71
    v_mul_f32 v245, v245, v251
    v_accvgpr_write_b32 a71, v245
    v_accvgpr_read_b32 v245, a72
    v_mul_f32 v245, v245, v248
    v_accvgpr_write_b32 a72, v245
    v_accvgpr_read_b32 v245, a73
    v_mul_f32 v245, v245, v249
    v_accvgpr_write_b32 a73, v245
    v_accvgpr_read_b32 v245, a74
    v_mul_f32 v245, v245, v250
    v_accvgpr_write_b32 a74, v245
    v_accvgpr_read_b32 v245, a75
    v_mul_f32 v245, v245, v251
    v_accvgpr_write_b32 a75, v245
    v_accvgpr_read_b32 v245, a76
    v_mul_f32 v245, v245, v248
    v_accvgpr_write_b32 a76, v245
    v_accvgpr_read_b32 v245, a77
    v_mul_f32 v245, v245, v249
    v_accvgpr_write_b32 a77, v245
    v_accvgpr_read_b32 v245, a78
    v_mul_f32 v245, v245, v250
    v_accvgpr_write_b32 a78, v245
    v_accvgpr_read_b32 v245, a79
    v_mul_f32 v245, v245, v251
    v_accvgpr_write_b32 a79, v245
    v_accvgpr_read_b32 v245, a80
    v_mul_f32 v245, v245, v248
    v_accvgpr_write_b32 a80, v245
    v_accvgpr_read_b32 v245, a81
    v_mul_f32 v245, v245, v249
    v_accvgpr_write_b32 a81, v245
    v_accvgpr_read_b32 v245, a82
    v_mul_f32 v245, v245, v250
    v_accvgpr_write_b32 a82, v245
    v_accvgpr_read_b32 v245, a83
    v_mul_f32 v245, v245, v251
    v_accvgpr_write_b32 a83, v245
    v_accvgpr_read_b32 v245, a84
    v_mul_f32 v245, v245, v248
    v_accvgpr_write_b32 a84, v245
    v_accvgpr_read_b32 v245, a85
    v_mul_f32 v245, v245, v249
    v_accvgpr_write_b32 a85, v245
    v_accvgpr_read_b32 v245, a86
    v_mul_f32 v245, v245, v250
    v_accvgpr_write_b32 a86, v245
    v_accvgpr_read_b32 v245, a87
    v_mul_f32 v245, v245, v251
    v_accvgpr_write_b32 a87, v245
    v_accvgpr_read_b32 v245, a88
    v_mul_f32 v245, v245, v248
    v_accvgpr_write_b32 a88, v245
    v_accvgpr_read_b32 v245, a89
    v_mul_f32 v245, v245, v249
    v_accvgpr_write_b32 a89, v245
    v_accvgpr_read_b32 v245, a90
    v_mul_f32 v245, v245, v250
    v_accvgpr_write_b32 a90, v245
    v_accvgpr_read_b32 v245, a91
    v_mul_f32 v245, v245, v251
    v_accvgpr_write_b32 a91, v245
    v_accvgpr_read_b32 v245, a92
    v_mul_f32 v245, v245, v248
    v_accvgpr_write_b32 a92, v245
    v_accvgpr_read_b32 v245, a93
    v_mul_f32 v245, v245, v249
    v_accvgpr_write_b32 a93, v245
    v_accvgpr_read_b32 v245, a94
    v_mul_f32 v245, v245, v250
    v_accvgpr_write_b32 a94, v245
    v_accvgpr_read_b32 v245, a95
    v_mul_f32 v245, v245, v251
    v_accvgpr_write_b32 a95, v245
    v_max3_f32 v244, v120, v121, v122
    v_max3_f32 v244, v244, v123, v124
    v_max3_f32 v244, v244, v125, v126
    v_max_f32 v244, v244, v127
    v_mov_b32 v245, v244
    s_nop 1
    v_permlane16_swap_b32 v244, v245
    s_nop 1
    v_max_f32 v244, v244, v245
    v_mov_b32 v245, v244
    s_nop 1
    v_permlane32_swap_b32 v244, v245
    s_nop 1
    v_max3_f32 v244, v244, v245, 0
    v_ceil_f32 v244, v244
    v_exp_f32_e64 v246, -v244
    s_nop 0
    v_lshlrev_b32 v247, 16, v172
    v_and_b32 v248, s86, v172
    v_mul_f32 v247, v247, v246
    v_mul_f32 v248, v248, v246
    v_perm_b32 v172, v248, v247, s4
    v_lshlrev_b32 v247, 16, v173
    v_and_b32 v248, s86, v173
    v_mul_f32 v247, v247, v246
    v_mul_f32 v248, v248, v246
    v_perm_b32 v173, v248, v247, s4
    v_lshlrev_b32 v247, 16, v174
    v_and_b32 v248, s86, v174
    v_mul_f32 v247, v247, v246
    v_mul_f32 v248, v248, v246
    v_perm_b32 v174, v248, v247, s4
    v_lshlrev_b32 v247, 16, v175
    v_and_b32 v248, s86, v175
    v_mul_f32 v247, v247, v246
    v_mul_f32 v248, v248, v246
    v_perm_b32 v175, v248, v247, s4
    v_sub_f32 v120, v120, v244
    v_sub_f32 v88, v88, v244
    v_sub_f32 v121, v121, v244
    v_sub_f32 v89, v89, v244
    v_sub_f32 v122, v122, v244
    v_sub_f32 v90, v90, v244
    v_sub_f32 v123, v123, v244
    v_sub_f32 v91, v91, v244
    v_sub_f32 v124, v124, v244
    v_sub_f32 v92, v92, v244
    v_sub_f32 v125, v125, v244
    v_sub_f32 v93, v93, v244
    v_sub_f32 v126, v126, v244
    v_sub_f32 v94, v94, v244
    v_sub_f32 v127, v127, v244
    v_sub_f32 v95, v95, v244
    v_sub_f32 v140, v140, v244
    v_sub_f32 v141, v141, v244
    v_sub_f32 v142, v142, v244
    v_sub_f32 v143, v143, v244
    v_mul_f32 v199, v199, v246
    v_lshrrev_b32 v247, 2, v1
    v_add_u32 v247, s91, v247
    ds_write_b32 v247, v246 offset:2048
    s_nop 1
    v_lshrrev_b32 v247, 8, v1
    v_lshl_add_u32 v247, v247, 4, s91
    ds_read_b128 v[248:251], v247 offset:2048
    s_waitcnt lgkmcnt(0)
    v_accvgpr_read_b32 v245, a96
    v_mul_f32 v245, v245, v248
    v_accvgpr_write_b32 a96, v245
    v_accvgpr_read_b32 v245, a97
    v_mul_f32 v245, v245, v249
    v_accvgpr_write_b32 a97, v245
    v_accvgpr_read_b32 v245, a98
    v_mul_f32 v245, v245, v250
    v_accvgpr_write_b32 a98, v245
    v_accvgpr_read_b32 v245, a99
    v_mul_f32 v245, v245, v251
    v_accvgpr_write_b32 a99, v245
    v_accvgpr_read_b32 v245, a100
    v_mul_f32 v245, v245, v248
    v_accvgpr_write_b32 a100, v245
    v_accvgpr_read_b32 v245, a101
    v_mul_f32 v245, v245, v249
    v_accvgpr_write_b32 a101, v245
    v_accvgpr_read_b32 v245, a102
    v_mul_f32 v245, v245, v250
    v_accvgpr_write_b32 a102, v245
    v_accvgpr_read_b32 v245, a103
    v_mul_f32 v245, v245, v251
    v_accvgpr_write_b32 a103, v245
    v_accvgpr_read_b32 v245, a104
    v_mul_f32 v245, v245, v248
    v_accvgpr_write_b32 a104, v245
    v_accvgpr_read_b32 v245, a105
    v_mul_f32 v245, v245, v249
    v_accvgpr_write_b32 a105, v245
    v_accvgpr_read_b32 v245, a106
    v_mul_f32 v245, v245, v250
    v_accvgpr_write_b32 a106, v245
    v_accvgpr_read_b32 v245, a107
    v_mul_f32 v245, v245, v251
    v_accvgpr_write_b32 a107, v245
    v_accvgpr_read_b32 v245, a108
    v_mul_f32 v245, v245, v248
    v_accvgpr_write_b32 a108, v245
    v_accvgpr_read_b32 v245, a109
    v_mul_f32 v245, v245, v249
    v_accvgpr_write_b32 a109, v245
    v_accvgpr_read_b32 v245, a110
    v_mul_f32 v245, v245, v250
    v_accvgpr_write_b32 a110, v245
    v_accvgpr_read_b32 v245, a111
    v_mul_f32 v245, v245, v251
    v_accvgpr_write_b32 a111, v245
    v_accvgpr_read_b32 v245, a112
    v_mul_f32 v245, v245, v248
    v_accvgpr_write_b32 a112, v245
    v_accvgpr_read_b32 v245, a113
    v_mul_f32 v245, v245, v249
    v_accvgpr_write_b32 a113, v245
    v_accvgpr_read_b32 v245, a114
    v_mul_f32 v245, v245, v250
    v_accvgpr_write_b32 a114, v245
    v_accvgpr_read_b32 v245, a115
    v_mul_f32 v245, v245, v251
    v_accvgpr_write_b32 a115, v245
    v_accvgpr_read_b32 v245, a116
    v_mul_f32 v245, v245, v248
    v_accvgpr_write_b32 a116, v245
    v_accvgpr_read_b32 v245, a117
    v_mul_f32 v245, v245, v249
    v_accvgpr_write_b32 a117, v245
    v_accvgpr_read_b32 v245, a118
    v_mul_f32 v245, v245, v250
    v_accvgpr_write_b32 a118, v245
    v_accvgpr_read_b32 v245, a119
    v_mul_f32 v245, v245, v251
    v_accvgpr_write_b32 a119, v245
    v_accvgpr_read_b32 v245, a120
    v_mul_f32 v245, v245, v248
    v_accvgpr_write_b32 a120, v245
    v_accvgpr_read_b32 v245, a121
    v_mul_f32 v245, v245, v249
    v_accvgpr_write_b32 a121, v245
    v_accvgpr_read_b32 v245, a122
    v_mul_f32 v245, v245, v250
    v_accvgpr_write_b32 a122, v245
    v_accvgpr_read_b32 v245, a123
    v_mul_f32 v245, v245, v251
    v_accvgpr_write_b32 a123, v245
    v_accvgpr_read_b32 v245, a124
    v_mul_f32 v245, v245, v248
    v_accvgpr_write_b32 a124, v245
    v_accvgpr_read_b32 v245, a125
    v_mul_f32 v245, v245, v249
    v_accvgpr_write_b32 a125, v245
    v_accvgpr_read_b32 v245, a126
    v_mul_f32 v245, v245, v250
    v_accvgpr_write_b32 a126, v245
    v_accvgpr_read_b32 v245, a127
    v_mul_f32 v245, v245, v251
    v_accvgpr_write_b32 a127, v245
    v_mov_b64 v[192:193], v[196:197]
    v_mov_b64 v[194:195], v[198:199]
    v_exp_f32 v244, v112
    v_exp_f32 v245, v113
    v_exp_f32 v246, v114
    v_exp_f32 v247, v115
    v_exp_f32 v248, v116
    v_exp_f32 v249, v117
    v_exp_f32 v250, v118
    v_exp_f32 v251, v119
    s_nop 0
    v_perm_b32 v56, v245, v244, s4
    v_perm_b32 v57, v247, v246, s4
    v_perm_b32 v58, v249, v248, s4
    v_perm_b32 v59, v251, v250, s4
    v_exp_f32 v244, v120
    v_exp_f32 v245, v121
    v_exp_f32 v246, v122
    v_exp_f32 v247, v123
    v_exp_f32 v248, v124
    v_exp_f32 v249, v125
    v_exp_f32 v250, v126
    v_exp_f32 v251, v127
    s_nop 0
    v_perm_b32 v60, v245, v244, s4
    v_perm_b32 v61, v247, v246, s4
    v_perm_b32 v62, v249, v248, s4
    v_perm_b32 v63, v251, v250, s4
    s_nop 1
    v_smfmac_f32_16x16x64_bf16 v[192:195], v[148:151], v[56:63], v255
    s_nop 7
    s_nop 7
    s_setpc_b64 s[88:89]
L_rareh_6110:
    s_nop 15
    v_cndmask_b32_e64 v192, v192, 0, s[98:99]
    v_max3_f32 v244, v96, v97, v98
    v_max3_f32 v244, v244, v99, v100
    v_max3_f32 v244, v244, v101, v102
    v_max_f32 v244, v244, v103
    v_mov_b32 v245, v244
    s_nop 1
    v_permlane16_swap_b32 v244, v245
    s_nop 1
    v_max_f32 v244, v244, v245
    v_mov_b32 v245, v244
    s_nop 1
    v_permlane32_swap_b32 v244, v245
    s_nop 1
    v_max3_f32 v244, v244, v245, 0
    v_ceil_f32 v244, v244
    v_exp_f32_e64 v246, -v244
    s_nop 0
    v_lshlrev_b32 v247, 16, v160
    v_and_b32 v248, s86, v160
    v_mul_f32 v247, v247, v246
    v_mul_f32 v248, v248, v246
    v_perm_b32 v160, v248, v247, s4
    v_lshlrev_b32 v247, 16, v161
    v_and_b32 v248, s86, v161
    v_mul_f32 v247, v247, v246
    v_mul_f32 v248, v248, v246
    v_perm_b32 v161, v248, v247, s4
    v_lshlrev_b32 v247, 16, v162
    v_and_b32 v248, s86, v162
    v_mul_f32 v247, v247, v246
    v_mul_f32 v248, v248, v246
    v_perm_b32 v162, v248, v247, s4
    v_lshlrev_b32 v247, 16, v163
    v_and_b32 v248, s86, v163
    v_mul_f32 v247, v247, v246
    v_mul_f32 v248, v248, v246
    v_perm_b32 v163, v248, v247, s4
    v_sub_f32 v96, v96, v244
    v_sub_f32 v64, v64, v244
    v_sub_f32 v97, v97, v244
    v_sub_f32 v65, v65, v244
    v_sub_f32 v98, v98, v244
    v_sub_f32 v66, v66, v244
    v_sub_f32 v99, v99, v244
    v_sub_f32 v67, v67, v244
    v_sub_f32 v100, v100, v244
    v_sub_f32 v68, v68, v244
    v_sub_f32 v101, v101, v244
    v_sub_f32 v69, v69, v244
    v_sub_f32 v102, v102, v244
    v_sub_f32 v70, v70, v244
    v_sub_f32 v103, v103, v244
    v_sub_f32 v71, v71, v244
    v_sub_f32 v128, v128, v244
    v_sub_f32 v129, v129, v244
    v_sub_f32 v130, v130, v244
    v_sub_f32 v131, v131, v244
    v_mul_f32 v192, v192, v246
    v_lshrrev_b32 v247, 2, v1
    v_add_u32 v247, s91, v247
    ds_write_b32 v247, v246 offset:2048
    s_nop 1
    v_lshrrev_b32 v247, 8, v1
    v_lshl_add_u32 v247, v247, 4, s91
    ds_read_b128 v[248:251], v247 offset:2048
    s_waitcnt lgkmcnt(0)
    v_accvgpr_read_b32 v245, a0
    v_mul_f32 v245, v245, v248
    v_accvgpr_write_b32 a0, v245
    v_accvgpr_read_b32 v245, a1
    v_mul_f32 v245, v245, v249
    v_accvgpr_write_b32 a1, v245
    v_accvgpr_read_b32 v245, a2
    v_mul_f32 v245, v245, v250
    v_accvgpr_write_b32 a2, v245
    v_accvgpr_read_b32 v245, a3
    v_mul_f32 v245, v245, v251
    v_accvgpr_write_b32 a3, v245
    v_accvgpr_read_b32 v245, a4
    v_mul_f32 v245, v245, v248
    v_accvgpr_write_b32 a4, v245
    v_accvgpr_read_b32 v245, a5
    v_mul_f32 v245, v245, v249
    v_accvgpr_write_b32 a5, v245
    v_accvgpr_read_b32 v245, a6
    v_mul_f32 v245, v245, v250
    v_accvgpr_write_b32 a6, v245
    v_accvgpr_read_b32 v245, a7
    v_mul_f32 v245, v245, v251
    v_accvgpr_write_b32 a7, v245
    v_accvgpr_read_b32 v245, a8
    v_mul_f32 v245, v245, v248
    v_accvgpr_write_b32 a8, v245
    v_accvgpr_read_b32 v245, a9
    v_mul_f32 v245, v245, v249
    v_accvgpr_write_b32 a9, v245
    v_accvgpr_read_b32 v245, a10
    v_mul_f32 v245, v245, v250
    v_accvgpr_write_b32 a10, v245
    v_accvgpr_read_b32 v245, a11
    v_mul_f32 v245, v245, v251
    v_accvgpr_write_b32 a11, v245
    v_accvgpr_read_b32 v245, a12
    v_mul_f32 v245, v245, v248
    v_accvgpr_write_b32 a12, v245
    v_accvgpr_read_b32 v245, a13
    v_mul_f32 v245, v245, v249
    v_accvgpr_write_b32 a13, v245
    v_accvgpr_read_b32 v245, a14
    v_mul_f32 v245, v245, v250
    v_accvgpr_write_b32 a14, v245
    v_accvgpr_read_b32 v245, a15
    v_mul_f32 v245, v245, v251
    v_accvgpr_write_b32 a15, v245
    v_accvgpr_read_b32 v245, a16
    v_mul_f32 v245, v245, v248
    v_accvgpr_write_b32 a16, v245
    v_accvgpr_read_b32 v245, a17
    v_mul_f32 v245, v245, v249
    v_accvgpr_write_b32 a17, v245
    v_accvgpr_read_b32 v245, a18
    v_mul_f32 v245, v245, v250
    v_accvgpr_write_b32 a18, v245
    v_accvgpr_read_b32 v245, a19
    v_mul_f32 v245, v245, v251
    v_accvgpr_write_b32 a19, v245
    v_accvgpr_read_b32 v245, a20
    v_mul_f32 v245, v245, v248
    v_accvgpr_write_b32 a20, v245
    v_accvgpr_read_b32 v245, a21
    v_mul_f32 v245, v245, v249
    v_accvgpr_write_b32 a21, v245
    v_accvgpr_read_b32 v245, a22
    v_mul_f32 v245, v245, v250
    v_accvgpr_write_b32 a22, v245
    v_accvgpr_read_b32 v245, a23
    v_mul_f32 v245, v245, v251
    v_accvgpr_write_b32 a23, v245
    v_accvgpr_read_b32 v245, a24
    v_mul_f32 v245, v245, v248
    v_accvgpr_write_b32 a24, v245
    v_accvgpr_read_b32 v245, a25
    v_mul_f32 v245, v245, v249
    v_accvgpr_write_b32 a25, v245
    v_accvgpr_read_b32 v245, a26
    v_mul_f32 v245, v245, v250
    v_accvgpr_write_b32 a26, v245
    v_accvgpr_read_b32 v245, a27
    v_mul_f32 v245, v245, v251
    v_accvgpr_write_b32 a27, v245
    v_accvgpr_read_b32 v245, a28
    v_mul_f32 v245, v245, v248
    v_accvgpr_write_b32 a28, v245
    v_accvgpr_read_b32 v245, a29
    v_mul_f32 v245, v245, v249
    v_accvgpr_write_b32 a29, v245
    v_accvgpr_read_b32 v245, a30
    v_mul_f32 v245, v245, v250
    v_accvgpr_write_b32 a30, v245
    v_accvgpr_read_b32 v245, a31
    v_mul_f32 v245, v245, v251
    v_accvgpr_write_b32 a31, v245
    v_max3_f32 v244, v104, v105, v106
    v_max3_f32 v244, v244, v107, v108
    v_max3_f32 v244, v244, v109, v110
    v_max_f32 v244, v244, v111
    v_mov_b32 v245, v244
    s_nop 1
    v_permlane16_swap_b32 v244, v245
    s_nop 1
    v_max_f32 v244, v244, v245
    v_mov_b32 v245, v244
    s_nop 1
    v_permlane32_swap_b32 v244, v245
    s_nop 1
    v_max3_f32 v244, v244, v245, 0
    v_ceil_f32 v244, v244
    v_exp_f32_e64 v246, -v244
    s_nop 0
    v_lshlrev_b32 v247, 16, v164
    v_and_b32 v248, s86, v164
    v_mul_f32 v247, v247, v246
    v_mul_f32 v248, v248, v246
    v_perm_b32 v164, v248, v247, s4
    v_lshlrev_b32 v247, 16, v165
    v_and_b32 v248, s86, v165
    v_mul_f32 v247, v247, v246
    v_mul_f32 v248, v248, v246
    v_perm_b32 v165, v248, v247, s4
    v_lshlrev_b32 v247, 16, v166
    v_and_b32 v248, s86, v166
    v_mul_f32 v247, v247, v246
    v_mul_f32 v248, v248, v246
    v_perm_b32 v166, v248, v247, s4
    v_lshlrev_b32 v247, 16, v167
    v_and_b32 v248, s86, v167
    v_mul_f32 v247, v247, v246
    v_mul_f32 v248, v248, v246
    v_perm_b32 v167, v248, v247, s4
    v_sub_f32 v104, v104, v244
    v_sub_f32 v72, v72, v244
    v_sub_f32 v105, v105, v244
    v_sub_f32 v73, v73, v244
    v_sub_f32 v106, v106, v244
    v_sub_f32 v74, v74, v244
    v_sub_f32 v107, v107, v244
    v_sub_f32 v75, v75, v244
    v_sub_f32 v108, v108, v244
    v_sub_f32 v76, v76, v244
    v_sub_f32 v109, v109, v244
    v_sub_f32 v77, v77, v244
    v_sub_f32 v110, v110, v244
    v_sub_f32 v78, v78, v244
    v_sub_f32 v111, v111, v244
    v_sub_f32 v79, v79, v244
    v_sub_f32 v132, v132, v244
    v_sub_f32 v133, v133, v244
    v_sub_f32 v134, v134, v244
    v_sub_f32 v135, v135, v244
    v_mul_f32 v193, v193, v246
    v_lshrrev_b32 v247, 2, v1
    v_add_u32 v247, s91, v247
    ds_write_b32 v247, v246 offset:2048
    s_nop 1
    v_lshrrev_b32 v247, 8, v1
    v_lshl_add_u32 v247, v247, 4, s91
    ds_read_b128 v[248:251], v247 offset:2048
    s_waitcnt lgkmcnt(0)
    v_accvgpr_read_b32 v245, a32
    v_mul_f32 v245, v245, v248
    v_accvgpr_write_b32 a32, v245
    v_accvgpr_read_b32 v245, a33
    v_mul_f32 v245, v245, v249
    v_accvgpr_write_b32 a33, v245
    v_accvgpr_read_b32 v245, a34
    v_mul_f32 v245, v245, v250
    v_accvgpr_write_b32 a34, v245
    v_accvgpr_read_b32 v245, a35
    v_mul_f32 v245, v245, v251
    v_accvgpr_write_b32 a35, v245
    v_accvgpr_read_b32 v245, a36
    v_mul_f32 v245, v245, v248
    v_accvgpr_write_b32 a36, v245
    v_accvgpr_read_b32 v245, a37
    v_mul_f32 v245, v245, v249
    v_accvgpr_write_b32 a37, v245
    v_accvgpr_read_b32 v245, a38
    v_mul_f32 v245, v245, v250
    v_accvgpr_write_b32 a38, v245
    v_accvgpr_read_b32 v245, a39
    v_mul_f32 v245, v245, v251
    v_accvgpr_write_b32 a39, v245
    v_accvgpr_read_b32 v245, a40
    v_mul_f32 v245, v245, v248
    v_accvgpr_write_b32 a40, v245
    v_accvgpr_read_b32 v245, a41
    v_mul_f32 v245, v245, v249
    v_accvgpr_write_b32 a41, v245
    v_accvgpr_read_b32 v245, a42
    v_mul_f32 v245, v245, v250
    v_accvgpr_write_b32 a42, v245
    v_accvgpr_read_b32 v245, a43
    v_mul_f32 v245, v245, v251
    v_accvgpr_write_b32 a43, v245
    v_accvgpr_read_b32 v245, a44
    v_mul_f32 v245, v245, v248
    v_accvgpr_write_b32 a44, v245
    v_accvgpr_read_b32 v245, a45
    v_mul_f32 v245, v245, v249
    v_accvgpr_write_b32 a45, v245
    v_accvgpr_read_b32 v245, a46
    v_mul_f32 v245, v245, v250
    v_accvgpr_write_b32 a46, v245
    v_accvgpr_read_b32 v245, a47
    v_mul_f32 v245, v245, v251
    v_accvgpr_write_b32 a47, v245
    v_accvgpr_read_b32 v245, a48
    v_mul_f32 v245, v245, v248
    v_accvgpr_write_b32 a48, v245
    v_accvgpr_read_b32 v245, a49
    v_mul_f32 v245, v245, v249
    v_accvgpr_write_b32 a49, v245
    v_accvgpr_read_b32 v245, a50
    v_mul_f32 v245, v245, v250
    v_accvgpr_write_b32 a50, v245
    v_accvgpr_read_b32 v245, a51
    v_mul_f32 v245, v245, v251
    v_accvgpr_write_b32 a51, v245
    v_accvgpr_read_b32 v245, a52
    v_mul_f32 v245, v245, v248
    v_accvgpr_write_b32 a52, v245
    v_accvgpr_read_b32 v245, a53
    v_mul_f32 v245, v245, v249
    v_accvgpr_write_b32 a53, v245
    v_accvgpr_read_b32 v245, a54
    v_mul_f32 v245, v245, v250
    v_accvgpr_write_b32 a54, v245
    v_accvgpr_read_b32 v245, a55
    v_mul_f32 v245, v245, v251
    v_accvgpr_write_b32 a55, v245
    v_accvgpr_read_b32 v245, a56
    v_mul_f32 v245, v245, v248
    v_accvgpr_write_b32 a56, v245
    v_accvgpr_read_b32 v245, a57
    v_mul_f32 v245, v245, v249
    v_accvgpr_write_b32 a57, v245
    v_accvgpr_read_b32 v245, a58
    v_mul_f32 v245, v245, v250
    v_accvgpr_write_b32 a58, v245
    v_accvgpr_read_b32 v245, a59
    v_mul_f32 v245, v245, v251
    v_accvgpr_write_b32 a59, v245
    v_accvgpr_read_b32 v245, a60
    v_mul_f32 v245, v245, v248
    v_accvgpr_write_b32 a60, v245
    v_accvgpr_read_b32 v245, a61
    v_mul_f32 v245, v245, v249
    v_accvgpr_write_b32 a61, v245
    v_accvgpr_read_b32 v245, a62
    v_mul_f32 v245, v245, v250
    v_accvgpr_write_b32 a62, v245
    v_accvgpr_read_b32 v245, a63
    v_mul_f32 v245, v245, v251
    v_accvgpr_write_b32 a63, v245
    v_mov_b64 v[196:197], v[192:193]
    v_mov_b64 v[198:199], v[194:195]
    v_exp_f32 v244, v96
    v_exp_f32 v245, v97
    v_exp_f32 v246, v98
    v_exp_f32 v247, v99
    v_exp_f32 v248, v100
    v_exp_f32 v249, v101
    v_exp_f32 v250, v102
    v_exp_f32 v251, v103
    s_nop 0
    v_perm_b32 v176, v245, v244, s4
    v_perm_b32 v177, v247, v246, s4
    v_perm_b32 v178, v249, v248, s4
    v_perm_b32 v179, v251, v250, s4
    v_exp_f32 v244, v104
    v_exp_f32 v245, v105
    v_exp_f32 v246, v106
    v_exp_f32 v247, v107
    v_exp_f32 v248, v108
    v_exp_f32 v249, v109
    v_exp_f32 v250, v110
    v_exp_f32 v251, v111
    s_nop 0
    v_perm_b32 v180, v245, v244, s4
    v_perm_b32 v181, v247, v246, s4
    v_perm_b32 v182, v249, v248, s4
    v_perm_b32 v183, v251, v250, s4
    s_nop 1
    v_smfmac_f32_16x16x64_bf16 v[196:199], v[144:147], v[176:183], v255
    s_nop 7
    s_nop 7
    s_setpc_b64 s[88:89]
L_rareh_6200:
    s_nop 15
    v_cndmask_b32_e64 v196, v196, 0, s[98:99]
    v_max3_f32 v244, v64, v65, v66
    v_max3_f32 v244, v244, v67, v68
    v_max3_f32 v244, v244, v69, v70
    v_max_f32 v244, v244, v71
    v_mov_b32 v245, v244
    s_nop 1
    v_permlane16_swap_b32 v244, v245
    s_nop 1
    v_max_f32 v244, v244, v245
    v_mov_b32 v245, v244
    s_nop 1
    v_permlane32_swap_b32 v244, v245
    s_nop 1
    v_max3_f32 v244, v244, v245, 0
    v_ceil_f32 v244, v244
    v_exp_f32_e64 v246, -v244
    s_nop 0
    v_lshlrev_b32 v247, 16, v176
    v_and_b32 v248, s86, v176
    v_mul_f32 v247, v247, v246
    v_mul_f32 v248, v248, v246
    v_perm_b32 v176, v248, v247, s4
    v_lshlrev_b32 v247, 16, v177
    v_and_b32 v248, s86, v177
    v_mul_f32 v247, v247, v246
    v_mul_f32 v248, v248, v246
    v_perm_b32 v177, v248, v247, s4
    v_lshlrev_b32 v247, 16, v178
    v_and_b32 v248, s86, v178
    v_mul_f32 v247, v247, v246
    v_mul_f32 v248, v248, v246
    v_perm_b32 v178, v248, v247, s4
    v_lshlrev_b32 v247, 16, v179
    v_and_b32 v248, s86, v179
    v_mul_f32 v247, v247, v246
    v_mul_f32 v248, v248, v246
    v_perm_b32 v179, v248, v247, s4
    v_sub_f32 v64, v64, v244
    v_sub_f32 v96, v96, v244
    v_sub_f32 v65, v65, v244
    v_sub_f32 v97, v97, v244
    v_sub_f32 v66, v66, v244
    v_sub_f32 v98, v98, v244
    v_sub_f32 v67, v67, v244
    v_sub_f32 v99, v99, v244
    v_sub_f32 v68, v68, v244
    v_sub_f32 v100, v100, v244
    v_sub_f32 v69, v69, v244
    v_sub_f32 v101, v101, v244
    v_sub_f32 v70, v70, v244
    v_sub_f32 v102, v102, v244
    v_sub_f32 v71, v71, v244
    v_sub_f32 v103, v103, v244
    v_sub_f32 v128, v128, v244
    v_sub_f32 v129, v129, v244
    v_sub_f32 v130, v130, v244
    v_sub_f32 v131, v131, v244
    v_mul_f32 v196, v196, v246
    v_lshrrev_b32 v247, 2, v1
    v_add_u32 v247, s91, v247
    ds_write_b32 v247, v246 offset:2048
    s_nop 1
    v_lshrrev_b32 v247, 8, v1
    v_lshl_add_u32 v247, v247, 4, s91
    ds_read_b128 v[248:251], v247 offset:2048
    s_waitcnt lgkmcnt(0)
    v_accvgpr_read_b32 v245, a0
    v_mul_f32 v245, v245, v248
    v_accvgpr_write_b32 a0, v245
    v_accvgpr_read_b32 v245, a1
    v_mul_f32 v245, v245, v249
    v_accvgpr_write_b32 a1, v245
    v_accvgpr_read_b32 v245, a2
    v_mul_f32 v245, v245, v250
    v_accvgpr_write_b32 a2, v245
    v_accvgpr_read_b32 v245, a3
    v_mul_f32 v245, v245, v251
    v_accvgpr_write_b32 a3, v245
    v_accvgpr_read_b32 v245, a4
    v_mul_f32 v245, v245, v248
    v_accvgpr_write_b32 a4, v245
    v_accvgpr_read_b32 v245, a5
    v_mul_f32 v245, v245, v249
    v_accvgpr_write_b32 a5, v245
    v_accvgpr_read_b32 v245, a6
    v_mul_f32 v245, v245, v250
    v_accvgpr_write_b32 a6, v245
    v_accvgpr_read_b32 v245, a7
    v_mul_f32 v245, v245, v251
    v_accvgpr_write_b32 a7, v245
    v_accvgpr_read_b32 v245, a8
    v_mul_f32 v245, v245, v248
    v_accvgpr_write_b32 a8, v245
    v_accvgpr_read_b32 v245, a9
    v_mul_f32 v245, v245, v249
    v_accvgpr_write_b32 a9, v245
    v_accvgpr_read_b32 v245, a10
    v_mul_f32 v245, v245, v250
    v_accvgpr_write_b32 a10, v245
    v_accvgpr_read_b32 v245, a11
    v_mul_f32 v245, v245, v251
    v_accvgpr_write_b32 a11, v245
    v_accvgpr_read_b32 v245, a12
    v_mul_f32 v245, v245, v248
    v_accvgpr_write_b32 a12, v245
    v_accvgpr_read_b32 v245, a13
    v_mul_f32 v245, v245, v249
    v_accvgpr_write_b32 a13, v245
    v_accvgpr_read_b32 v245, a14
    v_mul_f32 v245, v245, v250
    v_accvgpr_write_b32 a14, v245
    v_accvgpr_read_b32 v245, a15
    v_mul_f32 v245, v245, v251
    v_accvgpr_write_b32 a15, v245
    v_accvgpr_read_b32 v245, a16
    v_mul_f32 v245, v245, v248
    v_accvgpr_write_b32 a16, v245
    v_accvgpr_read_b32 v245, a17
    v_mul_f32 v245, v245, v249
    v_accvgpr_write_b32 a17, v245
    v_accvgpr_read_b32 v245, a18
    v_mul_f32 v245, v245, v250
    v_accvgpr_write_b32 a18, v245
    v_accvgpr_read_b32 v245, a19
    v_mul_f32 v245, v245, v251
    v_accvgpr_write_b32 a19, v245
    v_accvgpr_read_b32 v245, a20
    v_mul_f32 v245, v245, v248
    v_accvgpr_write_b32 a20, v245
    v_accvgpr_read_b32 v245, a21
    v_mul_f32 v245, v245, v249
    v_accvgpr_write_b32 a21, v245
    v_accvgpr_read_b32 v245, a22
    v_mul_f32 v245, v245, v250
    v_accvgpr_write_b32 a22, v245
    v_accvgpr_read_b32 v245, a23
    v_mul_f32 v245, v245, v251
    v_accvgpr_write_b32 a23, v245
    v_accvgpr_read_b32 v245, a24
    v_mul_f32 v245, v245, v248
    v_accvgpr_write_b32 a24, v245
    v_accvgpr_read_b32 v245, a25
    v_mul_f32 v245, v245, v249
    v_accvgpr_write_b32 a25, v245
    v_accvgpr_read_b32 v245, a26
    v_mul_f32 v245, v245, v250
    v_accvgpr_write_b32 a26, v245
    v_accvgpr_read_b32 v245, a27
    v_mul_f32 v245, v245, v251
    v_accvgpr_write_b32 a27, v245
    v_accvgpr_read_b32 v245, a28
    v_mul_f32 v245, v245, v248
    v_accvgpr_write_b32 a28, v245
    v_accvgpr_read_b32 v245, a29
    v_mul_f32 v245, v245, v249
    v_accvgpr_write_b32 a29, v245
    v_accvgpr_read_b32 v245, a30
    v_mul_f32 v245, v245, v250
    v_accvgpr_write_b32 a30, v245
    v_accvgpr_read_b32 v245, a31
    v_mul_f32 v245, v245, v251
    v_accvgpr_write_b32 a31, v245
    v_max3_f32 v244, v72, v73, v74
    v_max3_f32 v244, v244, v75, v76
    v_max3_f32 v244, v244, v77, v78
    v_max_f32 v244, v244, v79
    v_mov_b32 v245, v244
    s_nop 1
    v_permlane16_swap_b32 v244, v245
    s_nop 1
    v_max_f32 v244, v244, v245
    v_mov_b32 v245, v244
    s_nop 1
    v_permlane32_swap_b32 v244, v245
    s_nop 1
    v_max3_f32 v244, v244, v245, 0
    v_ceil_f32 v244, v244
    v_exp_f32_e64 v246, -v244
    s_nop 0
    v_lshlrev_b32 v247, 16, v180
    v_and_b32 v248, s86, v180
    v_mul_f32 v247, v247, v246
    v_mul_f32 v248, v248, v246
    v_perm_b32 v180, v248, v247, s4
    v_lshlrev_b32 v247, 16, v181
    v_and_b32 v248, s86, v181
    v_mul_f32 v247, v247, v246
    v_mul_f32 v248, v248, v246
    v_perm_b32 v181, v248, v247, s4
    v_lshlrev_b32 v247, 16, v182
    v_and_b32 v248, s86, v182
    v_mul_f32 v247, v247, v246
    v_mul_f32 v248, v248, v246
    v_perm_b32 v182, v248, v247, s4
    v_lshlrev_b32 v247, 16, v183
    v_and_b32 v248, s86, v183
    v_mul_f32 v247, v247, v246
    v_mul_f32 v248, v248, v246
    v_perm_b32 v183, v248, v247, s4
    v_sub_f32 v72, v72, v244
    v_sub_f32 v104, v104, v244
    v_sub_f32 v73, v73, v244
    v_sub_f32 v105, v105, v244
    v_sub_f32 v74, v74, v244
    v_sub_f32 v106, v106, v244
    v_sub_f32 v75, v75, v244
    v_sub_f32 v107, v107, v244
    v_sub_f32 v76, v76, v244
    v_sub_f32 v108, v108, v244
    v_sub_f32 v77, v77, v244
    v_sub_f32 v109, v109, v244
    v_sub_f32 v78, v78, v244
    v_sub_f32 v110, v110, v244
    v_sub_f32 v79, v79, v244
    v_sub_f32 v111, v111, v244
    v_sub_f32 v132, v132, v244
    v_sub_f32 v133, v133, v244
    v_sub_f32 v134, v134, v244
    v_sub_f32 v135, v135, v244
    v_mul_f32 v197, v197, v246
    v_lshrrev_b32 v247, 2, v1
    v_add_u32 v247, s91, v247
    ds_write_b32 v247, v246 offset:2048
    s_nop 1
    v_lshrrev_b32 v247, 8, v1
    v_lshl_add_u32 v247, v247, 4, s91
    ds_read_b128 v[248:251], v247 offset:2048
    s_waitcnt lgkmcnt(0)
    v_accvgpr_read_b32 v245, a32
    v_mul_f32 v245, v245, v248
    v_accvgpr_write_b32 a32, v245
    v_accvgpr_read_b32 v245, a33
    v_mul_f32 v245, v245, v249
    v_accvgpr_write_b32 a33, v245
    v_accvgpr_read_b32 v245, a34
    v_mul_f32 v245, v245, v250
    v_accvgpr_write_b32 a34, v245
    v_accvgpr_read_b32 v245, a35
    v_mul_f32 v245, v245, v251
    v_accvgpr_write_b32 a35, v245
    v_accvgpr_read_b32 v245, a36
    v_mul_f32 v245, v245, v248
    v_accvgpr_write_b32 a36, v245
    v_accvgpr_read_b32 v245, a37
    v_mul_f32 v245, v245, v249
    v_accvgpr_write_b32 a37, v245
    v_accvgpr_read_b32 v245, a38
    v_mul_f32 v245, v245, v250
    v_accvgpr_write_b32 a38, v245
    v_accvgpr_read_b32 v245, a39
    v_mul_f32 v245, v245, v251
    v_accvgpr_write_b32 a39, v245
    v_accvgpr_read_b32 v245, a40
    v_mul_f32 v245, v245, v248
    v_accvgpr_write_b32 a40, v245
    v_accvgpr_read_b32 v245, a41
    v_mul_f32 v245, v245, v249
    v_accvgpr_write_b32 a41, v245
    v_accvgpr_read_b32 v245, a42
    v_mul_f32 v245, v245, v250
    v_accvgpr_write_b32 a42, v245
    v_accvgpr_read_b32 v245, a43
    v_mul_f32 v245, v245, v251
    v_accvgpr_write_b32 a43, v245
    v_accvgpr_read_b32 v245, a44
    v_mul_f32 v245, v245, v248
    v_accvgpr_write_b32 a44, v245
    v_accvgpr_read_b32 v245, a45
    v_mul_f32 v245, v245, v249
    v_accvgpr_write_b32 a45, v245
    v_accvgpr_read_b32 v245, a46
    v_mul_f32 v245, v245, v250
    v_accvgpr_write_b32 a46, v245
    v_accvgpr_read_b32 v245, a47
    v_mul_f32 v245, v245, v251
    v_accvgpr_write_b32 a47, v245
    v_accvgpr_read_b32 v245, a48
    v_mul_f32 v245, v245, v248
    v_accvgpr_write_b32 a48, v245
    v_accvgpr_read_b32 v245, a49
    v_mul_f32 v245, v245, v249
    v_accvgpr_write_b32 a49, v245
    v_accvgpr_read_b32 v245, a50
    v_mul_f32 v245, v245, v250
    v_accvgpr_write_b32 a50, v245
    v_accvgpr_read_b32 v245, a51
    v_mul_f32 v245, v245, v251
    v_accvgpr_write_b32 a51, v245
    v_accvgpr_read_b32 v245, a52
    v_mul_f32 v245, v245, v248
    v_accvgpr_write_b32 a52, v245
    v_accvgpr_read_b32 v245, a53
    v_mul_f32 v245, v245, v249
    v_accvgpr_write_b32 a53, v245
    v_accvgpr_read_b32 v245, a54
    v_mul_f32 v245, v245, v250
    v_accvgpr_write_b32 a54, v245
    v_accvgpr_read_b32 v245, a55
    v_mul_f32 v245, v245, v251
    v_accvgpr_write_b32 a55, v245
    v_accvgpr_read_b32 v245, a56
    v_mul_f32 v245, v245, v248
    v_accvgpr_write_b32 a56, v245
    v_accvgpr_read_b32 v245, a57
    v_mul_f32 v245, v245, v249
    v_accvgpr_write_b32 a57, v245
    v_accvgpr_read_b32 v245, a58
    v_mul_f32 v245, v245, v250
    v_accvgpr_write_b32 a58, v245
    v_accvgpr_read_b32 v245, a59
    v_mul_f32 v245, v245, v251
    v_accvgpr_write_b32 a59, v245
    v_accvgpr_read_b32 v245, a60
    v_mul_f32 v245, v245, v248
    v_accvgpr_write_b32 a60, v245
    v_accvgpr_read_b32 v245, a61
    v_mul_f32 v245, v245, v249
    v_accvgpr_write_b32 a61, v245
    v_accvgpr_read_b32 v245, a62
    v_mul_f32 v245, v245, v250
    v_accvgpr_write_b32 a62, v245
    v_accvgpr_read_b32 v245, a63
    v_mul_f32 v245, v245, v251
    v_accvgpr_write_b32 a63, v245
    v_mov_b64 v[192:193], v[196:197]
    v_mov_b64 v[194:195], v[198:199]
    v_exp_f32 v244, v64
    v_exp_f32 v245, v65
    v_exp_f32 v246, v66
    v_exp_f32 v247, v67
    v_exp_f32 v248, v68
    v_exp_f32 v249, v69
    v_exp_f32 v250, v70
    v_exp_f32 v251, v71
    s_nop 0
    v_perm_b32 v152, v245, v244, s4
    v_perm_b32 v153, v247, v246, s4
    v_perm_b32 v154, v249, v248, s4
    v_perm_b32 v155, v251, v250, s4
    v_exp_f32 v244, v72
    v_exp_f32 v245, v73
    v_exp_f32 v246, v74
    v_exp_f32 v247, v75
    v_exp_f32 v248, v76
    v_exp_f32 v249, v77
    v_exp_f32 v250, v78
    v_exp_f32 v251, v79
    s_nop 0
    v_perm_b32 v156, v245, v244, s4
    v_perm_b32 v157, v247, v246, s4
    v_perm_b32 v158, v249, v248, s4
    v_perm_b32 v159, v251, v250, s4
    s_nop 1
    v_smfmac_f32_16x16x64_bf16 v[192:195], v[144:147], v[152:159], v255
    s_nop 7
    s_nop 7
    s_setpc_b64 s[88:89]
L_rareh_6211:
    s_nop 15
    v_cndmask_b32_e64 v192, v192, 0, s[98:99]
    v_max3_f32 v244, v80, v81, v82
    v_max3_f32 v244, v244, v83, v84
    v_max3_f32 v244, v244, v85, v86
    v_max_f32 v244, v244, v87
    v_mov_b32 v245, v244
    s_nop 1
    v_permlane16_swap_b32 v244, v245
    s_nop 1
    v_max_f32 v244, v244, v245
    v_mov_b32 v245, v244
    s_nop 1
    v_permlane32_swap_b32 v244, v245
    s_nop 1
    v_max3_f32 v244, v244, v245, 0
    v_ceil_f32 v244, v244
    v_exp_f32_e64 v246, -v244
    s_nop 0
    v_lshlrev_b32 v247, 16, v56
    v_and_b32 v248, s86, v56
    v_mul_f32 v247, v247, v246
    v_mul_f32 v248, v248, v246
    v_perm_b32 v56, v248, v247, s4
    v_lshlrev_b32 v247, 16, v57
    v_and_b32 v248, s86, v57
    v_mul_f32 v247, v247, v246
    v_mul_f32 v248, v248, v246
    v_perm_b32 v57, v248, v247, s4
    v_lshlrev_b32 v247, 16, v58
    v_and_b32 v248, s86, v58
    v_mul_f32 v247, v247, v246
    v_mul_f32 v248, v248, v246
    v_perm_b32 v58, v248, v247, s4
    v_lshlrev_b32 v247, 16, v59
    v_and_b32 v248, s86, v59
    v_mul_f32 v247, v247, v246
    v_mul_f32 v248, v248, v246
    v_perm_b32 v59, v248, v247, s4
    v_sub_f32 v80, v80, v244
    v_sub_f32 v112, v112, v244
    v_sub_f32 v81, v81, v244
    v_sub_f32 v113, v113, v244
    v_sub_f32 v82, v82, v244
    v_sub_f32 v114, v114, v244
    v_sub_f32 v83, v83, v244
    v_sub_f32 v115, v115, v244
    v_sub_f32 v84, v84, v244
    v_sub_f32 v116, v116, v244
    v_sub_f32 v85, v85, v244
    v_sub_f32 v117, v117, v244
    v_sub_f32 v86, v86, v244
    v_sub_f32 v118, v118, v244
    v_sub_f32 v87, v87, v244
    v_sub_f32 v119, v119, v244
    v_sub_f32 v136, v136, v244
    v_sub_f32 v137, v137, v244
    v_sub_f32 v138, v138, v244
    v_sub_f32 v139, v139, v244
    v_mul_f32 v194, v194, v246
    v_lshrrev_b32 v247, 2, v1
    v_add_u32 v247, s91, v247
    ds_write_b32 v247, v246 offset:2048
    s_nop 1
    v_lshrrev_b32 v247, 8, v1
    v_lshl_add_u32 v247, v247, 4, s91
    ds_read_b128 v[248:251], v247 offset:2048
    s_waitcnt lgkmcnt(0)
    v_accvgpr_read_b32 v245, a64
    v_mul_f32 v245, v245, v248
    v_accvgpr_write_b32 a64, v245
    v_accvgpr_read_b32 v245, a65
    v_mul_f32 v245, v245, v249
    v_accvgpr_write_b32 a65, v245
    v_accvgpr_read_b32 v245, a66
    v_mul_f32 v245, v245, v250
    v_accvgpr_write_b32 a66, v245
    v_accvgpr_read_b32 v245, a67
    v_mul_f32 v245, v245, v251
    v_accvgpr_write_b32 a67, v245
    v_accvgpr_read_b32 v245, a68
    v_mul_f32 v245, v245, v248
    v_accvgpr_write_b32 a68, v245
    v_accvgpr_read_b32 v245, a69
    v_mul_f32 v245, v245, v249
    v_accvgpr_write_b32 a69, v245
    v_accvgpr_read_b32 v245, a70
    v_mul_f32 v245, v245, v250
    v_accvgpr_write_b32 a70, v245
    v_accvgpr_read_b32 v245, a71
    v_mul_f32 v245, v245, v251
    v_accvgpr_write_b32 a71, v245
    v_accvgpr_read_b32 v245, a72
    v_mul_f32 v245, v245, v248
    v_accvgpr_write_b32 a72, v245
    v_accvgpr_read_b32 v245, a73
    v_mul_f32 v245, v245, v249
    v_accvgpr_write_b32 a73, v245
    v_accvgpr_read_b32 v245, a74
    v_mul_f32 v245, v245, v250
    v_accvgpr_write_b32 a74, v245
    v_accvgpr_read_b32 v245, a75
    v_mul_f32 v245, v245, v251
    v_accvgpr_write_b32 a75, v245
    v_accvgpr_read_b32 v245, a76
    v_mul_f32 v245, v245, v248
    v_accvgpr_write_b32 a76, v245
    v_accvgpr_read_b32 v245, a77
    v_mul_f32 v245, v245, v249
    v_accvgpr_write_b32 a77, v245
    v_accvgpr_read_b32 v245, a78
    v_mul_f32 v245, v245, v250
    v_accvgpr_write_b32 a78, v245
    v_accvgpr_read_b32 v245, a79
    v_mul_f32 v245, v245, v251
    v_accvgpr_write_b32 a79, v245
    v_accvgpr_read_b32 v245, a80
    v_mul_f32 v245, v245, v248
    v_accvgpr_write_b32 a80, v245
    v_accvgpr_read_b32 v245, a81
    v_mul_f32 v245, v245, v249
    v_accvgpr_write_b32 a81, v245
    v_accvgpr_read_b32 v245, a82
    v_mul_f32 v245, v245, v250
    v_accvgpr_write_b32 a82, v245
    v_accvgpr_read_b32 v245, a83
    v_mul_f32 v245, v245, v251
    v_accvgpr_write_b32 a83, v245
    v_accvgpr_read_b32 v245, a84
    v_mul_f32 v245, v245, v248
    v_accvgpr_write_b32 a84, v245
    v_accvgpr_read_b32 v245, a85
    v_mul_f32 v245, v245, v249
    v_accvgpr_write_b32 a85, v245
    v_accvgpr_read_b32 v245, a86
    v_mul_f32 v245, v245, v250
    v_accvgpr_write_b32 a86, v245
    v_accvgpr_read_b32 v245, a87
    v_mul_f32 v245, v245, v251
    v_accvgpr_write_b32 a87, v245
    v_accvgpr_read_b32 v245, a88
    v_mul_f32 v245, v245, v248
    v_accvgpr_write_b32 a88, v245
    v_accvgpr_read_b32 v245, a89
    v_mul_f32 v245, v245, v249
    v_accvgpr_write_b32 a89, v245
    v_accvgpr_read_b32 v245, a90
    v_mul_f32 v245, v245, v250
    v_accvgpr_write_b32 a90, v245
    v_accvgpr_read_b32 v245, a91
    v_mul_f32 v245, v245, v251
    v_accvgpr_write_b32 a91, v245
    v_accvgpr_read_b32 v245, a92
    v_mul_f32 v245, v245, v248
    v_accvgpr_write_b32 a92, v245
    v_accvgpr_read_b32 v245, a93
    v_mul_f32 v245, v245, v249
    v_accvgpr_write_b32 a93, v245
    v_accvgpr_read_b32 v245, a94
    v_mul_f32 v245, v245, v250
    v_accvgpr_write_b32 a94, v245
    v_accvgpr_read_b32 v245, a95
    v_mul_f32 v245, v245, v251
    v_accvgpr_write_b32 a95, v245
    v_max3_f32 v244, v88, v89, v90
    v_max3_f32 v244, v244, v91, v92
    v_max3_f32 v244, v244, v93, v94
    v_max_f32 v244, v244, v95
    v_mov_b32 v245, v244
    s_nop 1
    v_permlane16_swap_b32 v244, v245
    s_nop 1
    v_max_f32 v244, v244, v245
    v_mov_b32 v245, v244
    s_nop 1
    v_permlane32_swap_b32 v244, v245
    s_nop 1
    v_max3_f32 v244, v244, v245, 0
    v_ceil_f32 v244, v244
    v_exp_f32_e64 v246, -v244
    s_nop 0
    v_lshlrev_b32 v247, 16, v60
    v_and_b32 v248, s86, v60
    v_mul_f32 v247, v247, v246
    v_mul_f32 v248, v248, v246
    v_perm_b32 v60, v248, v247, s4
    v_lshlrev_b32 v247, 16, v61
    v_and_b32 v248, s86, v61
    v_mul_f32 v247, v247, v246
    v_mul_f32 v248, v248, v246
    v_perm_b32 v61, v248, v247, s4
    v_lshlrev_b32 v247, 16, v62
    v_and_b32 v248, s86, v62
    v_mul_f32 v247, v247, v246
    v_mul_f32 v248, v248, v246
    v_perm_b32 v62, v248, v247, s4
    v_lshlrev_b32 v247, 16, v63
    v_and_b32 v248, s86, v63
    v_mul_f32 v247, v247, v246
    v_mul_f32 v248, v248, v246
    v_perm_b32 v63, v248, v247, s4
    v_sub_f32 v88, v88, v244
    v_sub_f32 v120, v120, v244
    v_sub_f32 v89, v89, v244
    v_sub_f32 v121, v121, v244
    v_sub_f32 v90, v90, v244
    v_sub_f32 v122, v122, v244
    v_sub_f32 v91, v91, v244
    v_sub_f32 v123, v123, v244
    v_sub_f32 v92, v92, v244
    v_sub_f32 v124, v124, v244
    v_sub_f32 v93, v93, v244
    v_sub_f32 v125, v125, v244
    v_sub_f32 v94, v94, v244
    v_sub_f32 v126, v126, v244
    v_sub_f32 v95, v95, v244
    v_sub_f32 v127, v127, v244
    v_sub_f32 v140, v140, v244
    v_sub_f32 v141, v141, v244
    v_sub_f32 v142, v142, v244
    v_sub_f32 v143, v143, v244
    v_mul_f32 v195, v195, v246
    v_lshrrev_b32 v247, 2, v1
    v_add_u32 v247, s91, v247
    ds_write_b32 v247, v246 offset:2048
    s_nop 1
    v_lshrrev_b32 v247, 8, v1
    v_lshl_add_u32 v247, v247, 4, s91
    ds_read_b128 v[248:251], v247 offset:2048
    s_waitcnt lgkmcnt(0)
    v_accvgpr_read_b32 v245, a96
    v_mul_f32 v245, v245, v248
    v_accvgpr_write_b32 a96, v245
    v_accvgpr_read_b32 v245, a97
    v_mul_f32 v245, v245, v249
    v_accvgpr_write_b32 a97, v245
    v_accvgpr_read_b32 v245, a98
    v_mul_f32 v245, v245, v250
    v_accvgpr_write_b32 a98, v245
    v_accvgpr_read_b32 v245, a99
    v_mul_f32 v245, v245, v251
    v_accvgpr_write_b32 a99, v245
    v_accvgpr_read_b32 v245, a100
    v_mul_f32 v245, v245, v248
    v_accvgpr_write_b32 a100, v245
    v_accvgpr_read_b32 v245, a101
    v_mul_f32 v245, v245, v249
    v_accvgpr_write_b32 a101, v245
    v_accvgpr_read_b32 v245, a102
    v_mul_f32 v245, v245, v250
    v_accvgpr_write_b32 a102, v245
    v_accvgpr_read_b32 v245, a103
    v_mul_f32 v245, v245, v251
    v_accvgpr_write_b32 a103, v245
    v_accvgpr_read_b32 v245, a104
    v_mul_f32 v245, v245, v248
    v_accvgpr_write_b32 a104, v245
    v_accvgpr_read_b32 v245, a105
    v_mul_f32 v245, v245, v249
    v_accvgpr_write_b32 a105, v245
    v_accvgpr_read_b32 v245, a106
    v_mul_f32 v245, v245, v250
    v_accvgpr_write_b32 a106, v245
    v_accvgpr_read_b32 v245, a107
    v_mul_f32 v245, v245, v251
    v_accvgpr_write_b32 a107, v245
    v_accvgpr_read_b32 v245, a108
    v_mul_f32 v245, v245, v248
    v_accvgpr_write_b32 a108, v245
    v_accvgpr_read_b32 v245, a109
    v_mul_f32 v245, v245, v249
    v_accvgpr_write_b32 a109, v245
    v_accvgpr_read_b32 v245, a110
    v_mul_f32 v245, v245, v250
    v_accvgpr_write_b32 a110, v245
    v_accvgpr_read_b32 v245, a111
    v_mul_f32 v245, v245, v251
    v_accvgpr_write_b32 a111, v245
    v_accvgpr_read_b32 v245, a112
    v_mul_f32 v245, v245, v248
    v_accvgpr_write_b32 a112, v245
    v_accvgpr_read_b32 v245, a113
    v_mul_f32 v245, v245, v249
    v_accvgpr_write_b32 a113, v245
    v_accvgpr_read_b32 v245, a114
    v_mul_f32 v245, v245, v250
    v_accvgpr_write_b32 a114, v245
    v_accvgpr_read_b32 v245, a115
    v_mul_f32 v245, v245, v251
    v_accvgpr_write_b32 a115, v245
    v_accvgpr_read_b32 v245, a116
    v_mul_f32 v245, v245, v248
    v_accvgpr_write_b32 a116, v245
    v_accvgpr_read_b32 v245, a117
    v_mul_f32 v245, v245, v249
    v_accvgpr_write_b32 a117, v245
    v_accvgpr_read_b32 v245, a118
    v_mul_f32 v245, v245, v250
    v_accvgpr_write_b32 a118, v245
    v_accvgpr_read_b32 v245, a119
    v_mul_f32 v245, v245, v251
    v_accvgpr_write_b32 a119, v245
    v_accvgpr_read_b32 v245, a120
    v_mul_f32 v245, v245, v248
    v_accvgpr_write_b32 a120, v245
    v_accvgpr_read_b32 v245, a121
    v_mul_f32 v245, v245, v249
    v_accvgpr_write_b32 a121, v245
    v_accvgpr_read_b32 v245, a122
    v_mul_f32 v245, v245, v250
    v_accvgpr_write_b32 a122, v245
    v_accvgpr_read_b32 v245, a123
    v_mul_f32 v245, v245, v251
    v_accvgpr_write_b32 a123, v245
    v_accvgpr_read_b32 v245, a124
    v_mul_f32 v245, v245, v248
    v_accvgpr_write_b32 a124, v245
    v_accvgpr_read_b32 v245, a125
    v_mul_f32 v245, v245, v249
    v_accvgpr_write_b32 a125, v245
    v_accvgpr_read_b32 v245, a126
    v_mul_f32 v245, v245, v250
    v_accvgpr_write_b32 a126, v245
    v_accvgpr_read_b32 v245, a127
    v_mul_f32 v245, v245, v251
    v_accvgpr_write_b32 a127, v245
    v_mov_b64 v[196:197], v[192:193]
    v_mov_b64 v[198:199], v[194:195]
    v_exp_f32 v244, v80
    v_exp_f32 v245, v81
    v_exp_f32 v246, v82
    v_exp_f32 v247, v83
    v_exp_f32 v248, v84
    v_exp_f32 v249, v85
    v_exp_f32 v250, v86
    v_exp_f32 v251, v87
    s_nop 0
    v_perm_b32 v184, v245, v244, s4
    v_perm_b32 v185, v247, v246, s4
    v_perm_b32 v186, v249, v248, s4
    v_perm_b32 v187, v251, v250, s4
    v_exp_f32 v244, v88
    v_exp_f32 v245, v89
    v_exp_f32 v246, v90
    v_exp_f32 v247, v91
    v_exp_f32 v248, v92
    v_exp_f32 v249, v93
    v_exp_f32 v250, v94
    v_exp_f32 v251, v95
    s_nop 0
    v_perm_b32 v188, v245, v244, s4
    v_perm_b32 v189, v247, v246, s4
    v_perm_b32 v190, v249, v248, s4
    v_perm_b32 v191, v251, v250, s4
    s_nop 1
    v_smfmac_f32_16x16x64_bf16 v[196:199], v[148:151], v[184:191], v255
    s_nop 7
    s_nop 7
    s_setpc_b64 s[88:89]
L_rareh_6301:
    s_nop 15
    v_cndmask_b32_e64 v196, v196, 0, s[98:99]
    v_max3_f32 v244, v112, v113, v114
    v_max3_f32 v244, v244, v115, v116
    v_max3_f32 v244, v244, v117, v118
    v_max_f32 v244, v244, v119
    v_mov_b32 v245, v244
    s_nop 1
    v_permlane16_swap_b32 v244, v245
    s_nop 1
    v_max_f32 v244, v244, v245
    v_mov_b32 v245, v244
    s_nop 1
    v_permlane32_swap_b32 v244, v245
    s_nop 1
    v_max3_f32 v244, v244, v245, 0
    v_ceil_f32 v244, v244
    v_exp_f32_e64 v246, -v244
    s_nop 0
    v_lshlrev_b32 v247, 16, v184
    v_and_b32 v248, s86, v184
    v_mul_f32 v247, v247, v246
    v_mul_f32 v248, v248, v246
    v_perm_b32 v184, v248, v247, s4
    v_lshlrev_b32 v247, 16, v185
    v_and_b32 v248, s86, v185
    v_mul_f32 v247, v247, v246
    v_mul_f32 v248, v248, v246
    v_perm_b32 v185, v248, v247, s4
    v_lshlrev_b32 v247, 16, v186
    v_and_b32 v248, s86, v186
    v_mul_f32 v247, v247, v246
    v_mul_f32 v248, v248, v246
    v_perm_b32 v186, v248, v247, s4
    v_lshlrev_b32 v247, 16, v187
    v_and_b32 v248, s86, v187
    v_mul_f32 v247, v247, v246
    v_mul_f32 v248, v248, v246
    v_perm_b32 v187, v248, v247, s4
    v_sub_f32 v112, v112, v244
    v_sub_f32 v80, v80, v244
    v_sub_f32 v113, v113, v244
    v_sub_f32 v81, v81, v244
    v_sub_f32 v114, v114, v244
    v_sub_f32 v82, v82, v244
    v_sub_f32 v115, v115, v244
    v_sub_f32 v83, v83, v244
    v_sub_f32 v116, v116, v244
    v_sub_f32 v84, v84, v244
    v_sub_f32 v117, v117, v244
    v_sub_f32 v85, v85, v244
    v_sub_f32 v118, v118, v244
    v_sub_f32 v86, v86, v244
    v_sub_f32 v119, v119, v244
    v_sub_f32 v87, v87, v244
    v_sub_f32 v136, v136, v244
    v_sub_f32 v137, v137, v244
    v_sub_f32 v138, v138, v244
    v_sub_f32 v139, v139, v244
    v_mul_f32 v198, v198, v246
    v_lshrrev_b32 v247, 2, v1
    v_add_u32 v247, s91, v247
    ds_write_b32 v247, v246 offset:2048
    s_nop 1
    v_lshrrev_b32 v247, 8, v1
    v_lshl_add_u32 v247, v247, 4, s91
    ds_read_b128 v[248:251], v247 offset:2048
    s_waitcnt lgkmcnt(0)
    v_accvgpr_read_b32 v245, a64
    v_mul_f32 v245, v245, v248
    v_accvgpr_write_b32 a64, v245
    v_accvgpr_read_b32 v245, a65
    v_mul_f32 v245, v245, v249
    v_accvgpr_write_b32 a65, v245
    v_accvgpr_read_b32 v245, a66
    v_mul_f32 v245, v245, v250
    v_accvgpr_write_b32 a66, v245
    v_accvgpr_read_b32 v245, a67
    v_mul_f32 v245, v245, v251
    v_accvgpr_write_b32 a67, v245
    v_accvgpr_read_b32 v245, a68
    v_mul_f32 v245, v245, v248
    v_accvgpr_write_b32 a68, v245
    v_accvgpr_read_b32 v245, a69
    v_mul_f32 v245, v245, v249
    v_accvgpr_write_b32 a69, v245
    v_accvgpr_read_b32 v245, a70
    v_mul_f32 v245, v245, v250
    v_accvgpr_write_b32 a70, v245
    v_accvgpr_read_b32 v245, a71
    v_mul_f32 v245, v245, v251
    v_accvgpr_write_b32 a71, v245
    v_accvgpr_read_b32 v245, a72
    v_mul_f32 v245, v245, v248
    v_accvgpr_write_b32 a72, v245
    v_accvgpr_read_b32 v245, a73
    v_mul_f32 v245, v245, v249
    v_accvgpr_write_b32 a73, v245
    v_accvgpr_read_b32 v245, a74
    v_mul_f32 v245, v245, v250
    v_accvgpr_write_b32 a74, v245
    v_accvgpr_read_b32 v245, a75
    v_mul_f32 v245, v245, v251
    v_accvgpr_write_b32 a75, v245
    v_accvgpr_read_b32 v245, a76
    v_mul_f32 v245, v245, v248
    v_accvgpr_write_b32 a76, v245
    v_accvgpr_read_b32 v245, a77
    v_mul_f32 v245, v245, v249
    v_accvgpr_write_b32 a77, v245
    v_accvgpr_read_b32 v245, a78
    v_mul_f32 v245, v245, v250
    v_accvgpr_write_b32 a78, v245
    v_accvgpr_read_b32 v245, a79
    v_mul_f32 v245, v245, v251
    v_accvgpr_write_b32 a79, v245
    v_accvgpr_read_b32 v245, a80
    v_mul_f32 v245, v245, v248
    v_accvgpr_write_b32 a80, v245
    v_accvgpr_read_b32 v245, a81
    v_mul_f32 v245, v245, v249
    v_accvgpr_write_b32 a81, v245
    v_accvgpr_read_b32 v245, a82
    v_mul_f32 v245, v245, v250
    v_accvgpr_write_b32 a82, v245
    v_accvgpr_read_b32 v245, a83
    v_mul_f32 v245, v245, v251
    v_accvgpr_write_b32 a83, v245
    v_accvgpr_read_b32 v245, a84
    v_mul_f32 v245, v245, v248
    v_accvgpr_write_b32 a84, v245
    v_accvgpr_read_b32 v245, a85
    v_mul_f32 v245, v245, v249
    v_accvgpr_write_b32 a85, v245
    v_accvgpr_read_b32 v245, a86
    v_mul_f32 v245, v245, v250
    v_accvgpr_write_b32 a86, v245
    v_accvgpr_read_b32 v245, a87
    v_mul_f32 v245, v245, v251
    v_accvgpr_write_b32 a87, v245
    v_accvgpr_read_b32 v245, a88
    v_mul_f32 v245, v245, v248
    v_accvgpr_write_b32 a88, v245
    v_accvgpr_read_b32 v245, a89
    v_mul_f32 v245, v245, v249
    v_accvgpr_write_b32 a89, v245
    v_accvgpr_read_b32 v245, a90
    v_mul_f32 v245, v245, v250
    v_accvgpr_write_b32 a90, v245
    v_accvgpr_read_b32 v245, a91
    v_mul_f32 v245, v245, v251
    v_accvgpr_write_b32 a91, v245
    v_accvgpr_read_b32 v245, a92
    v_mul_f32 v245, v245, v248
    v_accvgpr_write_b32 a92, v245
    v_accvgpr_read_b32 v245, a93
    v_mul_f32 v245, v245, v249
    v_accvgpr_write_b32 a93, v245
    v_accvgpr_read_b32 v245, a94
    v_mul_f32 v245, v245, v250
    v_accvgpr_write_b32 a94, v245
    v_accvgpr_read_b32 v245, a95
    v_mul_f32 v245, v245, v251
    v_accvgpr_write_b32 a95, v245
    v_max3_f32 v244, v120, v121, v122
    v_max3_f32 v244, v244, v123, v124
    v_max3_f32 v244, v244, v125, v126
    v_max_f32 v244, v244, v127
    v_mov_b32 v245, v244
    s_nop 1
    v_permlane16_swap_b32 v244, v245
    s_nop 1
    v_max_f32 v244, v244, v245
    v_mov_b32 v245, v244
    s_nop 1
    v_permlane32_swap_b32 v244, v245
    s_nop 1
    v_max3_f32 v244, v244, v245, 0
    v_ceil_f32 v244, v244
    v_exp_f32_e64 v246, -v244
    s_nop 0
    v_lshlrev_b32 v247, 16, v188
    v_and_b32 v248, s86, v188
    v_mul_f32 v247, v247, v246
    v_mul_f32 v248, v248, v246
    v_perm_b32 v188, v248, v247, s4
    v_lshlrev_b32 v247, 16, v189
    v_and_b32 v248, s86, v189
    v_mul_f32 v247, v247, v246
    v_mul_f32 v248, v248, v246
    v_perm_b32 v189, v248, v247, s4
    v_lshlrev_b32 v247, 16, v190
    v_and_b32 v248, s86, v190
    v_mul_f32 v247, v247, v246
    v_mul_f32 v248, v248, v246
    v_perm_b32 v190, v248, v247, s4
    v_lshlrev_b32 v247, 16, v191
    v_and_b32 v248, s86, v191
    v_mul_f32 v247, v247, v246
    v_mul_f32 v248, v248, v246
    v_perm_b32 v191, v248, v247, s4
    v_sub_f32 v120, v120, v244
    v_sub_f32 v88, v88, v244
    v_sub_f32 v121, v121, v244
    v_sub_f32 v89, v89, v244
    v_sub_f32 v122, v122, v244
    v_sub_f32 v90, v90, v244
    v_sub_f32 v123, v123, v244
    v_sub_f32 v91, v91, v244
    v_sub_f32 v124, v124, v244
    v_sub_f32 v92, v92, v244
    v_sub_f32 v125, v125, v244
    v_sub_f32 v93, v93, v244
    v_sub_f32 v126, v126, v244
    v_sub_f32 v94, v94, v244
    v_sub_f32 v127, v127, v244
    v_sub_f32 v95, v95, v244
    v_sub_f32 v140, v140, v244
    v_sub_f32 v141, v141, v244
    v_sub_f32 v142, v142, v244
    v_sub_f32 v143, v143, v244
    v_mul_f32 v199, v199, v246
    v_lshrrev_b32 v247, 2, v1
    v_add_u32 v247, s91, v247
    ds_write_b32 v247, v246 offset:2048
    s_nop 1
    v_lshrrev_b32 v247, 8, v1
    v_lshl_add_u32 v247, v247, 4, s91
    ds_read_b128 v[248:251], v247 offset:2048
    s_waitcnt lgkmcnt(0)
    v_accvgpr_read_b32 v245, a96
    v_mul_f32 v245, v245, v248
    v_accvgpr_write_b32 a96, v245
    v_accvgpr_read_b32 v245, a97
    v_mul_f32 v245, v245, v249
    v_accvgpr_write_b32 a97, v245
    v_accvgpr_read_b32 v245, a98
    v_mul_f32 v245, v245, v250
    v_accvgpr_write_b32 a98, v245
    v_accvgpr_read_b32 v245, a99
    v_mul_f32 v245, v245, v251
    v_accvgpr_write_b32 a99, v245
    v_accvgpr_read_b32 v245, a100
    v_mul_f32 v245, v245, v248
    v_accvgpr_write_b32 a100, v245
    v_accvgpr_read_b32 v245, a101
    v_mul_f32 v245, v245, v249
    v_accvgpr_write_b32 a101, v245
    v_accvgpr_read_b32 v245, a102
    v_mul_f32 v245, v245, v250
    v_accvgpr_write_b32 a102, v245
    v_accvgpr_read_b32 v245, a103
    v_mul_f32 v245, v245, v251
    v_accvgpr_write_b32 a103, v245
    v_accvgpr_read_b32 v245, a104
    v_mul_f32 v245, v245, v248
    v_accvgpr_write_b32 a104, v245
    v_accvgpr_read_b32 v245, a105
    v_mul_f32 v245, v245, v249
    v_accvgpr_write_b32 a105, v245
    v_accvgpr_read_b32 v245, a106
    v_mul_f32 v245, v245, v250
    v_accvgpr_write_b32 a106, v245
    v_accvgpr_read_b32 v245, a107
    v_mul_f32 v245, v245, v251
    v_accvgpr_write_b32 a107, v245
    v_accvgpr_read_b32 v245, a108
    v_mul_f32 v245, v245, v248
    v_accvgpr_write_b32 a108, v245
    v_accvgpr_read_b32 v245, a109
    v_mul_f32 v245, v245, v249
    v_accvgpr_write_b32 a109, v245
    v_accvgpr_read_b32 v245, a110
    v_mul_f32 v245, v245, v250
    v_accvgpr_write_b32 a110, v245
    v_accvgpr_read_b32 v245, a111
    v_mul_f32 v245, v245, v251
    v_accvgpr_write_b32 a111, v245
    v_accvgpr_read_b32 v245, a112
    v_mul_f32 v245, v245, v248
    v_accvgpr_write_b32 a112, v245
    v_accvgpr_read_b32 v245, a113
    v_mul_f32 v245, v245, v249
    v_accvgpr_write_b32 a113, v245
    v_accvgpr_read_b32 v245, a114
    v_mul_f32 v245, v245, v250
    v_accvgpr_write_b32 a114, v245
    v_accvgpr_read_b32 v245, a115
    v_mul_f32 v245, v245, v251
    v_accvgpr_write_b32 a115, v245
    v_accvgpr_read_b32 v245, a116
    v_mul_f32 v245, v245, v248
    v_accvgpr_write_b32 a116, v245
    v_accvgpr_read_b32 v245, a117
    v_mul_f32 v245, v245, v249
    v_accvgpr_write_b32 a117, v245
    v_accvgpr_read_b32 v245, a118
    v_mul_f32 v245, v245, v250
    v_accvgpr_write_b32 a118, v245
    v_accvgpr_read_b32 v245, a119
    v_mul_f32 v245, v245, v251
    v_accvgpr_write_b32 a119, v245
    v_accvgpr_read_b32 v245, a120
    v_mul_f32 v245, v245, v248
    v_accvgpr_write_b32 a120, v245
    v_accvgpr_read_b32 v245, a121
    v_mul_f32 v245, v245, v249
    v_accvgpr_write_b32 a121, v245
    v_accvgpr_read_b32 v245, a122
    v_mul_f32 v245, v245, v250
    v_accvgpr_write_b32 a122, v245
    v_accvgpr_read_b32 v245, a123
    v_mul_f32 v245, v245, v251
    v_accvgpr_write_b32 a123, v245
    v_accvgpr_read_b32 v245, a124
    v_mul_f32 v245, v245, v248
    v_accvgpr_write_b32 a124, v245
    v_accvgpr_read_b32 v245, a125
    v_mul_f32 v245, v245, v249
    v_accvgpr_write_b32 a125, v245
    v_accvgpr_read_b32 v245, a126
    v_mul_f32 v245, v245, v250
    v_accvgpr_write_b32 a126, v245
    v_accvgpr_read_b32 v245, a127
    v_mul_f32 v245, v245, v251
    v_accvgpr_write_b32 a127, v245
    v_mov_b64 v[192:193], v[196:197]
    v_mov_b64 v[194:195], v[198:199]
    v_exp_f32 v244, v112
    v_exp_f32 v245, v113
    v_exp_f32 v246, v114
    v_exp_f32 v247, v115
    v_exp_f32 v248, v116
    v_exp_f32 v249, v117
    v_exp_f32 v250, v118
    v_exp_f32 v251, v119
    s_nop 0
    v_perm_b32 v168, v245, v244, s4
    v_perm_b32 v169, v247, v246, s4
    v_perm_b32 v170, v249, v248, s4
    v_perm_b32 v171, v251, v250, s4
    v_exp_f32 v244, v120
    v_exp_f32 v245, v121
    v_exp_f32 v246, v122
    v_exp_f32 v247, v123
    v_exp_f32 v248, v124
    v_exp_f32 v249, v125
    v_exp_f32 v250, v126
    v_exp_f32 v251, v127
    s_nop 0
    v_perm_b32 v172, v245, v244, s4
    v_perm_b32 v173, v247, v246, s4
    v_perm_b32 v174, v249, v248, s4
    v_perm_b32 v175, v251, v250, s4
    s_nop 1
    v_smfmac_f32_16x16x64_bf16 v[192:195], v[148:151], v[168:175], v255
    s_nop 7
    s_nop 7
    s_setpc_b64 s[88:89]
L_rareh_6310:
    s_nop 15
    v_cndmask_b32_e64 v192, v192, 0, s[98:99]
    v_max3_f32 v244, v96, v97, v98
    v_max3_f32 v244, v244, v99, v100
    v_max3_f32 v244, v244, v101, v102
    v_max_f32 v244, v244, v103
    v_mov_b32 v245, v244
    s_nop 1
    v_permlane16_swap_b32 v244, v245
    s_nop 1
    v_max_f32 v244, v244, v245
    v_mov_b32 v245, v244
    s_nop 1
    v_permlane32_swap_b32 v244, v245
    s_nop 1
    v_max3_f32 v244, v244, v245, 0
    v_ceil_f32 v244, v244
    v_exp_f32_e64 v246, -v244
    s_nop 0
    v_lshlrev_b32 v247, 16, v152
    v_and_b32 v248, s86, v152
    v_mul_f32 v247, v247, v246
    v_mul_f32 v248, v248, v246
    v_perm_b32 v152, v248, v247, s4
    v_lshlrev_b32 v247, 16, v153
    v_and_b32 v248, s86, v153
    v_mul_f32 v247, v247, v246
    v_mul_f32 v248, v248, v246
    v_perm_b32 v153, v248, v247, s4
    v_lshlrev_b32 v247, 16, v154
    v_and_b32 v248, s86, v154
    v_mul_f32 v247, v247, v246
    v_mul_f32 v248, v248, v246
    v_perm_b32 v154, v248, v247, s4
    v_lshlrev_b32 v247, 16, v155
    v_and_b32 v248, s86, v155
    v_mul_f32 v247, v247, v246
    v_mul_f32 v248, v248, v246
    v_perm_b32 v155, v248, v247, s4
    v_sub_f32 v96, v96, v244
    v_sub_f32 v64, v64, v244
    v_sub_f32 v97, v97, v244
    v_sub_f32 v65, v65, v244
    v_sub_f32 v98, v98, v244
    v_sub_f32 v66, v66, v244
    v_sub_f32 v99, v99, v244
    v_sub_f32 v67, v67, v244
    v_sub_f32 v100, v100, v244
    v_sub_f32 v68, v68, v244
    v_sub_f32 v101, v101, v244
    v_sub_f32 v69, v69, v244
    v_sub_f32 v102, v102, v244
    v_sub_f32 v70, v70, v244
    v_sub_f32 v103, v103, v244
    v_sub_f32 v71, v71, v244
    v_sub_f32 v128, v128, v244
    v_sub_f32 v129, v129, v244
    v_sub_f32 v130, v130, v244
    v_sub_f32 v131, v131, v244
    v_mul_f32 v192, v192, v246
    v_lshrrev_b32 v247, 2, v1
    v_add_u32 v247, s91, v247
    ds_write_b32 v247, v246 offset:2048
    s_nop 1
    v_lshrrev_b32 v247, 8, v1
    v_lshl_add_u32 v247, v247, 4, s91
    ds_read_b128 v[248:251], v247 offset:2048
    s_waitcnt lgkmcnt(0)
    v_accvgpr_read_b32 v245, a0
    v_mul_f32 v245, v245, v248
    v_accvgpr_write_b32 a0, v245
    v_accvgpr_read_b32 v245, a1
    v_mul_f32 v245, v245, v249
    v_accvgpr_write_b32 a1, v245
    v_accvgpr_read_b32 v245, a2
    v_mul_f32 v245, v245, v250
    v_accvgpr_write_b32 a2, v245
    v_accvgpr_read_b32 v245, a3
    v_mul_f32 v245, v245, v251
    v_accvgpr_write_b32 a3, v245
    v_accvgpr_read_b32 v245, a4
    v_mul_f32 v245, v245, v248
    v_accvgpr_write_b32 a4, v245
    v_accvgpr_read_b32 v245, a5
    v_mul_f32 v245, v245, v249
    v_accvgpr_write_b32 a5, v245
    v_accvgpr_read_b32 v245, a6
    v_mul_f32 v245, v245, v250
    v_accvgpr_write_b32 a6, v245
    v_accvgpr_read_b32 v245, a7
    v_mul_f32 v245, v245, v251
    v_accvgpr_write_b32 a7, v245
    v_accvgpr_read_b32 v245, a8
    v_mul_f32 v245, v245, v248
    v_accvgpr_write_b32 a8, v245
    v_accvgpr_read_b32 v245, a9
    v_mul_f32 v245, v245, v249
    v_accvgpr_write_b32 a9, v245
    v_accvgpr_read_b32 v245, a10
    v_mul_f32 v245, v245, v250
    v_accvgpr_write_b32 a10, v245
    v_accvgpr_read_b32 v245, a11
    v_mul_f32 v245, v245, v251
    v_accvgpr_write_b32 a11, v245
    v_accvgpr_read_b32 v245, a12
    v_mul_f32 v245, v245, v248
    v_accvgpr_write_b32 a12, v245
    v_accvgpr_read_b32 v245, a13
    v_mul_f32 v245, v245, v249
    v_accvgpr_write_b32 a13, v245
    v_accvgpr_read_b32 v245, a14
    v_mul_f32 v245, v245, v250
    v_accvgpr_write_b32 a14, v245
    v_accvgpr_read_b32 v245, a15
    v_mul_f32 v245, v245, v251
    v_accvgpr_write_b32 a15, v245
    v_accvgpr_read_b32 v245, a16
    v_mul_f32 v245, v245, v248
    v_accvgpr_write_b32 a16, v245
    v_accvgpr_read_b32 v245, a17
    v_mul_f32 v245, v245, v249
    v_accvgpr_write_b32 a17, v245
    v_accvgpr_read_b32 v245, a18
    v_mul_f32 v245, v245, v250
    v_accvgpr_write_b32 a18, v245
    v_accvgpr_read_b32 v245, a19
    v_mul_f32 v245, v245, v251
    v_accvgpr_write_b32 a19, v245
    v_accvgpr_read_b32 v245, a20
    v_mul_f32 v245, v245, v248
    v_accvgpr_write_b32 a20, v245
    v_accvgpr_read_b32 v245, a21
    v_mul_f32 v245, v245, v249
    v_accvgpr_write_b32 a21, v245
    v_accvgpr_read_b32 v245, a22
    v_mul_f32 v245, v245, v250
    v_accvgpr_write_b32 a22, v245
    v_accvgpr_read_b32 v245, a23
    v_mul_f32 v245, v245, v251
    v_accvgpr_write_b32 a23, v245
    v_accvgpr_read_b32 v245, a24
    v_mul_f32 v245, v245, v248
    v_accvgpr_write_b32 a24, v245
    v_accvgpr_read_b32 v245, a25
    v_mul_f32 v245, v245, v249
    v_accvgpr_write_b32 a25, v245
    v_accvgpr_read_b32 v245, a26
    v_mul_f32 v245, v245, v250
    v_accvgpr_write_b32 a26, v245
    v_accvgpr_read_b32 v245, a27
    v_mul_f32 v245, v245, v251
    v_accvgpr_write_b32 a27, v245
    v_accvgpr_read_b32 v245, a28
    v_mul_f32 v245, v245, v248
    v_accvgpr_write_b32 a28, v245
    v_accvgpr_read_b32 v245, a29
    v_mul_f32 v245, v245, v249
    v_accvgpr_write_b32 a29, v245
    v_accvgpr_read_b32 v245, a30
    v_mul_f32 v245, v245, v250
    v_accvgpr_write_b32 a30, v245
    v_accvgpr_read_b32 v245, a31
    v_mul_f32 v245, v245, v251
    v_accvgpr_write_b32 a31, v245
    v_max3_f32 v244, v104, v105, v106
    v_max3_f32 v244, v244, v107, v108
    v_max3_f32 v244, v244, v109, v110
    v_max_f32 v244, v244, v111
    v_mov_b32 v245, v244
    s_nop 1
    v_permlane16_swap_b32 v244, v245
    s_nop 1
    v_max_f32 v244, v244, v245
    v_mov_b32 v245, v244
    s_nop 1
    v_permlane32_swap_b32 v244, v245
    s_nop 1
    v_max3_f32 v244, v244, v245, 0
    v_ceil_f32 v244, v244
    v_exp_f32_e64 v246, -v244
    s_nop 0
    v_lshlrev_b32 v247, 16, v156
    v_and_b32 v248, s86, v156
    v_mul_f32 v247, v247, v246
    v_mul_f32 v248, v248, v246
    v_perm_b32 v156, v248, v247, s4
    v_lshlrev_b32 v247, 16, v157
    v_and_b32 v248, s86, v157
    v_mul_f32 v247, v247, v246
    v_mul_f32 v248, v248, v246
    v_perm_b32 v157, v248, v247, s4
    v_lshlrev_b32 v247, 16, v158
    v_and_b32 v248, s86, v158
    v_mul_f32 v247, v247, v246
    v_mul_f32 v248, v248, v246
    v_perm_b32 v158, v248, v247, s4
    v_lshlrev_b32 v247, 16, v159
    v_and_b32 v248, s86, v159
    v_mul_f32 v247, v247, v246
    v_mul_f32 v248, v248, v246
    v_perm_b32 v159, v248, v247, s4
    v_sub_f32 v104, v104, v244
    v_sub_f32 v72, v72, v244
    v_sub_f32 v105, v105, v244
    v_sub_f32 v73, v73, v244
    v_sub_f32 v106, v106, v244
    v_sub_f32 v74, v74, v244
    v_sub_f32 v107, v107, v244
    v_sub_f32 v75, v75, v244
    v_sub_f32 v108, v108, v244
    v_sub_f32 v76, v76, v244
    v_sub_f32 v109, v109, v244
    v_sub_f32 v77, v77, v244
    v_sub_f32 v110, v110, v244
    v_sub_f32 v78, v78, v244
    v_sub_f32 v111, v111, v244
    v_sub_f32 v79, v79, v244
    v_sub_f32 v132, v132, v244
    v_sub_f32 v133, v133, v244
    v_sub_f32 v134, v134, v244
    v_sub_f32 v135, v135, v244
    v_mul_f32 v193, v193, v246
    v_lshrrev_b32 v247, 2, v1
    v_add_u32 v247, s91, v247
    ds_write_b32 v247, v246 offset:2048
    s_nop 1
    v_lshrrev_b32 v247, 8, v1
    v_lshl_add_u32 v247, v247, 4, s91
    ds_read_b128 v[248:251], v247 offset:2048
    s_waitcnt lgkmcnt(0)
    v_accvgpr_read_b32 v245, a32
    v_mul_f32 v245, v245, v248
    v_accvgpr_write_b32 a32, v245
    v_accvgpr_read_b32 v245, a33
    v_mul_f32 v245, v245, v249
    v_accvgpr_write_b32 a33, v245
    v_accvgpr_read_b32 v245, a34
    v_mul_f32 v245, v245, v250
    v_accvgpr_write_b32 a34, v245
    v_accvgpr_read_b32 v245, a35
    v_mul_f32 v245, v245, v251
    v_accvgpr_write_b32 a35, v245
    v_accvgpr_read_b32 v245, a36
    v_mul_f32 v245, v245, v248
    v_accvgpr_write_b32 a36, v245
    v_accvgpr_read_b32 v245, a37
    v_mul_f32 v245, v245, v249
    v_accvgpr_write_b32 a37, v245
    v_accvgpr_read_b32 v245, a38
    v_mul_f32 v245, v245, v250
    v_accvgpr_write_b32 a38, v245
    v_accvgpr_read_b32 v245, a39
    v_mul_f32 v245, v245, v251
    v_accvgpr_write_b32 a39, v245
    v_accvgpr_read_b32 v245, a40
    v_mul_f32 v245, v245, v248
    v_accvgpr_write_b32 a40, v245
    v_accvgpr_read_b32 v245, a41
    v_mul_f32 v245, v245, v249
    v_accvgpr_write_b32 a41, v245
    v_accvgpr_read_b32 v245, a42
    v_mul_f32 v245, v245, v250
    v_accvgpr_write_b32 a42, v245
    v_accvgpr_read_b32 v245, a43
    v_mul_f32 v245, v245, v251
    v_accvgpr_write_b32 a43, v245
    v_accvgpr_read_b32 v245, a44
    v_mul_f32 v245, v245, v248
    v_accvgpr_write_b32 a44, v245
    v_accvgpr_read_b32 v245, a45
    v_mul_f32 v245, v245, v249
    v_accvgpr_write_b32 a45, v245
    v_accvgpr_read_b32 v245, a46
    v_mul_f32 v245, v245, v250
    v_accvgpr_write_b32 a46, v245
    v_accvgpr_read_b32 v245, a47
    v_mul_f32 v245, v245, v251
    v_accvgpr_write_b32 a47, v245
    v_accvgpr_read_b32 v245, a48
    v_mul_f32 v245, v245, v248
    v_accvgpr_write_b32 a48, v245
    v_accvgpr_read_b32 v245, a49
    v_mul_f32 v245, v245, v249
    v_accvgpr_write_b32 a49, v245
    v_accvgpr_read_b32 v245, a50
    v_mul_f32 v245, v245, v250
    v_accvgpr_write_b32 a50, v245
    v_accvgpr_read_b32 v245, a51
    v_mul_f32 v245, v245, v251
    v_accvgpr_write_b32 a51, v245
    v_accvgpr_read_b32 v245, a52
    v_mul_f32 v245, v245, v248
    v_accvgpr_write_b32 a52, v245
    v_accvgpr_read_b32 v245, a53
    v_mul_f32 v245, v245, v249
    v_accvgpr_write_b32 a53, v245
    v_accvgpr_read_b32 v245, a54
    v_mul_f32 v245, v245, v250
    v_accvgpr_write_b32 a54, v245
    v_accvgpr_read_b32 v245, a55
    v_mul_f32 v245, v245, v251
    v_accvgpr_write_b32 a55, v245
    v_accvgpr_read_b32 v245, a56
    v_mul_f32 v245, v245, v248
    v_accvgpr_write_b32 a56, v245
    v_accvgpr_read_b32 v245, a57
    v_mul_f32 v245, v245, v249
    v_accvgpr_write_b32 a57, v245
    v_accvgpr_read_b32 v245, a58
    v_mul_f32 v245, v245, v250
    v_accvgpr_write_b32 a58, v245
    v_accvgpr_read_b32 v245, a59
    v_mul_f32 v245, v245, v251
    v_accvgpr_write_b32 a59, v245
    v_accvgpr_read_b32 v245, a60
    v_mul_f32 v245, v245, v248
    v_accvgpr_write_b32 a60, v245
    v_accvgpr_read_b32 v245, a61
    v_mul_f32 v245, v245, v249
    v_accvgpr_write_b32 a61, v245
    v_accvgpr_read_b32 v245, a62
    v_mul_f32 v245, v245, v250
    v_accvgpr_write_b32 a62, v245
    v_accvgpr_read_b32 v245, a63
    v_mul_f32 v245, v245, v251
    v_accvgpr_write_b32 a63, v245
    v_mov_b64 v[196:197], v[192:193]
    v_mov_b64 v[198:199], v[194:195]
    v_exp_f32 v244, v96
    v_exp_f32 v245, v97
    v_exp_f32 v246, v98
    v_exp_f32 v247, v99
    v_exp_f32 v248, v100
    v_exp_f32 v249, v101
    v_exp_f32 v250, v102
    v_exp_f32 v251, v103
    s_nop 0
    v_perm_b32 v236, v245, v244, s4
    v_perm_b32 v237, v247, v246, s4
    v_perm_b32 v238, v249, v248, s4
    v_perm_b32 v239, v251, v250, s4
    v_exp_f32 v244, v104
    v_exp_f32 v245, v105
    v_exp_f32 v246, v106
    v_exp_f32 v247, v107
    v_exp_f32 v248, v108
    v_exp_f32 v249, v109
    v_exp_f32 v250, v110
    v_exp_f32 v251, v111
    s_nop 0
    v_perm_b32 v240, v245, v244, s4
    v_perm_b32 v241, v247, v246, s4
    v_perm_b32 v242, v249, v248, s4
    v_perm_b32 v243, v251, v250, s4
    s_nop 1
    v_smfmac_f32_16x16x64_bf16 v[196:199], v[144:147], v[236:243], v255
    s_nop 7
    s_nop 7
    s_setpc_b64 s[88:89]
L_spin_p0:
    s_mov_b32 s92, 0x8000
L_spinl_p0:
    s_sleep 1
    buffer_load_dwordx2 v[6:7], v3, s[24:27], s83 offen sc1
    s_waitcnt vmcnt(0)
    v_cmp_ne_u64 vcc, v[6:7], v[4:5]
    s_cbranch_vccz L_spinret_p0
    s_sub_u32 s92, s92, 1
    s_cmp_lg_u32 s92, 0
    s_cbranch_scc1 L_spinl_p0
    s_branch L_spinret_p0
L_spin_r0k:
    s_mov_b32 s92, 0x8000
L_spinl_r0k:
    s_sleep 1
    buffer_load_dwordx2 v[6:7], v3, s[24:27], s83 offen sc1
    s_waitcnt vmcnt(0)
    v_cmp_ne_u64_e64 vcc, v[6:7], v[4:5]
    s_cbranch_vccz L_spinret_r0k
    s_sub_u32 s92, s92, 1
    s_cmp_lg_u32 s92, 0
    s_cbranch_scc1 L_spinl_r0k
    s_branch L_spinret_r0k
L_spin_r0v:
    s_mov_b32 s92, 0x8000
L_spinl_r0v:
    s_sleep 1
    buffer_load_dwordx2 v[6:7], v3, s[24:27], s84 offen sc1
    s_waitcnt vmcnt(0)
    v_cmp_ne_u64 vcc, v[6:7], v[4:5]
    s_cbranch_vccz L_spinret_r0v
    s_sub_u32 s92, s92, 1
    s_cmp_lg_u32 s92, 0
    s_cbranch_scc1 L_spinl_r0v
    s_branch L_spinret_r0v
L_spin_rlk:
    s_mov_b32 s92, 0x8000
L_spinl_rlk:
    s_sleep 1
    buffer_load_dwordx2 v[6:7], v3, s[24:27], s83 offen sc1
    s_waitcnt vmcnt(0)
    v_cmp_ne_u64 vcc, v[6:7], v[4:5]
    s_cbranch_vccz L_spinret_rlk
    s_sub_u32 s92, s92, 1
    s_cmp_lg_u32 s92, 0
    s_cbranch_scc1 L_spinl_rlk
    s_branch L_spinret_rlk
L_spin_rlv:
    s_mov_b32 s92, 0x8000
L_spinl_rlv:
    s_sleep 1
    buffer_load_dwordx2 v[6:7], v3, s[24:27], s84 offen sc1
    s_waitcnt vmcnt(0)
    v_cmp_ne_u64 vcc, v[6:7], v[4:5]
    s_cbranch_vccz L_spinret_rlv
    s_sub_u32 s92, s92, 1
    s_cmp_lg_u32 s92, 0
    s_cbranch_scc1 L_spinl_rlv
    s_branch L_spinret_rlv
L_spin_r6k:
    s_mov_b32 s92, 0x8000
L_spinl_r6k:
    s_sleep 1
    buffer_load_dwordx2 v[6:7], v3, s[24:27], s83 offen sc1
    s_waitcnt vmcnt(0)
    v_cmp_ne_u64 vcc, v[6:7], v[4:5]
    s_cbranch_vccz L_spinret_r6k
    s_sub_u32 s92, s92, 1
    s_cmp_lg_u32 s92, 0
    s_cbranch_scc1 L_spinl_r6k
    s_branch L_spinret_r6k
L_spin_r6v:
    s_mov_b32 s92, 0x8000
L_spinl_r6v:
    s_sleep 1
    buffer_load_dwordx2 v[6:7], v3, s[24:27], s84 offen sc1
    s_waitcnt vmcnt(0)
    v_cmp_ne_u64 vcc, v[6:7], v[4:5]
    s_cbranch_vccz L_spinret_r6v
    s_sub_u32 s92, s92, 1
    s_cmp_lg_u32 s92, 0
    s_cbranch_scc1 L_spinl_r6v
    s_branch L_spinret_r6v
L_bad:
    v_lshlrev_b32 v213, 4, v1
    v_mov_b32 v215, 1
    s_lshr_b32 s14, s90, 20
    s_lshl4_add_u32 s14, s14, 10
    buffer_store_byte v215, v213, s[8:11], s14 offen sc1
    s_waitcnt vmcnt(0)
    s_branch L_bad_ret
L_verdict:
    s_bitcmp1_b32 s2, 31
    s_cbranch_scc1 L_verdict_ret
    s_mov_b32 s92, 0x8000
L_verdict_l:
    v_cmp_lt_u32 vcc, 0xffff, v213
    s_nop 1
    s_cbranch_vccnz L_restart
    v_cmp_eq_u32 vcc, 0x101, v213
    s_nop 1
    s_cmp_eq_u64 vcc, 0xffff
    s_cbranch_scc1 L_verdict_ret
    s_sleep 1
    buffer_load_dword v213, v1, s[8:11], 0 offen offset:8 sc1
    s_waitcnt vmcnt(0)
    s_sub_u32 s92, s92, 1
    s_cmp_lg_u32 s92, 0
    s_cbranch_scc1 L_verdict_l
    s_branch L_verdict_ret
L_restart:
    s_waitcnt vmcnt(0) lgkmcnt(0)
    s_barrier
    s_bitset1_b32 s2, 31
    v_lshrrev_b32 v0, 4, v1
    s_lshl_b32 s3, s96, 6
    v_add_u32 v0, s3, v0
    s_nop 15
    s_branch L_again
L_prepass:
    s_add_u32 s24, s24, 0x8000000
    s_addc_u32 s25, s25, 0
    s_mov_b32 s93, 0xe0000
    s_mov_b32 s94, 0x70000
    s_mov_b32 s95, 0x3800
    s_mov_b32 s92, 0xe00000
L_pk:
    s_lshr_b32 s93, s92, 5
    s_lshl1_add_u32 s93, s93, s77
    s_and_b32 s93, s93, 0xfffff
    s_lshr_b32 s94, s93, 1
    s_lshr_b32 s95, s93, 6
    buffer_load_dwordx4 v[128:131], v8, s[28:31], s93 offen offset:0
    buffer_load_dwordx4 v[132:135], v8, s[28:31], s93 offen offset:16
    buffer_load_dwordx4 v[136:139], v8, s[28:31], s93 offen offset:256
    buffer_load_dwordx4 v[140:143], v8, s[28:31], s93 offen offset:272
    buffer_load_dwordx2 v[176:177], v10, s[32:35], s95 offen
    buffer_load_dwordx2 v[178:179], v10, s[36:39], s95 offen
    buffer_load_dwordx4 v[160:163], v9, s[40:43], s94 offen offset:0
    buffer_load_dwordx4 v[164:167], v9, s[40:43], s94 offen offset:128
    buffer_load_dwordx4 v[168:171], v9, s[44:47], s94 offen offset:0
    buffer_load_dwordx4 v[172:175], v9, s[44:47], s94 offen offset:128
    s_waitcnt vmcnt(0)
    v_cvt_f32_i32 v144, v128
    v_cvt_f32_i32 v145, v129
    v_cvt_f32_i32 v146, v130
    v_cvt_f32_i32 v147, v131
    v_cvt_f32_i32 v148, v132
    v_cvt_f32_i32 v149, v133
    v_cvt_f32_i32 v150, v134
    v_cvt_f32_i32 v151, v135
    v_cvt_f32_i32 v152, v136
    v_cvt_f32_i32 v153, v137
    v_cvt_f32_i32 v154, v138
    v_cvt_f32_i32 v155, v139
    v_cvt_f32_i32 v156, v140
    v_cvt_f32_i32 v157, v141
    v_cvt_f32_i32 v158, v142
    v_cvt_f32_i32 v159, v143
    v_perm_b32 v176, v176, v176, s87
    v_perm_b32 v177, v177, v177, s87
    v_perm_b32 v178, v178, v178, s87
    v_perm_b32 v179, v179, v179, s87
    v_mul_f32 v176, s85, v176
    v_mul_f32 v177, s85, v177
    v_mul_f32_e64 v178, -v178, v176
    v_mul_f32_e64 v179, -v179, v177
    v_fma_f32 v144, v144, v176, v178
    v_fma_f32 v152, v152, v177, v179
    v_lshlrev_b32 v212, 16, v160
    v_lshlrev_b32 v213, 16, v164
    v_lshlrev_b32 v214, 16, v168
    v_lshlrev_b32 v215, 16, v172
    v_fma_f32 v204, v144, v212, s62
    v_fma_f32 v208, v152, v213, s62
    v_fma_f32 v204, -v152, v214, v204
    v_fma_f32 v208, v144, v215, v208
    v_fma_f32 v145, v145, v176, v178
    v_fma_f32 v153, v153, v177, v179
    v_and_b32 v212, s86, v160
    v_and_b32 v213, s86, v164
    v_and_b32 v214, s86, v168
    v_and_b32 v215, s86, v172
    v_fma_f32 v205, v145, v212, s62
    v_fma_f32 v209, v153, v213, s62
    v_fma_f32 v205, -v153, v214, v205
    v_fma_f32 v209, v145, v215, v209
    v_fma_f32 v146, v146, v176, v178
    v_fma_f32 v154, v154, v177, v179
    v_lshlrev_b32 v212, 16, v161
    v_lshlrev_b32 v213, 16, v165
    v_lshlrev_b32 v214, 16, v169
    v_lshlrev_b32 v215, 16, v173
    v_fma_f32 v206, v146, v212, s62
    v_fma_f32 v210, v154, v213, s62
    v_fma_f32 v206, -v154, v214, v206
    v_fma_f32 v210, v146, v215, v210
    v_fma_f32 v147, v147, v176, v178
    v_fma_f32 v155, v155, v177, v179
    v_and_b32 v212, s86, v161
    v_and_b32 v213, s86, v165
    v_and_b32 v214, s86, v169
    v_and_b32 v215, s86, v173
    v_fma_f32 v207, v147, v212, s62
    v_fma_f32 v211, v155, v213, s62
    v_fma_f32 v207, -v155, v214, v207
    v_fma_f32 v211, v147, v215, v211
    v_cvt_pk_bf16_f32 v144, v204, v205
    v_cvt_pk_bf16_f32 v145, v206, v207
    v_cvt_pk_bf16_f32 v146, v208, v209
    v_cvt_pk_bf16_f32 v147, v210, v211
    buffer_store_dwordx4 v[144:147], v0, s[24:27], s92 offen offset:0 sc1
    ds_write_b128 v234, v[144:147] offset:0
    v_fma_f32 v148, v148, v176, v178
    v_fma_f32 v156, v156, v177, v179
    v_lshlrev_b32 v212, 16, v162
    v_lshlrev_b32 v213, 16, v166
    v_lshlrev_b32 v214, 16, v170
    v_lshlrev_b32 v215, 16, v174
    v_fma_f32 v204, v148, v212, s62
    v_fma_f32 v208, v156, v213, s62
    v_fma_f32 v204, -v156, v214, v204
    v_fma_f32 v208, v148, v215, v208
    v_fma_f32 v149, v149, v176, v178
    v_fma_f32 v157, v157, v177, v179
    v_and_b32 v212, s86, v162
    v_and_b32 v213, s86, v166
    v_and_b32 v214, s86, v170
    v_and_b32 v215, s86, v174
    v_fma_f32 v205, v149, v212, s62
    v_fma_f32 v209, v157, v213, s62
    v_fma_f32 v205, -v157, v214, v205
    v_fma_f32 v209, v149, v215, v209
    v_fma_f32 v150, v150, v176, v178
    v_fma_f32 v158, v158, v177, v179
    v_lshlrev_b32 v212, 16, v163
    v_lshlrev_b32 v213, 16, v167
    v_lshlrev_b32 v214, 16, v171
    v_lshlrev_b32 v215, 16, v175
    v_fma_f32 v206, v150, v212, s62
    v_fma_f32 v210, v158, v213, s62
    v_fma_f32 v206, -v158, v214, v206
    v_fma_f32 v210, v150, v215, v210
    v_fma_f32 v151, v151, v176, v178
    v_fma_f32 v159, v159, v177, v179
    v_and_b32 v212, s86, v163
    v_and_b32 v213, s86, v167
    v_and_b32 v214, s86, v171
    v_and_b32 v215, s86, v175
    v_fma_f32 v207, v151, v212, s62
    v_fma_f32 v211, v159, v213, s62
    v_fma_f32 v207, -v159, v214, v207
    v_fma_f32 v211, v151, v215, v211
    v_cvt_pk_bf16_f32 v148, v204, v205
    v_cvt_pk_bf16_f32 v149, v206, v207
    v_cvt_pk_bf16_f32 v150, v208, v209
    v_cvt_pk_bf16_f32 v151, v210, v211
    buffer_store_dwordx4 v[148:151], v0, s[24:27], s92 offen offset:1024 sc1
    ds_write_b128 v234, v[148:151] offset:1024
    s_sub_u32 s93, s93, 0x20000
    s_sub_u32 s94, s94, 0x10000
    s_sub_u32 s95, s95, 0x800
    s_sub_u32 s92, s92, 0x200000
    s_cbranch_scc0 L_pk
    v_mov_b32 v160, v14
    s_mov_b32 s92, 4
L_pq:
    s_sub_u32 s93, 4, s92
    s_lshl_b32 s93, s93, 12
    s_xor_b32 s93, s93, s64
    v_add_u32 v160, s93, v14
    buffer_load_dwordx4 v[128:131], v160, s[8:11], s90 offen offset:0
    buffer_load_dwordx4 v[132:135], v160, s[8:11], s90 offen offset:128
    buffer_load_dwordx4 v[136:139], v160, s[12:15], 0 offen offset:0
    buffer_load_dwordx4 v[140:143], v160, s[12:15], 0 offen offset:128
    buffer_load_dwordx4 v[144:147], v160, s[16:19], 0 offen offset:0
    buffer_load_dwordx4 v[148:151], v160, s[16:19], 0 offen offset:128
    s_waitcnt vmcnt(0)
    v_perm_b32 v192, v132, v128, s3
    v_perm_b32 v193, v132, v128, s4
    v_perm_b32 v194, v144, v136, s3
    v_perm_b32 v195, v144, v136, s4
    v_perm_b32 v196, v140, v148, s3
    v_perm_b32 v197, v140, v148, s4
    v_dot2_f32_bf16 v136, v192, v194, 0 neg_hi:[1,0,0]
    v_dot2_f32_bf16 v144, v193, v195, 0 neg_hi:[1,0,0]
    v_dot2_f32_bf16 v140, v192, v196, 0
    v_dot2_f32_bf16 v148, v193, v197, 0
    v_perm_b32 v192, v133, v129, s3
    v_perm_b32 v193, v133, v129, s4
    v_perm_b32 v194, v145, v137, s3
    v_perm_b32 v195, v145, v137, s4
    v_perm_b32 v196, v141, v149, s3
    v_perm_b32 v197, v141, v149, s4
    v_dot2_f32_bf16 v137, v192, v194, 0 neg_hi:[1,0,0]
    v_dot2_f32_bf16 v145, v193, v195, 0 neg_hi:[1,0,0]
    v_dot2_f32_bf16 v141, v192, v196, 0
    v_dot2_f32_bf16 v149, v193, v197, 0
    v_perm_b32 v192, v134, v130, s3
    v_perm_b32 v193, v134, v130, s4
    v_perm_b32 v194, v146, v138, s3
    v_perm_b32 v195, v146, v138, s4
    v_perm_b32 v196, v142, v150, s3
    v_perm_b32 v197, v142, v150, s4
    v_dot2_f32_bf16 v138, v192, v194, 0 neg_hi:[1,0,0]
    v_dot2_f32_bf16 v146, v193, v195, 0 neg_hi:[1,0,0]
    v_dot2_f32_bf16 v142, v192, v196, 0
    v_dot2_f32_bf16 v150, v193, v197, 0
    v_perm_b32 v192, v135, v131, s3
    v_perm_b32 v193, v135, v131, s4
    v_perm_b32 v194, v147, v139, s3
    v_perm_b32 v195, v147, v139, s4
    v_perm_b32 v196, v143, v151, s3
    v_perm_b32 v197, v143, v151, s4
    v_dot2_f32_bf16 v139, v192, v194, 0 neg_hi:[1,0,0]
    v_dot2_f32_bf16 v147, v193, v195, 0 neg_hi:[1,0,0]
    v_dot2_f32_bf16 v143, v192, v196, 0
    v_dot2_f32_bf16 v151, v193, v197, 0
    v_cvt_pk_bf16_f32 v152, v136, v144
    v_cvt_pk_bf16_f32 v154, v140, v148
    v_cvt_pk_bf16_f32 v153, v137, v145
    v_cvt_pk_bf16_f32 v155, v141, v149
    v_cvt_pk_bf16_f32 v156, v138, v146
    v_cvt_pk_bf16_f32 v158, v142, v150
    v_cvt_pk_bf16_f32 v157, v139, v147
    v_cvt_pk_bf16_f32 v159, v143, v151
    ds_write_b128 v253, v[152:155] offset:0
    ds_write_b128 v253, v[156:159] offset:1024
    buffer_load_dwordx4 v[128:131], v160, s[8:11], s90 offen offset:64
    buffer_load_dwordx4 v[132:135], v160, s[8:11], s90 offen offset:192
    buffer_load_dwordx4 v[136:139], v160, s[12:15], 0 offen offset:64
    buffer_load_dwordx4 v[140:143], v160, s[12:15], 0 offen offset:192
    buffer_load_dwordx4 v[144:147], v160, s[16:19], 0 offen offset:64
    buffer_load_dwordx4 v[148:151], v160, s[16:19], 0 offen offset:192
    s_waitcnt vmcnt(0)
    v_perm_b32 v192, v132, v128, s3
    v_perm_b32 v193, v132, v128, s4
    v_perm_b32 v194, v144, v136, s3
    v_perm_b32 v195, v144, v136, s4
    v_perm_b32 v196, v140, v148, s3
    v_perm_b32 v197, v140, v148, s4
    v_dot2_f32_bf16 v136, v192, v194, 0 neg_hi:[1,0,0]
    v_dot2_f32_bf16 v144, v193, v195, 0 neg_hi:[1,0,0]
    v_dot2_f32_bf16 v140, v192, v196, 0
    v_dot2_f32_bf16 v148, v193, v197, 0
    v_perm_b32 v192, v133, v129, s3
    v_perm_b32 v193, v133, v129, s4
    v_perm_b32 v194, v145, v137, s3
    v_perm_b32 v195, v145, v137, s4
    v_perm_b32 v196, v141, v149, s3
    v_perm_b32 v197, v141, v149, s4
    v_dot2_f32_bf16 v137, v192, v194, 0 neg_hi:[1,0,0]
    v_dot2_f32_bf16 v145, v193, v195, 0 neg_hi:[1,0,0]
    v_dot2_f32_bf16 v141, v192, v196, 0
    v_dot2_f32_bf16 v149, v193, v197, 0
    v_perm_b32 v192, v134, v130, s3
    v_perm_b32 v193, v134, v130, s4
    v_perm_b32 v194, v146, v138, s3
    v_perm_b32 v195, v146, v138, s4
    v_perm_b32 v196, v142, v150, s3
    v_perm_b32 v197, v142, v150, s4
    v_dot2_f32_bf16 v138, v192, v194, 0 neg_hi:[1,0,0]
    v_dot2_f32_bf16 v146, v193, v195, 0 neg_hi:[1,0,0]
    v_dot2_f32_bf16 v142, v192, v196, 0
    v_dot2_f32_bf16 v150, v193, v197, 0
    v_perm_b32 v192, v135, v131, s3
    v_perm_b32 v193, v135, v131, s4
    v_perm_b32 v194, v147, v139, s3
    v_perm_b32 v195, v147, v139, s4
    v_perm_b32 v196, v143, v151, s3
    v_perm_b32 v197, v143, v151, s4
    v_dot2_f32_bf16 v139, v192, v194, 0 neg_hi:[1,0,0]
    v_dot2_f32_bf16 v147, v193, v195, 0 neg_hi:[1,0,0]
    v_dot2_f32_bf16 v143, v192, v196, 0
    v_dot2_f32_bf16 v151, v193, v197, 0
    v_cvt_pk_bf16_f32 v152, v136, v144
    v_cvt_pk_bf16_f32 v154, v140, v148
    v_cvt_pk_bf16_f32 v153, v137, v145
    v_cvt_pk_bf16_f32 v155, v141, v149
    v_cvt_pk_bf16_f32 v156, v138, v146
    v_cvt_pk_bf16_f32 v158, v142, v150
    v_cvt_pk_bf16_f32 v157, v139, v147
    v_cvt_pk_bf16_f32 v159, v143, v151
    ds_write_b128 v253, v[152:155] offset:2048
    ds_write_b128 v253, v[156:159] offset:3072
    v_add_u32 v160, 4096, v160
    s_nop 0
    v_add_u32 v253, 4096, v253
    s_sub_u32 s92, s92, 1
    s_cmp_lg_u32 s92, 0
    s_cbranch_scc1 L_pq
    s_mov_b32 s79, 0x7f000000
    v_add_u32 v234, 8192, v234
    v_add_u32 v253, 132096, v1
    s_waitcnt vmcnt(0) lgkmcnt(0)
    s_branch L_prepass_ret
L_rare_sub0:
    s_nop 15
    v_max3_f32 v244, v64, v65, v66
    v_max3_f32 v244, v244, v67, v68
    v_max3_f32 v244, v244, v69, v70
    v_max_f32 v244, v244, v71
    v_mov_b32 v245, v244
    s_nop 1
    v_permlane16_swap_b32 v244, v245
    s_nop 1
    v_max_f32 v244, v244, v245
    v_mov_b32 v245, v244
    s_nop 1
    v_permlane32_swap_b32 v244, v245
    s_nop 1
    v_max3_f32 v244, v244, v245, 0
    v_ceil_f32 v244, v244
    v_exp_f32_e64 v246, -v244
    s_nop 0
    v_lshlrev_b32 v247, 16, v236
    v_and_b32 v248, s86, v236
    v_mul_f32 v247, v247, v246
    v_mul_f32 v248, v248, v246
    v_perm_b32 v236, v248, v247, s4
    v_lshlrev_b32 v247, 16, v237
    v_and_b32 v248, s86, v237
    v_mul_f32 v247, v247, v246
    v_mul_f32 v248, v248, v246
    v_perm_b32 v237, v248, v247, s4
    v_lshlrev_b32 v247, 16, v238
    v_and_b32 v248, s86, v238
    v_mul_f32 v247, v247, v246
    v_mul_f32 v248, v248, v246
    v_perm_b32 v238, v248, v247, s4
    v_lshlrev_b32 v247, 16, v239
    v_and_b32 v248, s86, v239
    v_mul_f32 v247, v247, v246
    v_mul_f32 v248, v248, v246
    v_perm_b32 v239, v248, v247, s4
    v_sub_f32 v64, v64, v244
    v_sub_f32 v96, v96, v244
    v_sub_f32 v65, v65, v244
    v_sub_f32 v97, v97, v244
    v_sub_f32 v66, v66, v244
    v_sub_f32 v98, v98, v244
    v_sub_f32 v67, v67, v244
    v_sub_f32 v99, v99, v244
    v_sub_f32 v68, v68, v244
    v_sub_f32 v100, v100, v244
    v_sub_f32 v69, v69, v244
    v_sub_f32 v101, v101, v244
    v_sub_f32 v70, v70, v244
    v_sub_f32 v102, v102, v244
    v_sub_f32 v71, v71, v244
    v_sub_f32 v103, v103, v244
    v_sub_f32 v128, v128, v244
    v_sub_f32 v129, v129, v244
    v_sub_f32 v130, v130, v244
    v_sub_f32 v131, v131, v244
    v_cndmask_b32_e64 v245, v246, 0, s[98:99]
    v_mul_f32 v196, v196, v245
    v_lshrrev_b32 v247, 2, v1
    v_add_u32 v247, s91, v247
    ds_write_b32 v247, v246 offset:2048
    s_nop 1
    v_lshrrev_b32 v247, 8, v1
    v_lshl_add_u32 v247, v247, 4, s91
    ds_read_b128 v[248:251], v247 offset:2048
    s_waitcnt lgkmcnt(0)
    v_accvgpr_read_b32 v245, a0
    v_mul_f32 v245, v245, v248
    v_accvgpr_write_b32 a0, v245
    v_accvgpr_read_b32 v245, a1
    v_mul_f32 v245, v245, v249
    v_accvgpr_write_b32 a1, v245
    v_accvgpr_read_b32 v245, a2
    v_mul_f32 v245, v245, v250
    v_accvgpr_write_b32 a2, v245
    v_accvgpr_read_b32 v245, a3
    v_mul_f32 v245, v245, v251
    v_accvgpr_write_b32 a3, v245
    v_accvgpr_read_b32 v245, a4
    v_mul_f32 v245, v245, v248
    v_accvgpr_write_b32 a4, v245
    v_accvgpr_read_b32 v245, a5
    v_mul_f32 v245, v245, v249
    v_accvgpr_write_b32 a5, v245
    v_accvgpr_read_b32 v245, a6
    v_mul_f32 v245, v245, v250
    v_accvgpr_write_b32 a6, v245
    v_accvgpr_read_b32 v245, a7
    v_mul_f32 v245, v245, v251
    v_accvgpr_write_b32 a7, v245
    v_accvgpr_read_b32 v245, a8
    v_mul_f32 v245, v245, v248
    v_accvgpr_write_b32 a8, v245
    v_accvgpr_read_b32 v245, a9
    v_mul_f32 v245, v245, v249
    v_accvgpr_write_b32 a9, v245
    v_accvgpr_read_b32 v245, a10
    v_mul_f32 v245, v245, v250
    v_accvgpr_write_b32 a10, v245
    v_accvgpr_read_b32 v245, a11
    v_mul_f32 v245, v245, v251
    v_accvgpr_write_b32 a11, v245
    v_accvgpr_read_b32 v245, a12
    v_mul_f32 v245, v245, v248
    v_accvgpr_write_b32 a12, v245
    v_accvgpr_read_b32 v245, a13
    v_mul_f32 v245, v245, v249
    v_accvgpr_write_b32 a13, v245
    v_accvgpr_read_b32 v245, a14
    v_mul_f32 v245, v245, v250
    v_accvgpr_write_b32 a14, v245
    v_accvgpr_read_b32 v245, a15
    v_mul_f32 v245, v245, v251
    v_accvgpr_write_b32 a15, v245
    v_accvgpr_read_b32 v245, a16
    v_mul_f32 v245, v245, v248
    v_accvgpr_write_b32 a16, v245
    v_accvgpr_read_b32 v245, a17
    v_mul_f32 v245, v245, v249
    v_accvgpr_write_b32 a17, v245
    v_accvgpr_read_b32 v245, a18
    v_mul_f32 v245, v245, v250
    v_accvgpr_write_b32 a18, v245
    v_accvgpr_read_b32 v245, a19
    v_mul_f32 v245, v245, v251
    v_accvgpr_write_b32 a19, v245
    v_accvgpr_read_b32 v245, a20
    v_mul_f32 v245, v245, v248
    v_accvgpr_write_b32 a20, v245
    v_accvgpr_read_b32 v245, a21
    v_mul_f32 v245, v245, v249
    v_accvgpr_write_b32 a21, v245
    v_accvgpr_read_b32 v245, a22
    v_mul_f32 v245, v245, v250
    v_accvgpr_write_b32 a22, v245
    v_accvgpr_read_b32 v245, a23
    v_mul_f32 v245, v245, v251
    v_accvgpr_write_b32 a23, v245
    v_accvgpr_read_b32 v245, a24
    v_mul_f32 v245, v245, v248
    v_accvgpr_write_b32 a24, v245
    v_accvgpr_read_b32 v245, a25
    v_mul_f32 v245, v245, v249
    v_accvgpr_write_b32 a25, v245
    v_accvgpr_read_b32 v245, a26
    v_mul_f32 v245, v245, v250
    v_accvgpr_write_b32 a26, v245
    v_accvgpr_read_b32 v245, a27
    v_mul_f32 v245, v245, v251
    v_accvgpr_write_b32 a27, v245
    v_accvgpr_read_b32 v245, a28
    v_mul_f32 v245, v245, v248
    v_accvgpr_write_b32 a28, v245
    v_accvgpr_read_b32 v245, a29
    v_mul_f32 v245, v245, v249
    v_accvgpr_write_b32 a29, v245
    v_accvgpr_read_b32 v245, a30
    v_mul_f32 v245, v245, v250
    v_accvgpr_write_b32 a30, v245
    v_accvgpr_read_b32 v245, a31
    v_mul_f32 v245, v245, v251
    v_accvgpr_write_b32 a31, v245
    v_max3_f32 v244, v72, v73, v74
    v_max3_f32 v244, v244, v75, v76
    v_max3_f32 v244, v244, v77, v78
    v_max_f32 v244, v244, v79
    v_mov_b32 v245, v244
    s_nop 1
    v_permlane16_swap_b32 v244, v245
    s_nop 1
    v_max_f32 v244, v244, v245
    v_mov_b32 v245, v244
    s_nop 1
    v_permlane32_swap_b32 v244, v245
    s_nop 1
    v_max3_f32 v244, v244, v245, 0
    v_ceil_f32 v244, v244
    v_exp_f32_e64 v246, -v244
    s_nop 0
    v_lshlrev_b32 v247, 16, v240
    v_and_b32 v248, s86, v240
    v_mul_f32 v247, v247, v246
    v_mul_f32 v248, v248, v246
    v_perm_b32 v240, v248, v247, s4
    v_lshlrev_b32 v247, 16, v241
    v_and_b32 v248, s86, v241
    v_mul_f32 v247, v247, v246
    v_mul_f32 v248, v248, v246
    v_perm_b32 v241, v248, v247, s4
    v_lshlrev_b32 v247, 16, v242
    v_and_b32 v248, s86, v242
    v_mul_f32 v247, v247, v246
    v_mul_f32 v248, v248, v246
    v_perm_b32 v242, v248, v247, s4
    v_lshlrev_b32 v247, 16, v243
    v_and_b32 v248, s86, v243
    v_mul_f32 v247, v247, v246
    v_mul_f32 v248, v248, v246
    v_perm_b32 v243, v248, v247, s4
    v_sub_f32 v72, v72, v244
    v_sub_f32 v104, v104, v244
    v_sub_f32 v73, v73, v244
    v_sub_f32 v105, v105, v244
    v_sub_f32 v74, v74, v244
    v_sub_f32 v106, v106, v244
    v_sub_f32 v75, v75, v244
    v_sub_f32 v107, v107, v244
    v_sub_f32 v76, v76, v244
    v_sub_f32 v108, v108, v244
    v_sub_f32 v77, v77, v244
    v_sub_f32 v109, v109, v244
    v_sub_f32 v78, v78, v244
    v_sub_f32 v110, v110, v244
    v_sub_f32 v79, v79, v244
    v_sub_f32 v111, v111, v244
    v_sub_f32 v132, v132, v244
    v_sub_f32 v133, v133, v244
    v_sub_f32 v134, v134, v244
    v_sub_f32 v135, v135, v244
    v_mul_f32 v197, v197, v246
    v_lshrrev_b32 v247, 2, v1
    v_add_u32 v247, s91, v247
    ds_write_b32 v247, v246 offset:2048
    s_nop 1
    v_lshrrev_b32 v247, 8, v1
    v_lshl_add_u32 v247, v247, 4, s91
    ds_read_b128 v[248:251], v247 offset:2048
    s_waitcnt lgkmcnt(0)
    v_accvgpr_read_b32 v245, a32
    v_mul_f32 v245, v245, v248
    v_accvgpr_write_b32 a32, v245
    v_accvgpr_read_b32 v245, a33
    v_mul_f32 v245, v245, v249
    v_accvgpr_write_b32 a33, v245
    v_accvgpr_read_b32 v245, a34
    v_mul_f32 v245, v245, v250
    v_accvgpr_write_b32 a34, v245
    v_accvgpr_read_b32 v245, a35
    v_mul_f32 v245, v245, v251
    v_accvgpr_write_b32 a35, v245
    v_accvgpr_read_b32 v245, a36
    v_mul_f32 v245, v245, v248
    v_accvgpr_write_b32 a36, v245
    v_accvgpr_read_b32 v245, a37
    v_mul_f32 v245, v245, v249
    v_accvgpr_write_b32 a37, v245
    v_accvgpr_read_b32 v245, a38
    v_mul_f32 v245, v245, v250
    v_accvgpr_write_b32 a38, v245
    v_accvgpr_read_b32 v245, a39
    v_mul_f32 v245, v245, v251
    v_accvgpr_write_b32 a39, v245
    v_accvgpr_read_b32 v245, a40
    v_mul_f32 v245, v245, v248
    v_accvgpr_write_b32 a40, v245
    v_accvgpr_read_b32 v245, a41
    v_mul_f32 v245, v245, v249
    v_accvgpr_write_b32 a41, v245
    v_accvgpr_read_b32 v245, a42
    v_mul_f32 v245, v245, v250
    v_accvgpr_write_b32 a42, v245
    v_accvgpr_read_b32 v245, a43
    v_mul_f32 v245, v245, v251
    v_accvgpr_write_b32 a43, v245
    v_accvgpr_read_b32 v245, a44
    v_mul_f32 v245, v245, v248
    v_accvgpr_write_b32 a44, v245
    v_accvgpr_read_b32 v245, a45
    v_mul_f32 v245, v245, v249
    v_accvgpr_write_b32 a45, v245
    v_accvgpr_read_b32 v245, a46
    v_mul_f32 v245, v245, v250
    v_accvgpr_write_b32 a46, v245
    v_accvgpr_read_b32 v245, a47
    v_mul_f32 v245, v245, v251
    v_accvgpr_write_b32 a47, v245
    v_accvgpr_read_b32 v245, a48
    v_mul_f32 v245, v245, v248
    v_accvgpr_write_b32 a48, v245
    v_accvgpr_read_b32 v245, a49
    v_mul_f32 v245, v245, v249
    v_accvgpr_write_b32 a49, v245
    v_accvgpr_read_b32 v245, a50
    v_mul_f32 v245, v245, v250
    v_accvgpr_write_b32 a50, v245
    v_accvgpr_read_b32 v245, a51
    v_mul_f32 v245, v245, v251
    v_accvgpr_write_b32 a51, v245
    v_accvgpr_read_b32 v245, a52
    v_mul_f32 v245, v245, v248
    v_accvgpr_write_b32 a52, v245
    v_accvgpr_read_b32 v245, a53
    v_mul_f32 v245, v245, v249
    v_accvgpr_write_b32 a53, v245
    v_accvgpr_read_b32 v245, a54
    v_mul_f32 v245, v245, v250
    v_accvgpr_write_b32 a54, v245
    v_accvgpr_read_b32 v245, a55
    v_mul_f32 v245, v245, v251
    v_accvgpr_write_b32 a55, v245
    v_accvgpr_read_b32 v245, a56
    v_mul_f32 v245, v245, v248
    v_accvgpr_write_b32 a56, v245
    v_accvgpr_read_b32 v245, a57
    v_mul_f32 v245, v245, v249
    v_accvgpr_write_b32 a57, v245
    v_accvgpr_read_b32 v245, a58
    v_mul_f32 v245, v245, v250
    v_accvgpr_write_b32 a58, v245
    v_accvgpr_read_b32 v245, a59
    v_mul_f32 v245, v245, v251
    v_accvgpr_write_b32 a59, v245
    v_accvgpr_read_b32 v245, a60
    v_mul_f32 v245, v245, v248
    v_accvgpr_write_b32 a60, v245
    v_accvgpr_read_b32 v245, a61
    v_mul_f32 v245, v245, v249
    v_accvgpr_write_b32 a61, v245
    v_accvgpr_read_b32 v245, a62
    v_mul_f32 v245, v245, v250
    v_accvgpr_write_b32 a62, v245
    v_accvgpr_read_b32 v245, a63
    v_mul_f32 v245, v245, v251
    v_accvgpr_write_b32 a63, v245
    v_max3_f32 v244, v80, v81, v82
    v_max3_f32 v244, v244, v83, v84
    v_max3_f32 v244, v244, v85, v86
    v_max_f32 v244, v244, v87
    v_mov_b32 v245, v244
    s_nop 1
    v_permlane16_swap_b32 v244, v245
    s_nop 1
    v_max_f32 v244, v244, v245
    v_mov_b32 v245, v244
    s_nop 1
    v_permlane32_swap_b32 v244, v245
    s_nop 1
    v_max3_f32 v244, v244, v245, 0
    v_ceil_f32 v244, v244
    v_exp_f32_e64 v246, -v244
    s_nop 0
    v_lshlrev_b32 v247, 16, v184
    v_and_b32 v248, s86, v184
    v_mul_f32 v247, v247, v246
    v_mul_f32 v248, v248, v246
    v_perm_b32 v184, v248, v247, s4
    v_lshlrev_b32 v247, 16, v185
    v_and_b32 v248, s86, v185
    v_mul_f32 v247, v247, v246
    v_mul_f32 v248, v248, v246
    v_perm_b32 v185, v248, v247, s4
    v_lshlrev_b32 v247, 16, v186
    v_and_b32 v248, s86, v186
    v_mul_f32 v247, v247, v246
    v_mul_f32 v248, v248, v246
    v_perm_b32 v186, v248, v247, s4
    v_lshlrev_b32 v247, 16, v187
    v_and_b32 v248, s86, v187
    v_mul_f32 v247, v247, v246
    v_mul_f32 v248, v248, v246
    v_perm_b32 v187, v248, v247, s4
    v_sub_f32 v80, v80, v244
    v_sub_f32 v112, v112, v244
    v_sub_f32 v81, v81, v244
    v_sub_f32 v113, v113, v244
    v_sub_f32 v82, v82, v244
    v_sub_f32 v114, v114, v244
    v_sub_f32 v83, v83, v244
    v_sub_f32 v115, v115, v244
    v_sub_f32 v84, v84, v244
    v_sub_f32 v116, v116, v244
    v_sub_f32 v85, v85, v244
    v_sub_f32 v117, v117, v244
    v_sub_f32 v86, v86, v244
    v_sub_f32 v118, v118, v244
    v_sub_f32 v87, v87, v244
    v_sub_f32 v119, v119, v244
    v_sub_f32 v136, v136, v244
    v_sub_f32 v137, v137, v244
    v_sub_f32 v138, v138, v244
    v_sub_f32 v139, v139, v244
    v_mul_f32 v198, v198, v246
    v_lshrrev_b32 v247, 2, v1
    v_add_u32 v247, s91, v247
    ds_write_b32 v247, v246 offset:2048
    s_nop 1
    v_lshrrev_b32 v247, 8, v1
    v_lshl_add_u32 v247, v247, 4, s91
    ds_read_b128 v[248:251], v247 offset:2048
    s_waitcnt lgkmcnt(0)
    v_accvgpr_read_b32 v245, a64
    v_mul_f32 v245, v245, v248
    v_accvgpr_write_b32 a64, v245
    v_accvgpr_read_b32 v245, a65
    v_mul_f32 v245, v245, v249
    v_accvgpr_write_b32 a65, v245
    v_accvgpr_read_b32 v245, a66
    v_mul_f32 v245, v245, v250
    v_accvgpr_write_b32 a66, v245
    v_accvgpr_read_b32 v245, a67
    v_mul_f32 v245, v245, v251
    v_accvgpr_write_b32 a67, v245
    v_accvgpr_read_b32 v245, a68
    v_mul_f32 v245, v245, v248
    v_accvgpr_write_b32 a68, v245
    v_accvgpr_read_b32 v245, a69
    v_mul_f32 v245, v245, v249
    v_accvgpr_write_b32 a69, v245
    v_accvgpr_read_b32 v245, a70
    v_mul_f32 v245, v245, v250
    v_accvgpr_write_b32 a70, v245
    v_accvgpr_read_b32 v245, a71
    v_mul_f32 v245, v245, v251
    v_accvgpr_write_b32 a71, v245
    v_accvgpr_read_b32 v245, a72
    v_mul_f32 v245, v245, v248
    v_accvgpr_write_b32 a72, v245
    v_accvgpr_read_b32 v245, a73
    v_mul_f32 v245, v245, v249
    v_accvgpr_write_b32 a73, v245
    v_accvgpr_read_b32 v245, a74
    v_mul_f32 v245, v245, v250
    v_accvgpr_write_b32 a74, v245
    v_accvgpr_read_b32 v245, a75
    v_mul_f32 v245, v245, v251
    v_accvgpr_write_b32 a75, v245
    v_accvgpr_read_b32 v245, a76
    v_mul_f32 v245, v245, v248
    v_accvgpr_write_b32 a76, v245
    v_accvgpr_read_b32 v245, a77
    v_mul_f32 v245, v245, v249
    v_accvgpr_write_b32 a77, v245
    v_accvgpr_read_b32 v245, a78
    v_mul_f32 v245, v245, v250
    v_accvgpr_write_b32 a78, v245
    v_accvgpr_read_b32 v245, a79
    v_mul_f32 v245, v245, v251
    v_accvgpr_write_b32 a79, v245
    v_accvgpr_read_b32 v245, a80
    v_mul_f32 v245, v245, v248
    v_accvgpr_write_b32 a80, v245
    v_accvgpr_read_b32 v245, a81
    v_mul_f32 v245, v245, v249
    v_accvgpr_write_b32 a81, v245
    v_accvgpr_read_b32 v245, a82
    v_mul_f32 v245, v245, v250
    v_accvgpr_write_b32 a82, v245
    v_accvgpr_read_b32 v245, a83
    v_mul_f32 v245, v245, v251
    v_accvgpr_write_b32 a83, v245
    v_accvgpr_read_b32 v245, a84
    v_mul_f32 v245, v245, v248
    v_accvgpr_write_b32 a84, v245
    v_accvgpr_read_b32 v245, a85
    v_mul_f32 v245, v245, v249
    v_accvgpr_write_b32 a85, v245
    v_accvgpr_read_b32 v245, a86
    v_mul_f32 v245, v245, v250
    v_accvgpr_write_b32 a86, v245
    v_accvgpr_read_b32 v245, a87
    v_mul_f32 v245, v245, v251
    v_accvgpr_write_b32 a87, v245
    v_accvgpr_read_b32 v245, a88
    v_mul_f32 v245, v245, v248
    v_accvgpr_write_b32 a88, v245
    v_accvgpr_read_b32 v245, a89
    v_mul_f32 v245, v245, v249
    v_accvgpr_write_b32 a89, v245
    v_accvgpr_read_b32 v245, a90
    v_mul_f32 v245, v245, v250
    v_accvgpr_write_b32 a90, v245
    v_accvgpr_read_b32 v245, a91
    v_mul_f32 v245, v245, v251
    v_accvgpr_write_b32 a91, v245
    v_accvgpr_read_b32 v245, a92
    v_mul_f32 v245, v245, v248
    v_accvgpr_write_b32 a92, v245
    v_accvgpr_read_b32 v245, a93
    v_mul_f32 v245, v245, v249
    v_accvgpr_write_b32 a93, v245
    v_accvgpr_read_b32 v245, a94
    v_mul_f32 v245, v245, v250
    v_accvgpr_write_b32 a94, v245
    v_accvgpr_read_b32 v245, a95
    v_mul_f32 v245, v245, v251
    v_accvgpr_write_b32 a95, v245
    v_max3_f32 v244, v88, v89, v90
    v_max3_f32 v244, v244, v91, v92
    v_max3_f32 v244, v244, v93, v94
    v_max_f32 v244, v244, v95
    v_mov_b32 v245, v244
    s_nop 1
    v_permlane16_swap_b32 v244, v245
    s_nop 1
    v_max_f32 v244, v244, v245
    v_mov_b32 v245, v244
    s_nop 1
    v_permlane32_swap_b32 v244, v245
    s_nop 1
    v_max3_f32 v244, v244, v245, 0
    v_ceil_f32 v244, v244
    v_exp_f32_e64 v246, -v244
    s_nop 0
    v_lshlrev_b32 v247, 16, v188
    v_and_b32 v248, s86, v188
    v_mul_f32 v247, v247, v246
    v_mul_f32 v248, v248, v246
    v_perm_b32 v188, v248, v247, s4
    v_lshlrev_b32 v247, 16, v189
    v_and_b32 v248, s86, v189
    v_mul_f32 v247, v247, v246
    v_mul_f32 v248, v248, v246
    v_perm_b32 v189, v248, v247, s4
    v_lshlrev_b32 v247, 16, v190
    v_and_b32 v248, s86, v190
    v_mul_f32 v247, v247, v246
    v_mul_f32 v248, v248, v246
    v_perm_b32 v190, v248, v247, s4
    v_lshlrev_b32 v247, 16, v191
    v_and_b32 v248, s86, v191
    v_mul_f32 v247, v247, v246
    v_mul_f32 v248, v248, v246
    v_perm_b32 v191, v248, v247, s4
    v_sub_f32 v88, v88, v244
    v_sub_f32 v120, v120, v244
    v_sub_f32 v89, v89, v244
    v_sub_f32 v121, v121, v244
    v_sub_f32 v90, v90, v244
    v_sub_f32 v122, v122, v244
    v_sub_f32 v91, v91, v244
    v_sub_f32 v123, v123, v244
    v_sub_f32 v92, v92, v244
    v_sub_f32 v124, v124, v244
    v_sub_f32 v93, v93, v244
    v_sub_f32 v125, v125, v244
    v_sub_f32 v94, v94, v244
    v_sub_f32 v126, v126, v244
    v_sub_f32 v95, v95, v244
    v_sub_f32 v127, v127, v244
    v_sub_f32 v140, v140, v244
    v_sub_f32 v141, v141, v244
    v_sub_f32 v142, v142, v244
    v_sub_f32 v143, v143, v244
    v_mul_f32 v199, v199, v246
    v_lshrrev_b32 v247, 2, v1
    v_add_u32 v247, s91, v247
    ds_write_b32 v247, v246 offset:2048
    s_nop 1
    v_lshrrev_b32 v247, 8, v1
    v_lshl_add_u32 v247, v247, 4, s91
    ds_read_b128 v[248:251], v247 offset:2048
    s_waitcnt lgkmcnt(0)
    v_accvgpr_read_b32 v245, a96
    v_mul_f32 v245, v245, v248
    v_accvgpr_write_b32 a96, v245
    v_accvgpr_read_b32 v245, a97
    v_mul_f32 v245, v245, v249
    v_accvgpr_write_b32 a97, v245
    v_accvgpr_read_b32 v245, a98
    v_mul_f32 v245, v245, v250
    v_accvgpr_write_b32 a98, v245
    v_accvgpr_read_b32 v245, a99
    v_mul_f32 v245, v245, v251
    v_accvgpr_write_b32 a99, v245
    v_accvgpr_read_b32 v245, a100
    v_mul_f32 v245, v245, v248
    v_accvgpr_write_b32 a100, v245
    v_accvgpr_read_b32 v245, a101
    v_mul_f32 v245, v245, v249
    v_accvgpr_write_b32 a101, v245
    v_accvgpr_read_b32 v245, a102
    v_mul_f32 v245, v245, v250
    v_accvgpr_write_b32 a102, v245
    v_accvgpr_read_b32 v245, a103
    v_mul_f32 v245, v245, v251
    v_accvgpr_write_b32 a103, v245
    v_accvgpr_read_b32 v245, a104
    v_mul_f32 v245, v245, v248
    v_accvgpr_write_b32 a104, v245
    v_accvgpr_read_b32 v245, a105
    v_mul_f32 v245, v245, v249
    v_accvgpr_write_b32 a105, v245
    v_accvgpr_read_b32 v245, a106
    v_mul_f32 v245, v245, v250
    v_accvgpr_write_b32 a106, v245
    v_accvgpr_read_b32 v245, a107
    v_mul_f32 v245, v245, v251
    v_accvgpr_write_b32 a107, v245
    v_accvgpr_read_b32 v245, a108
    v_mul_f32 v245, v245, v248
    v_accvgpr_write_b32 a108, v245
    v_accvgpr_read_b32 v245, a109
    v_mul_f32 v245, v245, v249
    v_accvgpr_write_b32 a109, v245
    v_accvgpr_read_b32 v245, a110
    v_mul_f32 v245, v245, v250
    v_accvgpr_write_b32 a110, v245
    v_accvgpr_read_b32 v245, a111
    v_mul_f32 v245, v245, v251
    v_accvgpr_write_b32 a111, v245
    v_accvgpr_read_b32 v245, a112
    v_mul_f32 v245, v245, v248
    v_accvgpr_write_b32 a112, v245
    v_accvgpr_read_b32 v245, a113
    v_mul_f32 v245, v245, v249
    v_accvgpr_write_b32 a113, v245
    v_accvgpr_read_b32 v245, a114
    v_mul_f32 v245, v245, v250
    v_accvgpr_write_b32 a114, v245
    v_accvgpr_read_b32 v245, a115
    v_mul_f32 v245, v245, v251
    v_accvgpr_write_b32 a115, v245
    v_accvgpr_read_b32 v245, a116
    v_mul_f32 v245, v245, v248
    v_accvgpr_write_b32 a116, v245
    v_accvgpr_read_b32 v245, a117
    v_mul_f32 v245, v245, v249
    v_accvgpr_write_b32 a117, v245
    v_accvgpr_read_b32 v245, a118
    v_mul_f32 v245, v245, v250
    v_accvgpr_write_b32 a118, v245
    v_accvgpr_read_b32 v245, a119
    v_mul_f32 v245, v245, v251
    v_accvgpr_write_b32 a119, v245
    v_accvgpr_read_b32 v245, a120
    v_mul_f32 v245, v245, v248
    v_accvgpr_write_b32 a120, v245
    v_accvgpr_read_b32 v245, a121
    v_mul_f32 v245, v245, v249
    v_accvgpr_write_b32 a121, v245
    v_accvgpr_read_b32 v245, a122
    v_mul_f32 v245, v245, v250
    v_accvgpr_write_b32 a122, v245
    v_accvgpr_read_b32 v245, a123
    v_mul_f32 v245, v245, v251
    v_accvgpr_write_b32 a123, v245
    v_accvgpr_read_b32 v245, a124
    v_mul_f32 v245, v245, v248
    v_accvgpr_write_b32 a124, v245
    v_accvgpr_read_b32 v245, a125
    v_mul_f32 v245, v245, v249
    v_accvgpr_write_b32 a125, v245
    v_accvgpr_read_b32 v245, a126
    v_mul_f32 v245, v245, v250
    v_accvgpr_write_b32 a126, v245
    v_accvgpr_read_b32 v245, a127
    v_mul_f32 v245, v245, v251
    v_accvgpr_write_b32 a127, v245
    v_mov_b64 v[192:193], v[196:197]
    v_mov_b64 v[194:195], v[198:199]
    v_exp_f32 v244, v64
    v_exp_f32 v245, v65
    v_exp_f32 v246, v66
    v_exp_f32 v247, v67
    v_exp_f32 v248, v68
    v_exp_f32 v249, v69
    v_exp_f32 v250, v70
    v_exp_f32 v251, v71
    s_nop 0
    v_perm_b32 v160, v245, v244, s4
    v_perm_b32 v161, v247, v246, s4
    v_perm_b32 v162, v249, v248, s4
    v_perm_b32 v163, v251, v250, s4
    s_nop 1
    v_exp_f32 v244, v72
    v_exp_f32 v245, v73
    v_exp_f32 v246, v74
    v_exp_f32 v247, v75
    v_exp_f32 v248, v76
    v_exp_f32 v249, v77
    v_exp_f32 v250, v78
    v_exp_f32 v251, v79
    s_nop 0
    v_perm_b32 v164, v245, v244, s4
    v_perm_b32 v165, v247, v246, s4
    v_perm_b32 v166, v249, v248, s4
    v_perm_b32 v167, v251, v250, s4
    s_nop 1
    v_smfmac_f32_16x16x64_bf16 v[192:195], v[144:147], v[160:167], v255
    v_exp_f32 v244, v80
    v_exp_f32 v245, v81
    v_exp_f32 v246, v82
    v_exp_f32 v247, v83
    v_exp_f32 v248, v84
    v_exp_f32 v249, v85
    v_exp_f32 v250, v86
    v_exp_f32 v251, v87
    s_nop 0
    v_perm_b32 v168, v245, v244, s4
    v_perm_b32 v169, v247, v246, s4
    v_perm_b32 v170, v249, v248, s4
    v_perm_b32 v171, v251, v250, s4
    s_nop 1
    v_exp_f32 v244, v88
    v_exp_f32 v245, v89
    v_exp_f32 v246, v90
    v_exp_f32 v247, v91
    v_exp_f32 v248, v92
    v_exp_f32 v249, v93
    v_exp_f32 v250, v94
    v_exp_f32 v251, v95
    s_nop 0
    v_perm_b32 v172, v245, v244, s4
    v_perm_b32 v173, v247, v246, s4
    v_perm_b32 v174, v249, v248, s4
    v_perm_b32 v175, v251, v250, s4
    s_nop 1
    v_smfmac_f32_16x16x64_bf16 v[192:195], v[148:151], v[168:175], v255
    s_nop 7
    s_nop 7
    s_setpc_b64 s[88:89]
L_rare_sub1:
    s_nop 15
    v_max3_f32 v244, v96, v97, v98
    v_max3_f32 v244, v244, v99, v100
    v_max3_f32 v244, v244, v101, v102
    v_max_f32 v244, v244, v103
    v_mov_b32 v245, v244
    s_nop 1
    v_permlane16_swap_b32 v244, v245
    s_nop 1
    v_max_f32 v244, v244, v245
    v_mov_b32 v245, v244
    s_nop 1
    v_permlane32_swap_b32 v244, v245
    s_nop 1
    v_max3_f32 v244, v244, v245, 0
    v_ceil_f32 v244, v244
    v_exp_f32_e64 v246, -v244
    s_nop 0
    v_lshlrev_b32 v247, 16, v160
    v_and_b32 v248, s86, v160
    v_mul_f32 v247, v247, v246
    v_mul_f32 v248, v248, v246
    v_perm_b32 v160, v248, v247, s4
    v_lshlrev_b32 v247, 16, v161
    v_and_b32 v248, s86, v161
    v_mul_f32 v247, v247, v246
    v_mul_f32 v248, v248, v246
    v_perm_b32 v161, v248, v247, s4
    v_lshlrev_b32 v247, 16, v162
    v_and_b32 v248, s86, v162
    v_mul_f32 v247, v247, v246
    v_mul_f32 v248, v248, v246
    v_perm_b32 v162, v248, v247, s4
    v_lshlrev_b32 v247, 16, v163
    v_and_b32 v248, s86, v163
    v_mul_f32 v247, v247, v246
    v_mul_f32 v248, v248, v246
    v_perm_b32 v163, v248, v247, s4
    v_sub_f32 v96, v96, v244
    v_sub_f32 v64, v64, v244
    v_sub_f32 v97, v97, v244
    v_sub_f32 v65, v65, v244
    v_sub_f32 v98, v98, v244
    v_sub_f32 v66, v66, v244
    v_sub_f32 v99, v99, v244
    v_sub_f32 v67, v67, v244
    v_sub_f32 v100, v100, v244
    v_sub_f32 v68, v68, v244
    v_sub_f32 v101, v101, v244
    v_sub_f32 v69, v69, v244
    v_sub_f32 v102, v102, v244
    v_sub_f32 v70, v70, v244
    v_sub_f32 v103, v103, v244
    v_sub_f32 v71, v71, v244
    v_sub_f32 v128, v128, v244
    v_sub_f32 v129, v129, v244
    v_sub_f32 v130, v130, v244
    v_sub_f32 v131, v131, v244
    v_cndmask_b32_e64 v245, v246, 0, s[98:99]
    v_mul_f32 v192, v192, v245
    v_lshrrev_b32 v247, 2, v1
    v_add_u32 v247, s91, v247
    ds_write_b32 v247, v246 offset:2048
    s_nop 1
    v_lshrrev_b32 v247, 8, v1
    v_lshl_add_u32 v247, v247, 4, s91
    ds_read_b128 v[248:251], v247 offset:2048
    s_waitcnt lgkmcnt(0)
    v_accvgpr_read_b32 v245, a0
    v_mul_f32 v245, v245, v248
    v_accvgpr_write_b32 a0, v245
    v_accvgpr_read_b32 v245, a1
    v_mul_f32 v245, v245, v249
    v_accvgpr_write_b32 a1, v245
    v_accvgpr_read_b32 v245, a2
    v_mul_f32 v245, v245, v250
    v_accvgpr_write_b32 a2, v245
    v_accvgpr_read_b32 v245, a3
    v_mul_f32 v245, v245, v251
    v_accvgpr_write_b32 a3, v245
    v_accvgpr_read_b32 v245, a4
    v_mul_f32 v245, v245, v248
    v_accvgpr_write_b32 a4, v245
    v_accvgpr_read_b32 v245, a5
    v_mul_f32 v245, v245, v249
    v_accvgpr_write_b32 a5, v245
    v_accvgpr_read_b32 v245, a6
    v_mul_f32 v245, v245, v250
    v_accvgpr_write_b32 a6, v245
    v_accvgpr_read_b32 v245, a7
    v_mul_f32 v245, v245, v251
    v_accvgpr_write_b32 a7, v245
    v_accvgpr_read_b32 v245, a8
    v_mul_f32 v245, v245, v248
    v_accvgpr_write_b32 a8, v245
    v_accvgpr_read_b32 v245, a9
    v_mul_f32 v245, v245, v249
    v_accvgpr_write_b32 a9, v245
    v_accvgpr_read_b32 v245, a10
    v_mul_f32 v245, v245, v250
    v_accvgpr_write_b32 a10, v245
    v_accvgpr_read_b32 v245, a11
    v_mul_f32 v245, v245, v251
    v_accvgpr_write_b32 a11, v245
    v_accvgpr_read_b32 v245, a12
    v_mul_f32 v245, v245, v248
    v_accvgpr_write_b32 a12, v245
    v_accvgpr_read_b32 v245, a13
    v_mul_f32 v245, v245, v249
    v_accvgpr_write_b32 a13, v245
    v_accvgpr_read_b32 v245, a14
    v_mul_f32 v245, v245, v250
    v_accvgpr_write_b32 a14, v245
    v_accvgpr_read_b32 v245, a15
    v_mul_f32 v245, v245, v251
    v_accvgpr_write_b32 a15, v245
    v_accvgpr_read_b32 v245, a16
    v_mul_f32 v245, v245, v248
    v_accvgpr_write_b32 a16, v245
    v_accvgpr_read_b32 v245, a17
    v_mul_f32 v245, v245, v249
    v_accvgpr_write_b32 a17, v245
    v_accvgpr_read_b32 v245, a18
    v_mul_f32 v245, v245, v250
    v_accvgpr_write_b32 a18, v245
    v_accvgpr_read_b32 v245, a19
    v_mul_f32 v245, v245, v251
    v_accvgpr_write_b32 a19, v245
    v_accvgpr_read_b32 v245, a20
    v_mul_f32 v245, v245, v248
    v_accvgpr_write_b32 a20, v245
    v_accvgpr_read_b32 v245, a21
    v_mul_f32 v245, v245, v249
    v_accvgpr_write_b32 a21, v245
    v_accvgpr_read_b32 v245, a22
    v_mul_f32 v245, v245, v250
    v_accvgpr_write_b32 a22, v245
    v_accvgpr_read_b32 v245, a23
    v_mul_f32 v245, v245, v251
    v_accvgpr_write_b32 a23, v245
    v_accvgpr_read_b32 v245, a24
    v_mul_f32 v245, v245, v248
    v_accvgpr_write_b32 a24, v245
    v_accvgpr_read_b32 v245, a25
    v_mul_f32 v245, v245, v249
    v_accvgpr_write_b32 a25, v245
    v_accvgpr_read_b32 v245, a26
    v_mul_f32 v245, v245, v250
    v_accvgpr_write_b32 a26, v245
    v_accvgpr_read_b32 v245, a27
    v_mul_f32 v245, v245, v251
    v_accvgpr_write_b32 a27, v245
    v_accvgpr_read_b32 v245, a28
    v_mul_f32 v245, v245, v248
    v_accvgpr_write_b32 a28, v245
    v_accvgpr_read_b32 v245, a29
    v_mul_f32 v245, v245, v249
    v_accvgpr_write_b32 a29, v245
    v_accvgpr_read_b32 v245, a30
    v_mul_f32 v245, v245, v250
    v_accvgpr_write_b32 a30, v245
    v_accvgpr_read_b32 v245, a31
    v_mul_f32 v245, v245, v251
    v_accvgpr_write_b32 a31, v245
    v_max3_f32 v244, v104, v105, v106
    v_max3_f32 v244, v244, v107, v108
    v_max3_f32 v244, v244, v109, v110
    v_max_f32 v244, v244, v111
    v_mov_b32 v245, v244
    s_nop 1
    v_permlane16_swap_b32 v244, v245
    s_nop 1
    v_max_f32 v244, v244, v245
    v_mov_b32 v245, v244
    s_nop 1
    v_permlane32_swap_b32 v244, v245
    s_nop 1
    v_max3_f32 v244, v244, v245, 0
    v_ceil_f32 v244, v244
    v_exp_f32_e64 v246, -v244
    s_nop 0
    v_lshlrev_b32 v247, 16, v164
    v_and_b32 v248, s86, v164
    v_mul_f32 v247, v247, v246
    v_mul_f32 v248, v248, v246
    v_perm_b32 v164, v248, v247, s4
    v_lshlrev_b32 v247, 16, v165
    v_and_b32 v248, s86, v165
    v_mul_f32 v247, v247, v246
    v_mul_f32 v248, v248, v246
    v_perm_b32 v165, v248, v247, s4
    v_lshlrev_b32 v247, 16, v166
    v_and_b32 v248, s86, v166
    v_mul_f32 v247, v247, v246
    v_mul_f32 v248, v248, v246
    v_perm_b32 v166, v248, v247, s4
    v_lshlrev_b32 v247, 16, v167
    v_and_b32 v248, s86, v167
    v_mul_f32 v247, v247, v246
    v_mul_f32 v248, v248, v246
    v_perm_b32 v167, v248, v247, s4
    v_sub_f32 v104, v104, v244
    v_sub_f32 v72, v72, v244
    v_sub_f32 v105, v105, v244
    v_sub_f32 v73, v73, v244
    v_sub_f32 v106, v106, v244
    v_sub_f32 v74, v74, v244
    v_sub_f32 v107, v107, v244
    v_sub_f32 v75, v75, v244
    v_sub_f32 v108, v108, v244
    v_sub_f32 v76, v76, v244
    v_sub_f32 v109, v109, v244
    v_sub_f32 v77, v77, v244
    v_sub_f32 v110, v110, v244
    v_sub_f32 v78, v78, v244
    v_sub_f32 v111, v111, v244
    v_sub_f32 v79, v79, v244
    v_sub_f32 v132, v132, v244
    v_sub_f32 v133, v133, v244
    v_sub_f32 v134, v134, v244
    v_sub_f32 v135, v135, v244
    v_mul_f32 v193, v193, v246
    v_lshrrev_b32 v247, 2, v1
    v_add_u32 v247, s91, v247
    ds_write_b32 v247, v246 offset:2048
    s_nop 1
    v_lshrrev_b32 v247, 8, v1
    v_lshl_add_u32 v247, v247, 4, s91
    ds_read_b128 v[248:251], v247 offset:2048
    s_waitcnt lgkmcnt(0)
    v_accvgpr_read_b32 v245, a32
    v_mul_f32 v245, v245, v248
    v_accvgpr_write_b32 a32, v245
    v_accvgpr_read_b32 v245, a33
    v_mul_f32 v245, v245, v249
    v_accvgpr_write_b32 a33, v245
    v_accvgpr_read_b32 v245, a34
    v_mul_f32 v245, v245, v250
    v_accvgpr_write_b32 a34, v245
    v_accvgpr_read_b32 v245, a35
    v_mul_f32 v245, v245, v251
    v_accvgpr_write_b32 a35, v245
    v_accvgpr_read_b32 v245, a36
    v_mul_f32 v245, v245, v248
    v_accvgpr_write_b32 a36, v245
    v_accvgpr_read_b32 v245, a37
    v_mul_f32 v245, v245, v249
    v_accvgpr_write_b32 a37, v245
    v_accvgpr_read_b32 v245, a38
    v_mul_f32 v245, v245, v250
    v_accvgpr_write_b32 a38, v245
    v_accvgpr_read_b32 v245, a39
    v_mul_f32 v245, v245, v251
    v_accvgpr_write_b32 a39, v245
    v_accvgpr_read_b32 v245, a40
    v_mul_f32 v245, v245, v248
    v_accvgpr_write_b32 a40, v245
    v_accvgpr_read_b32 v245, a41
    v_mul_f32 v245, v245, v249
    v_accvgpr_write_b32 a41, v245
    v_accvgpr_read_b32 v245, a42
    v_mul_f32 v245, v245, v250
    v_accvgpr_write_b32 a42, v245
    v_accvgpr_read_b32 v245, a43
    v_mul_f32 v245, v245, v251
    v_accvgpr_write_b32 a43, v245
    v_accvgpr_read_b32 v245, a44
    v_mul_f32 v245, v245, v248
    v_accvgpr_write_b32 a44, v245
    v_accvgpr_read_b32 v245, a45
    v_mul_f32 v245, v245, v249
    v_accvgpr_write_b32 a45, v245
    v_accvgpr_read_b32 v245, a46
    v_mul_f32 v245, v245, v250
    v_accvgpr_write_b32 a46, v245
    v_accvgpr_read_b32 v245, a47
    v_mul_f32 v245, v245, v251
    v_accvgpr_write_b32 a47, v245
    v_accvgpr_read_b32 v245, a48
    v_mul_f32 v245, v245, v248
    v_accvgpr_write_b32 a48, v245
    v_accvgpr_read_b32 v245, a49
    v_mul_f32 v245, v245, v249
    v_accvgpr_write_b32 a49, v245
    v_accvgpr_read_b32 v245, a50
    v_mul_f32 v245, v245, v250
    v_accvgpr_write_b32 a50, v245
    v_accvgpr_read_b32 v245, a51
    v_mul_f32 v245, v245, v251
    v_accvgpr_write_b32 a51, v245
    v_accvgpr_read_b32 v245, a52
    v_mul_f32 v245, v245, v248
    v_accvgpr_write_b32 a52, v245
    v_accvgpr_read_b32 v245, a53
    v_mul_f32 v245, v245, v249
    v_accvgpr_write_b32 a53, v245
    v_accvgpr_read_b32 v245, a54
    v_mul_f32 v245, v245, v250
    v_accvgpr_write_b32 a54, v245
    v_accvgpr_read_b32 v245, a55
    v_mul_f32 v245, v245, v251
    v_accvgpr_write_b32 a55, v245
    v_accvgpr_read_b32 v245, a56
    v_mul_f32 v245, v245, v248
    v_accvgpr_write_b32 a56, v245
    v_accvgpr_read_b32 v245, a57
    v_mul_f32 v245, v245, v249
    v_accvgpr_write_b32 a57, v245
    v_accvgpr_read_b32 v245, a58
    v_mul_f32 v245, v245, v250
    v_accvgpr_write_b32 a58, v245
    v_accvgpr_read_b32 v245, a59
    v_mul_f32 v245, v245, v251
    v_accvgpr_write_b32 a59, v245
    v_accvgpr_read_b32 v245, a60
    v_mul_f32 v245, v245, v248
    v_accvgpr_write_b32 a60, v245
    v_accvgpr_read_b32 v245, a61
    v_mul_f32 v245, v245, v249
    v_accvgpr_write_b32 a61, v245
    v_accvgpr_read_b32 v245, a62
    v_mul_f32 v245, v245, v250
    v_accvgpr_write_b32 a62, v245
    v_accvgpr_read_b32 v245, a63
    v_mul_f32 v245, v245, v251
    v_accvgpr_write_b32 a63, v245
    v_max3_f32 v244, v112, v113, v114
    v_max3_f32 v244, v244, v115, v116
    v_max3_f32 v244, v244, v117, v118
    v_max_f32 v244, v244, v119
    v_mov_b32 v245, v244
    s_nop 1
    v_permlane16_swap_b32 v244, v245
    s_nop 1
    v_max_f32 v244, v244, v245
    v_mov_b32 v245, v244
    s_nop 1
    v_permlane32_swap_b32 v244, v245
    s_nop 1
    v_max3_f32 v244, v244, v245, 0
    v_ceil_f32 v244, v244
    v_exp_f32_e64 v246, -v244
    s_nop 0
    v_lshlrev_b32 v247, 16, v168
    v_and_b32 v248, s86, v168
    v_mul_f32 v247, v247, v246
    v_mul_f32 v248, v248, v246
    v_perm_b32 v168, v248, v247, s4
    v_lshlrev_b32 v247, 16, v169
    v_and_b32 v248, s86, v169
    v_mul_f32 v247, v247, v246
    v_mul_f32 v248, v248, v246
    v_perm_b32 v169, v248, v247, s4
    v_lshlrev_b32 v247, 16, v170
    v_and_b32 v248, s86, v170
    v_mul_f32 v247, v247, v246
    v_mul_f32 v248, v248, v246
    v_perm_b32 v170, v248, v247, s4
    v_lshlrev_b32 v247, 16, v171
    v_and_b32 v248, s86, v171
    v_mul_f32 v247, v247, v246
    v_mul_f32 v248, v248, v246
    v_perm_b32 v171, v248, v247, s4
    v_sub_f32 v112, v112, v244
    v_sub_f32 v80, v80, v244
    v_sub_f32 v113, v113, v244
    v_sub_f32 v81, v81, v244
    v_sub_f32 v114, v114, v244
    v_sub_f32 v82, v82, v244
    v_sub_f32 v115, v115, v244
    v_sub_f32 v83, v83, v244
    v_sub_f32 v116, v116, v244
    v_sub_f32 v84, v84, v244
    v_sub_f32 v117, v117, v244
    v_sub_f32 v85, v85, v244
    v_sub_f32 v118, v118, v244
    v_sub_f32 v86, v86, v244
    v_sub_f32 v119, v119, v244
    v_sub_f32 v87, v87, v244
    v_sub_f32 v136, v136, v244
    v_sub_f32 v137, v137, v244
    v_sub_f32 v138, v138, v244
    v_sub_f32 v139, v139, v244
    v_mul_f32 v194, v194, v246
    v_lshrrev_b32 v247, 2, v1
    v_add_u32 v247, s91, v247
    ds_write_b32 v247, v246 offset:2048
    s_nop 1
    v_lshrrev_b32 v247, 8, v1
    v_lshl_add_u32 v247, v247, 4, s91
    ds_read_b128 v[248:251], v247 offset:2048
    s_waitcnt lgkmcnt(0)
    v_accvgpr_read_b32 v245, a64
    v_mul_f32 v245, v245, v248
    v_accvgpr_write_b32 a64, v245
    v_accvgpr_read_b32 v245, a65
    v_mul_f32 v245, v245, v249
    v_accvgpr_write_b32 a65, v245
    v_accvgpr_read_b32 v245, a66
    v_mul_f32 v245, v245, v250
    v_accvgpr_write_b32 a66, v245
    v_accvgpr_read_b32 v245, a67
    v_mul_f32 v245, v245, v251
    v_accvgpr_write_b32 a67, v245
    v_accvgpr_read_b32 v245, a68
    v_mul_f32 v245, v245, v248
    v_accvgpr_write_b32 a68, v245
    v_accvgpr_read_b32 v245, a69
    v_mul_f32 v245, v245, v249
    v_accvgpr_write_b32 a69, v245
    v_accvgpr_read_b32 v245, a70
    v_mul_f32 v245, v245, v250
    v_accvgpr_write_b32 a70, v245
    v_accvgpr_read_b32 v245, a71
    v_mul_f32 v245, v245, v251
    v_accvgpr_write_b32 a71, v245
    v_accvgpr_read_b32 v245, a72
    v_mul_f32 v245, v245, v248
    v_accvgpr_write_b32 a72, v245
    v_accvgpr_read_b32 v245, a73
    v_mul_f32 v245, v245, v249
    v_accvgpr_write_b32 a73, v245
    v_accvgpr_read_b32 v245, a74
    v_mul_f32 v245, v245, v250
    v_accvgpr_write_b32 a74, v245
    v_accvgpr_read_b32 v245, a75
    v_mul_f32 v245, v245, v251
    v_accvgpr_write_b32 a75, v245
    v_accvgpr_read_b32 v245, a76
    v_mul_f32 v245, v245, v248
    v_accvgpr_write_b32 a76, v245
    v_accvgpr_read_b32 v245, a77
    v_mul_f32 v245, v245, v249
    v_accvgpr_write_b32 a77, v245
    v_accvgpr_read_b32 v245, a78
    v_mul_f32 v245, v245, v250
    v_accvgpr_write_b32 a78, v245
    v_accvgpr_read_b32 v245, a79
    v_mul_f32 v245, v245, v251
    v_accvgpr_write_b32 a79, v245
    v_accvgpr_read_b32 v245, a80
    v_mul_f32 v245, v245, v248
    v_accvgpr_write_b32 a80, v245
    v_accvgpr_read_b32 v245, a81
    v_mul_f32 v245, v245, v249
    v_accvgpr_write_b32 a81, v245
    v_accvgpr_read_b32 v245, a82
    v_mul_f32 v245, v245, v250
    v_accvgpr_write_b32 a82, v245
    v_accvgpr_read_b32 v245, a83
    v_mul_f32 v245, v245, v251
    v_accvgpr_write_b32 a83, v245
    v_accvgpr_read_b32 v245, a84
    v_mul_f32 v245, v245, v248
    v_accvgpr_write_b32 a84, v245
    v_accvgpr_read_b32 v245, a85
    v_mul_f32 v245, v245, v249
    v_accvgpr_write_b32 a85, v245
    v_accvgpr_read_b32 v245, a86
    v_mul_f32 v245, v245, v250
    v_accvgpr_write_b32 a86, v245
    v_accvgpr_read_b32 v245, a87
    v_mul_f32 v245, v245, v251
    v_accvgpr_write_b32 a87, v245
    v_accvgpr_read_b32 v245, a88
    v_mul_f32 v245, v245, v248
    v_accvgpr_write_b32 a88, v245
    v_accvgpr_read_b32 v245, a89
    v_mul_f32 v245, v245, v249
    v_accvgpr_write_b32 a89, v245
    v_accvgpr_read_b32 v245, a90
    v_mul_f32 v245, v245, v250
    v_accvgpr_write_b32 a90, v245
    v_accvgpr_read_b32 v245, a91
    v_mul_f32 v245, v245, v251
    v_accvgpr_write_b32 a91, v245
    v_accvgpr_read_b32 v245, a92
    v_mul_f32 v245, v245, v248
    v_accvgpr_write_b32 a92, v245
    v_accvgpr_read_b32 v245, a93
    v_mul_f32 v245, v245, v249
    v_accvgpr_write_b32 a93, v245
    v_accvgpr_read_b32 v245, a94
    v_mul_f32 v245, v245, v250
    v_accvgpr_write_b32 a94, v245
    v_accvgpr_read_b32 v245, a95
    v_mul_f32 v245, v245, v251
    v_accvgpr_write_b32 a95, v245
    v_max3_f32 v244, v120, v121, v122
    v_max3_f32 v244, v244, v123, v124
    v_max3_f32 v244, v244, v125, v126
    v_max_f32 v244, v244, v127
    v_mov_b32 v245, v244
    s_nop 1
    v_permlane16_swap_b32 v244, v245
    s_nop 1
    v_max_f32 v244, v244, v245
    v_mov_b32 v245, v244
    s_nop 1
    v_permlane32_swap_b32 v244, v245
    s_nop 1
    v_max3_f32 v244, v244, v245, 0
    v_ceil_f32 v244, v244
    v_exp_f32_e64 v246, -v244
    s_nop 0
    v_lshlrev_b32 v247, 16, v172
    v_and_b32 v248, s86, v172
    v_mul_f32 v247, v247, v246
    v_mul_f32 v248, v248, v246
    v_perm_b32 v172, v248, v247, s4
    v_lshlrev_b32 v247, 16, v173
    v_and_b32 v248, s86, v173
    v_mul_f32 v247, v247, v246
    v_mul_f32 v248, v248, v246
    v_perm_b32 v173, v248, v247, s4
    v_lshlrev_b32 v247, 16, v174
    v_and_b32 v248, s86, v174
    v_mul_f32 v247, v247, v246
    v_mul_f32 v248, v248, v246
    v_perm_b32 v174, v248, v247, s4
    v_lshlrev_b32 v247, 16, v175
    v_and_b32 v248, s86, v175
    v_mul_f32 v247, v247, v246
    v_mul_f32 v248, v248, v246
    v_perm_b32 v175, v248, v247, s4
    v_sub_f32 v120, v120, v244
    v_sub_f32 v88, v88, v244
    v_sub_f32 v121, v121, v244
    v_sub_f32 v89, v89, v244
    v_sub_f32 v122, v122, v244
    v_sub_f32 v90, v90, v244
    v_sub_f32 v123, v123, v244
    v_sub_f32 v91, v91, v244
    v_sub_f32 v124, v124, v244
    v_sub_f32 v92, v92, v244
    v_sub_f32 v125, v125, v244
    v_sub_f32 v93, v93, v244
    v_sub_f32 v126, v126, v244
    v_sub_f32 v94, v94, v244
    v_sub_f32 v127, v127, v244
    v_sub_f32 v95, v95, v244
    v_sub_f32 v140, v140, v244
    v_sub_f32 v141, v141, v244
    v_sub_f32 v142, v142, v244
    v_sub_f32 v143, v143, v244
    v_mul_f32 v195, v195, v246
    v_lshrrev_b32 v247, 2, v1
    v_add_u32 v247, s91, v247
    ds_write_b32 v247, v246 offset:2048
    s_nop 1
    v_lshrrev_b32 v247, 8, v1
    v_lshl_add_u32 v247, v247, 4, s91
    ds_read_b128 v[248:251], v247 offset:2048
    s_waitcnt lgkmcnt(0)
    v_accvgpr_read_b32 v245, a96
    v_mul_f32 v245, v245, v248
    v_accvgpr_write_b32 a96, v245
    v_accvgpr_read_b32 v245, a97
    v_mul_f32 v245, v245, v249
    v_accvgpr_write_b32 a97, v245
    v_accvgpr_read_b32 v245, a98
    v_mul_f32 v245, v245, v250
    v_accvgpr_write_b32 a98, v245
    v_accvgpr_read_b32 v245, a99
    v_mul_f32 v245, v245, v251
    v_accvgpr_write_b32 a99, v245
    v_accvgpr_read_b32 v245, a100
    v_mul_f32 v245, v245, v248
    v_accvgpr_write_b32 a100, v245
    v_accvgpr_read_b32 v245, a101
    v_mul_f32 v245, v245, v249
    v_accvgpr_write_b32 a101, v245
    v_accvgpr_read_b32 v245, a102
    v_mul_f32 v245, v245, v250
    v_accvgpr_write_b32 a102, v245
    v_accvgpr_read_b32 v245, a103
    v_mul_f32 v245, v245, v251
    v_accvgpr_write_b32 a103, v245
    v_accvgpr_read_b32 v245, a104
    v_mul_f32 v245, v245, v248
    v_accvgpr_write_b32 a104, v245
    v_accvgpr_read_b32 v245, a105
    v_mul_f32 v245, v245, v249
    v_accvgpr_write_b32 a105, v245
    v_accvgpr_read_b32 v245, a106
    v_mul_f32 v245, v245, v250
    v_accvgpr_write_b32 a106, v245
    v_accvgpr_read_b32 v245, a107
    v_mul_f32 v245, v245, v251
    v_accvgpr_write_b32 a107, v245
    v_accvgpr_read_b32 v245, a108
    v_mul_f32 v245, v245, v248
    v_accvgpr_write_b32 a108, v245
    v_accvgpr_read_b32 v245, a109
    v_mul_f32 v245, v245, v249
    v_accvgpr_write_b32 a109, v245
    v_accvgpr_read_b32 v245, a110
    v_mul_f32 v245, v245, v250
    v_accvgpr_write_b32 a110, v245
    v_accvgpr_read_b32 v245, a111
    v_mul_f32 v245, v245, v251
    v_accvgpr_write_b32 a111, v245
    v_accvgpr_read_b32 v245, a112
    v_mul_f32 v245, v245, v248
    v_accvgpr_write_b32 a112, v245
    v_accvgpr_read_b32 v245, a113
    v_mul_f32 v245, v245, v249
    v_accvgpr_write_b32 a113, v245
    v_accvgpr_read_b32 v245, a114
    v_mul_f32 v245, v245, v250
    v_accvgpr_write_b32 a114, v245
    v_accvgpr_read_b32 v245, a115
    v_mul_f32 v245, v245, v251
    v_accvgpr_write_b32 a115, v245
    v_accvgpr_read_b32 v245, a116
    v_mul_f32 v245, v245, v248
    v_accvgpr_write_b32 a116, v245
    v_accvgpr_read_b32 v245, a117
    v_mul_f32 v245, v245, v249
    v_accvgpr_write_b32 a117, v245
    v_accvgpr_read_b32 v245, a118
    v_mul_f32 v245, v245, v250
    v_accvgpr_write_b32 a118, v245
    v_accvgpr_read_b32 v245, a119
    v_mul_f32 v245, v245, v251
    v_accvgpr_write_b32 a119, v245
    v_accvgpr_read_b32 v245, a120
    v_mul_f32 v245, v245, v248
    v_accvgpr_write_b32 a120, v245
    v_accvgpr_read_b32 v245, a121
    v_mul_f32 v245, v245, v249
    v_accvgpr_write_b32 a121, v245
    v_accvgpr_read_b32 v245, a122
    v_mul_f32 v245, v245, v250
    v_accvgpr_write_b32 a122, v245
    v_accvgpr_read_b32 v245, a123
    v_mul_f32 v245, v245, v251
    v_accvgpr_write_b32 a123, v245
    v_accvgpr_read_b32 v245, a124
    v_mul_f32 v245, v245, v248
    v_accvgpr_write_b32 a124, v245
    v_accvgpr_read_b32 v245, a125
    v_mul_f32 v245, v245, v249
    v_accvgpr_write_b32 a125, v245
    v_accvgpr_read_b32 v245, a126
    v_mul_f32 v245, v245, v250
    v_accvgpr_write_b32 a126, v245
    v_accvgpr_read_b32 v245, a127
    v_mul_f32 v245, v245, v251
    v_accvgpr_write_b32 a127, v245
    v_mov_b64 v[196:197], v[192:193]
    v_mov_b64 v[198:199], v[194:195]
    v_exp_f32 v244, v96
    v_exp_f32 v245, v97
    v_exp_f32 v246, v98
    v_exp_f32 v247, v99
    v_exp_f32 v248, v100
    v_exp_f32 v249, v101
    v_exp_f32 v250, v102
    v_exp_f32 v251, v103
    s_nop 0
    v_perm_b32 v176, v245, v244, s4
    v_perm_b32 v177, v247, v246, s4
    v_perm_b32 v178, v249, v248, s4
    v_perm_b32 v179, v251, v250, s4
    s_nop 1
    v_exp_f32 v244, v104
    v_exp_f32 v245, v105
    v_exp_f32 v246, v106
    v_exp_f32 v247, v107
    v_exp_f32 v248, v108
    v_exp_f32 v249, v109
    v_exp_f32 v250, v110
    v_exp_f32 v251, v111
    s_nop 0
    v_perm_b32 v180, v245, v244, s4
    v_perm_b32 v181, v247, v246, s4
    v_perm_b32 v182, v249, v248, s4
    v_perm_b32 v183, v251, v250, s4
    s_nop 1
    v_smfmac_f32_16x16x64_bf16 v[196:199], v[144:147], v[176:183], v255
    v_exp_f32 v244, v112
    v_exp_f32 v245, v113
    v_exp_f32 v246, v114
    v_exp_f32 v247, v115
    v_exp_f32 v248, v116
    v_exp_f32 v249, v117
    v_exp_f32 v250, v118
    v_exp_f32 v251, v119
    s_nop 0
    v_perm_b32 v184, v245, v244, s4
    v_perm_b32 v185, v247, v246, s4
    v_perm_b32 v186, v249, v248, s4
    v_perm_b32 v187, v251, v250, s4
    s_nop 1
    v_exp_f32 v244, v120
    v_exp_f32 v245, v121
    v_exp_f32 v246, v122
    v_exp_f32 v247, v123
    v_exp_f32 v248, v124
    v_exp_f32 v249, v125
    v_exp_f32 v250, v126
    v_exp_f32 v251, v127
    s_nop 0
    v_perm_b32 v188, v245, v244, s4
    v_perm_b32 v189, v247, v246, s4
    v_perm_b32 v190, v249, v248, s4
    v_perm_b32 v191, v251, v250, s4
    s_nop 1
    v_smfmac_f32_16x16x64_bf16 v[196:199], v[148:151], v[184:191], v255
    s_nop 7
    s_nop 7
    s_setpc_b64 s[88:89]
L_rare_sub2:
    s_nop 15
    v_max3_f32 v244, v64, v65, v66
    v_max3_f32 v244, v244, v67, v68
    v_max3_f32 v244, v244, v69, v70
    v_max_f32 v244, v244, v71
    v_mov_b32 v245, v244
    s_nop 1
    v_permlane16_swap_b32 v244, v245
    s_nop 1
    v_max_f32 v244, v244, v245
    v_mov_b32 v245, v244
    s_nop 1
    v_permlane32_swap_b32 v244, v245
    s_nop 1
    v_max3_f32 v244, v244, v245, 0
    v_ceil_f32 v244, v244
    v_exp_f32_e64 v246, -v244
    s_nop 0
    v_lshlrev_b32 v247, 16, v176
    v_and_b32 v248, s86, v176
    v_mul_f32 v247, v247, v246
    v_mul_f32 v248, v248, v246
    v_perm_b32 v176, v248, v247, s4
    v_lshlrev_b32 v247, 16, v177
    v_and_b32 v248, s86, v177
    v_mul_f32 v247, v247, v246
    v_mul_f32 v248, v248, v246
    v_perm_b32 v177, v248, v247, s4
    v_lshlrev_b32 v247, 16, v178
    v_and_b32 v248, s86, v178
    v_mul_f32 v247, v247, v246
    v_mul_f32 v248, v248, v246
    v_perm_b32 v178, v248, v247, s4
    v_lshlrev_b32 v247, 16, v179
    v_and_b32 v248, s86, v179
    v_mul_f32 v247, v247, v246
    v_mul_f32 v248, v248, v246
    v_perm_b32 v179, v248, v247, s4
    v_sub_f32 v64, v64, v244
    v_sub_f32 v96, v96, v244
    v_sub_f32 v65, v65, v244
    v_sub_f32 v97, v97, v244
    v_sub_f32 v66, v66, v244
    v_sub_f32 v98, v98, v244
    v_sub_f32 v67, v67, v244
    v_sub_f32 v99, v99, v244
    v_sub_f32 v68, v68, v244
    v_sub_f32 v100, v100, v244
    v_sub_f32 v69, v69, v244
    v_sub_f32 v101, v101, v244
    v_sub_f32 v70, v70, v244
    v_sub_f32 v102, v102, v244
    v_sub_f32 v71, v71, v244
    v_sub_f32 v103, v103, v244
    v_sub_f32 v128, v128, v244
    v_sub_f32 v129, v129, v244
    v_sub_f32 v130, v130, v244
    v_sub_f32 v131, v131, v244
    v_cndmask_b32_e64 v245, v246, 0, s[98:99]
    v_mul_f32 v196, v196, v245
    v_lshrrev_b32 v247, 2, v1
    v_add_u32 v247, s91, v247
    ds_write_b32 v247, v246 offset:2048
    s_nop 1
    v_lshrrev_b32 v247, 8, v1
    v_lshl_add_u32 v247, v247, 4, s91
    ds_read_b128 v[248:251], v247 offset:2048
    s_waitcnt lgkmcnt(0)
    v_accvgpr_read_b32 v245, a0
    v_mul_f32 v245, v245, v248
    v_accvgpr_write_b32 a0, v245
    v_accvgpr_read_b32 v245, a1
    v_mul_f32 v245, v245, v249
    v_accvgpr_write_b32 a1, v245
    v_accvgpr_read_b32 v245, a2
    v_mul_f32 v245, v245, v250
    v_accvgpr_write_b32 a2, v245
    v_accvgpr_read_b32 v245, a3
    v_mul_f32 v245, v245, v251
    v_accvgpr_write_b32 a3, v245
    v_accvgpr_read_b32 v245, a4
    v_mul_f32 v245, v245, v248
    v_accvgpr_write_b32 a4, v245
    v_accvgpr_read_b32 v245, a5
    v_mul_f32 v245, v245, v249
    v_accvgpr_write_b32 a5, v245
    v_accvgpr_read_b32 v245, a6
    v_mul_f32 v245, v245, v250
    v_accvgpr_write_b32 a6, v245
    v_accvgpr_read_b32 v245, a7
    v_mul_f32 v245, v245, v251
    v_accvgpr_write_b32 a7, v245
    v_accvgpr_read_b32 v245, a8
    v_mul_f32 v245, v245, v248
    v_accvgpr_write_b32 a8, v245
    v_accvgpr_read_b32 v245, a9
    v_mul_f32 v245, v245, v249
    v_accvgpr_write_b32 a9, v245
    v_accvgpr_read_b32 v245, a10
    v_mul_f32 v245, v245, v250
    v_accvgpr_write_b32 a10, v245
    v_accvgpr_read_b32 v245, a11
    v_mul_f32 v245, v245, v251
    v_accvgpr_write_b32 a11, v245
    v_accvgpr_read_b32 v245, a12
    v_mul_f32 v245, v245, v248
    v_accvgpr_write_b32 a12, v245
    v_accvgpr_read_b32 v245, a13
    v_mul_f32 v245, v245, v249
    v_accvgpr_write_b32 a13, v245
    v_accvgpr_read_b32 v245, a14
    v_mul_f32 v245, v245, v250
    v_accvgpr_write_b32 a14, v245
    v_accvgpr_read_b32 v245, a15
    v_mul_f32 v245, v245, v251
    v_accvgpr_write_b32 a15, v245
    v_accvgpr_read_b32 v245, a16
    v_mul_f32 v245, v245, v248
    v_accvgpr_write_b32 a16, v245
    v_accvgpr_read_b32 v245, a17
    v_mul_f32 v245, v245, v249
    v_accvgpr_write_b32 a17, v245
    v_accvgpr_read_b32 v245, a18
    v_mul_f32 v245, v245, v250
    v_accvgpr_write_b32 a18, v245
    v_accvgpr_read_b32 v245, a19
    v_mul_f32 v245, v245, v251
    v_accvgpr_write_b32 a19, v245
    v_accvgpr_read_b32 v245, a20
    v_mul_f32 v245, v245, v248
    v_accvgpr_write_b32 a20, v245
    v_accvgpr_read_b32 v245, a21
    v_mul_f32 v245, v245, v249
    v_accvgpr_write_b32 a21, v245
    v_accvgpr_read_b32 v245, a22
    v_mul_f32 v245, v245, v250
    v_accvgpr_write_b32 a22, v245
    v_accvgpr_read_b32 v245, a23
    v_mul_f32 v245, v245, v251
    v_accvgpr_write_b32 a23, v245
    v_accvgpr_read_b32 v245, a24
    v_mul_f32 v245, v245, v248
    v_accvgpr_write_b32 a24, v245
    v_accvgpr_read_b32 v245, a25
    v_mul_f32 v245, v245, v249
    v_accvgpr_write_b32 a25, v245
    v_accvgpr_read_b32 v245, a26
    v_mul_f32 v245, v245, v250
    v_accvgpr_write_b32 a26, v245
    v_accvgpr_read_b32 v245, a27
    v_mul_f32 v245, v245, v251
    v_accvgpr_write_b32 a27, v245
    v_accvgpr_read_b32 v245, a28
    v_mul_f32 v245, v245, v248
    v_accvgpr_write_b32 a28, v245
    v_accvgpr_read_b32 v245, a29
    v_mul_f32 v245, v245, v249
    v_accvgpr_write_b32 a29, v245
    v_accvgpr_read_b32 v245, a30
    v_mul_f32 v245, v245, v250
    v_accvgpr_write_b32 a30, v245
    v_accvgpr_read_b32 v245, a31
    v_mul_f32 v245, v245, v251
    v_accvgpr_write_b32 a31, v245
    v_max3_f32 v244, v72, v73, v74
    v_max3_f32 v244, v244, v75, v76
    v_max3_f32 v244, v244, v77, v78
    v_max_f32 v244, v244, v79
    v_mov_b32 v245, v244
    s_nop 1
    v_permlane16_swap_b32 v244, v245
    s_nop 1
    v_max_f32 v244, v244, v245
    v_mov_b32 v245, v244
    s_nop 1
    v_permlane32_swap_b32 v244, v245
    s_nop 1
    v_max3_f32 v244, v244, v245, 0
    v_ceil_f32 v244, v244
    v_exp_f32_e64 v246, -v244
    s_nop 0
    v_lshlrev_b32 v247, 16, v180
    v_and_b32 v248, s86, v180
    v_mul_f32 v247, v247, v246
    v_mul_f32 v248, v248, v246
    v_perm_b32 v180, v248, v247, s4
    v_lshlrev_b32 v247, 16, v181
    v_and_b32 v248, s86, v181
    v_mul_f32 v247, v247, v246
    v_mul_f32 v248, v248, v246
    v_perm_b32 v181, v248, v247, s4
    v_lshlrev_b32 v247, 16, v182
    v_and_b32 v248, s86, v182
    v_mul_f32 v247, v247, v246
    v_mul_f32 v248, v248, v246
    v_perm_b32 v182, v248, v247, s4
    v_lshlrev_b32 v247, 16, v183
    v_and_b32 v248, s86, v183
    v_mul_f32 v247, v247, v246
    v_mul_f32 v248, v248, v246
    v_perm_b32 v183, v248, v247, s4
    v_sub_f32 v72, v72, v244
    v_sub_f32 v104, v104, v244
    v_sub_f32 v73, v73, v244
    v_sub_f32 v105, v105, v244
    v_sub_f32 v74, v74, v244
    v_sub_f32 v106, v106, v244
    v_sub_f32 v75, v75, v244
    v_sub_f32 v107, v107, v244
    v_sub_f32 v76, v76, v244
    v_sub_f32 v108, v108, v244
    v_sub_f32 v77, v77, v244
    v_sub_f32 v109, v109, v244
    v_sub_f32 v78, v78, v244
    v_sub_f32 v110, v110, v244
    v_sub_f32 v79, v79, v244
    v_sub_f32 v111, v111, v244
    v_sub_f32 v132, v132, v244
    v_sub_f32 v133, v133, v244
    v_sub_f32 v134, v134, v244
    v_sub_f32 v135, v135, v244
    v_mul_f32 v197, v197, v246
    v_lshrrev_b32 v247, 2, v1
    v_add_u32 v247, s91, v247
    ds_write_b32 v247, v246 offset:2048
    s_nop 1
    v_lshrrev_b32 v247, 8, v1
    v_lshl_add_u32 v247, v247, 4, s91
    ds_read_b128 v[248:251], v247 offset:2048
    s_waitcnt lgkmcnt(0)
    v_accvgpr_read_b32 v245, a32
    v_mul_f32 v245, v245, v248
    v_accvgpr_write_b32 a32, v245
    v_accvgpr_read_b32 v245, a33
    v_mul_f32 v245, v245, v249
    v_accvgpr_write_b32 a33, v245
    v_accvgpr_read_b32 v245, a34
    v_mul_f32 v245, v245, v250
    v_accvgpr_write_b32 a34, v245
    v_accvgpr_read_b32 v245, a35
    v_mul_f32 v245, v245, v251
    v_accvgpr_write_b32 a35, v245
    v_accvgpr_read_b32 v245, a36
    v_mul_f32 v245, v245, v248
    v_accvgpr_write_b32 a36, v245
    v_accvgpr_read_b32 v245, a37
    v_mul_f32 v245, v245, v249
    v_accvgpr_write_b32 a37, v245
    v_accvgpr_read_b32 v245, a38
    v_mul_f32 v245, v245, v250
    v_accvgpr_write_b32 a38, v245
    v_accvgpr_read_b32 v245, a39
    v_mul_f32 v245, v245, v251
    v_accvgpr_write_b32 a39, v245
    v_accvgpr_read_b32 v245, a40
    v_mul_f32 v245, v245, v248
    v_accvgpr_write_b32 a40, v245
    v_accvgpr_read_b32 v245, a41
    v_mul_f32 v245, v245, v249
    v_accvgpr_write_b32 a41, v245
    v_accvgpr_read_b32 v245, a42
    v_mul_f32 v245, v245, v250
    v_accvgpr_write_b32 a42, v245
    v_accvgpr_read_b32 v245, a43
    v_mul_f32 v245, v245, v251
    v_accvgpr_write_b32 a43, v245
    v_accvgpr_read_b32 v245, a44
    v_mul_f32 v245, v245, v248
    v_accvgpr_write_b32 a44, v245
    v_accvgpr_read_b32 v245, a45
    v_mul_f32 v245, v245, v249
    v_accvgpr_write_b32 a45, v245
    v_accvgpr_read_b32 v245, a46
    v_mul_f32 v245, v245, v250
    v_accvgpr_write_b32 a46, v245
    v_accvgpr_read_b32 v245, a47
    v_mul_f32 v245, v245, v251
    v_accvgpr_write_b32 a47, v245
    v_accvgpr_read_b32 v245, a48
    v_mul_f32 v245, v245, v248
    v_accvgpr_write_b32 a48, v245
    v_accvgpr_read_b32 v245, a49
    v_mul_f32 v245, v245, v249
    v_accvgpr_write_b32 a49, v245
    v_accvgpr_read_b32 v245, a50
    v_mul_f32 v245, v245, v250
    v_accvgpr_write_b32 a50, v245
    v_accvgpr_read_b32 v245, a51
    v_mul_f32 v245, v245, v251
    v_accvgpr_write_b32 a51, v245
    v_accvgpr_read_b32 v245, a52
    v_mul_f32 v245, v245, v248
    v_accvgpr_write_b32 a52, v245
    v_accvgpr_read_b32 v245, a53
    v_mul_f32 v245, v245, v249
    v_accvgpr_write_b32 a53, v245
    v_accvgpr_read_b32 v245, a54
    v_mul_f32 v245, v245, v250
    v_accvgpr_write_b32 a54, v245
    v_accvgpr_read_b32 v245, a55
    v_mul_f32 v245, v245, v251
    v_accvgpr_write_b32 a55, v245
    v_accvgpr_read_b32 v245, a56
    v_mul_f32 v245, v245, v248
    v_accvgpr_write_b32 a56, v245
    v_accvgpr_read_b32 v245, a57
    v_mul_f32 v245, v245, v249
    v_accvgpr_write_b32 a57, v245
    v_accvgpr_read_b32 v245, a58
    v_mul_f32 v245, v245, v250
    v_accvgpr_write_b32 a58, v245
    v_accvgpr_read_b32 v245, a59
    v_mul_f32 v245, v245, v251
    v_accvgpr_write_b32 a59, v245
    v_accvgpr_read_b32 v245, a60
    v_mul_f32 v245, v245, v248
    v_accvgpr_write_b32 a60, v245
    v_accvgpr_read_b32 v245, a61
    v_mul_f32 v245, v245, v249
    v_accvgpr_write_b32 a61, v245
    v_accvgpr_read_b32 v245, a62
    v_mul_f32 v245, v245, v250
    v_accvgpr_write_b32 a62, v245
    v_accvgpr_read_b32 v245, a63
    v_mul_f32 v245, v245, v251
    v_accvgpr_write_b32 a63, v245
    v_max3_f32 v244, v80, v81, v82
    v_max3_f32 v244, v244, v83, v84
    v_max3_f32 v244, v244, v85, v86
    v_max_f32 v244, v244, v87
    v_mov_b32 v245, v244
    s_nop 1
    v_permlane16_swap_b32 v244, v245
    s_nop 1
    v_max_f32 v244, v244, v245
    v_mov_b32 v245, v244
    s_nop 1
    v_permlane32_swap_b32 v244, v245
    s_nop 1
    v_max3_f32 v244, v244, v245, 0
    v_ceil_f32 v244, v244
    v_exp_f32_e64 v246, -v244
    s_nop 0
    v_lshlrev_b32 v247, 16, v184
    v_and_b32 v248, s86, v184
    v_mul_f32 v247, v247, v246
    v_mul_f32 v248, v248, v246
    v_perm_b32 v184, v248, v247, s4
    v_lshlrev_b32 v247, 16, v185
    v_and_b32 v248, s86, v185
    v_mul_f32 v247, v247, v246
    v_mul_f32 v248, v248, v246
    v_perm_b32 v185, v248, v247, s4
    v_lshlrev_b32 v247, 16, v186
    v_and_b32 v248, s86, v186
    v_mul_f32 v247, v247, v246
    v_mul_f32 v248, v248, v246
    v_perm_b32 v186, v248, v247, s4
    v_lshlrev_b32 v247, 16, v187
    v_and_b32 v248, s86, v187
    v_mul_f32 v247, v247, v246
    v_mul_f32 v248, v248, v246
    v_perm_b32 v187, v248, v247, s4
    v_sub_f32 v80, v80, v244
    v_sub_f32 v112, v112, v244
    v_sub_f32 v81, v81, v244
    v_sub_f32 v113, v113, v244
    v_sub_f32 v82, v82, v244
    v_sub_f32 v114, v114, v244
    v_sub_f32 v83, v83, v244
    v_sub_f32 v115, v115, v244
    v_sub_f32 v84, v84, v244
    v_sub_f32 v116, v116, v244
    v_sub_f32 v85, v85, v244
    v_sub_f32 v117, v117, v244
    v_sub_f32 v86, v86, v244
    v_sub_f32 v118, v118, v244
    v_sub_f32 v87, v87, v244
    v_sub_f32 v119, v119, v244
    v_sub_f32 v136, v136, v244
    v_sub_f32 v137, v137, v244
    v_sub_f32 v138, v138, v244
    v_sub_f32 v139, v139, v244
    v_mul_f32 v198, v198, v246
    v_lshrrev_b32 v247, 2, v1
    v_add_u32 v247, s91, v247
    ds_write_b32 v247, v246 offset:2048
    s_nop 1
    v_lshrrev_b32 v247, 8, v1
    v_lshl_add_u32 v247, v247, 4, s91
    ds_read_b128 v[248:251], v247 offset:2048
    s_waitcnt lgkmcnt(0)
    v_accvgpr_read_b32 v245, a64
    v_mul_f32 v245, v245, v248
    v_accvgpr_write_b32 a64, v245
    v_accvgpr_read_b32 v245, a65
    v_mul_f32 v245, v245, v249
    v_accvgpr_write_b32 a65, v245
    v_accvgpr_read_b32 v245, a66
    v_mul_f32 v245, v245, v250
    v_accvgpr_write_b32 a66, v245
    v_accvgpr_read_b32 v245, a67
    v_mul_f32 v245, v245, v251
    v_accvgpr_write_b32 a67, v245
    v_accvgpr_read_b32 v245, a68
    v_mul_f32 v245, v245, v248
    v_accvgpr_write_b32 a68, v245
    v_accvgpr_read_b32 v245, a69
    v_mul_f32 v245, v245, v249
    v_accvgpr_write_b32 a69, v245
    v_accvgpr_read_b32 v245, a70
    v_mul_f32 v245, v245, v250
    v_accvgpr_write_b32 a70, v245
    v_accvgpr_read_b32 v245, a71
    v_mul_f32 v245, v245, v251
    v_accvgpr_write_b32 a71, v245
    v_accvgpr_read_b32 v245, a72
    v_mul_f32 v245, v245, v248
    v_accvgpr_write_b32 a72, v245
    v_accvgpr_read_b32 v245, a73
    v_mul_f32 v245, v245, v249
    v_accvgpr_write_b32 a73, v245
    v_accvgpr_read_b32 v245, a74
    v_mul_f32 v245, v245, v250
    v_accvgpr_write_b32 a74, v245
    v_accvgpr_read_b32 v245, a75
    v_mul_f32 v245, v245, v251
    v_accvgpr_write_b32 a75, v245
    v_accvgpr_read_b32 v245, a76
    v_mul_f32 v245, v245, v248
    v_accvgpr_write_b32 a76, v245
    v_accvgpr_read_b32 v245, a77
    v_mul_f32 v245, v245, v249
    v_accvgpr_write_b32 a77, v245
    v_accvgpr_read_b32 v245, a78
    v_mul_f32 v245, v245, v250
    v_accvgpr_write_b32 a78, v245
    v_accvgpr_read_b32 v245, a79
    v_mul_f32 v245, v245, v251
    v_accvgpr_write_b32 a79, v245
    v_accvgpr_read_b32 v245, a80
    v_mul_f32 v245, v245, v248
    v_accvgpr_write_b32 a80, v245
    v_accvgpr_read_b32 v245, a81
    v_mul_f32 v245, v245, v249
    v_accvgpr_write_b32 a81, v245
    v_accvgpr_read_b32 v245, a82
    v_mul_f32 v245, v245, v250
    v_accvgpr_write_b32 a82, v245
    v_accvgpr_read_b32 v245, a83
    v_mul_f32 v245, v245, v251
    v_accvgpr_write_b32 a83, v245
    v_accvgpr_read_b32 v245, a84
    v_mul_f32 v245, v245, v248
    v_accvgpr_write_b32 a84, v245
    v_accvgpr_read_b32 v245, a85
    v_mul_f32 v245, v245, v249
    v_accvgpr_write_b32 a85, v245
    v_accvgpr_read_b32 v245, a86
    v_mul_f32 v245, v245, v250
    v_accvgpr_write_b32 a86, v245
    v_accvgpr_read_b32 v245, a87
    v_mul_f32 v245, v245, v251
    v_accvgpr_write_b32 a87, v245
    v_accvgpr_read_b32 v245, a88
    v_mul_f32 v245, v245, v248
    v_accvgpr_write_b32 a88, v245
    v_accvgpr_read_b32 v245, a89
    v_mul_f32 v245, v245, v249
    v_accvgpr_write_b32 a89, v245
    v_accvgpr_read_b32 v245, a90
    v_mul_f32 v245, v245, v250
    v_accvgpr_write_b32 a90, v245
    v_accvgpr_read_b32 v245, a91
    v_mul_f32 v245, v245, v251
    v_accvgpr_write_b32 a91, v245
    v_accvgpr_read_b32 v245, a92
    v_mul_f32 v245, v245, v248
    v_accvgpr_write_b32 a92, v245
    v_accvgpr_read_b32 v245, a93
    v_mul_f32 v245, v245, v249
    v_accvgpr_write_b32 a93, v245
    v_accvgpr_read_b32 v245, a94
    v_mul_f32 v245, v245, v250
    v_accvgpr_write_b32 a94, v245
    v_accvgpr_read_b32 v245, a95
    v_mul_f32 v245, v245, v251
    v_accvgpr_write_b32 a95, v245
    v_max3_f32 v244, v88, v89, v90
    v_max3_f32 v244, v244, v91, v92
    v_max3_f32 v244, v244, v93, v94
    v_max_f32 v244, v244, v95
    v_mov_b32 v245, v244
    s_nop 1
    v_permlane16_swap_b32 v244, v245
    s_nop 1
    v_max_f32 v244, v244, v245
    v_mov_b32 v245, v244
    s_nop 1
    v_permlane32_swap_b32 v244, v245
    s_nop 1
    v_max3_f32 v244, v244, v245, 0
    v_ceil_f32 v244, v244
    v_exp_f32_e64 v246, -v244
    s_nop 0
    v_lshlrev_b32 v247, 16, v188
    v_and_b32 v248, s86, v188
    v_mul_f32 v247, v247, v246
    v_mul_f32 v248, v248, v246
    v_perm_b32 v188, v248, v247, s4
    v_lshlrev_b32 v247, 16, v189
    v_and_b32 v248, s86, v189
    v_mul_f32 v247, v247, v246
    v_mul_f32 v248, v248, v246
    v_perm_b32 v189, v248, v247, s4
    v_lshlrev_b32 v247, 16, v190
    v_and_b32 v248, s86, v190
    v_mul_f32 v247, v247, v246
    v_mul_f32 v248, v248, v246
    v_perm_b32 v190, v248, v247, s4
    v_lshlrev_b32 v247, 16, v191
    v_and_b32 v248, s86, v191
    v_mul_f32 v247, v247, v246
    v_mul_f32 v248, v248, v246
    v_perm_b32 v191, v248, v247, s4
    v_sub_f32 v88, v88, v244
    v_sub_f32 v120, v120, v244
    v_sub_f32 v89, v89, v244
    v_sub_f32 v121, v121, v244
    v_sub_f32 v90, v90, v244
    v_sub_f32 v122, v122, v244
    v_sub_f32 v91, v91, v244
    v_sub_f32 v123, v123, v244
    v_sub_f32 v92, v92, v244
    v_sub_f32 v124, v124, v244
    v_sub_f32 v93, v93, v244
    v_sub_f32 v125, v125, v244
    v_sub_f32 v94, v94, v244
    v_sub_f32 v126, v126, v244
    v_sub_f32 v95, v95, v244
    v_sub_f32 v127, v127, v244
    v_sub_f32 v140, v140, v244
    v_sub_f32 v141, v141, v244
    v_sub_f32 v142, v142, v244
    v_sub_f32 v143, v143, v244
    v_mul_f32 v199, v199, v246
    v_lshrrev_b32 v247, 2, v1
    v_add_u32 v247, s91, v247
    ds_write_b32 v247, v246 offset:2048
    s_nop 1
    v_lshrrev_b32 v247, 8, v1
    v_lshl_add_u32 v247, v247, 4, s91
    ds_read_b128 v[248:251], v247 offset:2048
    s_waitcnt lgkmcnt(0)
    v_accvgpr_read_b32 v245, a96
    v_mul_f32 v245, v245, v248
    v_accvgpr_write_b32 a96, v245
    v_accvgpr_read_b32 v245, a97
    v_mul_f32 v245, v245, v249
    v_accvgpr_write_b32 a97, v245
    v_accvgpr_read_b32 v245, a98
    v_mul_f32 v245, v245, v250
    v_accvgpr_write_b32 a98, v245
    v_accvgpr_read_b32 v245, a99
    v_mul_f32 v245, v245, v251
    v_accvgpr_write_b32 a99, v245
    v_accvgpr_read_b32 v245, a100
    v_mul_f32 v245, v245, v248
    v_accvgpr_write_b32 a100, v245
    v_accvgpr_read_b32 v245, a101
    v_mul_f32 v245, v245, v249
    v_accvgpr_write_b32 a101, v245
    v_accvgpr_read_b32 v245, a102
    v_mul_f32 v245, v245, v250
    v_accvgpr_write_b32 a102, v245
    v_accvgpr_read_b32 v245, a103
    v_mul_f32 v245, v245, v251
    v_accvgpr_write_b32 a103, v245
    v_accvgpr_read_b32 v245, a104
    v_mul_f32 v245, v245, v248
    v_accvgpr_write_b32 a104, v245
    v_accvgpr_read_b32 v245, a105
    v_mul_f32 v245, v245, v249
    v_accvgpr_write_b32 a105, v245
    v_accvgpr_read_b32 v245, a106
    v_mul_f32 v245, v245, v250
    v_accvgpr_write_b32 a106, v245
    v_accvgpr_read_b32 v245, a107
    v_mul_f32 v245, v245, v251
    v_accvgpr_write_b32 a107, v245
    v_accvgpr_read_b32 v245, a108
    v_mul_f32 v245, v245, v248
    v_accvgpr_write_b32 a108, v245
    v_accvgpr_read_b32 v245, a109
    v_mul_f32 v245, v245, v249
    v_accvgpr_write_b32 a109, v245
    v_accvgpr_read_b32 v245, a110
    v_mul_f32 v245, v245, v250
    v_accvgpr_write_b32 a110, v245
    v_accvgpr_read_b32 v245, a111
    v_mul_f32 v245, v245, v251
    v_accvgpr_write_b32 a111, v245
    v_accvgpr_read_b32 v245, a112
    v_mul_f32 v245, v245, v248
    v_accvgpr_write_b32 a112, v245
    v_accvgpr_read_b32 v245, a113
    v_mul_f32 v245, v245, v249
    v_accvgpr_write_b32 a113, v245
    v_accvgpr_read_b32 v245, a114
    v_mul_f32 v245, v245, v250
    v_accvgpr_write_b32 a114, v245
    v_accvgpr_read_b32 v245, a115
    v_mul_f32 v245, v245, v251
    v_accvgpr_write_b32 a115, v245
    v_accvgpr_read_b32 v245, a116
    v_mul_f32 v245, v245, v248
    v_accvgpr_write_b32 a116, v245
    v_accvgpr_read_b32 v245, a117
    v_mul_f32 v245, v245, v249
    v_accvgpr_write_b32 a117, v245
    v_accvgpr_read_b32 v245, a118
    v_mul_f32 v245, v245, v250
    v_accvgpr_write_b32 a118, v245
    v_accvgpr_read_b32 v245, a119
    v_mul_f32 v245, v245, v251
    v_accvgpr_write_b32 a119, v245
    v_accvgpr_read_b32 v245, a120
    v_mul_f32 v245, v245, v248
    v_accvgpr_write_b32 a120, v245
    v_accvgpr_read_b32 v245, a121
    v_mul_f32 v245, v245, v249
    v_accvgpr_write_b32 a121, v245
    v_accvgpr_read_b32 v245, a122
    v_mul_f32 v245, v245, v250
    v_accvgpr_write_b32 a122, v245
    v_accvgpr_read_b32 v245, a123
    v_mul_f32 v245, v245, v251
    v_accvgpr_write_b32 a123, v245
    v_accvgpr_read_b32 v245, a124
    v_mul_f32 v245, v245, v248
    v_accvgpr_write_b32 a124, v245
    v_accvgpr_read_b32 v245, a125
    v_mul_f32 v245, v245, v249
    v_accvgpr_write_b32 a125, v245
    v_accvgpr_read_b32 v245, a126
    v_mul_f32 v245, v245, v250
    v_accvgpr_write_b32 a126, v245
    v_accvgpr_read_b32 v245, a127
    v_mul_f32 v245, v245, v251
    v_accvgpr_write_b32 a127, v245
    v_mov_b64 v[192:193], v[196:197]
    v_mov_b64 v[194:195], v[198:199]
    v_exp_f32 v244, v64
    v_exp_f32 v245, v65
    v_exp_f32 v246, v66
    v_exp_f32 v247, v67
    v_exp_f32 v248, v68
    v_exp_f32 v249, v69
    v_exp_f32 v250, v70
    v_exp_f32 v251, v71
    s_nop 0
    v_perm_b32 v152, v245, v244, s4
    v_perm_b32 v153, v247, v246, s4
    v_perm_b32 v154, v249, v248, s4
    v_perm_b32 v155, v251, v250, s4
    s_nop 1
    v_exp_f32 v244, v72
    v_exp_f32 v245, v73
    v_exp_f32 v246, v74
    v_exp_f32 v247, v75
    v_exp_f32 v248, v76
    v_exp_f32 v249, v77
    v_exp_f32 v250, v78
    v_exp_f32 v251, v79
    s_nop 0
    v_perm_b32 v156, v245, v244, s4
    v_perm_b32 v157, v247, v246, s4
    v_perm_b32 v158, v249, v248, s4
    v_perm_b32 v159, v251, v250, s4
    s_nop 1
    v_smfmac_f32_16x16x64_bf16 v[192:195], v[144:147], v[152:159], v255
    v_exp_f32 v244, v80
    v_exp_f32 v245, v81
    v_exp_f32 v246, v82
    v_exp_f32 v247, v83
    v_exp_f32 v248, v84
    v_exp_f32 v249, v85
    v_exp_f32 v250, v86
    v_exp_f32 v251, v87
    s_nop 0
    v_perm_b32 v168, v245, v244, s4
    v_perm_b32 v169, v247, v246, s4
    v_perm_b32 v170, v249, v248, s4
    v_perm_b32 v171, v251, v250, s4
    s_nop 1
    v_exp_f32 v244, v88
    v_exp_f32 v245, v89
    v_exp_f32 v246, v90
    v_exp_f32 v247, v91
    v_exp_f32 v248, v92
    v_exp_f32 v249, v93
    v_exp_f32 v250, v94
    v_exp_f32 v251, v95
    s_nop 0
    v_perm_b32 v172, v245, v244, s4
    v_perm_b32 v173, v247, v246, s4
    v_perm_b32 v174, v249, v248, s4
    v_perm_b32 v175, v251, v250, s4
    s_nop 1
    v_smfmac_f32_16x16x64_bf16 v[192:195], v[148:151], v[168:175], v255
    s_nop 7
    s_nop 7
    s_setpc_b64 s[88:89]
L_rare_sub3:
    s_nop 15
    v_max3_f32 v244, v96, v97, v98
    v_max3_f32 v244, v244, v99, v100
    v_max3_f32 v244, v244, v101, v102
    v_max_f32 v244, v244, v103
    v_mov_b32 v245, v244
    s_nop 1
    v_permlane16_swap_b32 v244, v245
    s_nop 1
    v_max_f32 v244, v244, v245
    v_mov_b32 v245, v244
    s_nop 1
    v_permlane32_swap_b32 v244, v245
    s_nop 1
    v_max3_f32 v244, v244, v245, 0
    v_ceil_f32 v244, v244
    v_exp_f32_e64 v246, -v244
    s_nop 0
    v_lshlrev_b32 v247, 16, v152
    v_and_b32 v248, s86, v152
    v_mul_f32 v247, v247, v246
    v_mul_f32 v248, v248, v246
    v_perm_b32 v152, v248, v247, s4
    v_lshlrev_b32 v247, 16, v153
    v_and_b32 v248, s86, v153
    v_mul_f32 v247, v247, v246
    v_mul_f32 v248, v248, v246
    v_perm_b32 v153, v248, v247, s4
    v_lshlrev_b32 v247, 16, v154
    v_and_b32 v248, s86, v154
    v_mul_f32 v247, v247, v246
    v_mul_f32 v248, v248, v246
    v_perm_b32 v154, v248, v247, s4
    v_lshlrev_b32 v247, 16, v155
    v_and_b32 v248, s86, v155
    v_mul_f32 v247, v247, v246
    v_mul_f32 v248, v248, v246
    v_perm_b32 v155, v248, v247, s4
    v_sub_f32 v96, v96, v244
    v_sub_f32 v64, v64, v244
    v_sub_f32 v97, v97, v244
    v_sub_f32 v65, v65, v244
    v_sub_f32 v98, v98, v244
    v_sub_f32 v66, v66, v244
    v_sub_f32 v99, v99, v244
    v_sub_f32 v67, v67, v244
    v_sub_f32 v100, v100, v244
    v_sub_f32 v68, v68, v244
    v_sub_f32 v101, v101, v244
    v_sub_f32 v69, v69, v244
    v_sub_f32 v102, v102, v244
    v_sub_f32 v70, v70, v244
    v_sub_f32 v103, v103, v244
    v_sub_f32 v71, v71, v244
    v_sub_f32 v128, v128, v244
    v_sub_f32 v129, v129, v244
    v_sub_f32 v130, v130, v244
    v_sub_f32 v131, v131, v244
    v_cndmask_b32_e64 v245, v246, 0, s[98:99]
    v_mul_f32 v192, v192, v245
    v_lshrrev_b32 v247, 2, v1
    v_add_u32 v247, s91, v247
    ds_write_b32 v247, v246 offset:2048
    s_nop 1
    v_lshrrev_b32 v247, 8, v1
    v_lshl_add_u32 v247, v247, 4, s91
    ds_read_b128 v[248:251], v247 offset:2048
    s_waitcnt lgkmcnt(0)
    v_accvgpr_read_b32 v245, a0
    v_mul_f32 v245, v245, v248
    v_accvgpr_write_b32 a0, v245
    v_accvgpr_read_b32 v245, a1
    v_mul_f32 v245, v245, v249
    v_accvgpr_write_b32 a1, v245
    v_accvgpr_read_b32 v245, a2
    v_mul_f32 v245, v245, v250
    v_accvgpr_write_b32 a2, v245
    v_accvgpr_read_b32 v245, a3
    v_mul_f32 v245, v245, v251
    v_accvgpr_write_b32 a3, v245
    v_accvgpr_read_b32 v245, a4
    v_mul_f32 v245, v245, v248
    v_accvgpr_write_b32 a4, v245
    v_accvgpr_read_b32 v245, a5
    v_mul_f32 v245, v245, v249
    v_accvgpr_write_b32 a5, v245
    v_accvgpr_read_b32 v245, a6
    v_mul_f32 v245, v245, v250
    v_accvgpr_write_b32 a6, v245
    v_accvgpr_read_b32 v245, a7
    v_mul_f32 v245, v245, v251
    v_accvgpr_write_b32 a7, v245
    v_accvgpr_read_b32 v245, a8
    v_mul_f32 v245, v245, v248
    v_accvgpr_write_b32 a8, v245
    v_accvgpr_read_b32 v245, a9
    v_mul_f32 v245, v245, v249
    v_accvgpr_write_b32 a9, v245
    v_accvgpr_read_b32 v245, a10
    v_mul_f32 v245, v245, v250
    v_accvgpr_write_b32 a10, v245
    v_accvgpr_read_b32 v245, a11
    v_mul_f32 v245, v245, v251
    v_accvgpr_write_b32 a11, v245
    v_accvgpr_read_b32 v245, a12
    v_mul_f32 v245, v245, v248
    v_accvgpr_write_b32 a12, v245
    v_accvgpr_read_b32 v245, a13
    v_mul_f32 v245, v245, v249
    v_accvgpr_write_b32 a13, v245
    v_accvgpr_read_b32 v245, a14
    v_mul_f32 v245, v245, v250
    v_accvgpr_write_b32 a14, v245
    v_accvgpr_read_b32 v245, a15
    v_mul_f32 v245, v245, v251
    v_accvgpr_write_b32 a15, v245
    v_accvgpr_read_b32 v245, a16
    v_mul_f32 v245, v245, v248
    v_accvgpr_write_b32 a16, v245
    v_accvgpr_read_b32 v245, a17
    v_mul_f32 v245, v245, v249
    v_accvgpr_write_b32 a17, v245
    v_accvgpr_read_b32 v245, a18
    v_mul_f32 v245, v245, v250
    v_accvgpr_write_b32 a18, v245
    v_accvgpr_read_b32 v245, a19
    v_mul_f32 v245, v245, v251
    v_accvgpr_write_b32 a19, v245
    v_accvgpr_read_b32 v245, a20
    v_mul_f32 v245, v245, v248
    v_accvgpr_write_b32 a20, v245
    v_accvgpr_read_b32 v245, a21
    v_mul_f32 v245, v245, v249
    v_accvgpr_write_b32 a21, v245
    v_accvgpr_read_b32 v245, a22
    v_mul_f32 v245, v245, v250
    v_accvgpr_write_b32 a22, v245
    v_accvgpr_read_b32 v245, a23
    v_mul_f32 v245, v245, v251
    v_accvgpr_write_b32 a23, v245
    v_accvgpr_read_b32 v245, a24
    v_mul_f32 v245, v245, v248
    v_accvgpr_write_b32 a24, v245
    v_accvgpr_read_b32 v245, a25
    v_mul_f32 v245, v245, v249
    v_accvgpr_write_b32 a25, v245
    v_accvgpr_read_b32 v245, a26
    v_mul_f32 v245, v245, v250
    v_accvgpr_write_b32 a26, v245
    v_accvgpr_read_b32 v245, a27
    v_mul_f32 v245, v245, v251
    v_accvgpr_write_b32 a27, v245
    v_accvgpr_read_b32 v245, a28
    v_mul_f32 v245, v245, v248
    v_accvgpr_write_b32 a28, v245
    v_accvgpr_read_b32 v245, a29
    v_mul_f32 v245, v245, v249
    v_accvgpr_write_b32 a29, v245
    v_accvgpr_read_b32 v245, a30
    v_mul_f32 v245, v245, v250
    v_accvgpr_write_b32 a30, v245
    v_accvgpr_read_b32 v245, a31
    v_mul_f32 v245, v245, v251
    v_accvgpr_write_b32 a31, v245
    v_max3_f32 v244, v104, v105, v106
    v_max3_f32 v244, v244, v107, v108
    v_max3_f32 v244, v244, v109, v110
    v_max_f32 v244, v244, v111
    v_mov_b32 v245, v244
    s_nop 1
    v_permlane16_swap_b32 v244, v245
    s_nop 1
    v_max_f32 v244, v244, v245
    v_mov_b32 v245, v244
    s_nop 1
    v_permlane32_swap_b32 v244, v245
    s_nop 1
    v_max3_f32 v244, v244, v245, 0
    v_ceil_f32 v244, v244
    v_exp_f32_e64 v246, -v244
    s_nop 0
    v_lshlrev_b32 v247, 16, v156
    v_and_b32 v248, s86, v156
    v_mul_f32 v247, v247, v246
    v_mul_f32 v248, v248, v246
    v_perm_b32 v156, v248, v247, s4
    v_lshlrev_b32 v247, 16, v157
    v_and_b32 v248, s86, v157
    v_mul_f32 v247, v247, v246
    v_mul_f32 v248, v248, v246
    v_perm_b32 v157, v248, v247, s4
    v_lshlrev_b32 v247, 16, v158
    v_and_b32 v248, s86, v158
    v_mul_f32 v247, v247, v246
    v_mul_f32 v248, v248, v246
    v_perm_b32 v158, v248, v247, s4
    v_lshlrev_b32 v247, 16, v159
    v_and_b32 v248, s86, v159
    v_mul_f32 v247, v247, v246
    v_mul_f32 v248, v248, v246
    v_perm_b32 v159, v248, v247, s4
    v_sub_f32 v104, v104, v244
    v_sub_f32 v72, v72, v244
    v_sub_f32 v105, v105, v244
    v_sub_f32 v73, v73, v244
    v_sub_f32 v106, v106, v244
    v_sub_f32 v74, v74, v244
    v_sub_f32 v107, v107, v244
    v_sub_f32 v75, v75, v244
    v_sub_f32 v108, v108, v244
    v_sub_f32 v76, v76, v244
    v_sub_f32 v109, v109, v244
    v_sub_f32 v77, v77, v244
    v_sub_f32 v110, v110, v244
    v_sub_f32 v78, v78, v244
    v_sub_f32 v111, v111, v244
    v_sub_f32 v79, v79, v244
    v_sub_f32 v132, v132, v244
    v_sub_f32 v133, v133, v244
    v_sub_f32 v134, v134, v244
    v_sub_f32 v135, v135, v244
    v_mul_f32 v193, v193, v246
    v_lshrrev_b32 v247, 2, v1
    v_add_u32 v247, s91, v247
    ds_write_b32 v247, v246 offset:2048
    s_nop 1
    v_lshrrev_b32 v247, 8, v1
    v_lshl_add_u32 v247, v247, 4, s91
    ds_read_b128 v[248:251], v247 offset:2048
    s_waitcnt lgkmcnt(0)
    v_accvgpr_read_b32 v245, a32
    v_mul_f32 v245, v245, v248
    v_accvgpr_write_b32 a32, v245
    v_accvgpr_read_b32 v245, a33
    v_mul_f32 v245, v245, v249
    v_accvgpr_write_b32 a33, v245
    v_accvgpr_read_b32 v245, a34
    v_mul_f32 v245, v245, v250
    v_accvgpr_write_b32 a34, v245
    v_accvgpr_read_b32 v245, a35
    v_mul_f32 v245, v245, v251
    v_accvgpr_write_b32 a35, v245
    v_accvgpr_read_b32 v245, a36
    v_mul_f32 v245, v245, v248
    v_accvgpr_write_b32 a36, v245
    v_accvgpr_read_b32 v245, a37
    v_mul_f32 v245, v245, v249
    v_accvgpr_write_b32 a37, v245
    v_accvgpr_read_b32 v245, a38
    v_mul_f32 v245, v245, v250
    v_accvgpr_write_b32 a38, v245
    v_accvgpr_read_b32 v245, a39
    v_mul_f32 v245, v245, v251
    v_accvgpr_write_b32 a39, v245
    v_accvgpr_read_b32 v245, a40
    v_mul_f32 v245, v245, v248
    v_accvgpr_write_b32 a40, v245
    v_accvgpr_read_b32 v245, a41
    v_mul_f32 v245, v245, v249
    v_accvgpr_write_b32 a41, v245
    v_accvgpr_read_b32 v245, a42
    v_mul_f32 v245, v245, v250
    v_accvgpr_write_b32 a42, v245
    v_accvgpr_read_b32 v245, a43
    v_mul_f32 v245, v245, v251
    v_accvgpr_write_b32 a43, v245
    v_accvgpr_read_b32 v245, a44
    v_mul_f32 v245, v245, v248
    v_accvgpr_write_b32 a44, v245
    v_accvgpr_read_b32 v245, a45
    v_mul_f32 v245, v245, v249
    v_accvgpr_write_b32 a45, v245
    v_accvgpr_read_b32 v245, a46
    v_mul_f32 v245, v245, v250
    v_accvgpr_write_b32 a46, v245
    v_accvgpr_read_b32 v245, a47
    v_mul_f32 v245, v245, v251
    v_accvgpr_write_b32 a47, v245
    v_accvgpr_read_b32 v245, a48
    v_mul_f32 v245, v245, v248
    v_accvgpr_write_b32 a48, v245
    v_accvgpr_read_b32 v245, a49
    v_mul_f32 v245, v245, v249
    v_accvgpr_write_b32 a49, v245
    v_accvgpr_read_b32 v245, a50
    v_mul_f32 v245, v245, v250
    v_accvgpr_write_b32 a50, v245
    v_accvgpr_read_b32 v245, a51
    v_mul_f32 v245, v245, v251
    v_accvgpr_write_b32 a51, v245
    v_accvgpr_read_b32 v245, a52
    v_mul_f32 v245, v245, v248
    v_accvgpr_write_b32 a52, v245
    v_accvgpr_read_b32 v245, a53
    v_mul_f32 v245, v245, v249
    v_accvgpr_write_b32 a53, v245
    v_accvgpr_read_b32 v245, a54
    v_mul_f32 v245, v245, v250
    v_accvgpr_write_b32 a54, v245
    v_accvgpr_read_b32 v245, a55
    v_mul_f32 v245, v245, v251
    v_accvgpr_write_b32 a55, v245
    v_accvgpr_read_b32 v245, a56
    v_mul_f32 v245, v245, v248
    v_accvgpr_write_b32 a56, v245
    v_accvgpr_read_b32 v245, a57
    v_mul_f32 v245, v245, v249
    v_accvgpr_write_b32 a57, v245
    v_accvgpr_read_b32 v245, a58
    v_mul_f32 v245, v245, v250
    v_accvgpr_write_b32 a58, v245
    v_accvgpr_read_b32 v245, a59
    v_mul_f32 v245, v245, v251
    v_accvgpr_write_b32 a59, v245
    v_accvgpr_read_b32 v245, a60
    v_mul_f32 v245, v245, v248
    v_accvgpr_write_b32 a60, v245
    v_accvgpr_read_b32 v245, a61
    v_mul_f32 v245, v245, v249
    v_accvgpr_write_b32 a61, v245
    v_accvgpr_read_b32 v245, a62
    v_mul_f32 v245, v245, v250
    v_accvgpr_write_b32 a62, v245
    v_accvgpr_read_b32 v245, a63
    v_mul_f32 v245, v245, v251
    v_accvgpr_write_b32 a63, v245
    v_max3_f32 v244, v112, v113, v114
    v_max3_f32 v244, v244, v115, v116
    v_max3_f32 v244, v244, v117, v118
    v_max_f32 v244, v244, v119
    v_mov_b32 v245, v244
    s_nop 1
    v_permlane16_swap_b32 v244, v245
    s_nop 1
    v_max_f32 v244, v244, v245
    v_mov_b32 v245, v244
    s_nop 1
    v_permlane32_swap_b32 v244, v245
    s_nop 1
    v_max3_f32 v244, v244, v245, 0
    v_ceil_f32 v244, v244
    v_exp_f32_e64 v246, -v244
    s_nop 0
    v_lshlrev_b32 v247, 16, v168
    v_and_b32 v248, s86, v168
    v_mul_f32 v247, v247, v246
    v_mul_f32 v248, v248, v246
    v_perm_b32 v168, v248, v247, s4
    v_lshlrev_b32 v247, 16, v169
    v_and_b32 v248, s86, v169
    v_mul_f32 v247, v247, v246
    v_mul_f32 v248, v248, v246
    v_perm_b32 v169, v248, v247, s4
    v_lshlrev_b32 v247, 16, v170
    v_and_b32 v248, s86, v170
    v_mul_f32 v247, v247, v246
    v_mul_f32 v248, v248, v246
    v_perm_b32 v170, v248, v247, s4
    v_lshlrev_b32 v247, 16, v171
    v_and_b32 v248, s86, v171
    v_mul_f32 v247, v247, v246
    v_mul_f32 v248, v248, v246
    v_perm_b32 v171, v248, v247, s4
    v_sub_f32 v112, v112, v244
    v_sub_f32 v80, v80, v244
    v_sub_f32 v113, v113, v244
    v_sub_f32 v81, v81, v244
    v_sub_f32 v114, v114, v244
    v_sub_f32 v82, v82, v244
    v_sub_f32 v115, v115, v244
    v_sub_f32 v83, v83, v244
    v_sub_f32 v116, v116, v244
    v_sub_f32 v84, v84, v244
    v_sub_f32 v117, v117, v244
    v_sub_f32 v85, v85, v244
    v_sub_f32 v118, v118, v244
    v_sub_f32 v86, v86, v244
    v_sub_f32 v119, v119, v244
    v_sub_f32 v87, v87, v244
    v_sub_f32 v136, v136, v244
    v_sub_f32 v137, v137, v244
    v_sub_f32 v138, v138, v244
    v_sub_f32 v139, v139, v244
    v_mul_f32 v194, v194, v246
    v_lshrrev_b32 v247, 2, v1
    v_add_u32 v247, s91, v247
    ds_write_b32 v247, v246 offset:2048
    s_nop 1
    v_lshrrev_b32 v247, 8, v1
    v_lshl_add_u32 v247, v247, 4, s91
    ds_read_b128 v[248:251], v247 offset:2048
    s_waitcnt lgkmcnt(0)
    v_accvgpr_read_b32 v245, a64
    v_mul_f32 v245, v245, v248
    v_accvgpr_write_b32 a64, v245
    v_accvgpr_read_b32 v245, a65
    v_mul_f32 v245, v245, v249
    v_accvgpr_write_b32 a65, v245
    v_accvgpr_read_b32 v245, a66
    v_mul_f32 v245, v245, v250
    v_accvgpr_write_b32 a66, v245
    v_accvgpr_read_b32 v245, a67
    v_mul_f32 v245, v245, v251
    v_accvgpr_write_b32 a67, v245
    v_accvgpr_read_b32 v245, a68
    v_mul_f32 v245, v245, v248
    v_accvgpr_write_b32 a68, v245
    v_accvgpr_read_b32 v245, a69
    v_mul_f32 v245, v245, v249
    v_accvgpr_write_b32 a69, v245
    v_accvgpr_read_b32 v245, a70
    v_mul_f32 v245, v245, v250
    v_accvgpr_write_b32 a70, v245
    v_accvgpr_read_b32 v245, a71
    v_mul_f32 v245, v245, v251
    v_accvgpr_write_b32 a71, v245
    v_accvgpr_read_b32 v245, a72
    v_mul_f32 v245, v245, v248
    v_accvgpr_write_b32 a72, v245
    v_accvgpr_read_b32 v245, a73
    v_mul_f32 v245, v245, v249
    v_accvgpr_write_b32 a73, v245
    v_accvgpr_read_b32 v245, a74
    v_mul_f32 v245, v245, v250
    v_accvgpr_write_b32 a74, v245
    v_accvgpr_read_b32 v245, a75
    v_mul_f32 v245, v245, v251
    v_accvgpr_write_b32 a75, v245
    v_accvgpr_read_b32 v245, a76
    v_mul_f32 v245, v245, v248
    v_accvgpr_write_b32 a76, v245
    v_accvgpr_read_b32 v245, a77
    v_mul_f32 v245, v245, v249
    v_accvgpr_write_b32 a77, v245
    v_accvgpr_read_b32 v245, a78
    v_mul_f32 v245, v245, v250
    v_accvgpr_write_b32 a78, v245
    v_accvgpr_read_b32 v245, a79
    v_mul_f32 v245, v245, v251
    v_accvgpr_write_b32 a79, v245
    v_accvgpr_read_b32 v245, a80
    v_mul_f32 v245, v245, v248
    v_accvgpr_write_b32 a80, v245
    v_accvgpr_read_b32 v245, a81
    v_mul_f32 v245, v245, v249
    v_accvgpr_write_b32 a81, v245
    v_accvgpr_read_b32 v245, a82
    v_mul_f32 v245, v245, v250
    v_accvgpr_write_b32 a82, v245
    v_accvgpr_read_b32 v245, a83
    v_mul_f32 v245, v245, v251
    v_accvgpr_write_b32 a83, v245
    v_accvgpr_read_b32 v245, a84
    v_mul_f32 v245, v245, v248
    v_accvgpr_write_b32 a84, v245
    v_accvgpr_read_b32 v245, a85
    v_mul_f32 v245, v245, v249
    v_accvgpr_write_b32 a85, v245
    v_accvgpr_read_b32 v245, a86
    v_mul_f32 v245, v245, v250
    v_accvgpr_write_b32 a86, v245
    v_accvgpr_read_b32 v245, a87
    v_mul_f32 v245, v245, v251
    v_accvgpr_write_b32 a87, v245
    v_accvgpr_read_b32 v245, a88
    v_mul_f32 v245, v245, v248
    v_accvgpr_write_b32 a88, v245
    v_accvgpr_read_b32 v245, a89
    v_mul_f32 v245, v245, v249
    v_accvgpr_write_b32 a89, v245
    v_accvgpr_read_b32 v245, a90
    v_mul_f32 v245, v245, v250
    v_accvgpr_write_b32 a90, v245
    v_accvgpr_read_b32 v245, a91
    v_mul_f32 v245, v245, v251
    v_accvgpr_write_b32 a91, v245
    v_accvgpr_read_b32 v245, a92
    v_mul_f32 v245, v245, v248
    v_accvgpr_write_b32 a92, v245
    v_accvgpr_read_b32 v245, a93
    v_mul_f32 v245, v245, v249
    v_accvgpr_write_b32 a93, v245
    v_accvgpr_read_b32 v245, a94
    v_mul_f32 v245, v245, v250
    v_accvgpr_write_b32 a94, v245
    v_accvgpr_read_b32 v245, a95
    v_mul_f32 v245, v245, v251
    v_accvgpr_write_b32 a95, v245
    v_max3_f32 v244, v120, v121, v122
    v_max3_f32 v244, v244, v123, v124
    v_max3_f32 v244, v244, v125, v126
    v_max_f32 v244, v244, v127
    v_mov_b32 v245, v244
    s_nop 1
    v_permlane16_swap_b32 v244, v245
    s_nop 1
    v_max_f32 v244, v244, v245
    v_mov_b32 v245, v244
    s_nop 1
    v_permlane32_swap_b32 v244, v245
    s_nop 1
    v_max3_f32 v244, v244, v245, 0
    v_ceil_f32 v244, v244
    v_exp_f32_e64 v246, -v244
    s_nop 0
    v_lshlrev_b32 v247, 16, v172
    v_and_b32 v248, s86, v172
    v_mul_f32 v247, v247, v246
    v_mul_f32 v248, v248, v246
    v_perm_b32 v172, v248, v247, s4
    v_lshlrev_b32 v247, 16, v173
    v_and_b32 v248, s86, v173
    v_mul_f32 v247, v247, v246
    v_mul_f32 v248, v248, v246
    v_perm_b32 v173, v248, v247, s4
    v_lshlrev_b32 v247, 16, v174
    v_and_b32 v248, s86, v174
    v_mul_f32 v247, v247, v246
    v_mul_f32 v248, v248, v246
    v_perm_b32 v174, v248, v247, s4
    v_lshlrev_b32 v247, 16, v175
    v_and_b32 v248, s86, v175
    v_mul_f32 v247, v247, v246
    v_mul_f32 v248, v248, v246
    v_perm_b32 v175, v248, v247, s4
    v_sub_f32 v120, v120, v244
    v_sub_f32 v88, v88, v244
    v_sub_f32 v121, v121, v244
    v_sub_f32 v89, v89, v244
    v_sub_f32 v122, v122, v244
    v_sub_f32 v90, v90, v244
    v_sub_f32 v123, v123, v244
    v_sub_f32 v91, v91, v244
    v_sub_f32 v124, v124, v244
    v_sub_f32 v92, v92, v244
    v_sub_f32 v125, v125, v244
    v_sub_f32 v93, v93, v244
    v_sub_f32 v126, v126, v244
    v_sub_f32 v94, v94, v244
    v_sub_f32 v127, v127, v244
    v_sub_f32 v95, v95, v244
    v_sub_f32 v140, v140, v244
    v_sub_f32 v141, v141, v244
    v_sub_f32 v142, v142, v244
    v_sub_f32 v143, v143, v244
    v_mul_f32 v195, v195, v246
    v_lshrrev_b32 v247, 2, v1
    v_add_u32 v247, s91, v247
    ds_write_b32 v247, v246 offset:2048
    s_nop 1
    v_lshrrev_b32 v247, 8, v1
    v_lshl_add_u32 v247, v247, 4, s91
    ds_read_b128 v[248:251], v247 offset:2048
    s_waitcnt lgkmcnt(0)
    v_accvgpr_read_b32 v245, a96
    v_mul_f32 v245, v245, v248
    v_accvgpr_write_b32 a96, v245
    v_accvgpr_read_b32 v245, a97
    v_mul_f32 v245, v245, v249
    v_accvgpr_write_b32 a97, v245
    v_accvgpr_read_b32 v245, a98
    v_mul_f32 v245, v245, v250
    v_accvgpr_write_b32 a98, v245
    v_accvgpr_read_b32 v245, a99
    v_mul_f32 v245, v245, v251
    v_accvgpr_write_b32 a99, v245
    v_accvgpr_read_b32 v245, a100
    v_mul_f32 v245, v245, v248
    v_accvgpr_write_b32 a100, v245
    v_accvgpr_read_b32 v245, a101
    v_mul_f32 v245, v245, v249
    v_accvgpr_write_b32 a101, v245
    v_accvgpr_read_b32 v245, a102
    v_mul_f32 v245, v245, v250
    v_accvgpr_write_b32 a102, v245
    v_accvgpr_read_b32 v245, a103
    v_mul_f32 v245, v245, v251
    v_accvgpr_write_b32 a103, v245
    v_accvgpr_read_b32 v245, a104
    v_mul_f32 v245, v245, v248
    v_accvgpr_write_b32 a104, v245
    v_accvgpr_read_b32 v245, a105
    v_mul_f32 v245, v245, v249
    v_accvgpr_write_b32 a105, v245
    v_accvgpr_read_b32 v245, a106
    v_mul_f32 v245, v245, v250
    v_accvgpr_write_b32 a106, v245
    v_accvgpr_read_b32 v245, a107
    v_mul_f32 v245, v245, v251
    v_accvgpr_write_b32 a107, v245
    v_accvgpr_read_b32 v245, a108
    v_mul_f32 v245, v245, v248
    v_accvgpr_write_b32 a108, v245
    v_accvgpr_read_b32 v245, a109
    v_mul_f32 v245, v245, v249
    v_accvgpr_write_b32 a109, v245
    v_accvgpr_read_b32 v245, a110
    v_mul_f32 v245, v245, v250
    v_accvgpr_write_b32 a110, v245
    v_accvgpr_read_b32 v245, a111
    v_mul_f32 v245, v245, v251
    v_accvgpr_write_b32 a111, v245
    v_accvgpr_read_b32 v245, a112
    v_mul_f32 v245, v245, v248
    v_accvgpr_write_b32 a112, v245
    v_accvgpr_read_b32 v245, a113
    v_mul_f32 v245, v245, v249
    v_accvgpr_write_b32 a113, v245
    v_accvgpr_read_b32 v245, a114
    v_mul_f32 v245, v245, v250
    v_accvgpr_write_b32 a114, v245
    v_accvgpr_read_b32 v245, a115
    v_mul_f32 v245, v245, v251
    v_accvgpr_write_b32 a115, v245
    v_accvgpr_read_b32 v245, a116
    v_mul_f32 v245, v245, v248
    v_accvgpr_write_b32 a116, v245
    v_accvgpr_read_b32 v245, a117
    v_mul_f32 v245, v245, v249
    v_accvgpr_write_b32 a117, v245
    v_accvgpr_read_b32 v245, a118
    v_mul_f32 v245, v245, v250
    v_accvgpr_write_b32 a118, v245
    v_accvgpr_read_b32 v245, a119
    v_mul_f32 v245, v245, v251
    v_accvgpr_write_b32 a119, v245
    v_accvgpr_read_b32 v245, a120
    v_mul_f32 v245, v245, v248
    v_accvgpr_write_b32 a120, v245
    v_accvgpr_read_b32 v245, a121
    v_mul_f32 v245, v245, v249
    v_accvgpr_write_b32 a121, v245
    v_accvgpr_read_b32 v245, a122
    v_mul_f32 v245, v245, v250
    v_accvgpr_write_b32 a122, v245
    v_accvgpr_read_b32 v245, a123
    v_mul_f32 v245, v245, v251
    v_accvgpr_write_b32 a123, v245
    v_accvgpr_read_b32 v245, a124
    v_mul_f32 v245, v245, v248
    v_accvgpr_write_b32 a124, v245
    v_accvgpr_read_b32 v245, a125
    v_mul_f32 v245, v245, v249
    v_accvgpr_write_b32 a125, v245
    v_accvgpr_read_b32 v245, a126
    v_mul_f32 v245, v245, v250
    v_accvgpr_write_b32 a126, v245
    v_accvgpr_read_b32 v245, a127
    v_mul_f32 v245, v245, v251
    v_accvgpr_write_b32 a127, v245
    v_mov_b64 v[196:197], v[192:193]
    v_mov_b64 v[198:199], v[194:195]
    v_exp_f32 v244, v96
    v_exp_f32 v245, v97
    v_exp_f32 v246, v98
    v_exp_f32 v247, v99
    v_exp_f32 v248, v100
    v_exp_f32 v249, v101
    v_exp_f32 v250, v102
    v_exp_f32 v251, v103
    s_nop 0
    v_perm_b32 v236, v245, v244, s4
    v_perm_b32 v237, v247, v246, s4
    v_perm_b32 v238, v249, v248, s4
    v_perm_b32 v239, v251, v250, s4
    s_nop 1
    v_exp_f32 v244, v104
    v_exp_f32 v245, v105
    v_exp_f32 v246, v106
    v_exp_f32 v247, v107
    v_exp_f32 v248, v108
    v_exp_f32 v249, v109
    v_exp_f32 v250, v110
    v_exp_f32 v251, v111
    s_nop 0
    v_perm_b32 v240, v245, v244, s4
    v_perm_b32 v241, v247, v246, s4
    v_perm_b32 v242, v249, v248, s4
    v_perm_b32 v243, v251, v250, s4
    s_nop 1
    v_smfmac_f32_16x16x64_bf16 v[196:199], v[144:147], v[236:243], v255
    v_exp_f32 v244, v112
    v_exp_f32 v245, v113
    v_exp_f32 v246, v114
    v_exp_f32 v247, v115
    v_exp_f32 v248, v116
    v_exp_f32 v249, v117
    v_exp_f32 v250, v118
    v_exp_f32 v251, v119
    s_nop 0
    v_perm_b32 v184, v245, v244, s4
    v_perm_b32 v185, v247, v246, s4
    v_perm_b32 v186, v249, v248, s4
    v_perm_b32 v187, v251, v250, s4
    s_nop 1
    v_exp_f32 v244, v120
    v_exp_f32 v245, v121
    v_exp_f32 v246, v122
    v_exp_f32 v247, v123
    v_exp_f32 v248, v124
    v_exp_f32 v249, v125
    v_exp_f32 v250, v126
    v_exp_f32 v251, v127
    s_nop 0
    v_perm_b32 v188, v245, v244, s4
    v_perm_b32 v189, v247, v246, s4
    v_perm_b32 v190, v249, v248, s4
    v_perm_b32 v191, v251, v250, s4
    s_nop 1
    v_smfmac_f32_16x16x64_bf16 v[196:199], v[148:151], v[184:191], v255
    s_nop 7
    s_nop 7
    s_setpc_b64 s[88:89]
L_codeend:
.section .rodata,"a"
.p2align 6
.amdhsa_kernel standalone__kv_cache_quant_pre_rope_vs_post_rope__prompt_kernel
  .amdhsa_next_free_vgpr 512
  .amdhsa_next_free_sgpr 102
  .amdhsa_accum_offset 256
  .amdhsa_group_segment_fixed_size 0
  .amdhsa_kernarg_size 112
  .amdhsa_user_sgpr_count 2
  .amdhsa_user_sgpr_kernarg_segment_ptr 1
  .amdhsa_system_sgpr_workgroup_id_x 1
.end_amdhsa_kernel
```
